```python
import torch

def _softmax(x, axis=-1):
    return torch.softmax(x, dim=axis)

def _gelu(x):
    return torch.nn.functional.gelu(x, approximate='tanh')

def _silu(x):
    return torch.nn.functional.silu(x)

def _sigmoid(x):
    return torch.sigmoid(x)

def _layernorm(x, axis=-1, eps=1e-05):
    m = x.mean(dim=axis, keepdim=True)
    v = x.var(dim=axis, keepdim=True, unbiased=False)
    return (x - m) / torch.sqrt(v + eps)

def _scatter_add(tgt, idx, src, axis=0):
    return tgt.clone().index_add_(axis, idx, src)

def _segment_sum(src, seg, n):
    out = torch.zeros((n,) + src.shape[1:], dtype=src.dtype)
    return out.index_add_(0, seg, src)

def _pad(x, pw):
    flat = tuple((v for pair in reversed(pw) for v in pair))
    return torch.nn.functional.pad(x, flat)
kernel_name = 'recurrent_scan__memory_aug_recurrent_mem_tr__glu_gated_bilinear__prompt'

def setup_inputs():

    _w = lambda a: (lambda t: t.to(torch.bfloat16) if t.is_floating_point() else t)(torch.as_tensor(a))

    def _A_setup():
        B, S, Dm = (1, 2048, 640)
        H, Dh = (32, 192)
        M, seg = (8, 32)
        seg = min(seg, S)
        S = S // seg * seg
        return {'x': _w((lambda *s: torch.randn(*s, dtype=torch.bfloat16) * 0.1)(B, S, Dm)), 'mem0': _w((lambda *s: torch.randn(*s, dtype=torch.bfloat16) * 1.6)(B, M, Dm)), 'Wq': _w((lambda *s: torch.randn(*s, dtype=torch.bfloat16) * 0.8)(Dm, H, Dh) * Dm ** (-0.5)), 'Wk': _w((lambda *s: torch.randn(*s, dtype=torch.bfloat16) * 0.8)(Dm, H, Dh) * Dm ** (-0.5)), 'Wv': _w((lambda *s: torch.randn(*s, dtype=torch.bfloat16) * 1.6)(Dm, H, Dh) * Dm ** (-0.5)), 'Wo': _w((lambda *s: torch.randn(*s, dtype=torch.bfloat16) * 1.6)(H, Dh, Dm) * (H * Dh) ** (-0.5)), 'seg_len': seg}
    _A_in = _A_setup()

    def _B_setup():
        B, S, D, F = (1, 2048, 640, 1536)
        return {'x': _w((lambda *s: torch.randn(*s, dtype=torch.bfloat16) * 0.1)(B, S, D)), 'w_gate': _w((lambda *s: torch.randn(*s, dtype=torch.bfloat16) * 0.4)(D, F) * D ** (-0.5)), 'w_up': _w((lambda *s: torch.randn(*s, dtype=torch.bfloat16) * 0.4)(D, F) * D ** (-0.5)), 'w_down': _w((lambda *s: torch.randn(*s, dtype=torch.bfloat16) * 0.4)(F, D) * F ** (-0.5))}
    _B_in = _B_setup()
    return {'A_x': _A_in['x'], 'A_mem0': _A_in['mem0'], 'A_Wq': _A_in['Wq'], 'A_Wk': _A_in['Wk'], 'A_Wv': _A_in['Wv'], 'A_Wo': _A_in['Wo'], 'A_seg_len': _A_in['seg_len'], 'B_x': _B_in['x'], 'B_w_gate': _B_in['w_gate'], 'B_w_up': _B_in['w_up'], 'B_w_down': _B_in['w_down']}

def reference(A_x, A_mem0, A_Wq, A_Wk, A_Wv, A_Wo, A_seg_len, B_x, B_w_gate, B_w_up, B_w_down):

    def _A_ref(x, mem0, Wq, Wk, Wv, Wo, seg_len):
        B, S, Dm = x.shape
        H, Dh = (Wq.shape[1], Wq.shape[2])
        M = mem0.shape[1]
        scale = Dh ** (-0.5)
        n_seg = S // seg_len
        L = M + seg_len
        idx = torch.arange(L)
        mask = (idx[:, None] < M) | (idx[:, None] >= idx[None, :])
        mem = mem0
        outs = []
        for s in range(n_seg):
            xs = x[:, s * seg_len:(s + 1) * seg_len, :].clone()
            h = torch.concatenate([mem, xs], axis=1)
            q = torch.einsum('btd,dhe->bhte', h, Wq)
            k = torch.einsum('btd,dhe->bhte', h, Wk)
            v = torch.einsum('btd,dhe->bhte', h, Wv)
            scores = torch.einsum('bhqe,bhke->bhqk', q, k) * scale
            scores = torch.where(mask[None, None], scores, -1000000000.0)
            p = _softmax(scores, axis=-1)
            o = torch.einsum('bhqk,bhke->bhqe', p, v)
            o = torch.einsum('bhte,hed->btd', o, Wo)
            mem = o[:, :M, :].clone()
            outs.append(o[:, M:, :])
        return torch.concatenate(outs, axis=1)

    def _B_ref(x, w_gate, w_up, w_down):
        g = torch.einsum('bsd,df->bsf', x, w_gate)
        u = torch.einsum('bsd,df->bsf', x, w_up)
        h = g * u
        return torch.einsum('bsf,fd->bsd', h, w_down)
    x = A_x
    xn = _layernorm(x, axis=-1)
    s = _A_ref(xn, A_mem0, A_Wq, A_Wk, A_Wv, A_Wo, A_seg_len)
    g = _silu(_B_ref(xn, B_w_gate, B_w_up, B_w_down))
    return x + s * g
```

```asm
; @launch kernel=recurrent_scan__memory_aug_recurrent_mem_tr__glu_gated_bilinear__prompt_kernel grid=(256,1,1) block=(256,1,1) lds=163840
.amdgcn_target "amdgcn-amd-amdhsa--gfx950"
.text

.macro mfa d, x, y
v_mfma_f32_16x16x32_bf16 v[\d:\d+3], a[\x:\x+3], a[\y:\y+3], v[\d:\d+3]
.endm
.macro mfz d, x, y
v_mfma_f32_16x16x32_bf16 v[\d:\d+3], a[\x:\x+3], a[\y:\y+3], 0
.endm
.macro mfv d, x, y
v_mfma_f32_16x16x32_bf16 v[\d:\d+3], v[\x:\x+3], a[\y:\y+3], v[\d:\d+3]
.endm
.macro mfw d, x, y
v_mfma_f32_16x16x32_bf16 v[\d:\d+3], v[\x:\x+3], a[\y:\y+3], 0
.endm
.macro mfx d, x, y
v_mfma_f32_16x16x32_bf16 v[\d:\d+3], v[\x:\x+3], v[\y:\y+3], v[\d:\d+3]
.endm
.macro tra r, b, o
ds_read_b64_tr_b16 a[\r:\r+1], v\b offset:\o
.endm
.macro cvp d, x, y
v_cvt_pk_bf16_f32 v\d, v\x, v\y
.endm
.macro wl n
s_waitcnt lgkmcnt(\n)
.endm
.macro wv n
s_waitcnt vmcnt(\n)
.endm
.macro sad d, x, y
s_add_u32 s\d, s\x, \y
.endm
.globl recurrent_scan__memory_aug_recurrent_mem_tr__glu_gated_bilinear__prompt_kernel
.p2align 8
.type recurrent_scan__memory_aug_recurrent_mem_tr__glu_gated_bilinear__prompt_kernel,@function
recurrent_scan__memory_aug_recurrent_mem_tr__glu_gated_bilinear__prompt_kernel:
s_cmp_lt_u32 s2, 256
s_cbranch_scc1 L_main_go
s_endpgm
L_main_go:
s_getpc_b64 s[40:41]
L_warmref:
s_lshr_b32 s42, s2, 3
s_lshl_b32 s42, s42, 13
v_lshlrev_b32 v2, 4, v0
v_add_u32 v2, s42, v2
v_add_u32 v3, 4096, v2
s_mov_b32 s42, L_qtab-L_warmref-16
v_min_u32 v2, s42, v2
v_min_u32 v3, s42, v3
global_load_dwordx4 a[248:251], v2, s[40:41]
global_load_dwordx4 a[252:255], v3, s[40:41]
s_load_dwordx2 s[32:33], s[0:1], 96
s_load_dwordx2 s[34:35], s[0:1], 104
s_memrealtime s[36:37]
v_and_b32 v1, 63, v0
v_lshrrev_b32 v2, 6, v0
s_nop 0
v_readfirstlane_b32 s4, v2
v_lshlrev_b32 v20, 4, v1
wl 0
s_mov_b32 s84, s32
s_and_b32 s85, s33, 0xffff
s_mov_b32 s86, 256
s_mov_b32 s87, 0x00020000
sad 88,34,11534336
s_addc_u32 s89, s35, 0
s_and_b32 s89, s89, 0xffff
s_mov_b32 s90, 294912
s_mov_b32 s91, 0x00020000
s_add_u32 s38, s2, s4
s_cmp_lg_u32 s38, 0
s_cbranch_scc1 L_notag
s_getreg_b32 s38, hwreg(HW_REG_XCC_ID)
s_and_b32 s38, s38, 7
s_and_b32 s36, s36, -16
s_or_b32 s36, s36, 8
s_or_b32 s36, s36, s38
v_mov_b32 v2, s36
v_mov_b32 v3, 0
s_mov_b64 exec, 1
buffer_store_dword v2, v3, s[84:87], 0 offen offset:128 sc1
s_mov_b64 exec, -1
L_notag:
s_load_dwordx2 s[44:45], s[0:1], 96
wl 0
s_and_b32 s45, s45, 0xffff
s_mov_b32 s46, 256
s_mov_b32 s47, 0x00020000
v_mov_b32 v3, 0
s_mov_b32 s48, 0
L_gt_1:
buffer_load_dword v2, v3, s[44:47], 0 offen offset:128 sc1
wv 0
v_readfirstlane_b32 s100, v2
sad 48,48,1
s_cmp_lg_u32 s100, 0
s_cbranch_scc1 L_gtd_2
s_sleep 0
s_cmp_lt_u32 s48, 400000
s_cbranch_scc1 L_gt_1
L_gtd_2:
s_not_b32 s101, s100
s_add_u32 s42, s2, s100
s_and_b32 s42, s42, 7
s_and_b32 s2, s2, -8
s_or_b32 s2, s2, s42
s_getpc_b64 s[40:41]
L_vmref:
s_add_u32 s40, s40, L_vmap-L_vmref
s_addc_u32 s41, s41, 0
s_and_b32 s42, s2, -4
s_load_dword s43, s[40:41], s42
s_and_b32 s42, s2, 3
s_lshl_b32 s42, s42, 3
wl 0
s_lshr_b32 s43, s43, s42
s_and_b32 s2, s43, 0xff
s_cmp_lt_u32 s2, 32
s_cbranch_scc0 L_notqk
s_load_dwordx2 s[36:37], s[0:1], 104
v_and_b32 v1, 63, v0
v_lshrrev_b32 v2, 6, v0
s_nop 0
v_readfirstlane_b32 s4, v2
v_lshlrev_b32 v7, 4, v1
v_bfe_u32 v2, v1, 3, 1
v_mul_u32_u24 v2, 0xaaaa, v2
v_add_u32 v6, 0x4444, v2
s_mov_b32 s42, 400000
s_mov_b32 s3, s2
wl 0
sad 8,36,0
s_addc_u32 s9, s37, 0
s_and_b32 s9, s9, 0xffff
s_mov_b32 s10, 8388608
s_mov_b32 s11, 0x00020000
s_load_dwordx2 s[48:49], s[0:1], 16
s_load_dwordx2 s[50:51], s[0:1], 24
wl 0
s_mov_b32 s12, s48
s_and_b32 s13, s49, 0xffff
s_mov_b32 s14, 7864320
s_mov_b32 s15, 0x00020000
s_mov_b32 s16, s50
s_and_b32 s17, s51, 0xffff
s_mov_b32 s18, 7864320
s_mov_b32 s19, 0x00020000
v_lshrrev_b32 v2, 3, v1
s_lshl_b32 s38, s4, 3
v_add_u32 v2, s38, v2
v_and_b32 v5, 7, v1
v_mul_u32_u24 v64, 12288, v2
v_lshl_add_u32 v64, v5, 4, v64
v_bfe_u32 v3, v2, 2, 2
v_bfe_u32 v4, v1, 1, 2
v_xor_b32 v4, v4, v3
v_and_b32 v5, 1, v1
v_lshl_or_b32 v4, v4, 1, v5
v_lshlrev_b32 v65, 7, v2
v_lshl_add_u32 v65, v4, 4, v65
v_add_u32 v65, 81920, v65
v_bfe_u32 v2, v1, 5, 1
v_lshlrev_b32 v3, 4, v2
v_bfe_u32 v2, v1, 3, 1
v_lshl_add_u32 v3, v2, 3, v3
v_lshlrev_b32 v4, 1, v2
v_bfe_u32 v2, v1, 4, 1
v_lshl_add_u32 v3, v2, 2, v3
v_or_b32 v4, v4, v2
v_bfe_u32 v2, v1, 2, 1
v_add_u32 v3, v3, v2
v_lshlrev_b32 v3, 7, v3
v_and_b32 v2, 3, v1
v_lshl_add_u32 v3, v2, 3, v3
v_add_u32 v3, 81920, v3
s_mul_i32 s38, s4, 3
sad 38,38,0
s_and_b32 s39, s38, 3
s_lshr_b32 s38, s38, 2
s_lshl_b32 s38, s38, 12
v_xor_b32 v2, s39, v4
v_lshl_add_u32 v8, v2, 5, v3
v_add_u32 v8, s38, v8
s_mul_i32 s38, s4, 3
sad 38,38,1
s_and_b32 s39, s38, 3
s_lshr_b32 s38, s38, 2
s_lshl_b32 s38, s38, 12
v_xor_b32 v2, s39, v4
v_lshl_add_u32 v9, v2, 5, v3
v_add_u32 v9, s38, v9
s_mul_i32 s38, s4, 3
sad 38,38,2
s_and_b32 s39, s38, 3
s_lshr_b32 s38, s38, 2
s_lshl_b32 s38, s38, 12
v_xor_b32 v2, s39, v4
v_lshl_add_u32 v10, v2, 5, v3
v_add_u32 v10, s38, v10
s_mul_i32 s52, s3, 384
s_mul_i32 s54, s4, 20480
v_add_u32 v19, s54, v7
s_cmp_eq_u32 s4, 1
s_cbranch_scc1 L_pv_5
s_cmp_eq_u32 s4, 2
s_cbranch_scc1 L_pv_6
s_cmp_eq_u32 s4, 3
s_cbranch_scc1 L_pv_7
L_pv_4:
sad 38,52,0
buffer_load_dwordx4 a[0:3], v64, s[12:15], s38 offen offset:0
buffer_load_dwordx4 a[16:19], v64, s[12:15], s38 offen offset:128
buffer_load_dwordx4 a[24:27], v64, s[12:15], s38 offen offset:256
buffer_load_dwordx4 a[8:11], v64, s[16:19], s38 offen offset:0
buffer_load_dwordx4 v[24:27], v64, s[16:19], s38 offen offset:128
buffer_load_dwordx4 a[32:35], v64, s[16:19], s38 offen offset:256
sad 38,52,393216
buffer_load_dwordx4 a[4:7], v64, s[12:15], s38 offen offset:0
buffer_load_dwordx4 a[20:23], v64, s[12:15], s38 offen offset:128
buffer_load_dwordx4 a[28:31], v64, s[12:15], s38 offen offset:256
buffer_load_dwordx4 a[12:15], v64, s[16:19], s38 offen offset:0
buffer_load_dwordx4 v[28:31], v64, s[16:19], s38 offen offset:128
buffer_load_dwordx4 a[36:39], v64, s[16:19], s38 offen offset:256
sad 38,52,786432
buffer_load_dwordx4 a[120:123], v64, s[12:15], s38 offen offset:0
buffer_load_dwordx4 a[216:219], v64, s[12:15], s38 offen offset:128
buffer_load_dwordx4 v[160:163], v64, s[12:15], s38 offen offset:256
buffer_load_dwordx4 a[128:131], v64, s[16:19], s38 offen offset:0
buffer_load_dwordx4 v[68:71], v64, s[16:19], s38 offen offset:128
buffer_load_dwordx4 v[168:171], v64, s[16:19], s38 offen offset:256
sad 38,52,1179648
buffer_load_dwordx4 a[124:127], v64, s[12:15], s38 offen offset:0
buffer_load_dwordx4 a[220:223], v64, s[12:15], s38 offen offset:128
buffer_load_dwordx4 v[164:167], v64, s[12:15], s38 offen offset:256
buffer_load_dwordx4 a[132:135], v64, s[16:19], s38 offen offset:0
buffer_load_dwordx4 v[72:75], v64, s[16:19], s38 offen offset:128
buffer_load_dwordx4 v[172:175], v64, s[16:19], s38 offen offset:256
sad 38,52,1572864
buffer_load_dwordx4 a[136:139], v64, s[12:15], s38 offen offset:0
buffer_load_dwordx4 a[224:227], v64, s[12:15], s38 offen offset:128
buffer_load_dwordx4 v[176:179], v64, s[12:15], s38 offen offset:256
buffer_load_dwordx4 v[48:51], v64, s[16:19], s38 offen offset:0
buffer_load_dwordx4 a[232:235], v64, s[16:19], s38 offen offset:128
buffer_load_dwordx4 v[184:187], v64, s[16:19], s38 offen offset:256
sad 38,52,1966080
buffer_load_dwordx4 a[140:143], v64, s[12:15], s38 offen offset:0
buffer_load_dwordx4 a[228:231], v64, s[12:15], s38 offen offset:128
buffer_load_dwordx4 v[180:183], v64, s[12:15], s38 offen offset:256
buffer_load_dwordx4 v[52:55], v64, s[16:19], s38 offen offset:0
buffer_load_dwordx4 a[236:239], v64, s[16:19], s38 offen offset:128
buffer_load_dwordx4 v[188:191], v64, s[16:19], s38 offen offset:256
sad 38,52,2359296
buffer_load_dwordx4 a[144:147], v64, s[12:15], s38 offen offset:0
buffer_load_dwordx4 a[240:243], v64, s[12:15], s38 offen offset:128
buffer_load_dwordx4 v[192:195], v64, s[12:15], s38 offen offset:256
buffer_load_dwordx4 a[152:155], v64, s[16:19], s38 offen offset:0
buffer_load_dwordx4 a[248:251], v64, s[16:19], s38 offen offset:128
buffer_load_dwordx4 v[92:95], v64, s[16:19], s38 offen offset:256
sad 38,52,2752512
buffer_load_dwordx4 a[148:151], v64, s[12:15], s38 offen offset:0
buffer_load_dwordx4 a[244:247], v64, s[12:15], s38 offen offset:128
buffer_load_dwordx4 v[196:199], v64, s[12:15], s38 offen offset:256
buffer_load_dwordx4 a[156:159], v64, s[16:19], s38 offen offset:0
buffer_load_dwordx4 a[252:255], v64, s[16:19], s38 offen offset:128
buffer_load_dwordx4 v[96:99], v64, s[16:19], s38 offen offset:256
sad 38,52,3145728
buffer_load_dwordx4 a[40:43], v64, s[12:15], s38 offen offset:0
buffer_load_dwordx4 a[56:59], v64, s[12:15], s38 offen offset:128
buffer_load_dwordx4 a[64:67], v64, s[12:15], s38 offen offset:256
buffer_load_dwordx4 a[48:51], v64, s[16:19], s38 offen offset:0
buffer_load_dwordx4 v[32:35], v64, s[16:19], s38 offen offset:128
buffer_load_dwordx4 a[72:75], v64, s[16:19], s38 offen offset:256
sad 38,52,3538944
buffer_load_dwordx4 a[44:47], v64, s[12:15], s38 offen offset:0
buffer_load_dwordx4 a[60:63], v64, s[12:15], s38 offen offset:128
buffer_load_dwordx4 a[68:71], v64, s[12:15], s38 offen offset:256
buffer_load_dwordx4 a[52:55], v64, s[16:19], s38 offen offset:0
buffer_load_dwordx4 v[36:39], v64, s[16:19], s38 offen offset:128
buffer_load_dwordx4 a[76:79], v64, s[16:19], s38 offen offset:256
wv 54
ds_write_b128 v65, a[0:3] offset:0
ds_write_b128 v65, a[16:19] offset:4096
ds_write_b128 v65, a[24:27] offset:8192
ds_write_b128 v65, a[8:11] offset:12288
ds_write_b128 v65, v[24:27] offset:16384
ds_write_b128 v65, a[32:35] offset:20480
wl 0
s_barrier
tra 0,8,0
tra 2,8,256
tra 16,9,0
tra 18,9,256
tra 24,10,0
tra 26,10,256
tra 8,8,12288
tra 10,8,12544
ds_read_b64_tr_b16 v[24:25], v9 offset:12288
ds_read_b64_tr_b16 v[26:27], v9 offset:12544
tra 32,10,12288
tra 34,10,12544
wl 0
ds_write_b128 v19, v[24:27] offset:0
sad 38,52,3932160
buffer_load_dwordx4 a[160:163], v64, s[12:15], s38 offen offset:0
buffer_load_dwordx4 v[112:115], v64, s[12:15], s38 offen offset:128
buffer_load_dwordx4 v[200:203], v64, s[12:15], s38 offen offset:256
buffer_load_dwordx4 a[168:171], v64, s[16:19], s38 offen offset:0
buffer_load_dwordx4 v[76:79], v64, s[16:19], s38 offen offset:128
buffer_load_dwordx4 v[208:211], v64, s[16:19], s38 offen offset:256
wv 54
ds_write_b128 v65, a[4:7] offset:24576
ds_write_b128 v65, a[20:23] offset:28672
ds_write_b128 v65, a[28:31] offset:32768
ds_write_b128 v65, a[12:15] offset:36864
ds_write_b128 v65, v[28:31] offset:40960
ds_write_b128 v65, a[36:39] offset:45056
wl 0
s_barrier
tra 4,8,24576
tra 6,8,24832
tra 20,9,24576
tra 22,9,24832
tra 28,10,24576
tra 30,10,24832
tra 12,8,36864
tra 14,8,37120
ds_read_b64_tr_b16 v[28:29], v9 offset:36864
ds_read_b64_tr_b16 v[30:31], v9 offset:37120
tra 36,10,36864
tra 38,10,37120
wl 0
ds_write_b128 v19, v[28:31] offset:1024
sad 38,52,4325376
buffer_load_dwordx4 a[164:167], v64, s[12:15], s38 offen offset:0
buffer_load_dwordx4 v[116:119], v64, s[12:15], s38 offen offset:128
buffer_load_dwordx4 v[204:207], v64, s[12:15], s38 offen offset:256
buffer_load_dwordx4 a[172:175], v64, s[16:19], s38 offen offset:0
buffer_load_dwordx4 v[80:83], v64, s[16:19], s38 offen offset:128
buffer_load_dwordx4 v[212:215], v64, s[16:19], s38 offen offset:256
wv 54
ds_write_b128 v65, a[120:123] offset:0
ds_write_b128 v65, a[216:219] offset:4096
ds_write_b128 v65, v[160:163] offset:8192
ds_write_b128 v65, a[128:131] offset:12288
ds_write_b128 v65, v[68:71] offset:16384
ds_write_b128 v65, v[168:171] offset:20480
wl 0
s_barrier
tra 120,8,0
tra 122,8,256
tra 216,9,0
tra 218,9,256
ds_read_b64_tr_b16 v[160:161], v10 offset:0
ds_read_b64_tr_b16 v[162:163], v10 offset:256
tra 128,8,12288
tra 130,8,12544
ds_read_b64_tr_b16 v[68:69], v9 offset:12288
ds_read_b64_tr_b16 v[70:71], v9 offset:12544
ds_read_b64_tr_b16 v[168:169], v10 offset:12288
ds_read_b64_tr_b16 v[170:171], v10 offset:12544
wl 0
ds_write_b128 v19, v[68:71] offset:10240
sad 38,52,4718592
buffer_load_dwordx4 a[176:179], v64, s[12:15], s38 offen offset:0
buffer_load_dwordx4 v[120:123], v64, s[12:15], s38 offen offset:128
buffer_load_dwordx4 v[216:219], v64, s[12:15], s38 offen offset:256
buffer_load_dwordx4 v[56:59], v64, s[16:19], s38 offen offset:0
buffer_load_dwordx4 v[128:131], v64, s[16:19], s38 offen offset:128
buffer_load_dwordx4 v[224:227], v64, s[16:19], s38 offen offset:256
wv 54
ds_write_b128 v65, a[124:127] offset:24576
ds_write_b128 v65, a[220:223] offset:28672
ds_write_b128 v65, v[164:167] offset:32768
ds_write_b128 v65, a[132:135] offset:36864
ds_write_b128 v65, v[72:75] offset:40960
ds_write_b128 v65, v[172:175] offset:45056
wl 0
s_barrier
tra 124,8,24576
tra 126,8,24832
tra 220,9,24576
tra 222,9,24832
ds_read_b64_tr_b16 v[164:165], v10 offset:24576
ds_read_b64_tr_b16 v[166:167], v10 offset:24832
tra 132,8,36864
tra 134,8,37120
ds_read_b64_tr_b16 v[72:73], v9 offset:36864
ds_read_b64_tr_b16 v[74:75], v9 offset:37120
ds_read_b64_tr_b16 v[172:173], v10 offset:36864
ds_read_b64_tr_b16 v[174:175], v10 offset:37120
wl 0
ds_write_b128 v19, v[72:75] offset:11264
sad 38,52,5111808
buffer_load_dwordx4 a[180:183], v64, s[12:15], s38 offen offset:0
buffer_load_dwordx4 v[124:127], v64, s[12:15], s38 offen offset:128
buffer_load_dwordx4 v[220:223], v64, s[12:15], s38 offen offset:256
buffer_load_dwordx4 v[60:63], v64, s[16:19], s38 offen offset:0
buffer_load_dwordx4 v[132:135], v64, s[16:19], s38 offen offset:128
buffer_load_dwordx4 v[228:231], v64, s[16:19], s38 offen offset:256
wv 54
ds_write_b128 v65, a[136:139] offset:0
ds_write_b128 v65, a[224:227] offset:4096
ds_write_b128 v65, v[176:179] offset:8192
ds_write_b128 v65, v[48:51] offset:12288
ds_write_b128 v65, a[232:235] offset:16384
ds_write_b128 v65, v[184:187] offset:20480
wl 0
s_barrier
tra 136,8,0
tra 138,8,256
tra 224,9,0
tra 226,9,256
ds_read_b64_tr_b16 v[176:177], v10 offset:0
ds_read_b64_tr_b16 v[178:179], v10 offset:256
ds_read_b64_tr_b16 v[48:49], v8 offset:12288
ds_read_b64_tr_b16 v[50:51], v8 offset:12544
tra 232,9,12288
tra 234,9,12544
ds_read_b64_tr_b16 v[184:185], v10 offset:12288
ds_read_b64_tr_b16 v[186:187], v10 offset:12544
wl 0
ds_write_b128 v19, v[48:51] offset:6144
sad 38,52,5505024
buffer_load_dwordx4 a[184:187], v64, s[12:15], s38 offen offset:0
buffer_load_dwordx4 v[136:139], v64, s[12:15], s38 offen offset:128
buffer_load_dwordx4 v[232:235], v64, s[12:15], s38 offen offset:256
buffer_load_dwordx4 a[192:195], v64, s[16:19], s38 offen offset:0
buffer_load_dwordx4 v[144:147], v64, s[16:19], s38 offen offset:128
buffer_load_dwordx4 v[100:103], v64, s[16:19], s38 offen offset:256
wv 54
ds_write_b128 v65, a[140:143] offset:24576
ds_write_b128 v65, a[228:231] offset:28672
ds_write_b128 v65, v[180:183] offset:32768
ds_write_b128 v65, v[52:55] offset:36864
ds_write_b128 v65, a[236:239] offset:40960
ds_write_b128 v65, v[188:191] offset:45056
wl 0
s_barrier
tra 140,8,24576
tra 142,8,24832
tra 228,9,24576
tra 230,9,24832
ds_read_b64_tr_b16 v[180:181], v10 offset:24576
ds_read_b64_tr_b16 v[182:183], v10 offset:24832
ds_read_b64_tr_b16 v[52:53], v8 offset:36864
ds_read_b64_tr_b16 v[54:55], v8 offset:37120
tra 236,9,36864
tra 238,9,37120
ds_read_b64_tr_b16 v[188:189], v10 offset:36864
ds_read_b64_tr_b16 v[190:191], v10 offset:37120
wl 0
ds_write_b128 v19, v[52:55] offset:7168
sad 38,52,5898240
buffer_load_dwordx4 a[188:191], v64, s[12:15], s38 offen offset:0
buffer_load_dwordx4 v[140:143], v64, s[12:15], s38 offen offset:128
buffer_load_dwordx4 v[236:239], v64, s[12:15], s38 offen offset:256
buffer_load_dwordx4 a[196:199], v64, s[16:19], s38 offen offset:0
buffer_load_dwordx4 v[148:151], v64, s[16:19], s38 offen offset:128
buffer_load_dwordx4 v[104:107], v64, s[16:19], s38 offen offset:256
wv 54
ds_write_b128 v65, a[144:147] offset:0
ds_write_b128 v65, a[240:243] offset:4096
ds_write_b128 v65, v[192:195] offset:8192
ds_write_b128 v65, a[152:155] offset:12288
ds_write_b128 v65, a[248:251] offset:16384
ds_write_b128 v65, v[92:95] offset:20480
wl 0
s_barrier
tra 144,8,0
tra 146,8,256
tra 240,9,0
tra 242,9,256
ds_read_b64_tr_b16 v[192:193], v10 offset:0
ds_read_b64_tr_b16 v[194:195], v10 offset:256
tra 152,8,12288
tra 154,8,12544
tra 248,9,12288
tra 250,9,12544
ds_read_b64_tr_b16 v[92:93], v10 offset:12288
ds_read_b64_tr_b16 v[94:95], v10 offset:12544
wl 0
ds_write_b128 v19, v[92:95] offset:16384
sad 38,52,6291456
buffer_load_dwordx4 a[80:83], v64, s[12:15], s38 offen offset:0
buffer_load_dwordx4 a[96:99], v64, s[12:15], s38 offen offset:128
buffer_load_dwordx4 a[104:107], v64, s[12:15], s38 offen offset:256
buffer_load_dwordx4 a[88:91], v64, s[16:19], s38 offen offset:0
buffer_load_dwordx4 v[40:43], v64, s[16:19], s38 offen offset:128
buffer_load_dwordx4 a[112:115], v64, s[16:19], s38 offen offset:256
wv 54
ds_write_b128 v65, a[148:151] offset:24576
ds_write_b128 v65, a[244:247] offset:28672
ds_write_b128 v65, v[196:199] offset:32768
ds_write_b128 v65, a[156:159] offset:36864
ds_write_b128 v65, a[252:255] offset:40960
ds_write_b128 v65, v[96:99] offset:45056
wl 0
s_barrier
tra 148,8,24576
tra 150,8,24832
tra 244,9,24576
tra 246,9,24832
ds_read_b64_tr_b16 v[196:197], v10 offset:24576
ds_read_b64_tr_b16 v[198:199], v10 offset:24832
tra 156,8,36864
tra 158,8,37120
tra 252,9,36864
tra 254,9,37120
ds_read_b64_tr_b16 v[96:97], v10 offset:36864
ds_read_b64_tr_b16 v[98:99], v10 offset:37120
wl 0
ds_write_b128 v19, v[96:99] offset:17408
sad 38,52,6684672
buffer_load_dwordx4 a[84:87], v64, s[12:15], s38 offen offset:0
buffer_load_dwordx4 a[100:103], v64, s[12:15], s38 offen offset:128
buffer_load_dwordx4 a[108:111], v64, s[12:15], s38 offen offset:256
buffer_load_dwordx4 a[92:95], v64, s[16:19], s38 offen offset:0
buffer_load_dwordx4 v[44:47], v64, s[16:19], s38 offen offset:128
buffer_load_dwordx4 a[116:119], v64, s[16:19], s38 offen offset:256
wv 54
ds_write_b128 v65, a[40:43] offset:0
ds_write_b128 v65, a[56:59] offset:4096
ds_write_b128 v65, a[64:67] offset:8192
ds_write_b128 v65, a[48:51] offset:12288
ds_write_b128 v65, v[32:35] offset:16384
ds_write_b128 v65, a[72:75] offset:20480
wl 0
s_barrier
tra 40,8,0
tra 42,8,256
tra 56,9,0
tra 58,9,256
tra 64,10,0
tra 66,10,256
tra 48,8,12288
tra 50,8,12544
ds_read_b64_tr_b16 v[32:33], v9 offset:12288
ds_read_b64_tr_b16 v[34:35], v9 offset:12544
tra 72,10,12288
tra 74,10,12544
wl 0
ds_write_b128 v19, v[32:35] offset:2048
sad 38,52,7077888
buffer_load_dwordx4 a[200:203], v64, s[12:15], s38 offen offset:0
buffer_load_dwordx4 v[152:155], v64, s[12:15], s38 offen offset:128
buffer_load_dwordx4 v[240:243], v64, s[12:15], s38 offen offset:256
buffer_load_dwordx4 a[208:211], v64, s[16:19], s38 offen offset:0
buffer_load_dwordx4 v[84:87], v64, s[16:19], s38 offen offset:128
buffer_load_dwordx4 v[248:251], v64, s[16:19], s38 offen offset:256
wv 54
ds_write_b128 v65, a[44:47] offset:24576
ds_write_b128 v65, a[60:63] offset:28672
ds_write_b128 v65, a[68:71] offset:32768
ds_write_b128 v65, a[52:55] offset:36864
ds_write_b128 v65, v[36:39] offset:40960
ds_write_b128 v65, a[76:79] offset:45056
wl 0
s_barrier
tra 44,8,24576
tra 46,8,24832
tra 60,9,24576
tra 62,9,24832
tra 68,10,24576
tra 70,10,24832
tra 52,8,36864
tra 54,8,37120
ds_read_b64_tr_b16 v[36:37], v9 offset:36864
ds_read_b64_tr_b16 v[38:39], v9 offset:37120
tra 76,10,36864
tra 78,10,37120
wl 0
ds_write_b128 v19, v[36:39] offset:3072
sad 38,52,7471104
buffer_load_dwordx4 a[204:207], v64, s[12:15], s38 offen offset:0
buffer_load_dwordx4 v[156:159], v64, s[12:15], s38 offen offset:128
buffer_load_dwordx4 v[244:247], v64, s[12:15], s38 offen offset:256
buffer_load_dwordx4 a[212:215], v64, s[16:19], s38 offen offset:0
buffer_load_dwordx4 v[88:91], v64, s[16:19], s38 offen offset:128
buffer_load_dwordx4 v[252:255], v64, s[16:19], s38 offen offset:256
wv 54
ds_write_b128 v65, a[160:163] offset:0
ds_write_b128 v65, v[112:115] offset:4096
ds_write_b128 v65, v[200:203] offset:8192
ds_write_b128 v65, a[168:171] offset:12288
ds_write_b128 v65, v[76:79] offset:16384
ds_write_b128 v65, v[208:211] offset:20480
wl 0
s_barrier
tra 160,8,0
tra 162,8,256
ds_read_b64_tr_b16 v[112:113], v9 offset:0
ds_read_b64_tr_b16 v[114:115], v9 offset:256
ds_read_b64_tr_b16 v[200:201], v10 offset:0
ds_read_b64_tr_b16 v[202:203], v10 offset:256
tra 168,8,12288
tra 170,8,12544
ds_read_b64_tr_b16 v[76:77], v9 offset:12288
ds_read_b64_tr_b16 v[78:79], v9 offset:12544
ds_read_b64_tr_b16 v[208:209], v10 offset:12288
ds_read_b64_tr_b16 v[210:211], v10 offset:12544
wl 0
ds_write_b128 v19, v[76:79] offset:12288
wv 48
ds_write_b128 v65, a[164:167] offset:24576
ds_write_b128 v65, v[116:119] offset:28672
ds_write_b128 v65, v[204:207] offset:32768
ds_write_b128 v65, a[172:175] offset:36864
ds_write_b128 v65, v[80:83] offset:40960
ds_write_b128 v65, v[212:215] offset:45056
wl 0
s_barrier
tra 164,8,24576
tra 166,8,24832
ds_read_b64_tr_b16 v[116:117], v9 offset:24576
ds_read_b64_tr_b16 v[118:119], v9 offset:24832
ds_read_b64_tr_b16 v[204:205], v10 offset:24576
ds_read_b64_tr_b16 v[206:207], v10 offset:24832
tra 172,8,36864
tra 174,8,37120
ds_read_b64_tr_b16 v[80:81], v9 offset:36864
ds_read_b64_tr_b16 v[82:83], v9 offset:37120
ds_read_b64_tr_b16 v[212:213], v10 offset:36864
ds_read_b64_tr_b16 v[214:215], v10 offset:37120
wl 0
ds_write_b128 v19, v[80:83] offset:13312
wv 42
ds_write_b128 v65, a[176:179] offset:0
ds_write_b128 v65, v[120:123] offset:4096
ds_write_b128 v65, v[216:219] offset:8192
ds_write_b128 v65, v[56:59] offset:12288
ds_write_b128 v65, v[128:131] offset:16384
ds_write_b128 v65, v[224:227] offset:20480
wl 0
s_barrier
tra 176,8,0
tra 178,8,256
ds_read_b64_tr_b16 v[120:121], v9 offset:0
ds_read_b64_tr_b16 v[122:123], v9 offset:256
ds_read_b64_tr_b16 v[216:217], v10 offset:0
ds_read_b64_tr_b16 v[218:219], v10 offset:256
ds_read_b64_tr_b16 v[56:57], v8 offset:12288
ds_read_b64_tr_b16 v[58:59], v8 offset:12544
ds_read_b64_tr_b16 v[128:129], v9 offset:12288
ds_read_b64_tr_b16 v[130:131], v9 offset:12544
ds_read_b64_tr_b16 v[224:225], v10 offset:12288
ds_read_b64_tr_b16 v[226:227], v10 offset:12544
wl 0
ds_write_b128 v19, v[56:59] offset:8192
wv 36
ds_write_b128 v65, a[180:183] offset:24576
ds_write_b128 v65, v[124:127] offset:28672
ds_write_b128 v65, v[220:223] offset:32768
ds_write_b128 v65, v[60:63] offset:36864
ds_write_b128 v65, v[132:135] offset:40960
ds_write_b128 v65, v[228:231] offset:45056
wl 0
s_barrier
tra 180,8,24576
tra 182,8,24832
ds_read_b64_tr_b16 v[124:125], v9 offset:24576
ds_read_b64_tr_b16 v[126:127], v9 offset:24832
ds_read_b64_tr_b16 v[220:221], v10 offset:24576
ds_read_b64_tr_b16 v[222:223], v10 offset:24832
ds_read_b64_tr_b16 v[60:61], v8 offset:36864
ds_read_b64_tr_b16 v[62:63], v8 offset:37120
ds_read_b64_tr_b16 v[132:133], v9 offset:36864
ds_read_b64_tr_b16 v[134:135], v9 offset:37120
ds_read_b64_tr_b16 v[228:229], v10 offset:36864
ds_read_b64_tr_b16 v[230:231], v10 offset:37120
wl 0
ds_write_b128 v19, v[60:63] offset:9216
wv 30
ds_write_b128 v65, a[184:187] offset:0
ds_write_b128 v65, v[136:139] offset:4096
ds_write_b128 v65, v[232:235] offset:8192
ds_write_b128 v65, a[192:195] offset:12288
ds_write_b128 v65, v[144:147] offset:16384
ds_write_b128 v65, v[100:103] offset:20480
wl 0
s_barrier
tra 184,8,0
tra 186,8,256
ds_read_b64_tr_b16 v[136:137], v9 offset:0
ds_read_b64_tr_b16 v[138:139], v9 offset:256
ds_read_b64_tr_b16 v[232:233], v10 offset:0
ds_read_b64_tr_b16 v[234:235], v10 offset:256
tra 192,8,12288
tra 194,8,12544
ds_read_b64_tr_b16 v[144:145], v9 offset:12288
ds_read_b64_tr_b16 v[146:147], v9 offset:12544
ds_read_b64_tr_b16 v[100:101], v10 offset:12288
ds_read_b64_tr_b16 v[102:103], v10 offset:12544
wl 0
ds_write_b128 v19, v[100:103] offset:18432
wv 24
ds_write_b128 v65, a[188:191] offset:24576
ds_write_b128 v65, v[140:143] offset:28672
ds_write_b128 v65, v[236:239] offset:32768
ds_write_b128 v65, a[196:199] offset:36864
ds_write_b128 v65, v[148:151] offset:40960
ds_write_b128 v65, v[104:107] offset:45056
wl 0
s_barrier
tra 188,8,24576
tra 190,8,24832
ds_read_b64_tr_b16 v[140:141], v9 offset:24576
ds_read_b64_tr_b16 v[142:143], v9 offset:24832
ds_read_b64_tr_b16 v[236:237], v10 offset:24576
ds_read_b64_tr_b16 v[238:239], v10 offset:24832
tra 196,8,36864
tra 198,8,37120
ds_read_b64_tr_b16 v[148:149], v9 offset:36864
ds_read_b64_tr_b16 v[150:151], v9 offset:37120
ds_read_b64_tr_b16 v[104:105], v10 offset:36864
ds_read_b64_tr_b16 v[106:107], v10 offset:37120
wl 0
ds_write_b128 v19, v[104:107] offset:19456
wv 18
ds_write_b128 v65, a[80:83] offset:0
ds_write_b128 v65, a[96:99] offset:4096
ds_write_b128 v65, a[104:107] offset:8192
ds_write_b128 v65, a[88:91] offset:12288
ds_write_b128 v65, v[40:43] offset:16384
ds_write_b128 v65, a[112:115] offset:20480
wl 0
s_barrier
tra 80,8,0
tra 82,8,256
tra 96,9,0
tra 98,9,256
tra 104,10,0
tra 106,10,256
tra 88,8,12288
tra 90,8,12544
ds_read_b64_tr_b16 v[40:41], v9 offset:12288
ds_read_b64_tr_b16 v[42:43], v9 offset:12544
tra 112,10,12288
tra 114,10,12544
wl 0
ds_write_b128 v19, v[40:43] offset:4096
wv 12
ds_write_b128 v65, a[84:87] offset:24576
ds_write_b128 v65, a[100:103] offset:28672
ds_write_b128 v65, a[108:111] offset:32768
ds_write_b128 v65, a[92:95] offset:36864
ds_write_b128 v65, v[44:47] offset:40960
ds_write_b128 v65, a[116:119] offset:45056
wl 0
s_barrier
tra 84,8,24576
tra 86,8,24832
tra 100,9,24576
tra 102,9,24832
tra 108,10,24576
tra 110,10,24832
tra 92,8,36864
tra 94,8,37120
ds_read_b64_tr_b16 v[44:45], v9 offset:36864
ds_read_b64_tr_b16 v[46:47], v9 offset:37120
tra 116,10,36864
tra 118,10,37120
wl 0
ds_write_b128 v19, v[44:47] offset:5120
wv 6
ds_write_b128 v65, a[200:203] offset:0
ds_write_b128 v65, v[152:155] offset:4096
ds_write_b128 v65, v[240:243] offset:8192
ds_write_b128 v65, a[208:211] offset:12288
ds_write_b128 v65, v[84:87] offset:16384
ds_write_b128 v65, v[248:251] offset:20480
wl 0
s_barrier
tra 200,8,0
tra 202,8,256
ds_read_b64_tr_b16 v[152:153], v9 offset:0
ds_read_b64_tr_b16 v[154:155], v9 offset:256
ds_read_b64_tr_b16 v[240:241], v10 offset:0
ds_read_b64_tr_b16 v[242:243], v10 offset:256
tra 208,8,12288
tra 210,8,12544
ds_read_b64_tr_b16 v[84:85], v9 offset:12288
ds_read_b64_tr_b16 v[86:87], v9 offset:12544
ds_read_b64_tr_b16 v[248:249], v10 offset:12288
ds_read_b64_tr_b16 v[250:251], v10 offset:12544
wl 0
ds_write_b128 v19, v[84:87] offset:14336
wv 0
ds_write_b128 v65, a[204:207] offset:24576
ds_write_b128 v65, v[156:159] offset:28672
ds_write_b128 v65, v[244:247] offset:32768
ds_write_b128 v65, a[212:215] offset:36864
ds_write_b128 v65, v[88:91] offset:40960
ds_write_b128 v65, v[252:255] offset:45056
wl 0
s_barrier
tra 204,8,24576
tra 206,8,24832
ds_read_b64_tr_b16 v[156:157], v9 offset:24576
ds_read_b64_tr_b16 v[158:159], v9 offset:24832
ds_read_b64_tr_b16 v[244:245], v10 offset:24576
ds_read_b64_tr_b16 v[246:247], v10 offset:24832
tra 212,8,36864
tra 214,8,37120
ds_read_b64_tr_b16 v[88:89], v9 offset:36864
ds_read_b64_tr_b16 v[90:91], v9 offset:37120
ds_read_b64_tr_b16 v[252:253], v10 offset:36864
ds_read_b64_tr_b16 v[254:255], v10 offset:37120
wl 0
ds_write_b128 v19, v[88:91] offset:15360
s_branch L_pd_3
L_pv_5:
sad 38,52,0
buffer_load_dwordx4 a[200:203], v64, s[12:15], s38 offen offset:0
buffer_load_dwordx4 v[152:155], v64, s[12:15], s38 offen offset:128
buffer_load_dwordx4 v[240:243], v64, s[12:15], s38 offen offset:256
buffer_load_dwordx4 a[208:211], v64, s[16:19], s38 offen offset:0
buffer_load_dwordx4 v[84:87], v64, s[16:19], s38 offen offset:128
buffer_load_dwordx4 v[248:251], v64, s[16:19], s38 offen offset:256
sad 38,52,393216
buffer_load_dwordx4 a[204:207], v64, s[12:15], s38 offen offset:0
buffer_load_dwordx4 v[156:159], v64, s[12:15], s38 offen offset:128
buffer_load_dwordx4 v[244:247], v64, s[12:15], s38 offen offset:256
buffer_load_dwordx4 a[212:215], v64, s[16:19], s38 offen offset:0
buffer_load_dwordx4 v[88:91], v64, s[16:19], s38 offen offset:128
buffer_load_dwordx4 v[252:255], v64, s[16:19], s38 offen offset:256
sad 38,52,786432
buffer_load_dwordx4 a[0:3], v64, s[12:15], s38 offen offset:0
buffer_load_dwordx4 a[16:19], v64, s[12:15], s38 offen offset:128
buffer_load_dwordx4 a[24:27], v64, s[12:15], s38 offen offset:256
buffer_load_dwordx4 a[8:11], v64, s[16:19], s38 offen offset:0
buffer_load_dwordx4 v[24:27], v64, s[16:19], s38 offen offset:128
buffer_load_dwordx4 a[32:35], v64, s[16:19], s38 offen offset:256
sad 38,52,1179648
buffer_load_dwordx4 a[4:7], v64, s[12:15], s38 offen offset:0
buffer_load_dwordx4 a[20:23], v64, s[12:15], s38 offen offset:128
buffer_load_dwordx4 a[28:31], v64, s[12:15], s38 offen offset:256
buffer_load_dwordx4 a[12:15], v64, s[16:19], s38 offen offset:0
buffer_load_dwordx4 v[28:31], v64, s[16:19], s38 offen offset:128
buffer_load_dwordx4 a[36:39], v64, s[16:19], s38 offen offset:256
sad 38,52,1572864
buffer_load_dwordx4 a[120:123], v64, s[12:15], s38 offen offset:0
buffer_load_dwordx4 a[216:219], v64, s[12:15], s38 offen offset:128
buffer_load_dwordx4 v[160:163], v64, s[12:15], s38 offen offset:256
buffer_load_dwordx4 a[128:131], v64, s[16:19], s38 offen offset:0
buffer_load_dwordx4 v[68:71], v64, s[16:19], s38 offen offset:128
buffer_load_dwordx4 v[168:171], v64, s[16:19], s38 offen offset:256
sad 38,52,1966080
buffer_load_dwordx4 a[124:127], v64, s[12:15], s38 offen offset:0
buffer_load_dwordx4 a[220:223], v64, s[12:15], s38 offen offset:128
buffer_load_dwordx4 v[164:167], v64, s[12:15], s38 offen offset:256
buffer_load_dwordx4 a[132:135], v64, s[16:19], s38 offen offset:0
buffer_load_dwordx4 v[72:75], v64, s[16:19], s38 offen offset:128
buffer_load_dwordx4 v[172:175], v64, s[16:19], s38 offen offset:256
sad 38,52,2359296
buffer_load_dwordx4 a[136:139], v64, s[12:15], s38 offen offset:0
buffer_load_dwordx4 a[224:227], v64, s[12:15], s38 offen offset:128
buffer_load_dwordx4 v[176:179], v64, s[12:15], s38 offen offset:256
buffer_load_dwordx4 v[48:51], v64, s[16:19], s38 offen offset:0
buffer_load_dwordx4 a[232:235], v64, s[16:19], s38 offen offset:128
buffer_load_dwordx4 v[184:187], v64, s[16:19], s38 offen offset:256
sad 38,52,2752512
buffer_load_dwordx4 a[140:143], v64, s[12:15], s38 offen offset:0
buffer_load_dwordx4 a[228:231], v64, s[12:15], s38 offen offset:128
buffer_load_dwordx4 v[180:183], v64, s[12:15], s38 offen offset:256
buffer_load_dwordx4 v[52:55], v64, s[16:19], s38 offen offset:0
buffer_load_dwordx4 a[236:239], v64, s[16:19], s38 offen offset:128
buffer_load_dwordx4 v[188:191], v64, s[16:19], s38 offen offset:256
sad 38,52,3145728
buffer_load_dwordx4 a[144:147], v64, s[12:15], s38 offen offset:0
buffer_load_dwordx4 a[240:243], v64, s[12:15], s38 offen offset:128
buffer_load_dwordx4 v[192:195], v64, s[12:15], s38 offen offset:256
buffer_load_dwordx4 a[152:155], v64, s[16:19], s38 offen offset:0
buffer_load_dwordx4 a[248:251], v64, s[16:19], s38 offen offset:128
buffer_load_dwordx4 v[92:95], v64, s[16:19], s38 offen offset:256
sad 38,52,3538944
buffer_load_dwordx4 a[148:151], v64, s[12:15], s38 offen offset:0
buffer_load_dwordx4 a[244:247], v64, s[12:15], s38 offen offset:128
buffer_load_dwordx4 v[196:199], v64, s[12:15], s38 offen offset:256
buffer_load_dwordx4 a[156:159], v64, s[16:19], s38 offen offset:0
buffer_load_dwordx4 a[252:255], v64, s[16:19], s38 offen offset:128
buffer_load_dwordx4 v[96:99], v64, s[16:19], s38 offen offset:256
wv 54
ds_write_b128 v65, a[200:203] offset:0
ds_write_b128 v65, v[152:155] offset:4096
ds_write_b128 v65, v[240:243] offset:8192
ds_write_b128 v65, a[208:211] offset:12288
ds_write_b128 v65, v[84:87] offset:16384
ds_write_b128 v65, v[248:251] offset:20480
wl 0
s_barrier
tra 200,8,0
tra 202,8,256
ds_read_b64_tr_b16 v[152:153], v9 offset:0
ds_read_b64_tr_b16 v[154:155], v9 offset:256
ds_read_b64_tr_b16 v[240:241], v10 offset:0
ds_read_b64_tr_b16 v[242:243], v10 offset:256
tra 208,8,12288
tra 210,8,12544
ds_read_b64_tr_b16 v[84:85], v9 offset:12288
ds_read_b64_tr_b16 v[86:87], v9 offset:12544
ds_read_b64_tr_b16 v[248:249], v10 offset:12288
ds_read_b64_tr_b16 v[250:251], v10 offset:12544
wl 0
ds_write_b128 v19, v[84:87] offset:14336
sad 38,52,3932160
buffer_load_dwordx4 a[40:43], v64, s[12:15], s38 offen offset:0
buffer_load_dwordx4 a[56:59], v64, s[12:15], s38 offen offset:128
buffer_load_dwordx4 a[64:67], v64, s[12:15], s38 offen offset:256
buffer_load_dwordx4 a[48:51], v64, s[16:19], s38 offen offset:0
buffer_load_dwordx4 v[32:35], v64, s[16:19], s38 offen offset:128
buffer_load_dwordx4 a[72:75], v64, s[16:19], s38 offen offset:256
wv 54
ds_write_b128 v65, a[204:207] offset:24576
ds_write_b128 v65, v[156:159] offset:28672
ds_write_b128 v65, v[244:247] offset:32768
ds_write_b128 v65, a[212:215] offset:36864
ds_write_b128 v65, v[88:91] offset:40960
ds_write_b128 v65, v[252:255] offset:45056
wl 0
s_barrier
tra 204,8,24576
tra 206,8,24832
ds_read_b64_tr_b16 v[156:157], v9 offset:24576
ds_read_b64_tr_b16 v[158:159], v9 offset:24832
ds_read_b64_tr_b16 v[244:245], v10 offset:24576
ds_read_b64_tr_b16 v[246:247], v10 offset:24832
tra 212,8,36864
tra 214,8,37120
ds_read_b64_tr_b16 v[88:89], v9 offset:36864
ds_read_b64_tr_b16 v[90:91], v9 offset:37120
ds_read_b64_tr_b16 v[252:253], v10 offset:36864
ds_read_b64_tr_b16 v[254:255], v10 offset:37120
wl 0
ds_write_b128 v19, v[88:91] offset:15360
sad 38,52,4325376
buffer_load_dwordx4 a[44:47], v64, s[12:15], s38 offen offset:0
buffer_load_dwordx4 a[60:63], v64, s[12:15], s38 offen offset:128
buffer_load_dwordx4 a[68:71], v64, s[12:15], s38 offen offset:256
buffer_load_dwordx4 a[52:55], v64, s[16:19], s38 offen offset:0
buffer_load_dwordx4 v[36:39], v64, s[16:19], s38 offen offset:128
buffer_load_dwordx4 a[76:79], v64, s[16:19], s38 offen offset:256
wv 54
ds_write_b128 v65, a[0:3] offset:0
ds_write_b128 v65, a[16:19] offset:4096
ds_write_b128 v65, a[24:27] offset:8192
ds_write_b128 v65, a[8:11] offset:12288
ds_write_b128 v65, v[24:27] offset:16384
ds_write_b128 v65, a[32:35] offset:20480
wl 0
s_barrier
tra 0,8,0
tra 2,8,256
tra 16,9,0
tra 18,9,256
tra 24,10,0
tra 26,10,256
tra 8,8,12288
tra 10,8,12544
ds_read_b64_tr_b16 v[24:25], v9 offset:12288
ds_read_b64_tr_b16 v[26:27], v9 offset:12544
tra 32,10,12288
tra 34,10,12544
wl 0
ds_write_b128 v19, v[24:27] offset:0
sad 38,52,4718592
buffer_load_dwordx4 a[160:163], v64, s[12:15], s38 offen offset:0
buffer_load_dwordx4 v[112:115], v64, s[12:15], s38 offen offset:128
buffer_load_dwordx4 v[200:203], v64, s[12:15], s38 offen offset:256
buffer_load_dwordx4 a[168:171], v64, s[16:19], s38 offen offset:0
buffer_load_dwordx4 v[76:79], v64, s[16:19], s38 offen offset:128
buffer_load_dwordx4 v[208:211], v64, s[16:19], s38 offen offset:256
wv 54
ds_write_b128 v65, a[4:7] offset:24576
ds_write_b128 v65, a[20:23] offset:28672
ds_write_b128 v65, a[28:31] offset:32768
ds_write_b128 v65, a[12:15] offset:36864
ds_write_b128 v65, v[28:31] offset:40960
ds_write_b128 v65, a[36:39] offset:45056
wl 0
s_barrier
tra 4,8,24576
tra 6,8,24832
tra 20,9,24576
tra 22,9,24832
tra 28,10,24576
tra 30,10,24832
tra 12,8,36864
tra 14,8,37120
ds_read_b64_tr_b16 v[28:29], v9 offset:36864
ds_read_b64_tr_b16 v[30:31], v9 offset:37120
tra 36,10,36864
tra 38,10,37120
wl 0
ds_write_b128 v19, v[28:31] offset:1024
sad 38,52,5111808
buffer_load_dwordx4 a[164:167], v64, s[12:15], s38 offen offset:0
buffer_load_dwordx4 v[116:119], v64, s[12:15], s38 offen offset:128
buffer_load_dwordx4 v[204:207], v64, s[12:15], s38 offen offset:256
buffer_load_dwordx4 a[172:175], v64, s[16:19], s38 offen offset:0
buffer_load_dwordx4 v[80:83], v64, s[16:19], s38 offen offset:128
buffer_load_dwordx4 v[212:215], v64, s[16:19], s38 offen offset:256
wv 54
ds_write_b128 v65, a[120:123] offset:0
ds_write_b128 v65, a[216:219] offset:4096
ds_write_b128 v65, v[160:163] offset:8192
ds_write_b128 v65, a[128:131] offset:12288
ds_write_b128 v65, v[68:71] offset:16384
ds_write_b128 v65, v[168:171] offset:20480
wl 0
s_barrier
tra 120,8,0
tra 122,8,256
tra 216,9,0
tra 218,9,256
ds_read_b64_tr_b16 v[160:161], v10 offset:0
ds_read_b64_tr_b16 v[162:163], v10 offset:256
tra 128,8,12288
tra 130,8,12544
ds_read_b64_tr_b16 v[68:69], v9 offset:12288
ds_read_b64_tr_b16 v[70:71], v9 offset:12544
ds_read_b64_tr_b16 v[168:169], v10 offset:12288
ds_read_b64_tr_b16 v[170:171], v10 offset:12544
wl 0
ds_write_b128 v19, v[68:71] offset:10240
sad 38,52,5505024
buffer_load_dwordx4 a[176:179], v64, s[12:15], s38 offen offset:0
buffer_load_dwordx4 v[120:123], v64, s[12:15], s38 offen offset:128
buffer_load_dwordx4 v[216:219], v64, s[12:15], s38 offen offset:256
buffer_load_dwordx4 v[56:59], v64, s[16:19], s38 offen offset:0
buffer_load_dwordx4 v[128:131], v64, s[16:19], s38 offen offset:128
buffer_load_dwordx4 v[224:227], v64, s[16:19], s38 offen offset:256
wv 54
ds_write_b128 v65, a[124:127] offset:24576
ds_write_b128 v65, a[220:223] offset:28672
ds_write_b128 v65, v[164:167] offset:32768
ds_write_b128 v65, a[132:135] offset:36864
ds_write_b128 v65, v[72:75] offset:40960
ds_write_b128 v65, v[172:175] offset:45056
wl 0
s_barrier
tra 124,8,24576
tra 126,8,24832
tra 220,9,24576
tra 222,9,24832
ds_read_b64_tr_b16 v[164:165], v10 offset:24576
ds_read_b64_tr_b16 v[166:167], v10 offset:24832
tra 132,8,36864
tra 134,8,37120
ds_read_b64_tr_b16 v[72:73], v9 offset:36864
ds_read_b64_tr_b16 v[74:75], v9 offset:37120
ds_read_b64_tr_b16 v[172:173], v10 offset:36864
ds_read_b64_tr_b16 v[174:175], v10 offset:37120
wl 0
ds_write_b128 v19, v[72:75] offset:11264
sad 38,52,5898240
buffer_load_dwordx4 a[180:183], v64, s[12:15], s38 offen offset:0
buffer_load_dwordx4 v[124:127], v64, s[12:15], s38 offen offset:128
buffer_load_dwordx4 v[220:223], v64, s[12:15], s38 offen offset:256
buffer_load_dwordx4 v[60:63], v64, s[16:19], s38 offen offset:0
buffer_load_dwordx4 v[132:135], v64, s[16:19], s38 offen offset:128
buffer_load_dwordx4 v[228:231], v64, s[16:19], s38 offen offset:256
wv 54
ds_write_b128 v65, a[136:139] offset:0
ds_write_b128 v65, a[224:227] offset:4096
ds_write_b128 v65, v[176:179] offset:8192
ds_write_b128 v65, v[48:51] offset:12288
ds_write_b128 v65, a[232:235] offset:16384
ds_write_b128 v65, v[184:187] offset:20480
wl 0
s_barrier
tra 136,8,0
tra 138,8,256
tra 224,9,0
tra 226,9,256
ds_read_b64_tr_b16 v[176:177], v10 offset:0
ds_read_b64_tr_b16 v[178:179], v10 offset:256
ds_read_b64_tr_b16 v[48:49], v8 offset:12288
ds_read_b64_tr_b16 v[50:51], v8 offset:12544
tra 232,9,12288
tra 234,9,12544
ds_read_b64_tr_b16 v[184:185], v10 offset:12288
ds_read_b64_tr_b16 v[186:187], v10 offset:12544
wl 0
ds_write_b128 v19, v[48:51] offset:6144
sad 38,52,6291456
buffer_load_dwordx4 a[184:187], v64, s[12:15], s38 offen offset:0
buffer_load_dwordx4 v[136:139], v64, s[12:15], s38 offen offset:128
buffer_load_dwordx4 v[232:235], v64, s[12:15], s38 offen offset:256
buffer_load_dwordx4 a[192:195], v64, s[16:19], s38 offen offset:0
buffer_load_dwordx4 v[144:147], v64, s[16:19], s38 offen offset:128
buffer_load_dwordx4 v[100:103], v64, s[16:19], s38 offen offset:256
wv 54
ds_write_b128 v65, a[140:143] offset:24576
ds_write_b128 v65, a[228:231] offset:28672
ds_write_b128 v65, v[180:183] offset:32768
ds_write_b128 v65, v[52:55] offset:36864
ds_write_b128 v65, a[236:239] offset:40960
ds_write_b128 v65, v[188:191] offset:45056
wl 0
s_barrier
tra 140,8,24576
tra 142,8,24832
tra 228,9,24576
tra 230,9,24832
ds_read_b64_tr_b16 v[180:181], v10 offset:24576
ds_read_b64_tr_b16 v[182:183], v10 offset:24832
ds_read_b64_tr_b16 v[52:53], v8 offset:36864
ds_read_b64_tr_b16 v[54:55], v8 offset:37120
tra 236,9,36864
tra 238,9,37120
ds_read_b64_tr_b16 v[188:189], v10 offset:36864
ds_read_b64_tr_b16 v[190:191], v10 offset:37120
wl 0
ds_write_b128 v19, v[52:55] offset:7168
sad 38,52,6684672
buffer_load_dwordx4 a[188:191], v64, s[12:15], s38 offen offset:0
buffer_load_dwordx4 v[140:143], v64, s[12:15], s38 offen offset:128
buffer_load_dwordx4 v[236:239], v64, s[12:15], s38 offen offset:256
buffer_load_dwordx4 a[196:199], v64, s[16:19], s38 offen offset:0
buffer_load_dwordx4 v[148:151], v64, s[16:19], s38 offen offset:128
buffer_load_dwordx4 v[104:107], v64, s[16:19], s38 offen offset:256
wv 54
ds_write_b128 v65, a[144:147] offset:0
ds_write_b128 v65, a[240:243] offset:4096
ds_write_b128 v65, v[192:195] offset:8192
ds_write_b128 v65, a[152:155] offset:12288
ds_write_b128 v65, a[248:251] offset:16384
ds_write_b128 v65, v[92:95] offset:20480
wl 0
s_barrier
tra 144,8,0
tra 146,8,256
tra 240,9,0
tra 242,9,256
ds_read_b64_tr_b16 v[192:193], v10 offset:0
ds_read_b64_tr_b16 v[194:195], v10 offset:256
tra 152,8,12288
tra 154,8,12544
tra 248,9,12288
tra 250,9,12544
ds_read_b64_tr_b16 v[92:93], v10 offset:12288
ds_read_b64_tr_b16 v[94:95], v10 offset:12544
wl 0
ds_write_b128 v19, v[92:95] offset:16384
sad 38,52,7077888
buffer_load_dwordx4 a[80:83], v64, s[12:15], s38 offen offset:0
buffer_load_dwordx4 a[96:99], v64, s[12:15], s38 offen offset:128
buffer_load_dwordx4 a[104:107], v64, s[12:15], s38 offen offset:256
buffer_load_dwordx4 a[88:91], v64, s[16:19], s38 offen offset:0
buffer_load_dwordx4 v[40:43], v64, s[16:19], s38 offen offset:128
buffer_load_dwordx4 a[112:115], v64, s[16:19], s38 offen offset:256
wv 54
ds_write_b128 v65, a[148:151] offset:24576
ds_write_b128 v65, a[244:247] offset:28672
ds_write_b128 v65, v[196:199] offset:32768
ds_write_b128 v65, a[156:159] offset:36864
ds_write_b128 v65, a[252:255] offset:40960
ds_write_b128 v65, v[96:99] offset:45056
wl 0
s_barrier
tra 148,8,24576
tra 150,8,24832
tra 244,9,24576
tra 246,9,24832
ds_read_b64_tr_b16 v[196:197], v10 offset:24576
ds_read_b64_tr_b16 v[198:199], v10 offset:24832
tra 156,8,36864
tra 158,8,37120
tra 252,9,36864
tra 254,9,37120
ds_read_b64_tr_b16 v[96:97], v10 offset:36864
ds_read_b64_tr_b16 v[98:99], v10 offset:37120
wl 0
ds_write_b128 v19, v[96:99] offset:17408
sad 38,52,7471104
buffer_load_dwordx4 a[84:87], v64, s[12:15], s38 offen offset:0
buffer_load_dwordx4 a[100:103], v64, s[12:15], s38 offen offset:128
buffer_load_dwordx4 a[108:111], v64, s[12:15], s38 offen offset:256
buffer_load_dwordx4 a[92:95], v64, s[16:19], s38 offen offset:0
buffer_load_dwordx4 v[44:47], v64, s[16:19], s38 offen offset:128
buffer_load_dwordx4 a[116:119], v64, s[16:19], s38 offen offset:256
wv 54
ds_write_b128 v65, a[40:43] offset:0
ds_write_b128 v65, a[56:59] offset:4096
ds_write_b128 v65, a[64:67] offset:8192
ds_write_b128 v65, a[48:51] offset:12288
ds_write_b128 v65, v[32:35] offset:16384
ds_write_b128 v65, a[72:75] offset:20480
wl 0
s_barrier
tra 40,8,0
tra 42,8,256
tra 56,9,0
tra 58,9,256
tra 64,10,0
tra 66,10,256
tra 48,8,12288
tra 50,8,12544
ds_read_b64_tr_b16 v[32:33], v9 offset:12288
ds_read_b64_tr_b16 v[34:35], v9 offset:12544
tra 72,10,12288
tra 74,10,12544
wl 0
ds_write_b128 v19, v[32:35] offset:2048
wv 48
ds_write_b128 v65, a[44:47] offset:24576
ds_write_b128 v65, a[60:63] offset:28672
ds_write_b128 v65, a[68:71] offset:32768
ds_write_b128 v65, a[52:55] offset:36864
ds_write_b128 v65, v[36:39] offset:40960
ds_write_b128 v65, a[76:79] offset:45056
wl 0
s_barrier
tra 44,8,24576
tra 46,8,24832
tra 60,9,24576
tra 62,9,24832
tra 68,10,24576
tra 70,10,24832
tra 52,8,36864
tra 54,8,37120
ds_read_b64_tr_b16 v[36:37], v9 offset:36864
ds_read_b64_tr_b16 v[38:39], v9 offset:37120
tra 76,10,36864
tra 78,10,37120
wl 0
ds_write_b128 v19, v[36:39] offset:3072
wv 42
ds_write_b128 v65, a[160:163] offset:0
ds_write_b128 v65, v[112:115] offset:4096
ds_write_b128 v65, v[200:203] offset:8192
ds_write_b128 v65, a[168:171] offset:12288
ds_write_b128 v65, v[76:79] offset:16384
ds_write_b128 v65, v[208:211] offset:20480
wl 0
s_barrier
tra 160,8,0
tra 162,8,256
ds_read_b64_tr_b16 v[112:113], v9 offset:0
ds_read_b64_tr_b16 v[114:115], v9 offset:256
ds_read_b64_tr_b16 v[200:201], v10 offset:0
ds_read_b64_tr_b16 v[202:203], v10 offset:256
tra 168,8,12288
tra 170,8,12544
ds_read_b64_tr_b16 v[76:77], v9 offset:12288
ds_read_b64_tr_b16 v[78:79], v9 offset:12544
ds_read_b64_tr_b16 v[208:209], v10 offset:12288
ds_read_b64_tr_b16 v[210:211], v10 offset:12544
wl 0
ds_write_b128 v19, v[76:79] offset:12288
wv 36
ds_write_b128 v65, a[164:167] offset:24576
ds_write_b128 v65, v[116:119] offset:28672
ds_write_b128 v65, v[204:207] offset:32768
ds_write_b128 v65, a[172:175] offset:36864
ds_write_b128 v65, v[80:83] offset:40960
ds_write_b128 v65, v[212:215] offset:45056
wl 0
s_barrier
tra 164,8,24576
tra 166,8,24832
ds_read_b64_tr_b16 v[116:117], v9 offset:24576
ds_read_b64_tr_b16 v[118:119], v9 offset:24832
ds_read_b64_tr_b16 v[204:205], v10 offset:24576
ds_read_b64_tr_b16 v[206:207], v10 offset:24832
tra 172,8,36864
tra 174,8,37120
ds_read_b64_tr_b16 v[80:81], v9 offset:36864
ds_read_b64_tr_b16 v[82:83], v9 offset:37120
ds_read_b64_tr_b16 v[212:213], v10 offset:36864
ds_read_b64_tr_b16 v[214:215], v10 offset:37120
wl 0
ds_write_b128 v19, v[80:83] offset:13312
wv 30
ds_write_b128 v65, a[176:179] offset:0
ds_write_b128 v65, v[120:123] offset:4096
ds_write_b128 v65, v[216:219] offset:8192
ds_write_b128 v65, v[56:59] offset:12288
ds_write_b128 v65, v[128:131] offset:16384
ds_write_b128 v65, v[224:227] offset:20480
wl 0
s_barrier
tra 176,8,0
tra 178,8,256
ds_read_b64_tr_b16 v[120:121], v9 offset:0
ds_read_b64_tr_b16 v[122:123], v9 offset:256
ds_read_b64_tr_b16 v[216:217], v10 offset:0
ds_read_b64_tr_b16 v[218:219], v10 offset:256
ds_read_b64_tr_b16 v[56:57], v8 offset:12288
ds_read_b64_tr_b16 v[58:59], v8 offset:12544
ds_read_b64_tr_b16 v[128:129], v9 offset:12288
ds_read_b64_tr_b16 v[130:131], v9 offset:12544
ds_read_b64_tr_b16 v[224:225], v10 offset:12288
ds_read_b64_tr_b16 v[226:227], v10 offset:12544
wl 0
ds_write_b128 v19, v[56:59] offset:8192
wv 24
ds_write_b128 v65, a[180:183] offset:24576
ds_write_b128 v65, v[124:127] offset:28672
ds_write_b128 v65, v[220:223] offset:32768
ds_write_b128 v65, v[60:63] offset:36864
ds_write_b128 v65, v[132:135] offset:40960
ds_write_b128 v65, v[228:231] offset:45056
wl 0
s_barrier
tra 180,8,24576
tra 182,8,24832
ds_read_b64_tr_b16 v[124:125], v9 offset:24576
ds_read_b64_tr_b16 v[126:127], v9 offset:24832
ds_read_b64_tr_b16 v[220:221], v10 offset:24576
ds_read_b64_tr_b16 v[222:223], v10 offset:24832
ds_read_b64_tr_b16 v[60:61], v8 offset:36864
ds_read_b64_tr_b16 v[62:63], v8 offset:37120
ds_read_b64_tr_b16 v[132:133], v9 offset:36864
ds_read_b64_tr_b16 v[134:135], v9 offset:37120
ds_read_b64_tr_b16 v[228:229], v10 offset:36864
ds_read_b64_tr_b16 v[230:231], v10 offset:37120
wl 0
ds_write_b128 v19, v[60:63] offset:9216
wv 18
ds_write_b128 v65, a[184:187] offset:0
ds_write_b128 v65, v[136:139] offset:4096
ds_write_b128 v65, v[232:235] offset:8192
ds_write_b128 v65, a[192:195] offset:12288
ds_write_b128 v65, v[144:147] offset:16384
ds_write_b128 v65, v[100:103] offset:20480
wl 0
s_barrier
tra 184,8,0
tra 186,8,256
ds_read_b64_tr_b16 v[136:137], v9 offset:0
ds_read_b64_tr_b16 v[138:139], v9 offset:256
ds_read_b64_tr_b16 v[232:233], v10 offset:0
ds_read_b64_tr_b16 v[234:235], v10 offset:256
tra 192,8,12288
tra 194,8,12544
ds_read_b64_tr_b16 v[144:145], v9 offset:12288
ds_read_b64_tr_b16 v[146:147], v9 offset:12544
ds_read_b64_tr_b16 v[100:101], v10 offset:12288
ds_read_b64_tr_b16 v[102:103], v10 offset:12544
wl 0
ds_write_b128 v19, v[100:103] offset:18432
wv 12
ds_write_b128 v65, a[188:191] offset:24576
ds_write_b128 v65, v[140:143] offset:28672
ds_write_b128 v65, v[236:239] offset:32768
ds_write_b128 v65, a[196:199] offset:36864
ds_write_b128 v65, v[148:151] offset:40960
ds_write_b128 v65, v[104:107] offset:45056
wl 0
s_barrier
tra 188,8,24576
tra 190,8,24832
ds_read_b64_tr_b16 v[140:141], v9 offset:24576
ds_read_b64_tr_b16 v[142:143], v9 offset:24832
ds_read_b64_tr_b16 v[236:237], v10 offset:24576
ds_read_b64_tr_b16 v[238:239], v10 offset:24832
tra 196,8,36864
tra 198,8,37120
ds_read_b64_tr_b16 v[148:149], v9 offset:36864
ds_read_b64_tr_b16 v[150:151], v9 offset:37120
ds_read_b64_tr_b16 v[104:105], v10 offset:36864
ds_read_b64_tr_b16 v[106:107], v10 offset:37120
wl 0
ds_write_b128 v19, v[104:107] offset:19456
wv 6
ds_write_b128 v65, a[80:83] offset:0
ds_write_b128 v65, a[96:99] offset:4096
ds_write_b128 v65, a[104:107] offset:8192
ds_write_b128 v65, a[88:91] offset:12288
ds_write_b128 v65, v[40:43] offset:16384
ds_write_b128 v65, a[112:115] offset:20480
wl 0
s_barrier
tra 80,8,0
tra 82,8,256
tra 96,9,0
tra 98,9,256
tra 104,10,0
tra 106,10,256
tra 88,8,12288
tra 90,8,12544
ds_read_b64_tr_b16 v[40:41], v9 offset:12288
ds_read_b64_tr_b16 v[42:43], v9 offset:12544
tra 112,10,12288
tra 114,10,12544
wl 0
ds_write_b128 v19, v[40:43] offset:4096
wv 0
ds_write_b128 v65, a[84:87] offset:24576
ds_write_b128 v65, a[100:103] offset:28672
ds_write_b128 v65, a[108:111] offset:32768
ds_write_b128 v65, a[92:95] offset:36864
ds_write_b128 v65, v[44:47] offset:40960
ds_write_b128 v65, a[116:119] offset:45056
wl 0
s_barrier
tra 84,8,24576
tra 86,8,24832
tra 100,9,24576
tra 102,9,24832
tra 108,10,24576
tra 110,10,24832
tra 92,8,36864
tra 94,8,37120
ds_read_b64_tr_b16 v[44:45], v9 offset:36864
ds_read_b64_tr_b16 v[46:47], v9 offset:37120
tra 116,10,36864
tra 118,10,37120
wl 0
ds_write_b128 v19, v[44:47] offset:5120
s_branch L_pd_3
L_pv_6:
sad 38,52,0
buffer_load_dwordx4 a[80:83], v64, s[12:15], s38 offen offset:0
buffer_load_dwordx4 a[96:99], v64, s[12:15], s38 offen offset:128
buffer_load_dwordx4 a[104:107], v64, s[12:15], s38 offen offset:256
buffer_load_dwordx4 a[88:91], v64, s[16:19], s38 offen offset:0
buffer_load_dwordx4 v[40:43], v64, s[16:19], s38 offen offset:128
buffer_load_dwordx4 a[112:115], v64, s[16:19], s38 offen offset:256
sad 38,52,393216
buffer_load_dwordx4 a[84:87], v64, s[12:15], s38 offen offset:0
buffer_load_dwordx4 a[100:103], v64, s[12:15], s38 offen offset:128
buffer_load_dwordx4 a[108:111], v64, s[12:15], s38 offen offset:256
buffer_load_dwordx4 a[92:95], v64, s[16:19], s38 offen offset:0
buffer_load_dwordx4 v[44:47], v64, s[16:19], s38 offen offset:128
buffer_load_dwordx4 a[116:119], v64, s[16:19], s38 offen offset:256
sad 38,52,786432
buffer_load_dwordx4 a[200:203], v64, s[12:15], s38 offen offset:0
buffer_load_dwordx4 v[152:155], v64, s[12:15], s38 offen offset:128
buffer_load_dwordx4 v[240:243], v64, s[12:15], s38 offen offset:256
buffer_load_dwordx4 a[208:211], v64, s[16:19], s38 offen offset:0
buffer_load_dwordx4 v[84:87], v64, s[16:19], s38 offen offset:128
buffer_load_dwordx4 v[248:251], v64, s[16:19], s38 offen offset:256
sad 38,52,1179648
buffer_load_dwordx4 a[204:207], v64, s[12:15], s38 offen offset:0
buffer_load_dwordx4 v[156:159], v64, s[12:15], s38 offen offset:128
buffer_load_dwordx4 v[244:247], v64, s[12:15], s38 offen offset:256
buffer_load_dwordx4 a[212:215], v64, s[16:19], s38 offen offset:0
buffer_load_dwordx4 v[88:91], v64, s[16:19], s38 offen offset:128
buffer_load_dwordx4 v[252:255], v64, s[16:19], s38 offen offset:256
sad 38,52,1572864
buffer_load_dwordx4 a[0:3], v64, s[12:15], s38 offen offset:0
buffer_load_dwordx4 a[16:19], v64, s[12:15], s38 offen offset:128
buffer_load_dwordx4 a[24:27], v64, s[12:15], s38 offen offset:256
buffer_load_dwordx4 a[8:11], v64, s[16:19], s38 offen offset:0
buffer_load_dwordx4 v[24:27], v64, s[16:19], s38 offen offset:128
buffer_load_dwordx4 a[32:35], v64, s[16:19], s38 offen offset:256
sad 38,52,1966080
buffer_load_dwordx4 a[4:7], v64, s[12:15], s38 offen offset:0
buffer_load_dwordx4 a[20:23], v64, s[12:15], s38 offen offset:128
buffer_load_dwordx4 a[28:31], v64, s[12:15], s38 offen offset:256
buffer_load_dwordx4 a[12:15], v64, s[16:19], s38 offen offset:0
buffer_load_dwordx4 v[28:31], v64, s[16:19], s38 offen offset:128
buffer_load_dwordx4 a[36:39], v64, s[16:19], s38 offen offset:256
sad 38,52,2359296
buffer_load_dwordx4 a[120:123], v64, s[12:15], s38 offen offset:0
buffer_load_dwordx4 a[216:219], v64, s[12:15], s38 offen offset:128
buffer_load_dwordx4 v[160:163], v64, s[12:15], s38 offen offset:256
buffer_load_dwordx4 a[128:131], v64, s[16:19], s38 offen offset:0
buffer_load_dwordx4 v[68:71], v64, s[16:19], s38 offen offset:128
buffer_load_dwordx4 v[168:171], v64, s[16:19], s38 offen offset:256
sad 38,52,2752512
buffer_load_dwordx4 a[124:127], v64, s[12:15], s38 offen offset:0
buffer_load_dwordx4 a[220:223], v64, s[12:15], s38 offen offset:128
buffer_load_dwordx4 v[164:167], v64, s[12:15], s38 offen offset:256
buffer_load_dwordx4 a[132:135], v64, s[16:19], s38 offen offset:0
buffer_load_dwordx4 v[72:75], v64, s[16:19], s38 offen offset:128
buffer_load_dwordx4 v[172:175], v64, s[16:19], s38 offen offset:256
sad 38,52,3145728
buffer_load_dwordx4 a[136:139], v64, s[12:15], s38 offen offset:0
buffer_load_dwordx4 a[224:227], v64, s[12:15], s38 offen offset:128
buffer_load_dwordx4 v[176:179], v64, s[12:15], s38 offen offset:256
buffer_load_dwordx4 v[48:51], v64, s[16:19], s38 offen offset:0
buffer_load_dwordx4 a[232:235], v64, s[16:19], s38 offen offset:128
buffer_load_dwordx4 v[184:187], v64, s[16:19], s38 offen offset:256
sad 38,52,3538944
buffer_load_dwordx4 a[140:143], v64, s[12:15], s38 offen offset:0
buffer_load_dwordx4 a[228:231], v64, s[12:15], s38 offen offset:128
buffer_load_dwordx4 v[180:183], v64, s[12:15], s38 offen offset:256
buffer_load_dwordx4 v[52:55], v64, s[16:19], s38 offen offset:0
buffer_load_dwordx4 a[236:239], v64, s[16:19], s38 offen offset:128
buffer_load_dwordx4 v[188:191], v64, s[16:19], s38 offen offset:256
wv 54
ds_write_b128 v65, a[80:83] offset:0
ds_write_b128 v65, a[96:99] offset:4096
ds_write_b128 v65, a[104:107] offset:8192
ds_write_b128 v65, a[88:91] offset:12288
ds_write_b128 v65, v[40:43] offset:16384
ds_write_b128 v65, a[112:115] offset:20480
wl 0
s_barrier
tra 80,8,0
tra 82,8,256
tra 96,9,0
tra 98,9,256
tra 104,10,0
tra 106,10,256
tra 88,8,12288
tra 90,8,12544
ds_read_b64_tr_b16 v[40:41], v9 offset:12288
ds_read_b64_tr_b16 v[42:43], v9 offset:12544
tra 112,10,12288
tra 114,10,12544
wl 0
ds_write_b128 v19, v[40:43] offset:4096
sad 38,52,3932160
buffer_load_dwordx4 a[144:147], v64, s[12:15], s38 offen offset:0
buffer_load_dwordx4 a[240:243], v64, s[12:15], s38 offen offset:128
buffer_load_dwordx4 v[192:195], v64, s[12:15], s38 offen offset:256
buffer_load_dwordx4 a[152:155], v64, s[16:19], s38 offen offset:0
buffer_load_dwordx4 a[248:251], v64, s[16:19], s38 offen offset:128
buffer_load_dwordx4 v[92:95], v64, s[16:19], s38 offen offset:256
wv 54
ds_write_b128 v65, a[84:87] offset:24576
ds_write_b128 v65, a[100:103] offset:28672
ds_write_b128 v65, a[108:111] offset:32768
ds_write_b128 v65, a[92:95] offset:36864
ds_write_b128 v65, v[44:47] offset:40960
ds_write_b128 v65, a[116:119] offset:45056
wl 0
s_barrier
tra 84,8,24576
tra 86,8,24832
tra 100,9,24576
tra 102,9,24832
tra 108,10,24576
tra 110,10,24832
tra 92,8,36864
tra 94,8,37120
ds_read_b64_tr_b16 v[44:45], v9 offset:36864
ds_read_b64_tr_b16 v[46:47], v9 offset:37120
tra 116,10,36864
tra 118,10,37120
wl 0
ds_write_b128 v19, v[44:47] offset:5120
sad 38,52,4325376
buffer_load_dwordx4 a[148:151], v64, s[12:15], s38 offen offset:0
buffer_load_dwordx4 a[244:247], v64, s[12:15], s38 offen offset:128
buffer_load_dwordx4 v[196:199], v64, s[12:15], s38 offen offset:256
buffer_load_dwordx4 a[156:159], v64, s[16:19], s38 offen offset:0
buffer_load_dwordx4 a[252:255], v64, s[16:19], s38 offen offset:128
buffer_load_dwordx4 v[96:99], v64, s[16:19], s38 offen offset:256
wv 54
ds_write_b128 v65, a[200:203] offset:0
ds_write_b128 v65, v[152:155] offset:4096
ds_write_b128 v65, v[240:243] offset:8192
ds_write_b128 v65, a[208:211] offset:12288
ds_write_b128 v65, v[84:87] offset:16384
ds_write_b128 v65, v[248:251] offset:20480
wl 0
s_barrier
tra 200,8,0
tra 202,8,256
ds_read_b64_tr_b16 v[152:153], v9 offset:0
ds_read_b64_tr_b16 v[154:155], v9 offset:256
ds_read_b64_tr_b16 v[240:241], v10 offset:0
ds_read_b64_tr_b16 v[242:243], v10 offset:256
tra 208,8,12288
tra 210,8,12544
ds_read_b64_tr_b16 v[84:85], v9 offset:12288
ds_read_b64_tr_b16 v[86:87], v9 offset:12544
ds_read_b64_tr_b16 v[248:249], v10 offset:12288
ds_read_b64_tr_b16 v[250:251], v10 offset:12544
wl 0
ds_write_b128 v19, v[84:87] offset:14336
sad 38,52,4718592
buffer_load_dwordx4 a[40:43], v64, s[12:15], s38 offen offset:0
buffer_load_dwordx4 a[56:59], v64, s[12:15], s38 offen offset:128
buffer_load_dwordx4 a[64:67], v64, s[12:15], s38 offen offset:256
buffer_load_dwordx4 a[48:51], v64, s[16:19], s38 offen offset:0
buffer_load_dwordx4 v[32:35], v64, s[16:19], s38 offen offset:128
buffer_load_dwordx4 a[72:75], v64, s[16:19], s38 offen offset:256
wv 54
ds_write_b128 v65, a[204:207] offset:24576
ds_write_b128 v65, v[156:159] offset:28672
ds_write_b128 v65, v[244:247] offset:32768
ds_write_b128 v65, a[212:215] offset:36864
ds_write_b128 v65, v[88:91] offset:40960
ds_write_b128 v65, v[252:255] offset:45056
wl 0
s_barrier
tra 204,8,24576
tra 206,8,24832
ds_read_b64_tr_b16 v[156:157], v9 offset:24576
ds_read_b64_tr_b16 v[158:159], v9 offset:24832
ds_read_b64_tr_b16 v[244:245], v10 offset:24576
ds_read_b64_tr_b16 v[246:247], v10 offset:24832
tra 212,8,36864
tra 214,8,37120
ds_read_b64_tr_b16 v[88:89], v9 offset:36864
ds_read_b64_tr_b16 v[90:91], v9 offset:37120
ds_read_b64_tr_b16 v[252:253], v10 offset:36864
ds_read_b64_tr_b16 v[254:255], v10 offset:37120
wl 0
ds_write_b128 v19, v[88:91] offset:15360
sad 38,52,5111808
buffer_load_dwordx4 a[44:47], v64, s[12:15], s38 offen offset:0
buffer_load_dwordx4 a[60:63], v64, s[12:15], s38 offen offset:128
buffer_load_dwordx4 a[68:71], v64, s[12:15], s38 offen offset:256
buffer_load_dwordx4 a[52:55], v64, s[16:19], s38 offen offset:0
buffer_load_dwordx4 v[36:39], v64, s[16:19], s38 offen offset:128
buffer_load_dwordx4 a[76:79], v64, s[16:19], s38 offen offset:256
wv 54
ds_write_b128 v65, a[0:3] offset:0
ds_write_b128 v65, a[16:19] offset:4096
ds_write_b128 v65, a[24:27] offset:8192
ds_write_b128 v65, a[8:11] offset:12288
ds_write_b128 v65, v[24:27] offset:16384
ds_write_b128 v65, a[32:35] offset:20480
wl 0
s_barrier
tra 0,8,0
tra 2,8,256
tra 16,9,0
tra 18,9,256
tra 24,10,0
tra 26,10,256
tra 8,8,12288
tra 10,8,12544
ds_read_b64_tr_b16 v[24:25], v9 offset:12288
ds_read_b64_tr_b16 v[26:27], v9 offset:12544
tra 32,10,12288
tra 34,10,12544
wl 0
ds_write_b128 v19, v[24:27] offset:0
sad 38,52,5505024
buffer_load_dwordx4 a[160:163], v64, s[12:15], s38 offen offset:0
buffer_load_dwordx4 v[112:115], v64, s[12:15], s38 offen offset:128
buffer_load_dwordx4 v[200:203], v64, s[12:15], s38 offen offset:256
buffer_load_dwordx4 a[168:171], v64, s[16:19], s38 offen offset:0
buffer_load_dwordx4 v[76:79], v64, s[16:19], s38 offen offset:128
buffer_load_dwordx4 v[208:211], v64, s[16:19], s38 offen offset:256
wv 54
ds_write_b128 v65, a[4:7] offset:24576
ds_write_b128 v65, a[20:23] offset:28672
ds_write_b128 v65, a[28:31] offset:32768
ds_write_b128 v65, a[12:15] offset:36864
ds_write_b128 v65, v[28:31] offset:40960
ds_write_b128 v65, a[36:39] offset:45056
wl 0
s_barrier
tra 4,8,24576
tra 6,8,24832
tra 20,9,24576
tra 22,9,24832
tra 28,10,24576
tra 30,10,24832
tra 12,8,36864
tra 14,8,37120
ds_read_b64_tr_b16 v[28:29], v9 offset:36864
ds_read_b64_tr_b16 v[30:31], v9 offset:37120
tra 36,10,36864
tra 38,10,37120
wl 0
ds_write_b128 v19, v[28:31] offset:1024
sad 38,52,5898240
buffer_load_dwordx4 a[164:167], v64, s[12:15], s38 offen offset:0
buffer_load_dwordx4 v[116:119], v64, s[12:15], s38 offen offset:128
buffer_load_dwordx4 v[204:207], v64, s[12:15], s38 offen offset:256
buffer_load_dwordx4 a[172:175], v64, s[16:19], s38 offen offset:0
buffer_load_dwordx4 v[80:83], v64, s[16:19], s38 offen offset:128
buffer_load_dwordx4 v[212:215], v64, s[16:19], s38 offen offset:256
wv 54
ds_write_b128 v65, a[120:123] offset:0
ds_write_b128 v65, a[216:219] offset:4096
ds_write_b128 v65, v[160:163] offset:8192
ds_write_b128 v65, a[128:131] offset:12288
ds_write_b128 v65, v[68:71] offset:16384
ds_write_b128 v65, v[168:171] offset:20480
wl 0
s_barrier
tra 120,8,0
tra 122,8,256
tra 216,9,0
tra 218,9,256
ds_read_b64_tr_b16 v[160:161], v10 offset:0
ds_read_b64_tr_b16 v[162:163], v10 offset:256
tra 128,8,12288
tra 130,8,12544
ds_read_b64_tr_b16 v[68:69], v9 offset:12288
ds_read_b64_tr_b16 v[70:71], v9 offset:12544
ds_read_b64_tr_b16 v[168:169], v10 offset:12288
ds_read_b64_tr_b16 v[170:171], v10 offset:12544
wl 0
ds_write_b128 v19, v[68:71] offset:10240
sad 38,52,6291456
buffer_load_dwordx4 a[176:179], v64, s[12:15], s38 offen offset:0
buffer_load_dwordx4 v[120:123], v64, s[12:15], s38 offen offset:128
buffer_load_dwordx4 v[216:219], v64, s[12:15], s38 offen offset:256
buffer_load_dwordx4 v[56:59], v64, s[16:19], s38 offen offset:0
buffer_load_dwordx4 v[128:131], v64, s[16:19], s38 offen offset:128
buffer_load_dwordx4 v[224:227], v64, s[16:19], s38 offen offset:256
wv 54
ds_write_b128 v65, a[124:127] offset:24576
ds_write_b128 v65, a[220:223] offset:28672
ds_write_b128 v65, v[164:167] offset:32768
ds_write_b128 v65, a[132:135] offset:36864
ds_write_b128 v65, v[72:75] offset:40960
ds_write_b128 v65, v[172:175] offset:45056
wl 0
s_barrier
tra 124,8,24576
tra 126,8,24832
tra 220,9,24576
tra 222,9,24832
ds_read_b64_tr_b16 v[164:165], v10 offset:24576
ds_read_b64_tr_b16 v[166:167], v10 offset:24832
tra 132,8,36864
tra 134,8,37120
ds_read_b64_tr_b16 v[72:73], v9 offset:36864
ds_read_b64_tr_b16 v[74:75], v9 offset:37120
ds_read_b64_tr_b16 v[172:173], v10 offset:36864
ds_read_b64_tr_b16 v[174:175], v10 offset:37120
wl 0
ds_write_b128 v19, v[72:75] offset:11264
sad 38,52,6684672
buffer_load_dwordx4 a[180:183], v64, s[12:15], s38 offen offset:0
buffer_load_dwordx4 v[124:127], v64, s[12:15], s38 offen offset:128
buffer_load_dwordx4 v[220:223], v64, s[12:15], s38 offen offset:256
buffer_load_dwordx4 v[60:63], v64, s[16:19], s38 offen offset:0
buffer_load_dwordx4 v[132:135], v64, s[16:19], s38 offen offset:128
buffer_load_dwordx4 v[228:231], v64, s[16:19], s38 offen offset:256
wv 54
ds_write_b128 v65, a[136:139] offset:0
ds_write_b128 v65, a[224:227] offset:4096
ds_write_b128 v65, v[176:179] offset:8192
ds_write_b128 v65, v[48:51] offset:12288
ds_write_b128 v65, a[232:235] offset:16384
ds_write_b128 v65, v[184:187] offset:20480
wl 0
s_barrier
tra 136,8,0
tra 138,8,256
tra 224,9,0
tra 226,9,256
ds_read_b64_tr_b16 v[176:177], v10 offset:0
ds_read_b64_tr_b16 v[178:179], v10 offset:256
ds_read_b64_tr_b16 v[48:49], v8 offset:12288
ds_read_b64_tr_b16 v[50:51], v8 offset:12544
tra 232,9,12288
tra 234,9,12544
ds_read_b64_tr_b16 v[184:185], v10 offset:12288
ds_read_b64_tr_b16 v[186:187], v10 offset:12544
wl 0
ds_write_b128 v19, v[48:51] offset:6144
sad 38,52,7077888
buffer_load_dwordx4 a[184:187], v64, s[12:15], s38 offen offset:0
buffer_load_dwordx4 v[136:139], v64, s[12:15], s38 offen offset:128
buffer_load_dwordx4 v[232:235], v64, s[12:15], s38 offen offset:256
buffer_load_dwordx4 a[192:195], v64, s[16:19], s38 offen offset:0
buffer_load_dwordx4 v[144:147], v64, s[16:19], s38 offen offset:128
buffer_load_dwordx4 v[100:103], v64, s[16:19], s38 offen offset:256
wv 54
ds_write_b128 v65, a[140:143] offset:24576
ds_write_b128 v65, a[228:231] offset:28672
ds_write_b128 v65, v[180:183] offset:32768
ds_write_b128 v65, v[52:55] offset:36864
ds_write_b128 v65, a[236:239] offset:40960
ds_write_b128 v65, v[188:191] offset:45056
wl 0
s_barrier
tra 140,8,24576
tra 142,8,24832
tra 228,9,24576
tra 230,9,24832
ds_read_b64_tr_b16 v[180:181], v10 offset:24576
ds_read_b64_tr_b16 v[182:183], v10 offset:24832
ds_read_b64_tr_b16 v[52:53], v8 offset:36864
ds_read_b64_tr_b16 v[54:55], v8 offset:37120
tra 236,9,36864
tra 238,9,37120
ds_read_b64_tr_b16 v[188:189], v10 offset:36864
ds_read_b64_tr_b16 v[190:191], v10 offset:37120
wl 0
ds_write_b128 v19, v[52:55] offset:7168
sad 38,52,7471104
buffer_load_dwordx4 a[188:191], v64, s[12:15], s38 offen offset:0
buffer_load_dwordx4 v[140:143], v64, s[12:15], s38 offen offset:128
buffer_load_dwordx4 v[236:239], v64, s[12:15], s38 offen offset:256
buffer_load_dwordx4 a[196:199], v64, s[16:19], s38 offen offset:0
buffer_load_dwordx4 v[148:151], v64, s[16:19], s38 offen offset:128
buffer_load_dwordx4 v[104:107], v64, s[16:19], s38 offen offset:256
wv 54
ds_write_b128 v65, a[144:147] offset:0
ds_write_b128 v65, a[240:243] offset:4096
ds_write_b128 v65, v[192:195] offset:8192
ds_write_b128 v65, a[152:155] offset:12288
ds_write_b128 v65, a[248:251] offset:16384
ds_write_b128 v65, v[92:95] offset:20480
wl 0
s_barrier
tra 144,8,0
tra 146,8,256
tra 240,9,0
tra 242,9,256
ds_read_b64_tr_b16 v[192:193], v10 offset:0
ds_read_b64_tr_b16 v[194:195], v10 offset:256
tra 152,8,12288
tra 154,8,12544
tra 248,9,12288
tra 250,9,12544
ds_read_b64_tr_b16 v[92:93], v10 offset:12288
ds_read_b64_tr_b16 v[94:95], v10 offset:12544
wl 0
ds_write_b128 v19, v[92:95] offset:16384
wv 48
ds_write_b128 v65, a[148:151] offset:24576
ds_write_b128 v65, a[244:247] offset:28672
ds_write_b128 v65, v[196:199] offset:32768
ds_write_b128 v65, a[156:159] offset:36864
ds_write_b128 v65, a[252:255] offset:40960
ds_write_b128 v65, v[96:99] offset:45056
wl 0
s_barrier
tra 148,8,24576
tra 150,8,24832
tra 244,9,24576
tra 246,9,24832
ds_read_b64_tr_b16 v[196:197], v10 offset:24576
ds_read_b64_tr_b16 v[198:199], v10 offset:24832
tra 156,8,36864
tra 158,8,37120
tra 252,9,36864
tra 254,9,37120
ds_read_b64_tr_b16 v[96:97], v10 offset:36864
ds_read_b64_tr_b16 v[98:99], v10 offset:37120
wl 0
ds_write_b128 v19, v[96:99] offset:17408
wv 42
ds_write_b128 v65, a[40:43] offset:0
ds_write_b128 v65, a[56:59] offset:4096
ds_write_b128 v65, a[64:67] offset:8192
ds_write_b128 v65, a[48:51] offset:12288
ds_write_b128 v65, v[32:35] offset:16384
ds_write_b128 v65, a[72:75] offset:20480
wl 0
s_barrier
tra 40,8,0
tra 42,8,256
tra 56,9,0
tra 58,9,256
tra 64,10,0
tra 66,10,256
tra 48,8,12288
tra 50,8,12544
ds_read_b64_tr_b16 v[32:33], v9 offset:12288
ds_read_b64_tr_b16 v[34:35], v9 offset:12544
tra 72,10,12288
tra 74,10,12544
wl 0
ds_write_b128 v19, v[32:35] offset:2048
wv 36
ds_write_b128 v65, a[44:47] offset:24576
ds_write_b128 v65, a[60:63] offset:28672
ds_write_b128 v65, a[68:71] offset:32768
ds_write_b128 v65, a[52:55] offset:36864
ds_write_b128 v65, v[36:39] offset:40960
ds_write_b128 v65, a[76:79] offset:45056
wl 0
s_barrier
tra 44,8,24576
tra 46,8,24832
tra 60,9,24576
tra 62,9,24832
tra 68,10,24576
tra 70,10,24832
tra 52,8,36864
tra 54,8,37120
ds_read_b64_tr_b16 v[36:37], v9 offset:36864
ds_read_b64_tr_b16 v[38:39], v9 offset:37120
tra 76,10,36864
tra 78,10,37120
wl 0
ds_write_b128 v19, v[36:39] offset:3072
wv 30
ds_write_b128 v65, a[160:163] offset:0
ds_write_b128 v65, v[112:115] offset:4096
ds_write_b128 v65, v[200:203] offset:8192
ds_write_b128 v65, a[168:171] offset:12288
ds_write_b128 v65, v[76:79] offset:16384
ds_write_b128 v65, v[208:211] offset:20480
wl 0
s_barrier
tra 160,8,0
tra 162,8,256
ds_read_b64_tr_b16 v[112:113], v9 offset:0
ds_read_b64_tr_b16 v[114:115], v9 offset:256
ds_read_b64_tr_b16 v[200:201], v10 offset:0
ds_read_b64_tr_b16 v[202:203], v10 offset:256
tra 168,8,12288
tra 170,8,12544
ds_read_b64_tr_b16 v[76:77], v9 offset:12288
ds_read_b64_tr_b16 v[78:79], v9 offset:12544
ds_read_b64_tr_b16 v[208:209], v10 offset:12288
ds_read_b64_tr_b16 v[210:211], v10 offset:12544
wl 0
ds_write_b128 v19, v[76:79] offset:12288
wv 24
ds_write_b128 v65, a[164:167] offset:24576
ds_write_b128 v65, v[116:119] offset:28672
ds_write_b128 v65, v[204:207] offset:32768
ds_write_b128 v65, a[172:175] offset:36864
ds_write_b128 v65, v[80:83] offset:40960
ds_write_b128 v65, v[212:215] offset:45056
wl 0
s_barrier
tra 164,8,24576
tra 166,8,24832
ds_read_b64_tr_b16 v[116:117], v9 offset:24576
ds_read_b64_tr_b16 v[118:119], v9 offset:24832
ds_read_b64_tr_b16 v[204:205], v10 offset:24576
ds_read_b64_tr_b16 v[206:207], v10 offset:24832
tra 172,8,36864
tra 174,8,37120
ds_read_b64_tr_b16 v[80:81], v9 offset:36864
ds_read_b64_tr_b16 v[82:83], v9 offset:37120
ds_read_b64_tr_b16 v[212:213], v10 offset:36864
ds_read_b64_tr_b16 v[214:215], v10 offset:37120
wl 0
ds_write_b128 v19, v[80:83] offset:13312
wv 18
ds_write_b128 v65, a[176:179] offset:0
ds_write_b128 v65, v[120:123] offset:4096
ds_write_b128 v65, v[216:219] offset:8192
ds_write_b128 v65, v[56:59] offset:12288
ds_write_b128 v65, v[128:131] offset:16384
ds_write_b128 v65, v[224:227] offset:20480
wl 0
s_barrier
tra 176,8,0
tra 178,8,256
ds_read_b64_tr_b16 v[120:121], v9 offset:0
ds_read_b64_tr_b16 v[122:123], v9 offset:256
ds_read_b64_tr_b16 v[216:217], v10 offset:0
ds_read_b64_tr_b16 v[218:219], v10 offset:256
ds_read_b64_tr_b16 v[56:57], v8 offset:12288
ds_read_b64_tr_b16 v[58:59], v8 offset:12544
ds_read_b64_tr_b16 v[128:129], v9 offset:12288
ds_read_b64_tr_b16 v[130:131], v9 offset:12544
ds_read_b64_tr_b16 v[224:225], v10 offset:12288
ds_read_b64_tr_b16 v[226:227], v10 offset:12544
wl 0
ds_write_b128 v19, v[56:59] offset:8192
wv 12
ds_write_b128 v65, a[180:183] offset:24576
ds_write_b128 v65, v[124:127] offset:28672
ds_write_b128 v65, v[220:223] offset:32768
ds_write_b128 v65, v[60:63] offset:36864
ds_write_b128 v65, v[132:135] offset:40960
ds_write_b128 v65, v[228:231] offset:45056
wl 0
s_barrier
tra 180,8,24576
tra 182,8,24832
ds_read_b64_tr_b16 v[124:125], v9 offset:24576
ds_read_b64_tr_b16 v[126:127], v9 offset:24832
ds_read_b64_tr_b16 v[220:221], v10 offset:24576
ds_read_b64_tr_b16 v[222:223], v10 offset:24832
ds_read_b64_tr_b16 v[60:61], v8 offset:36864
ds_read_b64_tr_b16 v[62:63], v8 offset:37120
ds_read_b64_tr_b16 v[132:133], v9 offset:36864
ds_read_b64_tr_b16 v[134:135], v9 offset:37120
ds_read_b64_tr_b16 v[228:229], v10 offset:36864
ds_read_b64_tr_b16 v[230:231], v10 offset:37120
wl 0
ds_write_b128 v19, v[60:63] offset:9216
wv 6
ds_write_b128 v65, a[184:187] offset:0
ds_write_b128 v65, v[136:139] offset:4096
ds_write_b128 v65, v[232:235] offset:8192
ds_write_b128 v65, a[192:195] offset:12288
ds_write_b128 v65, v[144:147] offset:16384
ds_write_b128 v65, v[100:103] offset:20480
wl 0
s_barrier
tra 184,8,0
tra 186,8,256
ds_read_b64_tr_b16 v[136:137], v9 offset:0
ds_read_b64_tr_b16 v[138:139], v9 offset:256
ds_read_b64_tr_b16 v[232:233], v10 offset:0
ds_read_b64_tr_b16 v[234:235], v10 offset:256
tra 192,8,12288
tra 194,8,12544
ds_read_b64_tr_b16 v[144:145], v9 offset:12288
ds_read_b64_tr_b16 v[146:147], v9 offset:12544
ds_read_b64_tr_b16 v[100:101], v10 offset:12288
ds_read_b64_tr_b16 v[102:103], v10 offset:12544
wl 0
ds_write_b128 v19, v[100:103] offset:18432
wv 0
ds_write_b128 v65, a[188:191] offset:24576
ds_write_b128 v65, v[140:143] offset:28672
ds_write_b128 v65, v[236:239] offset:32768
ds_write_b128 v65, a[196:199] offset:36864
ds_write_b128 v65, v[148:151] offset:40960
ds_write_b128 v65, v[104:107] offset:45056
wl 0
s_barrier
tra 188,8,24576
tra 190,8,24832
ds_read_b64_tr_b16 v[140:141], v9 offset:24576
ds_read_b64_tr_b16 v[142:143], v9 offset:24832
ds_read_b64_tr_b16 v[236:237], v10 offset:24576
ds_read_b64_tr_b16 v[238:239], v10 offset:24832
tra 196,8,36864
tra 198,8,37120
ds_read_b64_tr_b16 v[148:149], v9 offset:36864
ds_read_b64_tr_b16 v[150:151], v9 offset:37120
ds_read_b64_tr_b16 v[104:105], v10 offset:36864
ds_read_b64_tr_b16 v[106:107], v10 offset:37120
wl 0
ds_write_b128 v19, v[104:107] offset:19456
s_branch L_pd_3
L_pv_7:
sad 38,52,0
buffer_load_dwordx4 a[184:187], v64, s[12:15], s38 offen offset:0
buffer_load_dwordx4 v[136:139], v64, s[12:15], s38 offen offset:128
buffer_load_dwordx4 v[232:235], v64, s[12:15], s38 offen offset:256
buffer_load_dwordx4 a[192:195], v64, s[16:19], s38 offen offset:0
buffer_load_dwordx4 v[144:147], v64, s[16:19], s38 offen offset:128
buffer_load_dwordx4 v[100:103], v64, s[16:19], s38 offen offset:256
sad 38,52,393216
buffer_load_dwordx4 a[188:191], v64, s[12:15], s38 offen offset:0
buffer_load_dwordx4 v[140:143], v64, s[12:15], s38 offen offset:128
buffer_load_dwordx4 v[236:239], v64, s[12:15], s38 offen offset:256
buffer_load_dwordx4 a[196:199], v64, s[16:19], s38 offen offset:0
buffer_load_dwordx4 v[148:151], v64, s[16:19], s38 offen offset:128
buffer_load_dwordx4 v[104:107], v64, s[16:19], s38 offen offset:256
sad 38,52,786432
buffer_load_dwordx4 a[80:83], v64, s[12:15], s38 offen offset:0
buffer_load_dwordx4 a[96:99], v64, s[12:15], s38 offen offset:128
buffer_load_dwordx4 a[104:107], v64, s[12:15], s38 offen offset:256
buffer_load_dwordx4 a[88:91], v64, s[16:19], s38 offen offset:0
buffer_load_dwordx4 v[40:43], v64, s[16:19], s38 offen offset:128
buffer_load_dwordx4 a[112:115], v64, s[16:19], s38 offen offset:256
sad 38,52,1179648
buffer_load_dwordx4 a[84:87], v64, s[12:15], s38 offen offset:0
buffer_load_dwordx4 a[100:103], v64, s[12:15], s38 offen offset:128
buffer_load_dwordx4 a[108:111], v64, s[12:15], s38 offen offset:256
buffer_load_dwordx4 a[92:95], v64, s[16:19], s38 offen offset:0
buffer_load_dwordx4 v[44:47], v64, s[16:19], s38 offen offset:128
buffer_load_dwordx4 a[116:119], v64, s[16:19], s38 offen offset:256
sad 38,52,1572864
buffer_load_dwordx4 a[200:203], v64, s[12:15], s38 offen offset:0
buffer_load_dwordx4 v[152:155], v64, s[12:15], s38 offen offset:128
buffer_load_dwordx4 v[240:243], v64, s[12:15], s38 offen offset:256
buffer_load_dwordx4 a[208:211], v64, s[16:19], s38 offen offset:0
buffer_load_dwordx4 v[84:87], v64, s[16:19], s38 offen offset:128
buffer_load_dwordx4 v[248:251], v64, s[16:19], s38 offen offset:256
sad 38,52,1966080
buffer_load_dwordx4 a[204:207], v64, s[12:15], s38 offen offset:0
buffer_load_dwordx4 v[156:159], v64, s[12:15], s38 offen offset:128
buffer_load_dwordx4 v[244:247], v64, s[12:15], s38 offen offset:256
buffer_load_dwordx4 a[212:215], v64, s[16:19], s38 offen offset:0
buffer_load_dwordx4 v[88:91], v64, s[16:19], s38 offen offset:128
buffer_load_dwordx4 v[252:255], v64, s[16:19], s38 offen offset:256
sad 38,52,2359296
buffer_load_dwordx4 a[0:3], v64, s[12:15], s38 offen offset:0
buffer_load_dwordx4 a[16:19], v64, s[12:15], s38 offen offset:128
buffer_load_dwordx4 a[24:27], v64, s[12:15], s38 offen offset:256
buffer_load_dwordx4 a[8:11], v64, s[16:19], s38 offen offset:0
buffer_load_dwordx4 v[24:27], v64, s[16:19], s38 offen offset:128
buffer_load_dwordx4 a[32:35], v64, s[16:19], s38 offen offset:256
sad 38,52,2752512
buffer_load_dwordx4 a[4:7], v64, s[12:15], s38 offen offset:0
buffer_load_dwordx4 a[20:23], v64, s[12:15], s38 offen offset:128
buffer_load_dwordx4 a[28:31], v64, s[12:15], s38 offen offset:256
buffer_load_dwordx4 a[12:15], v64, s[16:19], s38 offen offset:0
buffer_load_dwordx4 v[28:31], v64, s[16:19], s38 offen offset:128
buffer_load_dwordx4 a[36:39], v64, s[16:19], s38 offen offset:256
sad 38,52,3145728
buffer_load_dwordx4 a[120:123], v64, s[12:15], s38 offen offset:0
buffer_load_dwordx4 a[216:219], v64, s[12:15], s38 offen offset:128
buffer_load_dwordx4 v[160:163], v64, s[12:15], s38 offen offset:256
buffer_load_dwordx4 a[128:131], v64, s[16:19], s38 offen offset:0
buffer_load_dwordx4 v[68:71], v64, s[16:19], s38 offen offset:128
buffer_load_dwordx4 v[168:171], v64, s[16:19], s38 offen offset:256
sad 38,52,3538944
buffer_load_dwordx4 a[124:127], v64, s[12:15], s38 offen offset:0
buffer_load_dwordx4 a[220:223], v64, s[12:15], s38 offen offset:128
buffer_load_dwordx4 v[164:167], v64, s[12:15], s38 offen offset:256
buffer_load_dwordx4 a[132:135], v64, s[16:19], s38 offen offset:0
buffer_load_dwordx4 v[72:75], v64, s[16:19], s38 offen offset:128
buffer_load_dwordx4 v[172:175], v64, s[16:19], s38 offen offset:256
wv 54
ds_write_b128 v65, a[184:187] offset:0
ds_write_b128 v65, v[136:139] offset:4096
ds_write_b128 v65, v[232:235] offset:8192
ds_write_b128 v65, a[192:195] offset:12288
ds_write_b128 v65, v[144:147] offset:16384
ds_write_b128 v65, v[100:103] offset:20480
wl 0
s_barrier
tra 184,8,0
tra 186,8,256
ds_read_b64_tr_b16 v[136:137], v9 offset:0
ds_read_b64_tr_b16 v[138:139], v9 offset:256
ds_read_b64_tr_b16 v[232:233], v10 offset:0
ds_read_b64_tr_b16 v[234:235], v10 offset:256
tra 192,8,12288
tra 194,8,12544
ds_read_b64_tr_b16 v[144:145], v9 offset:12288
ds_read_b64_tr_b16 v[146:147], v9 offset:12544
ds_read_b64_tr_b16 v[100:101], v10 offset:12288
ds_read_b64_tr_b16 v[102:103], v10 offset:12544
wl 0
ds_write_b128 v19, v[100:103] offset:18432
sad 38,52,3932160
buffer_load_dwordx4 a[136:139], v64, s[12:15], s38 offen offset:0
buffer_load_dwordx4 a[224:227], v64, s[12:15], s38 offen offset:128
buffer_load_dwordx4 v[176:179], v64, s[12:15], s38 offen offset:256
buffer_load_dwordx4 v[48:51], v64, s[16:19], s38 offen offset:0
buffer_load_dwordx4 a[232:235], v64, s[16:19], s38 offen offset:128
buffer_load_dwordx4 v[184:187], v64, s[16:19], s38 offen offset:256
wv 54
ds_write_b128 v65, a[188:191] offset:24576
ds_write_b128 v65, v[140:143] offset:28672
ds_write_b128 v65, v[236:239] offset:32768
ds_write_b128 v65, a[196:199] offset:36864
ds_write_b128 v65, v[148:151] offset:40960
ds_write_b128 v65, v[104:107] offset:45056
wl 0
s_barrier
tra 188,8,24576
tra 190,8,24832
ds_read_b64_tr_b16 v[140:141], v9 offset:24576
ds_read_b64_tr_b16 v[142:143], v9 offset:24832
ds_read_b64_tr_b16 v[236:237], v10 offset:24576
ds_read_b64_tr_b16 v[238:239], v10 offset:24832
tra 196,8,36864
tra 198,8,37120
ds_read_b64_tr_b16 v[148:149], v9 offset:36864
ds_read_b64_tr_b16 v[150:151], v9 offset:37120
ds_read_b64_tr_b16 v[104:105], v10 offset:36864
ds_read_b64_tr_b16 v[106:107], v10 offset:37120
wl 0
ds_write_b128 v19, v[104:107] offset:19456
sad 38,52,4325376
buffer_load_dwordx4 a[140:143], v64, s[12:15], s38 offen offset:0
buffer_load_dwordx4 a[228:231], v64, s[12:15], s38 offen offset:128
buffer_load_dwordx4 v[180:183], v64, s[12:15], s38 offen offset:256
buffer_load_dwordx4 v[52:55], v64, s[16:19], s38 offen offset:0
buffer_load_dwordx4 a[236:239], v64, s[16:19], s38 offen offset:128
buffer_load_dwordx4 v[188:191], v64, s[16:19], s38 offen offset:256
wv 54
ds_write_b128 v65, a[80:83] offset:0
ds_write_b128 v65, a[96:99] offset:4096
ds_write_b128 v65, a[104:107] offset:8192
ds_write_b128 v65, a[88:91] offset:12288
ds_write_b128 v65, v[40:43] offset:16384
ds_write_b128 v65, a[112:115] offset:20480
wl 0
s_barrier
tra 80,8,0
tra 82,8,256
tra 96,9,0
tra 98,9,256
tra 104,10,0
tra 106,10,256
tra 88,8,12288
tra 90,8,12544
ds_read_b64_tr_b16 v[40:41], v9 offset:12288
ds_read_b64_tr_b16 v[42:43], v9 offset:12544
tra 112,10,12288
tra 114,10,12544
wl 0
ds_write_b128 v19, v[40:43] offset:4096
sad 38,52,4718592
buffer_load_dwordx4 a[144:147], v64, s[12:15], s38 offen offset:0
buffer_load_dwordx4 a[240:243], v64, s[12:15], s38 offen offset:128
buffer_load_dwordx4 v[192:195], v64, s[12:15], s38 offen offset:256
buffer_load_dwordx4 a[152:155], v64, s[16:19], s38 offen offset:0
buffer_load_dwordx4 a[248:251], v64, s[16:19], s38 offen offset:128
buffer_load_dwordx4 v[92:95], v64, s[16:19], s38 offen offset:256
wv 54
ds_write_b128 v65, a[84:87] offset:24576
ds_write_b128 v65, a[100:103] offset:28672
ds_write_b128 v65, a[108:111] offset:32768
ds_write_b128 v65, a[92:95] offset:36864
ds_write_b128 v65, v[44:47] offset:40960
ds_write_b128 v65, a[116:119] offset:45056
wl 0
s_barrier
tra 84,8,24576
tra 86,8,24832
tra 100,9,24576
tra 102,9,24832
tra 108,10,24576
tra 110,10,24832
tra 92,8,36864
tra 94,8,37120
ds_read_b64_tr_b16 v[44:45], v9 offset:36864
ds_read_b64_tr_b16 v[46:47], v9 offset:37120
tra 116,10,36864
tra 118,10,37120
wl 0
ds_write_b128 v19, v[44:47] offset:5120
sad 38,52,5111808
buffer_load_dwordx4 a[148:151], v64, s[12:15], s38 offen offset:0
buffer_load_dwordx4 a[244:247], v64, s[12:15], s38 offen offset:128
buffer_load_dwordx4 v[196:199], v64, s[12:15], s38 offen offset:256
buffer_load_dwordx4 a[156:159], v64, s[16:19], s38 offen offset:0
buffer_load_dwordx4 a[252:255], v64, s[16:19], s38 offen offset:128
buffer_load_dwordx4 v[96:99], v64, s[16:19], s38 offen offset:256
wv 54
ds_write_b128 v65, a[200:203] offset:0
ds_write_b128 v65, v[152:155] offset:4096
ds_write_b128 v65, v[240:243] offset:8192
ds_write_b128 v65, a[208:211] offset:12288
ds_write_b128 v65, v[84:87] offset:16384
ds_write_b128 v65, v[248:251] offset:20480
wl 0
s_barrier
tra 200,8,0
tra 202,8,256
ds_read_b64_tr_b16 v[152:153], v9 offset:0
ds_read_b64_tr_b16 v[154:155], v9 offset:256
ds_read_b64_tr_b16 v[240:241], v10 offset:0
ds_read_b64_tr_b16 v[242:243], v10 offset:256
tra 208,8,12288
tra 210,8,12544
ds_read_b64_tr_b16 v[84:85], v9 offset:12288
ds_read_b64_tr_b16 v[86:87], v9 offset:12544
ds_read_b64_tr_b16 v[248:249], v10 offset:12288
ds_read_b64_tr_b16 v[250:251], v10 offset:12544
wl 0
ds_write_b128 v19, v[84:87] offset:14336
sad 38,52,5505024
buffer_load_dwordx4 a[40:43], v64, s[12:15], s38 offen offset:0
buffer_load_dwordx4 a[56:59], v64, s[12:15], s38 offen offset:128
buffer_load_dwordx4 a[64:67], v64, s[12:15], s38 offen offset:256
buffer_load_dwordx4 a[48:51], v64, s[16:19], s38 offen offset:0
buffer_load_dwordx4 v[32:35], v64, s[16:19], s38 offen offset:128
buffer_load_dwordx4 a[72:75], v64, s[16:19], s38 offen offset:256
wv 54
ds_write_b128 v65, a[204:207] offset:24576
ds_write_b128 v65, v[156:159] offset:28672
ds_write_b128 v65, v[244:247] offset:32768
ds_write_b128 v65, a[212:215] offset:36864
ds_write_b128 v65, v[88:91] offset:40960
ds_write_b128 v65, v[252:255] offset:45056
wl 0
s_barrier
tra 204,8,24576
tra 206,8,24832
ds_read_b64_tr_b16 v[156:157], v9 offset:24576
ds_read_b64_tr_b16 v[158:159], v9 offset:24832
ds_read_b64_tr_b16 v[244:245], v10 offset:24576
ds_read_b64_tr_b16 v[246:247], v10 offset:24832
tra 212,8,36864
tra 214,8,37120
ds_read_b64_tr_b16 v[88:89], v9 offset:36864
ds_read_b64_tr_b16 v[90:91], v9 offset:37120
ds_read_b64_tr_b16 v[252:253], v10 offset:36864
ds_read_b64_tr_b16 v[254:255], v10 offset:37120
wl 0
ds_write_b128 v19, v[88:91] offset:15360
sad 38,52,5898240
buffer_load_dwordx4 a[44:47], v64, s[12:15], s38 offen offset:0
buffer_load_dwordx4 a[60:63], v64, s[12:15], s38 offen offset:128
buffer_load_dwordx4 a[68:71], v64, s[12:15], s38 offen offset:256
buffer_load_dwordx4 a[52:55], v64, s[16:19], s38 offen offset:0
buffer_load_dwordx4 v[36:39], v64, s[16:19], s38 offen offset:128
buffer_load_dwordx4 a[76:79], v64, s[16:19], s38 offen offset:256
wv 54
ds_write_b128 v65, a[0:3] offset:0
ds_write_b128 v65, a[16:19] offset:4096
ds_write_b128 v65, a[24:27] offset:8192
ds_write_b128 v65, a[8:11] offset:12288
ds_write_b128 v65, v[24:27] offset:16384
ds_write_b128 v65, a[32:35] offset:20480
wl 0
s_barrier
tra 0,8,0
tra 2,8,256
tra 16,9,0
tra 18,9,256
tra 24,10,0
tra 26,10,256
tra 8,8,12288
tra 10,8,12544
ds_read_b64_tr_b16 v[24:25], v9 offset:12288
ds_read_b64_tr_b16 v[26:27], v9 offset:12544
tra 32,10,12288
tra 34,10,12544
wl 0
ds_write_b128 v19, v[24:27] offset:0
sad 38,52,6291456
buffer_load_dwordx4 a[160:163], v64, s[12:15], s38 offen offset:0
buffer_load_dwordx4 v[112:115], v64, s[12:15], s38 offen offset:128
buffer_load_dwordx4 v[200:203], v64, s[12:15], s38 offen offset:256
buffer_load_dwordx4 a[168:171], v64, s[16:19], s38 offen offset:0
buffer_load_dwordx4 v[76:79], v64, s[16:19], s38 offen offset:128
buffer_load_dwordx4 v[208:211], v64, s[16:19], s38 offen offset:256
wv 54
ds_write_b128 v65, a[4:7] offset:24576
ds_write_b128 v65, a[20:23] offset:28672
ds_write_b128 v65, a[28:31] offset:32768
ds_write_b128 v65, a[12:15] offset:36864
ds_write_b128 v65, v[28:31] offset:40960
ds_write_b128 v65, a[36:39] offset:45056
wl 0
s_barrier
tra 4,8,24576
tra 6,8,24832
tra 20,9,24576
tra 22,9,24832
tra 28,10,24576
tra 30,10,24832
tra 12,8,36864
tra 14,8,37120
ds_read_b64_tr_b16 v[28:29], v9 offset:36864
ds_read_b64_tr_b16 v[30:31], v9 offset:37120
tra 36,10,36864
tra 38,10,37120
wl 0
ds_write_b128 v19, v[28:31] offset:1024
sad 38,52,6684672
buffer_load_dwordx4 a[164:167], v64, s[12:15], s38 offen offset:0
buffer_load_dwordx4 v[116:119], v64, s[12:15], s38 offen offset:128
buffer_load_dwordx4 v[204:207], v64, s[12:15], s38 offen offset:256
buffer_load_dwordx4 a[172:175], v64, s[16:19], s38 offen offset:0
buffer_load_dwordx4 v[80:83], v64, s[16:19], s38 offen offset:128
buffer_load_dwordx4 v[212:215], v64, s[16:19], s38 offen offset:256
wv 54
ds_write_b128 v65, a[120:123] offset:0
ds_write_b128 v65, a[216:219] offset:4096
ds_write_b128 v65, v[160:163] offset:8192
ds_write_b128 v65, a[128:131] offset:12288
ds_write_b128 v65, v[68:71] offset:16384
ds_write_b128 v65, v[168:171] offset:20480
wl 0
s_barrier
tra 120,8,0
tra 122,8,256
tra 216,9,0
tra 218,9,256
ds_read_b64_tr_b16 v[160:161], v10 offset:0
ds_read_b64_tr_b16 v[162:163], v10 offset:256
tra 128,8,12288
tra 130,8,12544
ds_read_b64_tr_b16 v[68:69], v9 offset:12288
ds_read_b64_tr_b16 v[70:71], v9 offset:12544
ds_read_b64_tr_b16 v[168:169], v10 offset:12288
ds_read_b64_tr_b16 v[170:171], v10 offset:12544
wl 0
ds_write_b128 v19, v[68:71] offset:10240
sad 38,52,7077888
buffer_load_dwordx4 a[176:179], v64, s[12:15], s38 offen offset:0
buffer_load_dwordx4 v[120:123], v64, s[12:15], s38 offen offset:128
buffer_load_dwordx4 v[216:219], v64, s[12:15], s38 offen offset:256
buffer_load_dwordx4 v[56:59], v64, s[16:19], s38 offen offset:0
buffer_load_dwordx4 v[128:131], v64, s[16:19], s38 offen offset:128
buffer_load_dwordx4 v[224:227], v64, s[16:19], s38 offen offset:256
wv 54
ds_write_b128 v65, a[124:127] offset:24576
ds_write_b128 v65, a[220:223] offset:28672
ds_write_b128 v65, v[164:167] offset:32768
ds_write_b128 v65, a[132:135] offset:36864
ds_write_b128 v65, v[72:75] offset:40960
ds_write_b128 v65, v[172:175] offset:45056
wl 0
s_barrier
tra 124,8,24576
tra 126,8,24832
tra 220,9,24576
tra 222,9,24832
ds_read_b64_tr_b16 v[164:165], v10 offset:24576
ds_read_b64_tr_b16 v[166:167], v10 offset:24832
tra 132,8,36864
tra 134,8,37120
ds_read_b64_tr_b16 v[72:73], v9 offset:36864
ds_read_b64_tr_b16 v[74:75], v9 offset:37120
ds_read_b64_tr_b16 v[172:173], v10 offset:36864
ds_read_b64_tr_b16 v[174:175], v10 offset:37120
wl 0
ds_write_b128 v19, v[72:75] offset:11264
sad 38,52,7471104
buffer_load_dwordx4 a[180:183], v64, s[12:15], s38 offen offset:0
buffer_load_dwordx4 v[124:127], v64, s[12:15], s38 offen offset:128
buffer_load_dwordx4 v[220:223], v64, s[12:15], s38 offen offset:256
buffer_load_dwordx4 v[60:63], v64, s[16:19], s38 offen offset:0
buffer_load_dwordx4 v[132:135], v64, s[16:19], s38 offen offset:128
buffer_load_dwordx4 v[228:231], v64, s[16:19], s38 offen offset:256
wv 54
ds_write_b128 v65, a[136:139] offset:0
ds_write_b128 v65, a[224:227] offset:4096
ds_write_b128 v65, v[176:179] offset:8192
ds_write_b128 v65, v[48:51] offset:12288
ds_write_b128 v65, a[232:235] offset:16384
ds_write_b128 v65, v[184:187] offset:20480
wl 0
s_barrier
tra 136,8,0
tra 138,8,256
tra 224,9,0
tra 226,9,256
ds_read_b64_tr_b16 v[176:177], v10 offset:0
ds_read_b64_tr_b16 v[178:179], v10 offset:256
ds_read_b64_tr_b16 v[48:49], v8 offset:12288
ds_read_b64_tr_b16 v[50:51], v8 offset:12544
tra 232,9,12288
tra 234,9,12544
ds_read_b64_tr_b16 v[184:185], v10 offset:12288
ds_read_b64_tr_b16 v[186:187], v10 offset:12544
wl 0
ds_write_b128 v19, v[48:51] offset:6144
wv 48
ds_write_b128 v65, a[140:143] offset:24576
ds_write_b128 v65, a[228:231] offset:28672
ds_write_b128 v65, v[180:183] offset:32768
ds_write_b128 v65, v[52:55] offset:36864
ds_write_b128 v65, a[236:239] offset:40960
ds_write_b128 v65, v[188:191] offset:45056
wl 0
s_barrier
tra 140,8,24576
tra 142,8,24832
tra 228,9,24576
tra 230,9,24832
ds_read_b64_tr_b16 v[180:181], v10 offset:24576
ds_read_b64_tr_b16 v[182:183], v10 offset:24832
ds_read_b64_tr_b16 v[52:53], v8 offset:36864
ds_read_b64_tr_b16 v[54:55], v8 offset:37120
tra 236,9,36864
tra 238,9,37120
ds_read_b64_tr_b16 v[188:189], v10 offset:36864
ds_read_b64_tr_b16 v[190:191], v10 offset:37120
wl 0
ds_write_b128 v19, v[52:55] offset:7168
wv 42
ds_write_b128 v65, a[144:147] offset:0
ds_write_b128 v65, a[240:243] offset:4096
ds_write_b128 v65, v[192:195] offset:8192
ds_write_b128 v65, a[152:155] offset:12288
ds_write_b128 v65, a[248:251] offset:16384
ds_write_b128 v65, v[92:95] offset:20480
wl 0
s_barrier
tra 144,8,0
tra 146,8,256
tra 240,9,0
tra 242,9,256
ds_read_b64_tr_b16 v[192:193], v10 offset:0
ds_read_b64_tr_b16 v[194:195], v10 offset:256
tra 152,8,12288
tra 154,8,12544
tra 248,9,12288
tra 250,9,12544
ds_read_b64_tr_b16 v[92:93], v10 offset:12288
ds_read_b64_tr_b16 v[94:95], v10 offset:12544
wl 0
ds_write_b128 v19, v[92:95] offset:16384
wv 36
ds_write_b128 v65, a[148:151] offset:24576
ds_write_b128 v65, a[244:247] offset:28672
ds_write_b128 v65, v[196:199] offset:32768
ds_write_b128 v65, a[156:159] offset:36864
ds_write_b128 v65, a[252:255] offset:40960
ds_write_b128 v65, v[96:99] offset:45056
wl 0
s_barrier
tra 148,8,24576
tra 150,8,24832
tra 244,9,24576
tra 246,9,24832
ds_read_b64_tr_b16 v[196:197], v10 offset:24576
ds_read_b64_tr_b16 v[198:199], v10 offset:24832
tra 156,8,36864
tra 158,8,37120
tra 252,9,36864
tra 254,9,37120
ds_read_b64_tr_b16 v[96:97], v10 offset:36864
ds_read_b64_tr_b16 v[98:99], v10 offset:37120
wl 0
ds_write_b128 v19, v[96:99] offset:17408
wv 30
ds_write_b128 v65, a[40:43] offset:0
ds_write_b128 v65, a[56:59] offset:4096
ds_write_b128 v65, a[64:67] offset:8192
ds_write_b128 v65, a[48:51] offset:12288
ds_write_b128 v65, v[32:35] offset:16384
ds_write_b128 v65, a[72:75] offset:20480
wl 0
s_barrier
tra 40,8,0
tra 42,8,256
tra 56,9,0
tra 58,9,256
tra 64,10,0
tra 66,10,256
tra 48,8,12288
tra 50,8,12544
ds_read_b64_tr_b16 v[32:33], v9 offset:12288
ds_read_b64_tr_b16 v[34:35], v9 offset:12544
tra 72,10,12288
tra 74,10,12544
wl 0
ds_write_b128 v19, v[32:35] offset:2048
wv 24
ds_write_b128 v65, a[44:47] offset:24576
ds_write_b128 v65, a[60:63] offset:28672
ds_write_b128 v65, a[68:71] offset:32768
ds_write_b128 v65, a[52:55] offset:36864
ds_write_b128 v65, v[36:39] offset:40960
ds_write_b128 v65, a[76:79] offset:45056
wl 0
s_barrier
tra 44,8,24576
tra 46,8,24832
tra 60,9,24576
tra 62,9,24832
tra 68,10,24576
tra 70,10,24832
tra 52,8,36864
tra 54,8,37120
ds_read_b64_tr_b16 v[36:37], v9 offset:36864
ds_read_b64_tr_b16 v[38:39], v9 offset:37120
tra 76,10,36864
tra 78,10,37120
wl 0
ds_write_b128 v19, v[36:39] offset:3072
wv 18
ds_write_b128 v65, a[160:163] offset:0
ds_write_b128 v65, v[112:115] offset:4096
ds_write_b128 v65, v[200:203] offset:8192
ds_write_b128 v65, a[168:171] offset:12288
ds_write_b128 v65, v[76:79] offset:16384
ds_write_b128 v65, v[208:211] offset:20480
wl 0
s_barrier
tra 160,8,0
tra 162,8,256
ds_read_b64_tr_b16 v[112:113], v9 offset:0
ds_read_b64_tr_b16 v[114:115], v9 offset:256
ds_read_b64_tr_b16 v[200:201], v10 offset:0
ds_read_b64_tr_b16 v[202:203], v10 offset:256
tra 168,8,12288
tra 170,8,12544
ds_read_b64_tr_b16 v[76:77], v9 offset:12288
ds_read_b64_tr_b16 v[78:79], v9 offset:12544
ds_read_b64_tr_b16 v[208:209], v10 offset:12288
ds_read_b64_tr_b16 v[210:211], v10 offset:12544
wl 0
ds_write_b128 v19, v[76:79] offset:12288
wv 12
ds_write_b128 v65, a[164:167] offset:24576
ds_write_b128 v65, v[116:119] offset:28672
ds_write_b128 v65, v[204:207] offset:32768
ds_write_b128 v65, a[172:175] offset:36864
ds_write_b128 v65, v[80:83] offset:40960
ds_write_b128 v65, v[212:215] offset:45056
wl 0
s_barrier
tra 164,8,24576
tra 166,8,24832
ds_read_b64_tr_b16 v[116:117], v9 offset:24576
ds_read_b64_tr_b16 v[118:119], v9 offset:24832
ds_read_b64_tr_b16 v[204:205], v10 offset:24576
ds_read_b64_tr_b16 v[206:207], v10 offset:24832
tra 172,8,36864
tra 174,8,37120
ds_read_b64_tr_b16 v[80:81], v9 offset:36864
ds_read_b64_tr_b16 v[82:83], v9 offset:37120
ds_read_b64_tr_b16 v[212:213], v10 offset:36864
ds_read_b64_tr_b16 v[214:215], v10 offset:37120
wl 0
ds_write_b128 v19, v[80:83] offset:13312
wv 6
ds_write_b128 v65, a[176:179] offset:0
ds_write_b128 v65, v[120:123] offset:4096
ds_write_b128 v65, v[216:219] offset:8192
ds_write_b128 v65, v[56:59] offset:12288
ds_write_b128 v65, v[128:131] offset:16384
ds_write_b128 v65, v[224:227] offset:20480
wl 0
s_barrier
tra 176,8,0
tra 178,8,256
ds_read_b64_tr_b16 v[120:121], v9 offset:0
ds_read_b64_tr_b16 v[122:123], v9 offset:256
ds_read_b64_tr_b16 v[216:217], v10 offset:0
ds_read_b64_tr_b16 v[218:219], v10 offset:256
ds_read_b64_tr_b16 v[56:57], v8 offset:12288
ds_read_b64_tr_b16 v[58:59], v8 offset:12544
ds_read_b64_tr_b16 v[128:129], v9 offset:12288
ds_read_b64_tr_b16 v[130:131], v9 offset:12544
ds_read_b64_tr_b16 v[224:225], v10 offset:12288
ds_read_b64_tr_b16 v[226:227], v10 offset:12544
wl 0
ds_write_b128 v19, v[56:59] offset:8192
wv 0
ds_write_b128 v65, a[180:183] offset:24576
ds_write_b128 v65, v[124:127] offset:28672
ds_write_b128 v65, v[220:223] offset:32768
ds_write_b128 v65, v[60:63] offset:36864
ds_write_b128 v65, v[132:135] offset:40960
ds_write_b128 v65, v[228:231] offset:45056
wl 0
s_barrier
tra 180,8,24576
tra 182,8,24832
ds_read_b64_tr_b16 v[124:125], v9 offset:24576
ds_read_b64_tr_b16 v[126:127], v9 offset:24832
ds_read_b64_tr_b16 v[220:221], v10 offset:24576
ds_read_b64_tr_b16 v[222:223], v10 offset:24832
ds_read_b64_tr_b16 v[60:61], v8 offset:36864
ds_read_b64_tr_b16 v[62:63], v8 offset:37120
ds_read_b64_tr_b16 v[132:133], v9 offset:36864
ds_read_b64_tr_b16 v[134:135], v9 offset:37120
ds_read_b64_tr_b16 v[228:229], v10 offset:36864
ds_read_b64_tr_b16 v[230:231], v10 offset:37120
wl 0
ds_write_b128 v19, v[60:63] offset:9216
L_pd_3:
wl 0
s_barrier
sad 30,2,96
s_load_dwordx2 s[62:63], s[0:1], 0
s_load_dwordx2 s[64:65], s[0:1], 104
wl 0
s_mov_b32 s40, s62
s_and_b32 s41, s63, 0xffff
s_mov_b32 s42, 2621440
s_mov_b32 s43, 0x00020000
sad 44,64,8388608
s_addc_u32 s45, s65, 0
s_and_b32 s45, s45, 0xffff
s_mov_b32 s46, 2621440
s_mov_b32 s47, 0x00020000
v_lshrrev_b32 v1, 4, v0
v_and_b32 v2, 15, v0
v_mul_u32_u24 v3, 1280, v1
v_lshl_add_u32 v3, v2, 4, v3
s_mul_i32 s3, s30, 20480
buffer_load_dwordx4 v[8:11], v3, s[40:43], s3 offen offset:0
buffer_load_dwordx4 v[12:15], v3, s[40:43], s3 offen offset:256
buffer_load_dwordx4 v[16:19], v3, s[40:43], s3 offen offset:512
buffer_load_dwordx4 v[20:23], v3, s[40:43], s3 offen offset:768
buffer_load_dwordx4 v[24:27], v3, s[40:43], s3 offen offset:1024
wv 0
v_lshlrev_b32 v32, 16, v8
v_and_b32 v33, 0xffff0000, v8
v_lshlrev_b32 v34, 16, v9
v_and_b32 v35, 0xffff0000, v9
v_lshlrev_b32 v36, 16, v10
v_and_b32 v37, 0xffff0000, v10
v_lshlrev_b32 v38, 16, v11
v_and_b32 v39, 0xffff0000, v11
v_lshlrev_b32 v40, 16, v12
v_and_b32 v41, 0xffff0000, v12
v_lshlrev_b32 v42, 16, v13
v_and_b32 v43, 0xffff0000, v13
v_lshlrev_b32 v44, 16, v14
v_and_b32 v45, 0xffff0000, v14
v_lshlrev_b32 v46, 16, v15
v_and_b32 v47, 0xffff0000, v15
v_lshlrev_b32 v48, 16, v16
v_and_b32 v49, 0xffff0000, v16
v_lshlrev_b32 v50, 16, v17
v_and_b32 v51, 0xffff0000, v17
v_lshlrev_b32 v52, 16, v18
v_and_b32 v53, 0xffff0000, v18
v_lshlrev_b32 v54, 16, v19
v_and_b32 v55, 0xffff0000, v19
v_lshlrev_b32 v56, 16, v20
v_and_b32 v57, 0xffff0000, v20
v_lshlrev_b32 v58, 16, v21
v_and_b32 v59, 0xffff0000, v21
v_lshlrev_b32 v60, 16, v22
v_and_b32 v61, 0xffff0000, v22
v_lshlrev_b32 v62, 16, v23
v_and_b32 v63, 0xffff0000, v23
v_lshlrev_b32 v64, 16, v24
v_and_b32 v65, 0xffff0000, v24
v_lshlrev_b32 v66, 16, v25
v_and_b32 v67, 0xffff0000, v25
v_lshlrev_b32 v68, 16, v26
v_and_b32 v69, 0xffff0000, v26
v_lshlrev_b32 v70, 16, v27
v_and_b32 v71, 0xffff0000, v27
v_add_f32 v4, v32, v33
v_add_f32 v4, v4, v34
v_add_f32 v4, v4, v35
v_add_f32 v4, v4, v36
v_add_f32 v4, v4, v37
v_add_f32 v4, v4, v38
v_add_f32 v4, v4, v39
v_add_f32 v4, v4, v40
v_add_f32 v4, v4, v41
v_add_f32 v4, v4, v42
v_add_f32 v4, v4, v43
v_add_f32 v4, v4, v44
v_add_f32 v4, v4, v45
v_add_f32 v4, v4, v46
v_add_f32 v4, v4, v47
v_add_f32 v4, v4, v48
v_add_f32 v4, v4, v49
v_add_f32 v4, v4, v50
v_add_f32 v4, v4, v51
v_add_f32 v4, v4, v52
v_add_f32 v4, v4, v53
v_add_f32 v4, v4, v54
v_add_f32 v4, v4, v55
v_add_f32 v4, v4, v56
v_add_f32 v4, v4, v57
v_add_f32 v4, v4, v58
v_add_f32 v4, v4, v59
v_add_f32 v4, v4, v60
v_add_f32 v4, v4, v61
v_add_f32 v4, v4, v62
v_add_f32 v4, v4, v63
v_add_f32 v4, v4, v64
v_add_f32 v4, v4, v65
v_add_f32 v4, v4, v66
v_add_f32 v4, v4, v67
v_add_f32 v4, v4, v68
v_add_f32 v4, v4, v69
v_add_f32 v4, v4, v70
v_add_f32 v4, v4, v71
s_nop 1
v_add_f32_dpp v5, v4, v4 row_ror:8 row_mask:0xf bank_mask:0xf
v_mov_b32 v4, v5
s_nop 1
v_add_f32_dpp v5, v4, v4 row_ror:4 row_mask:0xf bank_mask:0xf
v_mov_b32 v4, v5
s_nop 1
v_add_f32_dpp v5, v4, v4 row_ror:2 row_mask:0xf bank_mask:0xf
v_mov_b32 v4, v5
s_nop 1
v_add_f32_dpp v5, v4, v4 row_ror:1 row_mask:0xf bank_mask:0xf
v_mov_b32 v4, v5
v_mul_f32 v4, 0x3acccccd, v4
v_mov_b32 v6, 0
v_sub_f32 v7, v32, v4
v_fmac_f32 v6, v7, v7
v_sub_f32 v7, v33, v4
v_fmac_f32 v6, v7, v7
v_sub_f32 v7, v34, v4
v_fmac_f32 v6, v7, v7
v_sub_f32 v7, v35, v4
v_fmac_f32 v6, v7, v7
v_sub_f32 v7, v36, v4
v_fmac_f32 v6, v7, v7
v_sub_f32 v7, v37, v4
v_fmac_f32 v6, v7, v7
v_sub_f32 v7, v38, v4
v_fmac_f32 v6, v7, v7
v_sub_f32 v7, v39, v4
v_fmac_f32 v6, v7, v7
v_sub_f32 v7, v40, v4
v_fmac_f32 v6, v7, v7
v_sub_f32 v7, v41, v4
v_fmac_f32 v6, v7, v7
v_sub_f32 v7, v42, v4
v_fmac_f32 v6, v7, v7
v_sub_f32 v7, v43, v4
v_fmac_f32 v6, v7, v7
v_sub_f32 v7, v44, v4
v_fmac_f32 v6, v7, v7
v_sub_f32 v7, v45, v4
v_fmac_f32 v6, v7, v7
v_sub_f32 v7, v46, v4
v_fmac_f32 v6, v7, v7
v_sub_f32 v7, v47, v4
v_fmac_f32 v6, v7, v7
v_sub_f32 v7, v48, v4
v_fmac_f32 v6, v7, v7
v_sub_f32 v7, v49, v4
v_fmac_f32 v6, v7, v7
v_sub_f32 v7, v50, v4
v_fmac_f32 v6, v7, v7
v_sub_f32 v7, v51, v4
v_fmac_f32 v6, v7, v7
v_sub_f32 v7, v52, v4
v_fmac_f32 v6, v7, v7
v_sub_f32 v7, v53, v4
v_fmac_f32 v6, v7, v7
v_sub_f32 v7, v54, v4
v_fmac_f32 v6, v7, v7
v_sub_f32 v7, v55, v4
v_fmac_f32 v6, v7, v7
v_sub_f32 v7, v56, v4
v_fmac_f32 v6, v7, v7
v_sub_f32 v7, v57, v4
v_fmac_f32 v6, v7, v7
v_sub_f32 v7, v58, v4
v_fmac_f32 v6, v7, v7
v_sub_f32 v7, v59, v4
v_fmac_f32 v6, v7, v7
v_sub_f32 v7, v60, v4
v_fmac_f32 v6, v7, v7
v_sub_f32 v7, v61, v4
v_fmac_f32 v6, v7, v7
v_sub_f32 v7, v62, v4
v_fmac_f32 v6, v7, v7
v_sub_f32 v7, v63, v4
v_fmac_f32 v6, v7, v7
v_sub_f32 v7, v64, v4
v_fmac_f32 v6, v7, v7
v_sub_f32 v7, v65, v4
v_fmac_f32 v6, v7, v7
v_sub_f32 v7, v66, v4
v_fmac_f32 v6, v7, v7
v_sub_f32 v7, v67, v4
v_fmac_f32 v6, v7, v7
v_sub_f32 v7, v68, v4
v_fmac_f32 v6, v7, v7
v_sub_f32 v7, v69, v4
v_fmac_f32 v6, v7, v7
v_sub_f32 v7, v70, v4
v_fmac_f32 v6, v7, v7
v_sub_f32 v7, v71, v4
v_fmac_f32 v6, v7, v7
s_nop 1
v_add_f32_dpp v5, v6, v6 row_ror:8 row_mask:0xf bank_mask:0xf
v_mov_b32 v6, v5
s_nop 1
v_add_f32_dpp v5, v6, v6 row_ror:4 row_mask:0xf bank_mask:0xf
v_mov_b32 v6, v5
s_nop 1
v_add_f32_dpp v5, v6, v6 row_ror:2 row_mask:0xf bank_mask:0xf
v_mov_b32 v6, v5
s_nop 1
v_add_f32_dpp v5, v6, v6 row_ror:1 row_mask:0xf bank_mask:0xf
v_mov_b32 v6, v5
v_mul_f32 v6, 0x3acccccd, v6
cvp 4,4,4
v_lshlrev_b32 v4, 16, v4
cvp 6,6,6
v_lshlrev_b32 v6, 16, v6
v_add_f32 v6, 0x3727c5ac, v6
cvp 6,6,6
v_lshlrev_b32 v6, 16, v6
v_sqrt_f32 v6, v6
s_nop 0
cvp 6,6,6
v_lshlrev_b32 v6, 16, v6
v_rcp_f32 v7, v6
s_nop 0
v_fma_f32 v5, -v6, v7, 2.0
v_mul_f32 v7, v7, v5
v_sub_f32 v32, v32, v4
v_sub_f32 v33, v33, v4
v_sub_f32 v34, v34, v4
v_sub_f32 v35, v35, v4
v_sub_f32 v36, v36, v4
v_sub_f32 v37, v37, v4
v_sub_f32 v38, v38, v4
v_sub_f32 v39, v39, v4
v_sub_f32 v40, v40, v4
v_sub_f32 v41, v41, v4
v_sub_f32 v42, v42, v4
v_sub_f32 v43, v43, v4
v_sub_f32 v44, v44, v4
v_sub_f32 v45, v45, v4
v_sub_f32 v46, v46, v4
v_sub_f32 v47, v47, v4
v_sub_f32 v48, v48, v4
v_sub_f32 v49, v49, v4
v_sub_f32 v50, v50, v4
v_sub_f32 v51, v51, v4
v_sub_f32 v52, v52, v4
v_sub_f32 v53, v53, v4
v_sub_f32 v54, v54, v4
v_sub_f32 v55, v55, v4
v_sub_f32 v56, v56, v4
v_sub_f32 v57, v57, v4
v_sub_f32 v58, v58, v4
v_sub_f32 v59, v59, v4
v_sub_f32 v60, v60, v4
v_sub_f32 v61, v61, v4
v_sub_f32 v62, v62, v4
v_sub_f32 v63, v63, v4
v_sub_f32 v64, v64, v4
v_sub_f32 v65, v65, v4
v_sub_f32 v66, v66, v4
v_sub_f32 v67, v67, v4
v_sub_f32 v68, v68, v4
v_sub_f32 v69, v69, v4
v_sub_f32 v70, v70, v4
v_sub_f32 v71, v71, v4
cvp 8,32,33
cvp 9,34,35
cvp 10,36,37
cvp 11,38,39
cvp 12,40,41
cvp 13,42,43
cvp 14,44,45
cvp 15,46,47
cvp 16,48,49
cvp 17,50,51
cvp 18,52,53
cvp 19,54,55
cvp 20,56,57
cvp 21,58,59
cvp 22,60,61
cvp 23,62,63
cvp 24,64,65
cvp 25,66,67
cvp 26,68,69
cvp 27,70,71
v_lshlrev_b32 v32, 16, v8
v_and_b32 v33, 0xffff0000, v8
v_lshlrev_b32 v34, 16, v9
v_and_b32 v35, 0xffff0000, v9
v_lshlrev_b32 v36, 16, v10
v_and_b32 v37, 0xffff0000, v10
v_lshlrev_b32 v38, 16, v11
v_and_b32 v39, 0xffff0000, v11
v_lshlrev_b32 v40, 16, v12
v_and_b32 v41, 0xffff0000, v12
v_lshlrev_b32 v42, 16, v13
v_and_b32 v43, 0xffff0000, v13
v_lshlrev_b32 v44, 16, v14
v_and_b32 v45, 0xffff0000, v14
v_lshlrev_b32 v46, 16, v15
v_and_b32 v47, 0xffff0000, v15
v_lshlrev_b32 v48, 16, v16
v_and_b32 v49, 0xffff0000, v16
v_lshlrev_b32 v50, 16, v17
v_and_b32 v51, 0xffff0000, v17
v_lshlrev_b32 v52, 16, v18
v_and_b32 v53, 0xffff0000, v18
v_lshlrev_b32 v54, 16, v19
v_and_b32 v55, 0xffff0000, v19
v_lshlrev_b32 v56, 16, v20
v_and_b32 v57, 0xffff0000, v20
v_lshlrev_b32 v58, 16, v21
v_and_b32 v59, 0xffff0000, v21
v_lshlrev_b32 v60, 16, v22
v_and_b32 v61, 0xffff0000, v22
v_lshlrev_b32 v62, 16, v23
v_and_b32 v63, 0xffff0000, v23
v_lshlrev_b32 v64, 16, v24
v_and_b32 v65, 0xffff0000, v24
v_lshlrev_b32 v66, 16, v25
v_and_b32 v67, 0xffff0000, v25
v_lshlrev_b32 v68, 16, v26
v_and_b32 v69, 0xffff0000, v26
v_lshlrev_b32 v70, 16, v27
v_and_b32 v71, 0xffff0000, v27
v_mul_f32 v5, v32, v7
v_fma_f32 v32, -v5, v6, v32
v_fma_f32 v32, v32, v7, v5
v_mul_f32 v5, v33, v7
v_fma_f32 v33, -v5, v6, v33
v_fma_f32 v33, v33, v7, v5
v_mul_f32 v5, v34, v7
v_fma_f32 v34, -v5, v6, v34
v_fma_f32 v34, v34, v7, v5
v_mul_f32 v5, v35, v7
v_fma_f32 v35, -v5, v6, v35
v_fma_f32 v35, v35, v7, v5
v_mul_f32 v5, v36, v7
v_fma_f32 v36, -v5, v6, v36
v_fma_f32 v36, v36, v7, v5
v_mul_f32 v5, v37, v7
v_fma_f32 v37, -v5, v6, v37
v_fma_f32 v37, v37, v7, v5
v_mul_f32 v5, v38, v7
v_fma_f32 v38, -v5, v6, v38
v_fma_f32 v38, v38, v7, v5
v_mul_f32 v5, v39, v7
v_fma_f32 v39, -v5, v6, v39
v_fma_f32 v39, v39, v7, v5
v_mul_f32 v5, v40, v7
v_fma_f32 v40, -v5, v6, v40
v_fma_f32 v40, v40, v7, v5
v_mul_f32 v5, v41, v7
v_fma_f32 v41, -v5, v6, v41
v_fma_f32 v41, v41, v7, v5
v_mul_f32 v5, v42, v7
v_fma_f32 v42, -v5, v6, v42
v_fma_f32 v42, v42, v7, v5
v_mul_f32 v5, v43, v7
v_fma_f32 v43, -v5, v6, v43
v_fma_f32 v43, v43, v7, v5
v_mul_f32 v5, v44, v7
v_fma_f32 v44, -v5, v6, v44
v_fma_f32 v44, v44, v7, v5
v_mul_f32 v5, v45, v7
v_fma_f32 v45, -v5, v6, v45
v_fma_f32 v45, v45, v7, v5
v_mul_f32 v5, v46, v7
v_fma_f32 v46, -v5, v6, v46
v_fma_f32 v46, v46, v7, v5
v_mul_f32 v5, v47, v7
v_fma_f32 v47, -v5, v6, v47
v_fma_f32 v47, v47, v7, v5
v_mul_f32 v5, v48, v7
v_fma_f32 v48, -v5, v6, v48
v_fma_f32 v48, v48, v7, v5
v_mul_f32 v5, v49, v7
v_fma_f32 v49, -v5, v6, v49
v_fma_f32 v49, v49, v7, v5
v_mul_f32 v5, v50, v7
v_fma_f32 v50, -v5, v6, v50
v_fma_f32 v50, v50, v7, v5
v_mul_f32 v5, v51, v7
v_fma_f32 v51, -v5, v6, v51
v_fma_f32 v51, v51, v7, v5
v_mul_f32 v5, v52, v7
v_fma_f32 v52, -v5, v6, v52
v_fma_f32 v52, v52, v7, v5
v_mul_f32 v5, v53, v7
v_fma_f32 v53, -v5, v6, v53
v_fma_f32 v53, v53, v7, v5
v_mul_f32 v5, v54, v7
v_fma_f32 v54, -v5, v6, v54
v_fma_f32 v54, v54, v7, v5
v_mul_f32 v5, v55, v7
v_fma_f32 v55, -v5, v6, v55
v_fma_f32 v55, v55, v7, v5
v_mul_f32 v5, v56, v7
v_fma_f32 v56, -v5, v6, v56
v_fma_f32 v56, v56, v7, v5
v_mul_f32 v5, v57, v7
v_fma_f32 v57, -v5, v6, v57
v_fma_f32 v57, v57, v7, v5
v_mul_f32 v5, v58, v7
v_fma_f32 v58, -v5, v6, v58
v_fma_f32 v58, v58, v7, v5
v_mul_f32 v5, v59, v7
v_fma_f32 v59, -v5, v6, v59
v_fma_f32 v59, v59, v7, v5
v_mul_f32 v5, v60, v7
v_fma_f32 v60, -v5, v6, v60
v_fma_f32 v60, v60, v7, v5
v_mul_f32 v5, v61, v7
v_fma_f32 v61, -v5, v6, v61
v_fma_f32 v61, v61, v7, v5
v_mul_f32 v5, v62, v7
v_fma_f32 v62, -v5, v6, v62
v_fma_f32 v62, v62, v7, v5
v_mul_f32 v5, v63, v7
v_fma_f32 v63, -v5, v6, v63
v_fma_f32 v63, v63, v7, v5
v_mul_f32 v5, v64, v7
v_fma_f32 v64, -v5, v6, v64
v_fma_f32 v64, v64, v7, v5
v_mul_f32 v5, v65, v7
v_fma_f32 v65, -v5, v6, v65
v_fma_f32 v65, v65, v7, v5
v_mul_f32 v5, v66, v7
v_fma_f32 v66, -v5, v6, v66
v_fma_f32 v66, v66, v7, v5
v_mul_f32 v5, v67, v7
v_fma_f32 v67, -v5, v6, v67
v_fma_f32 v67, v67, v7, v5
v_mul_f32 v5, v68, v7
v_fma_f32 v68, -v5, v6, v68
v_fma_f32 v68, v68, v7, v5
v_mul_f32 v5, v69, v7
v_fma_f32 v69, -v5, v6, v69
v_fma_f32 v69, v69, v7, v5
v_mul_f32 v5, v70, v7
v_fma_f32 v70, -v5, v6, v70
v_fma_f32 v70, v70, v7, v5
v_mul_f32 v5, v71, v7
v_fma_f32 v71, -v5, v6, v71
v_fma_f32 v71, v71, v7, v5
cvp 8,32,33
cvp 9,34,35
cvp 10,36,37
cvp 11,38,39
cvp 12,40,41
cvp 13,42,43
cvp 14,44,45
cvp 15,46,47
cvp 16,48,49
cvp 17,50,51
cvp 18,52,53
cvp 19,54,55
cvp 20,56,57
cvp 21,58,59
cvp 22,60,61
cvp 23,62,63
cvp 24,64,65
cvp 25,66,67
cvp 26,68,69
cvp 27,70,71
v_lshrrev_b32 v3, 2, v2
v_lshlrev_b32 v3, 10, v3
v_and_b32 v5, 1, v2
v_lshl_add_u32 v3, v5, 9, v3
v_bfe_u32 v5, v2, 1, 1
v_lshl_add_u32 v3, v5, 3, v3
v_lshl_add_u32 v3, v1, 4, v3
sad 48,3,0
buffer_store_dwordx2 v[8:9], v3, s[44:47], s48 offen sc1
buffer_store_dwordx2 v[10:11], v3, s[44:47], s48 offen offset:256 sc1
sad 48,3,4096
buffer_store_dwordx2 v[12:13], v3, s[44:47], s48 offen sc1
buffer_store_dwordx2 v[14:15], v3, s[44:47], s48 offen offset:256 sc1
sad 48,3,8192
buffer_store_dwordx2 v[16:17], v3, s[44:47], s48 offen sc1
buffer_store_dwordx2 v[18:19], v3, s[44:47], s48 offen offset:256 sc1
sad 48,3,12288
buffer_store_dwordx2 v[20:21], v3, s[44:47], s48 offen sc1
buffer_store_dwordx2 v[22:23], v3, s[44:47], s48 offen offset:256 sc1
sad 48,3,16384
buffer_store_dwordx2 v[24:25], v3, s[44:47], s48 offen sc1
buffer_store_dwordx2 v[26:27], v3, s[44:47], s48 offen offset:256 sc1
v_and_b32 v1, 63, v0
v_lshrrev_b32 v2, 6, v0
s_nop 0
v_readfirstlane_b32 s4, v2
v_lshlrev_b32 v20, 4, v1
sad 79,30,80
wv 0
s_barrier
s_cmp_lg_u32 s4, 1
s_cbranch_scc1 L_nf_8
s_lshl_b32 s83, s79, 7
v_and_b32 v2, 1, v1
v_cmp_eq_u32 vcc, 1, v2
v_mov_b32 v2, s100
v_mov_b32 v3, s101
v_cndmask_b32 v3, v2, v3, vcc
v_and_b32 v2, 31, v1
v_lshlrev_b32 v2, 2, v2
buffer_store_dword v3, v2, s[88:91], s83 offen sc1
L_nf_8:
s_load_dwordx2 s[36:37], s[0:1], 104
v_and_b32 v1, 63, v0
v_lshrrev_b32 v2, 6, v0
s_nop 0
v_readfirstlane_b32 s4, v2
v_lshlrev_b32 v7, 4, v1
v_bfe_u32 v2, v1, 3, 1
v_mul_u32_u24 v2, 0xaaaa, v2
v_add_u32 v6, 0x4444, v2
s_mov_b32 s42, 400000
s_mov_b32 s3, s2
wl 0
sad 8,36,0
s_addc_u32 s9, s37, 0
s_and_b32 s9, s9, 0xffff
s_mov_b32 s10, 8388608
s_mov_b32 s11, 0x00020000
sad 20,36,67108864
s_addc_u32 s21, s37, 0
s_and_b32 s21, s21, 0xffff
s_mov_b32 s22, 25165824
s_mov_b32 s23, 0x00020000
sad 24,36,100663296
s_addc_u32 s25, s37, 0
s_and_b32 s25, s25, 0xffff
s_mov_b32 s26, 25165824
s_mov_b32 s27, 0x00020000
sad 28,36,25165824
s_addc_u32 s29, s37, 0
s_and_b32 s29, s29, 0xffff
s_mov_b32 s30, 5242880
s_mov_b32 s31, 0x00020000
sad 32,36,11534336
s_addc_u32 s33, s37, 0
s_and_b32 s33, s33, 0xffff
s_mov_b32 s34, 294912
s_mov_b32 s35, 0x00020000
s_mul_i32 s54, s4, 20480
v_add_u32 v19, s54, v7
s_mul_i32 s38, s4, 1536
sad 38,38,131072
v_and_b32 v2, 15, v1
v_lshlrev_b32 v4, 5, v2
v_lshrrev_b32 v3, 4, v1
v_lshl_add_u32 v8, v3, 3, v4
v_add_u32 v8, s38, v8
v_lshlrev_b32 v9, 3, v1
v_add_u32 v9, 131072, v9
s_mul_i32 s38, s4, 1280
sad 38,38,137216
v_mul_u32_u24 v4, 160, v2
v_add_u32 v4, s38, v4
v_lshl_add_u32 v10, v3, 5, v4
v_add_u32 v10, 32, v10
v_lshl_add_u32 v11, v3, 4, v4
v_subrev_u32 v11, 32, v11
v_add_u32 v5, 142336, v7
v_cmp_gt_u32 vcc, 8, v2
s_nop 1
v_cndmask_b32 v10, v5, v10, vcc
v_cmp_le_u32 s[40:41], 2, v3
s_nop 1
s_and_b64 vcc, vcc, s[40:41]
s_nop 1
v_cndmask_b32 v11, v5, v11, vcc
s_lshl_b32 s38, s4, 2
v_add_u32 v4, s38, v3
v_min_u32 v5, 9, v2
v_mul_u32_u24 v12, 160, v4
v_lshl_add_u32 v12, v5, 4, v12
v_add_u32 v12, 137216, v12
v_cmp_gt_u32 vcc, 10, v2
v_mov_b32 v14, 0xf149f2ca
s_nop 0
v_cndmask_b32 v14, v14, 0, vcc
s_lshr_b32 s48, s3, 3
s_mul_i32 s48, s48, 5
s_and_b32 s50, s3, 3
s_bfe_u32 s51, s3, 0x10002
v_lshrrev_b32 v21, 1, v5
v_add_u32 v21, s48, v21
v_lshrrev_b32 v22, 3, v21
v_lshlrev_b32 v22, 14, v22
v_and_b32 v21, 7, v21
v_lshl_add_u32 v22, v21, 10, v22
s_lshl_b32 s38, s50, 1
s_add_u32 s38, s38, s51
s_lshl_b32 s38, s38, 7
sad 38,38,65536
v_add_u32 v22, s38, v22
v_lshl_add_u32 v22, v4, 4, v22
v_and_b32 v21, 1, v5
v_lshl_add_u32 v22, v21, 3, v22
v_mov_b32 v21, 0x7ffffff0
v_cndmask_b32 v13, v21, v22, vcc
s_lshl_b32 s38, s3, 7
sad 38,38,102400
v_lshrrev_b32 v22, 5, v1
v_lshlrev_b32 v22, 13, v22
v_add_u32 v22, s38, v22
v_mov_b32 v108, 0
v_and_b32 v107, 31, v1
v_lshl_add_u32 v107, v107, 2, v22
v_add_u32 v15, 81920, v7
v_lshlrev_b32 v16, 3, v1
v_add_u32 v16, 82944, v16
v_add_u32 v20, 1, v3
v_lshlrev_b32 v20, 12, v20
s_lshl_b32 s38, s48, 12
s_lshl_b32 s39, s51, 11
s_add_u32 s38, s38, s39
s_and_b32 s39, s4, 1
s_lshl_b32 s39, s39, 10
s_add_u32 s38, s38, s39
s_lshl_b32 s39, s50, 8
s_add_u32 s38, s38, s39
v_lshl_add_u32 v22, v2, 4, s38
v_add_u32 v17, v20, v22
v_lshl_add_u32 v18, v3, 3, v22
v_subrev_u32 v18, 16, v18
v_cmp_le_u32 vcc, 2, v3
s_nop 1
v_cndmask_b32 v18, v21, v18, vcc
s_mov_b64 s[66:67], vcc
s_and_b32 s39, s4, 1
s_lshl_b32 s39, s39, 4
v_add_u32 v20, s39, v2
v_lshlrev_b32 v21, 2, v3
v_add_u32 v22, 0, v21
v_cmp_le_u32 s[68:69], v22, v20
v_add_u32 v22, 1, v21
v_cmp_le_u32 s[70:71], v22, v20
v_add_u32 v22, 2, v21
v_cmp_le_u32 s[72:73], v22, v20
v_add_u32 v22, 3, v21
v_cmp_le_u32 s[74:75], v22, v20
v_add_u32 v22, 16, v21
v_cmp_le_u32 s[76:77], v22, v20
v_add_u32 v22, 17, v21
v_cmp_le_u32 s[78:79], v22, v20
v_add_u32 v22, 18, v21
v_cmp_le_u32 s[80:81], v22, v20
v_add_u32 v22, 19, v21
v_cmp_le_u32 s[82:83], v22, v20
v_lshlrev_b32 v20, 2, v3
v_sub_u32 v20, v2, v20
v_and_b32 v21, 1, v20
v_lshlrev_b32 v21, 4, v21
v_mov_b32 v22, 0x3f80
v_lshlrev_b32 v22, v21, v22
v_cmp_gt_u32 vcc, 4, v20
v_cmp_gt_u32 s[52:53], 2, v20
s_nop 1
v_cndmask_b32 v0, 0, v22, vcc
s_mov_b32 s56, 1037384597
s_mul_i32 s57, s3, 12288
s_mul_i32 s58, s4, 3072
sad 38,4,0
s_cmp_ge_u32 s38, 10
s_cselect_b32 s39, 10, 0
s_sub_u32 s38, s38, s39
s_lshr_b32 s39, s38, 3
s_lshl_b32 s39, s39, 14
s_and_b32 s38, s38, 7
s_lshl_b32 s38, s38, 10
s_add_u32 s60, s38, s39
sad 38,4,4
s_cmp_ge_u32 s38, 10
s_cselect_b32 s39, 10, 0
s_sub_u32 s38, s38, s39
s_lshr_b32 s39, s38, 3
s_lshl_b32 s39, s39, 14
s_and_b32 s38, s38, 7
s_lshl_b32 s38, s38, 10
s_add_u32 s61, s38, s39
sad 38,4,8
s_cmp_ge_u32 s38, 10
s_cselect_b32 s39, 10, 0
s_sub_u32 s38, s38, s39
s_lshr_b32 s39, s38, 3
s_lshl_b32 s39, s39, 14
s_and_b32 s38, s38, 7
s_lshl_b32 s38, s38, 10
s_add_u32 s62, s38, s39
v_lshrrev_b32 v20, 3, v1
v_mov_b32 v106, s60
v_mov_b32 v21, s61
v_mov_b32 v22, s62
v_cmp_eq_u32 vcc, 1, v20
s_nop 1
v_cndmask_b32 v106, v106, v21, vcc
v_cmp_le_u32 vcc, 2, v20
s_nop 1
v_cndmask_b32 v106, v106, v22, vcc
v_and_b32 v20, 7, v1
v_lshl_add_u32 v106, v20, 7, v106
v_add_u32 v106, 32768, v106
v_and_b32 v20, 31, v1
v_lshlrev_b32 v106, 7, v20
v_add_u32 v106, 102400, v106
s_lshl_b32 s38, s4, 10
sad 38,38,143616
v_add_u32 v104, s38, v7
s_cmp_eq_u32 s4, 2
s_cselect_b32 s39, 10240, 0
v_add_u32 v109, s39, v104
s_and_b32 s55, s4, 1
s_mul_i32 s55, s55, 6144
s_mov_b32 s5, 0
s_mov_b32 s84, 500
s_mov_b32 s65, 0
v_mov_b32 v2, 163808
v_mov_b32 v20, 0
v_mov_b32 v21, 0
ds_write_b64 v2, v[20:21]
sad 38,5,0
s_and_b32 s39, s38, 7
s_cmp_lg_u32 s39, 0
s_cbranch_scc1 L_gwd_9
s_cmp_ge_u32 s38, 64
s_cbranch_scc1 L_gwd_9
s_lshl_b32 s38, s38, 4
s_add_u32 s38, s38, s3
sad 38,38,640
s_lshl_b32 s39, s38, 7
v_min_u32 v3, 1, v1
v_mul_u32_u24 v3, 4096, v3
s_mov_b32 s43, 0
L_fw_10:
buffer_load_dwordx2 v[4:5], v3, s[32:35], s39 offen sc1
wv 0
v_xor_b32 v4, s100, v4
v_xor_b32 v5, s101, v5
v_or_b32 v4, v4, v5
v_cmp_ne_u32 vcc, 0, v4
sad 43,43,1
s_cbranch_vccz L_fwd_11
s_sleep 2
s_cmp_lt_u32 s43, 400000
s_cbranch_scc1 L_fw_10
L_fwd_11:
L_gwd_9:
sad 38,5,0
s_and_b32 s39, s38, 1
s_mul_i32 s39, s39, 24576
s_add_u32 s39, s39, s55
sad 39,39,81920
s_mul_i32 s38, s38, 393216
s_add_u32 s38, s38, s57
s_add_u32 s38, s38, s55
sad 40,38,3072
s_add_u32 m0, s39, 0
s_nop 0
buffer_load_dwordx4 v7, s[20:23], s38 offen offset:0 sc1 lds
buffer_load_dwordx4 v7, s[20:23], s38 offen offset:1024 sc1 lds
buffer_load_dwordx4 v7, s[20:23], s38 offen offset:2048 sc1 lds
s_add_u32 m0, s39, 3072
s_nop 0
buffer_load_dwordx4 v7, s[20:23], s40 offen offset:0 sc1 lds
buffer_load_dwordx4 v7, s[20:23], s40 offen offset:1024 sc1 lds
buffer_load_dwordx4 v7, s[20:23], s40 offen offset:2048 sc1 lds
s_add_u32 m0, s39, 12288
s_nop 0
buffer_load_dwordx4 v7, s[24:27], s38 offen offset:0 sc1 lds
buffer_load_dwordx4 v7, s[24:27], s38 offen offset:1024 sc1 lds
buffer_load_dwordx4 v7, s[24:27], s38 offen offset:2048 sc1 lds
s_add_u32 m0, s39, 15360
s_nop 0
buffer_load_dwordx4 v7, s[24:27], s40 offen offset:0 sc1 lds
buffer_load_dwordx4 v7, s[24:27], s40 offen offset:1024 sc1 lds
buffer_load_dwordx4 v7, s[24:27], s40 offen offset:2048 sc1 lds
s_mov_b32 s39, 26624
v_min_u32 v3, 31, v1
v_mul_u32_u24 v3, 128, v3
s_mov_b32 s43, 0
L_fw_12:
buffer_load_dwordx2 v[4:5], v3, s[32:35], s39 offen sc1
wv 0
v_xor_b32 v4, s100, v4
v_xor_b32 v5, s101, v5
v_or_b32 v4, v4, v5
v_cmp_ne_u32 vcc, 0, v4
sad 43,43,1
s_cbranch_vccz L_fwd_13
s_sleep 4
s_cmp_lt_u32 s43, 400000
s_cbranch_scc1 L_fw_12
L_fwd_13:
s_mov_b32 s39, 65536
v_min_u32 v3, 15, v1
v_mul_u32_u24 v3, 128, v3
s_mov_b32 s43, 0
L_fw_14:
buffer_load_dwordx2 v[4:5], v3, s[32:35], s39 offen sc1
wv 0
v_xor_b32 v4, s100, v4
v_xor_b32 v5, s101, v5
v_or_b32 v4, v4, v5
v_cmp_ne_u32 vcc, 0, v4
sad 43,43,1
s_cbranch_vccz L_fwd_15
s_sleep 4
s_cmp_lt_u32 s43, 400000
s_cbranch_scc1 L_fw_14
L_fwd_15:
v_lshlrev_b32 v2, 7, v1
s_lshl_b32 s38, s4, 4
sad 38,38,63488
sad 39,38,2048
buffer_load_dwordx4 v[24:27], v2, s[32:35], s38 offen sc1
buffer_load_dwordx4 v[28:31], v2, s[32:35], s39 offen sc1
s_getreg_b32 s40, hwreg(HW_REG_XCC_ID)
s_and_b32 s40, s40, 7
v_mov_b32 v32, -1
wv 0
v_xor_b32 v24, s100, v24
v_xor_b32 v25, s101, v25
v_xor_b32 v26, s40, v26
v_or3_b32 v24, v24, v25, v26
v_cmp_eq_u32 vcc, 0, v24
s_nop 1
v_cndmask_b32 v27, v32, v27, vcc
v_and_b32 v24, 0xffff, v27
v_lshrrev_b32 v25, 16, v27
v_xor_b32 v28, s100, v28
v_xor_b32 v29, s101, v29
v_xor_b32 v30, s40, v30
v_or3_b32 v28, v28, v29, v30
v_cmp_eq_u32 vcc, 0, v28
s_nop 1
v_cndmask_b32 v31, v32, v31, vcc
v_and_b32 v28, 0xffff, v31
v_lshrrev_b32 v29, 16, v31
v_min_u32 v24, v24, v28
v_min_u32 v25, v25, v29
s_nop 1
v_min_u32_dpp v24, v24, v24 row_ror:8 row_mask:0xf bank_mask:0xf
s_nop 1
v_min_u32_dpp v24, v24, v24 row_ror:4 row_mask:0xf bank_mask:0xf
s_nop 1
v_min_u32_dpp v24, v24, v24 row_ror:2 row_mask:0xf bank_mask:0xf
s_nop 1
v_min_u32_dpp v24, v24, v24 row_ror:1 row_mask:0xf bank_mask:0xf
s_nop 0
v_readlane_b32 s44, v24, 0
v_readlane_b32 s45, v24, 16
v_readlane_b32 s46, v24, 32
v_readlane_b32 s47, v24, 48
s_min_u32 s44, s44, s45
s_min_u32 s46, s46, s47
s_min_u32 s40, s44, s46
s_nop 1
v_min_u32_dpp v25, v25, v25 row_ror:8 row_mask:0xf bank_mask:0xf
s_nop 1
v_min_u32_dpp v25, v25, v25 row_ror:4 row_mask:0xf bank_mask:0xf
s_nop 1
v_min_u32_dpp v25, v25, v25 row_ror:2 row_mask:0xf bank_mask:0xf
s_nop 1
v_min_u32_dpp v25, v25, v25 row_ror:1 row_mask:0xf bank_mask:0xf
s_nop 0
v_readlane_b32 s44, v25, 0
v_readlane_b32 s45, v25, 16
v_readlane_b32 s46, v25, 32
v_readlane_b32 s47, v25, 48
s_min_u32 s44, s44, s45
s_min_u32 s46, s46, s47
s_min_u32 s41, s44, s46
v_mov_b32 v2, 163824
s_cmp_lt_u32 s41, s40
s_cselect_b32 s38, 1, 0
s_lshl_b32 s38, s38, s4
v_mov_b32 v3, s38
s_lshl_b32 s39, s4, 2
sad 39,39,163824
v_mov_b32 v4, s39
ds_write_b32 v4, v3
wl 0
s_barrier
ds_read_b128 v[24:27], v2
wl 0
v_or_b32 v24, v24, v25
v_or3_b32 v24, v24, v26, v27
s_nop 0
v_readfirstlane_b32 s6, v24
s_branch L_qk_16
.p2align 6
L_qk_16:
v_mov_b32 v64, 0
v_mov_b32 v65, 0
v_mov_b32 v66, 0
v_mov_b32 v67, 0
v_mov_b32 v68, 0
v_mov_b32 v69, 0
v_mov_b32 v70, 0
v_mov_b32 v71, 0
v_mov_b32 v72, 0
v_mov_b32 v73, 0
v_mov_b32 v74, 0
v_mov_b32 v75, 0
v_mov_b32 v76, 0
v_mov_b32 v77, 0
v_mov_b32 v78, 0
v_mov_b32 v79, 0
v_mov_b32 v80, 0
v_mov_b32 v81, 0
v_mov_b32 v82, 0
v_mov_b32 v83, 0
v_mov_b32 v84, 0
v_mov_b32 v85, 0
v_mov_b32 v86, 0
v_mov_b32 v87, 0
ds_read_b128 v[88:91], v19 offset:0
ds_read_b128 v[92:95], v19 offset:1024
ds_read_b128 v[96:99], v19 offset:2048
ds_read_b128 v[100:103], v19 offset:3072
s_and_b32 s59, s5, 1
s_mul_i32 s59, s59, 24576
s_add_u32 s38, s59, s58
v_add_u32 v20, s38, v15
v_add_u32 v21, s38, v16
s_mul_i32 s38, s4, 1536
v_add_u32 v22, s38, v9
v_cndmask_b32 v4, 0, v0, s[52:53]
v_cndmask_b32 v5, v0, 0, s[52:53]
v_lshlrev_b32 v23, 7, v1
v_add_u32 v23, 32768, v23
s_lshr_b32 s38, s5, 4
s_lshr_b32 s38, s6, s38
s_and_b32 s38, s38, 1
s_lshl_b32 s38, s38, 13
s_lshl_b32 s7, s5, 17
s_add_u32 s7, s7, s38
s_add_u32 s39, s7, s60
s_add_u32 s40, s7, s61
s_add_u32 s41, s7, s62
s_lshl_b32 s63, s5, 17
wl 0
s_cmp_eq_u32 s5, 0
s_cbranch_scc1 L_s0_17
s_cmp_eq_u32 s4, 1
s_cbranch_scc1 L_tg_19
v_mov_b32 v2, 163808
s_mov_b32 s43, 0
L_rd_18:
ds_read_b64 v[24:25], v2
wl 0
v_readfirstlane_b32 s85, v24
v_readfirstlane_b32 s44, v25
sad 43,43,1
s_cmp_eq_u32 s44, s5
s_cbranch_scc1 L_tg_19
s_cmp_lt_u32 s43, 100000
s_cbranch_scc1 L_rd_18
L_tg_19:
sad 43,85,62
L_wu_20:
s_memrealtime s[12:13]
wl 0
s_mul_i32 s12, s12, 6
s_sub_u32 s12, s43, s12
s_cmp_gt_i32 s12, 2400
s_cbranch_scc1 L_wud_21
s_cmp_lt_i32 s12, 150
s_cbranch_scc1 L_wf_22
s_sleep 1
s_branch L_wu_20
L_wf_22:
s_cmp_lt_i32 s12, 40
s_cbranch_scc1 L_wud_21
s_memrealtime s[12:13]
s_nop 2
s_memrealtime s[14:15]
s_nop 2
s_memrealtime s[16:17]
s_nop 2
s_memrealtime s[18:19]
s_nop 2
s_memrealtime s[44:45]
s_nop 2
s_memrealtime s[46:47]
s_nop 2
wl 0
s_add_u32 s12, s12, s14
s_add_u32 s16, s16, s18
s_add_u32 s44, s44, s46
s_add_u32 s12, s12, s16
s_add_u32 s12, s12, s44
s_sub_u32 s12, s43, s12
s_sub_u32 s12, s12, 50
L_wl_23:
s_sub_u32 s12, s12, 8
s_cmp_gt_i32 s12, 0
s_cbranch_scc1 L_wl_23
L_wud_21:
L_s0_17:
s_mov_b32 s43, 0
L_poll_24:
buffer_load_dwordx4 v[24:27], v7, s[8:11], s39 offen offset:0 sc1
buffer_load_dwordx4 v[28:31], v7, s[8:11], s40 offen offset:0 sc1
buffer_load_dwordx4 v[32:35], v7, s[8:11], s41 offen offset:0 sc1
wv 2
v_max3_u32 v2, v24, v25, v26
v_max_u32 v2, v2, v27
wv 1
v_max3_u32 v2, v2, v28, v29
v_max3_u32 v2, v2, v30, v31
wv 0
v_max3_u32 v2, v2, v32, v33
v_max3_u32 v2, v2, v34, v35
v_cmp_eq_u32 vcc, -1, v2
sad 43,43,1
s_cbranch_vccnz L_rt_26
L_pd_25:
ds_write_b128 v104, v[24:27]
v_smfmac_f32_16x16x64_bf16 v[64:67], v[24:27], a[0:7], v6
ds_write_b128 v104, v[28:31] offset:4096
v_smfmac_f32_16x16x64_bf16 v[68:71], v[24:27], a[8:15], v6
ds_write_b128 v104, v[32:35] offset:8192
v_smfmac_f32_16x16x64_bf16 v[72:75], v[24:27], a[16:23], v6
ds_write_b128 v109, v[24:27]
v_smfmac_f32_16x16x64_bf16 v[76:79], v[24:27], v[88:95], v6
ds_read_b128 v[88:91], v19 offset:4096
v_smfmac_f32_16x16x64_bf16 v[80:83], v[24:27], a[24:31], v6
ds_read_b128 v[92:95], v19 offset:5120
v_smfmac_f32_16x16x64_bf16 v[84:87], v[24:27], a[32:39], v6
v_smfmac_f32_16x16x64_bf16 v[64:67], v[28:31], a[40:47], v6
v_smfmac_f32_16x16x64_bf16 v[68:71], v[28:31], a[48:55], v6
wl 2
s_barrier
v_smfmac_f32_16x16x64_bf16 v[72:75], v[28:31], a[56:63], v6
s_memrealtime s[12:13]
ds_read_b128 v[36:39], v104 offset:1024
v_smfmac_f32_16x16x64_bf16 v[76:79], v[28:31], v[96:103], v6
s_memrealtime s[14:15]
ds_read_b128 v[40:43], v104 offset:2048
v_smfmac_f32_16x16x64_bf16 v[80:83], v[28:31], a[64:71], v6
s_memrealtime s[16:17]
ds_read_b128 v[44:47], v104 offset:3072
v_smfmac_f32_16x16x64_bf16 v[84:87], v[28:31], a[72:79], v6
s_memrealtime s[18:19]
ds_read_b128 v[48:51], v104 offset:5120
v_smfmac_f32_16x16x64_bf16 v[64:67], v[32:35], a[80:87], v6
s_memrealtime s[44:45]
ds_read_b128 v[52:55], v104 offset:6144
v_smfmac_f32_16x16x64_bf16 v[68:71], v[32:35], a[88:95], v6
s_memrealtime s[46:47]
ds_read_b128 v[56:59], v104 offset:7168
v_smfmac_f32_16x16x64_bf16 v[72:75], v[32:35], a[96:103], v6
ds_read_b128 v[60:63], v104 offset:9216
wl 7
v_smfmac_f32_16x16x64_bf16 v[76:79], v[32:35], v[88:95], v6
ds_read_b128 v[96:99], v19 offset:6144
v_smfmac_f32_16x16x64_bf16 v[80:83], v[32:35], a[104:111], v6
ds_read_b128 v[100:103], v19 offset:7168
v_smfmac_f32_16x16x64_bf16 v[84:87], v[32:35], a[112:119], v6
ds_read_b128 v[88:91], v19 offset:8192
wl 9
v_smfmac_f32_16x16x64_bf16 v[64:67], v[36:39], a[120:127], v6
ds_read_b128 v[92:95], v19 offset:9216
v_smfmac_f32_16x16x64_bf16 v[68:71], v[36:39], a[128:135], v6
s_cmp_lg_u32 s4, 0
s_cbranch_scc1 L_fl_27
wl 0
s_add_u32 s12, s12, s14
s_add_u32 s16, s16, s18
s_add_u32 s44, s44, s46
s_add_u32 s12, s12, s16
s_add_u32 s65, s12, s44
s_add_u32 s44, s65, s84
s_and_b32 s44, s44, -2
v_mov_b32 v3, s44
buffer_store_dword v3, v107, s[8:11], s63 offen sc1
L_fl_27:
wl 9
v_smfmac_f32_16x16x64_bf16 v[64:67], v[40:43], a[136:143], v6
wl 2
v_smfmac_f32_16x16x64_bf16 v[68:71], v[40:43], v[96:103], v6
ds_read_b128 v[96:99], v19 offset:10240
v_smfmac_f32_16x16x64_bf16 v[64:67], v[44:47], a[144:151], v6
ds_read_b128 v[100:103], v19 offset:11264
v_smfmac_f32_16x16x64_bf16 v[68:71], v[44:47], a[152:159], v6
ds_read_b128 v[28:31], v20
v_smfmac_f32_16x16x64_bf16 v[64:67], v[48:51], a[160:167], v6
ds_read_b128 v[32:35], v20 offset:1536
v_smfmac_f32_16x16x64_bf16 v[68:71], v[48:51], a[168:175], v6
ds_read_b64 v[110:111], v21
v_smfmac_f32_16x16x64_bf16 v[64:67], v[52:55], a[176:183], v6
wl 5
v_smfmac_f32_16x16x64_bf16 v[68:71], v[52:55], v[88:95], v6
ds_read_b128 v[88:91], v19 offset:12288
v_smfmac_f32_16x16x64_bf16 v[64:67], v[56:59], a[184:191], v6
ds_read_b128 v[92:95], v19 offset:13312
v_smfmac_f32_16x16x64_bf16 v[68:71], v[56:59], a[192:199], v6
v_smfmac_f32_16x16x64_bf16 v[64:67], v[60:63], a[200:207], v6
v_smfmac_f32_16x16x64_bf16 v[68:71], v[60:63], a[208:215], v6
v_smfmac_f32_16x16x64_bf16 v[72:75], v[36:39], a[216:223], v6
wl 5
v_smfmac_f32_16x16x64_bf16 v[76:79], v[36:39], v[96:103], v6
ds_read_b128 v[96:99], v19 offset:14336
v_smfmac_f32_16x16x64_bf16 v[72:75], v[40:43], a[224:231], v6
ds_read_b128 v[100:103], v19 offset:15360
v_smfmac_f32_16x16x64_bf16 v[76:79], v[40:43], a[232:239], v6
v_permlane32_swap_b32 v64, v68
v_smfmac_f32_16x16x64_bf16 v[72:75], v[44:47], a[240:247], v6
v_permlane32_swap_b32 v65, v69
v_smfmac_f32_16x16x64_bf16 v[76:79], v[44:47], a[248:255], v6
v_permlane32_swap_b32 v66, v70
v_smfmac_f32_16x16x64_bf16 v[72:75], v[48:51], v[112:119], v6
v_permlane32_swap_b32 v67, v71
wl 2
v_smfmac_f32_16x16x64_bf16 v[76:79], v[48:51], v[88:95], v6
v_add_f32 v64, v64, v68
v_smfmac_f32_16x16x64_bf16 v[72:75], v[52:55], v[120:127], v6
v_add_f32 v65, v65, v69
v_smfmac_f32_16x16x64_bf16 v[76:79], v[52:55], v[128:135], v6
v_add_f32 v66, v66, v70
v_smfmac_f32_16x16x64_bf16 v[72:75], v[56:59], v[136:143], v6
v_add_f32 v67, v67, v71
v_smfmac_f32_16x16x64_bf16 v[76:79], v[56:59], v[144:151], v6
cvp 68,64,65
v_smfmac_f32_16x16x64_bf16 v[72:75], v[60:63], v[152:159], v6
cvp 69,66,67
wl 0
v_smfmac_f32_16x16x64_bf16 v[76:79], v[60:63], v[96:103], v6
ds_write_b64 v8, v[68:69] offset:0
v_smfmac_f32_16x16x64_bf16 v[80:83], v[36:39], v[160:167], v6
ds_read_b128 v[88:91], v19 offset:16384
v_smfmac_f32_16x16x64_bf16 v[84:87], v[36:39], v[168:175], v6
ds_read_b128 v[92:95], v19 offset:17408
v_smfmac_f32_16x16x64_bf16 v[80:83], v[40:43], v[176:183], v6
ds_read_b128 v[96:99], v19 offset:18432
ds_read_b128 v[100:103], v19 offset:19456
v_smfmac_f32_16x16x64_bf16 v[84:87], v[40:43], v[184:191], v6
v_permlane32_swap_b32 v72, v76
v_permlane32_swap_b32 v73, v77
v_smfmac_f32_16x16x64_bf16 v[80:83], v[44:47], v[192:199], v6
v_permlane32_swap_b32 v74, v78
v_permlane32_swap_b32 v75, v79
wl 2
v_smfmac_f32_16x16x64_bf16 v[84:87], v[44:47], v[88:95], v6
v_add_f32 v72, v72, v76
v_add_f32 v73, v73, v77
v_smfmac_f32_16x16x64_bf16 v[80:83], v[48:51], v[200:207], v6
v_add_f32 v74, v74, v78
v_add_f32 v75, v75, v79
v_smfmac_f32_16x16x64_bf16 v[84:87], v[48:51], v[208:215], v6
cvp 76,72,73
cvp 77,74,75
v_smfmac_f32_16x16x64_bf16 v[80:83], v[52:55], v[216:223], v6
s_cmp_lg_u32 s4, 1
s_cbranch_scc1 L_r1_28
buffer_load_dword v105, v106, s[8:11], s7 offen sc1
buffer_load_dword v108, v23, s[8:11], s7 offen sc1
L_r1_28:
ds_write_b64 v8, v[76:77] offset:512
ds_read_b64_tr_b16 v[24:25], v22
v_smfmac_f32_16x16x64_bf16 v[84:87], v[52:55], v[224:231], v6
ds_read_b64_tr_b16 v[26:27], v22 offset:512
ds_read_b64 v[36:37], v21 offset:1536
v_smfmac_f32_16x16x64_bf16 v[80:83], v[56:59], v[232:239], v6
wl 4
v_smfmac_f32_16x16x64_bf16 v[84:87], v[56:59], v[96:103], v6
v_smfmac_f32_16x16x64_bf16 v[80:83], v[60:63], v[240:247], v6
v_smfmac_f32_16x16x64_bf16 v[84:87], v[60:63], v[248:255], v6
wl 1
v_mfma_f32_16x16x32_bf16 v[64:67], v[24:27], v[24:27], 0
v_mfma_f32_16x16x32_bf16 v[68:71], v[28:31], v[24:27], 0
s_nop 3
v_permlane32_swap_b32 v80, v84
v_permlane32_swap_b32 v81, v85
v_permlane32_swap_b32 v82, v86
v_permlane32_swap_b32 v83, v87
v_mfma_f32_16x16x32_bf16 v[72:75], v[32:35], v[24:27], 0
v_add_f32 v80, v80, v84
v_add_f32 v81, v81, v85
v_add_f32 v82, v82, v86
v_add_f32 v83, v83, v87
cvp 84,80,81
cvp 85,82,83
s_nop 0
ds_write_b64 v8, v[84:85] offset:1024
v_mfma_f32_16x16x16_bf16 v[40:43], v[84:85], v[4:5], 0
s_mov_b32 s40, 0x00ff00ff
s_mov_b32 s41, 0x00ff00ff
wl 1
s_nop 5
cvp 76,40,41
cvp 77,42,43
s_nop 1
v_mfma_f32_16x16x16_bf16 v[64:67], v[76:77], v[76:77], v[64:67]
v_mfma_f32_16x16x16_bf16 v[68:71], v[110:111], v[76:77], v[68:71]
v_mfma_f32_16x16x16_bf16 v[72:75], v[36:37], v[76:77], v[72:75]
s_nop 4
s_mov_b64 exec, s[40:41]
ds_write_b128 v11, v[64:67]
ds_write_b128 v10, v[68:71]
ds_write_b128 v10, v[72:75] offset:16
s_mov_b64 exec, -1
wl 0
s_barrier
s_cmp_ge_u32 s4, 2
s_cbranch_scc1 L_qkx_29
ds_read_b128 v[24:27], v12 offset:0
ds_read_b128 v[28:31], v12 offset:1280
ds_read_b128 v[32:35], v12 offset:2560
ds_read_b128 v[36:39], v12 offset:3840
s_xor_b32 s39, s7, 8192
wl 2
v_pk_add_f32 v[24:25], v[24:25], v[28:29]
v_pk_add_f32 v[26:27], v[26:27], v[30:31]
wl 0
v_pk_add_f32 v[32:33], v[32:33], v[36:37]
v_pk_add_f32 v[34:35], v[34:35], v[38:39]
v_pk_add_f32 v[24:25], v[24:25], v[32:33]
v_pk_add_f32 v[26:27], v[26:27], v[34:35]
v_max3_f32 v28, v24, v25, v26
v_max_f32 v28, v28, v27
s_nop 1
v_max_f32_dpp v28, v28, v28 row_ror:8 row_mask:0xf bank_mask:0xf
s_nop 1
v_max_f32_dpp v28, v28, v28 row_ror:4 row_mask:0xf bank_mask:0xf
s_nop 1
v_max_f32_dpp v28, v28, v28 row_ror:2 row_mask:0xf bank_mask:0xf
s_nop 1
v_max_f32_dpp v28, v28, v28 row_ror:1 row_mask:0xf bank_mask:0xf
v_sub_f32 v24, v24, v28
v_sub_f32 v25, v25, v28
v_sub_f32 v26, v26, v28
v_sub_f32 v27, v27, v28
v_fma_f32 v24, v24, s56, v14
v_fma_f32 v25, v25, s56, v14
v_fma_f32 v26, v26, s56, v14
v_fma_f32 v27, v27, s56, v14
v_exp_f32 v24, v24
v_exp_f32 v25, v25
v_exp_f32 v26, v26
v_exp_f32 v27, v27
v_add_f32 v28, v24, v25
v_add_f32 v29, v26, v27
v_add_f32 v28, v28, v29
s_nop 1
v_add_f32_dpp v28, v28, v28 row_ror:8 row_mask:0xf bank_mask:0xf
s_nop 1
v_add_f32_dpp v28, v28, v28 row_ror:4 row_mask:0xf bank_mask:0xf
s_nop 1
v_add_f32_dpp v28, v28, v28 row_ror:2 row_mask:0xf bank_mask:0xf
s_nop 1
v_add_f32_dpp v28, v28, v28 row_ror:1 row_mask:0xf bank_mask:0xf
v_rcp_f32 v28, v28
s_nop 0
v_mul_f32 v24, v24, v28
v_mul_f32 v25, v25, v28
v_mul_f32 v26, v26, v28
v_mul_f32 v27, v27, v28
cvp 30,24,25
cvp 31,26,27
v_min_u32 v30, -2, v30
v_min_u32 v31, -2, v31
buffer_store_dwordx2 v[30:31], v13, s[8:11], s7 offen sc1
buffer_store_dwordx2 v[30:31], v13, s[8:11], s39 offen sc1
s_cmp_eq_u32 s4, 1
s_cbranch_scc1 L_w1_31
s_memrealtime s[12:13]
s_nop 2
s_memrealtime s[14:15]
s_nop 2
s_memrealtime s[16:17]
s_nop 2
s_memrealtime s[18:19]
s_nop 2
s_memrealtime s[44:45]
s_nop 2
s_memrealtime s[46:47]
s_nop 2
wl 0
s_add_u32 s12, s12, s14
s_add_u32 s16, s16, s18
s_add_u32 s44, s44, s46
s_add_u32 s12, s12, s16
s_add_u32 s44, s12, s44
s_sub_u32 s44, s44, s65
s_sub_u32 s84, s84, 12
s_max_i32 s84, s84, s44
s_min_i32 s84, s84, 580
s_branch L_w2_32
L_w1_31:
wv 2
s_mov_b32 s43, 0
v_mov_b32 v3, v105
s_branch L_tfc_35
L_tf_33:
s_sleep 1
buffer_load_dword v3, v106, s[8:11], s7 offen sc1
wv 0
L_tfc_35:
v_cmp_eq_u32 vcc, -1, v3
sad 43,43,1
s_cbranch_vccnz L_rt_36
L_tfd_34:
v_readfirstlane_b32 s85, v3
s_nop 0
v_subrev_u32 v3, s85, v3
s_nop 1
v_max_i32_dpp v3, v3, v3 row_ror:8 row_mask:0xf bank_mask:0xf
s_nop 1
v_max_i32_dpp v3, v3, v3 row_ror:4 row_mask:0xf bank_mask:0xf
s_nop 1
v_max_i32_dpp v3, v3, v3 row_ror:2 row_mask:0xf bank_mask:0xf
s_nop 1
v_max_i32_dpp v3, v3, v3 row_ror:1 row_mask:0xf bank_mask:0xf
s_nop 0
v_readlane_b32 s44, v3, 0
v_readlane_b32 s45, v3, 16
s_max_i32 s44, s44, s45
s_add_u32 s85, s85, s44
s_nop 1
v_max_i32_dpp v108, v108, v108 row_ror:8 row_mask:0xf bank_mask:0xf
s_nop 1
v_max_i32_dpp v108, v108, v108 row_ror:4 row_mask:0xf bank_mask:0xf
s_nop 1
v_max_i32_dpp v108, v108, v108 row_ror:2 row_mask:0xf bank_mask:0xf
s_nop 1
v_max_i32_dpp v108, v108, v108 row_ror:1 row_mask:0xf bank_mask:0xf
s_nop 0
v_readlane_b32 s44, v108, 0
v_readlane_b32 s45, v108, 16
v_readlane_b32 s46, v108, 32
v_readlane_b32 s47, v108, 48
s_max_i32 s44, s44, s45
s_max_i32 s46, s46, s47
s_max_i32 s44, s44, s46
s_add_u32 s85, s85, s44
sad 44,5,1
v_mov_b32 v24, s85
v_mov_b32 v25, s44
v_mov_b32 v2, 163808
ds_write_b64 v2, v[24:25]
L_w2_32:
sad 38,5,1
s_and_b32 s39, s38, 7
s_cmp_lg_u32 s39, 0
s_cbranch_scc1 L_gwd_37
s_cmp_ge_u32 s38, 64
s_cbranch_scc1 L_gwd_37
s_lshl_b32 s38, s38, 4
s_add_u32 s38, s38, s3
sad 38,38,640
s_lshl_b32 s39, s38, 7
v_min_u32 v3, 1, v1
v_mul_u32_u24 v3, 4096, v3
s_mov_b32 s43, 0
L_fw_38:
buffer_load_dwordx2 v[4:5], v3, s[32:35], s39 offen sc1
wv 0
v_xor_b32 v4, s100, v4
v_xor_b32 v5, s101, v5
v_or_b32 v4, v4, v5
v_cmp_ne_u32 vcc, 0, v4
sad 43,43,1
s_cbranch_vccz L_fwd_39
s_sleep 2
s_cmp_lt_u32 s43, 400000
s_cbranch_scc1 L_fw_38
L_fwd_39:
L_gwd_37:
sad 38,5,1
s_and_b32 s39, s38, 1
s_mul_i32 s39, s39, 24576
s_add_u32 s39, s39, s55
sad 39,39,81920
s_mul_i32 s38, s38, 393216
s_add_u32 s38, s38, s57
s_add_u32 s38, s38, s55
sad 40,38,3072
s_add_u32 m0, s39, 0
s_nop 0
buffer_load_dwordx4 v7, s[20:23], s38 offen offset:0 sc1 lds
buffer_load_dwordx4 v7, s[20:23], s38 offen offset:1024 sc1 lds
buffer_load_dwordx4 v7, s[20:23], s38 offen offset:2048 sc1 lds
s_add_u32 m0, s39, 3072
s_nop 0
buffer_load_dwordx4 v7, s[20:23], s40 offen offset:0 sc1 lds
buffer_load_dwordx4 v7, s[20:23], s40 offen offset:1024 sc1 lds
buffer_load_dwordx4 v7, s[20:23], s40 offen offset:2048 sc1 lds
s_add_u32 m0, s39, 12288
s_nop 0
buffer_load_dwordx4 v7, s[24:27], s38 offen offset:0 sc1 lds
buffer_load_dwordx4 v7, s[24:27], s38 offen offset:1024 sc1 lds
buffer_load_dwordx4 v7, s[24:27], s38 offen offset:2048 sc1 lds
s_add_u32 m0, s39, 15360
s_nop 0
buffer_load_dwordx4 v7, s[24:27], s40 offen offset:0 sc1 lds
buffer_load_dwordx4 v7, s[24:27], s40 offen offset:1024 sc1 lds
buffer_load_dwordx4 v7, s[24:27], s40 offen offset:2048 sc1 lds
s_branch L_qkj_30
L_qkx_29:
s_and_b32 s39, s4, 1
s_mul_i32 s39, s39, 1536
s_add_u32 s39, s39, s59
v_add_u32 v20, s59, v15
v_add_u32 v21, s59, v16
v_add_u32 v22, s39, v15
v_add_u32 v23, s39, v16
ds_read_b128 v[24:27], v22 offset:12288
ds_read_b64_tr_b16 v[28:29], v9 offset:0
ds_read_b64_tr_b16 v[30:31], v9 offset:512
ds_read_b128 v[32:35], v20 offset:0
ds_read_b128 v[36:39], v20 offset:1536
ds_read_b64 v[40:41], v23 offset:12288
ds_read_b64_tr_b16 v[42:43], v9 offset:1024
ds_read_b64 v[44:45], v21 offset:0
ds_read_b64 v[46:47], v21 offset:1536
ds_read_b128 v[78:81], v22 offset:15360
ds_read_b64_tr_b16 v[82:83], v9 offset:1536
ds_read_b64_tr_b16 v[84:85], v9 offset:2048
ds_read_b128 v[86:89], v20 offset:3072
ds_read_b128 v[90:93], v20 offset:4608
ds_read_b64 v[94:95], v23 offset:15360
ds_read_b64_tr_b16 v[96:97], v9 offset:2560
ds_read_b64 v[98:99], v21 offset:3072
ds_read_b64 v[100:101], v21 offset:4608
wl 9
v_mfma_f32_16x16x32_bf16 v[64:67], v[28:31], v[24:27], 0
v_mfma_f32_16x16x32_bf16 v[68:71], v[32:35], v[24:27], 0
v_mfma_f32_16x16x32_bf16 v[72:75], v[36:39], v[24:27], 0
s_nop 3
v_mfma_f32_16x16x16_bf16 v[64:67], v[42:43], v[40:41], v[64:67]
v_mfma_f32_16x16x16_bf16 v[68:71], v[44:45], v[40:41], v[68:71]
v_mfma_f32_16x16x16_bf16 v[72:75], v[46:47], v[40:41], v[72:75]
s_nop 3
ds_read_b128 v[24:27], v22 offset:18432
ds_read_b64_tr_b16 v[28:29], v9 offset:3072
ds_read_b64_tr_b16 v[30:31], v9 offset:3584
ds_read_b128 v[32:35], v20 offset:6144
ds_read_b128 v[36:39], v20 offset:7680
ds_read_b64 v[40:41], v23 offset:18432
ds_read_b64_tr_b16 v[42:43], v9 offset:4096
ds_read_b64 v[44:45], v21 offset:6144
ds_read_b64 v[46:47], v21 offset:7680
wl 9
mfx 64,82,78
mfx 68,86,78
mfx 72,90,78
s_nop 3
v_mfma_f32_16x16x16_bf16 v[64:67], v[96:97], v[94:95], v[64:67]
v_mfma_f32_16x16x16_bf16 v[68:71], v[98:99], v[94:95], v[68:71]
v_mfma_f32_16x16x16_bf16 v[72:75], v[100:101], v[94:95], v[72:75]
s_nop 3
ds_read_b128 v[78:81], v22 offset:21504
ds_read_b64_tr_b16 v[82:83], v9 offset:4608
ds_read_b64_tr_b16 v[84:85], v9 offset:5120
ds_read_b128 v[86:89], v20 offset:9216
ds_read_b128 v[90:93], v20 offset:10752
ds_read_b64 v[94:95], v23 offset:21504
ds_read_b64_tr_b16 v[96:97], v9 offset:5632
ds_read_b64 v[98:99], v21 offset:9216
ds_read_b64 v[100:101], v21 offset:10752
wl 9
mfx 64,28,24
mfx 68,32,24
mfx 72,36,24
s_nop 3
v_mfma_f32_16x16x16_bf16 v[64:67], v[42:43], v[40:41], v[64:67]
v_mfma_f32_16x16x16_bf16 v[68:71], v[44:45], v[40:41], v[68:71]
v_mfma_f32_16x16x16_bf16 v[72:75], v[46:47], v[40:41], v[72:75]
s_nop 3
wl 0
mfx 64,82,78
mfx 68,86,78
mfx 72,90,78
s_nop 3
v_mfma_f32_16x16x16_bf16 v[64:67], v[96:97], v[94:95], v[64:67]
v_mfma_f32_16x16x16_bf16 v[68:71], v[98:99], v[94:95], v[68:71]
v_mfma_f32_16x16x16_bf16 v[72:75], v[100:101], v[94:95], v[72:75]
s_nop 3
s_nop 3
v_mov_b32 v24, 0xf149f2ca
v_mul_f32 v64, s56, v64
v_mul_f32 v65, s56, v65
v_mul_f32 v66, s56, v66
v_mul_f32 v67, s56, v67
v_mul_f32 v68, s56, v68
v_mul_f32 v69, s56, v69
v_mul_f32 v70, s56, v70
v_mul_f32 v71, s56, v71
v_mul_f32 v72, s56, v72
v_mul_f32 v73, s56, v73
v_mul_f32 v74, s56, v74
v_mul_f32 v75, s56, v75
v_cndmask_b32 v64, v24, v64, s[66:67]
v_cndmask_b32 v65, v24, v65, s[66:67]
v_cndmask_b32 v66, v24, v66, s[66:67]
v_cndmask_b32 v67, v24, v67, s[66:67]
v_cndmask_b32 v68, v24, v68, s[68:69]
v_cndmask_b32 v69, v24, v69, s[70:71]
v_cndmask_b32 v70, v24, v70, s[72:73]
v_cndmask_b32 v71, v24, v71, s[74:75]
v_cndmask_b32 v72, v24, v72, s[76:77]
v_cndmask_b32 v73, v24, v73, s[78:79]
v_cndmask_b32 v74, v24, v74, s[80:81]
v_cndmask_b32 v75, v24, v75, s[82:83]
v_max3_f32 v25, v64, v65, v66
v_max3_f32 v25, v25, v67, v68
v_max3_f32 v25, v25, v69, v70
v_max3_f32 v25, v25, v71, v72
v_max3_f32 v25, v25, v73, v74
v_max_f32 v25, v25, v75
v_mov_b32 v26, v25
v_mov_b32 v27, v25
s_nop 1
v_permlane32_swap_b32 v26, v27
s_nop 0
v_max_f32 v25, v26, v27
v_mov_b32 v26, v25
v_mov_b32 v27, v25
s_nop 1
v_permlane16_swap_b32 v26, v27
s_nop 0
v_max_f32 v25, v26, v27
v_sub_f32 v64, v64, v25
v_sub_f32 v65, v65, v25
v_sub_f32 v66, v66, v25
v_sub_f32 v67, v67, v25
v_sub_f32 v68, v68, v25
v_sub_f32 v69, v69, v25
v_sub_f32 v70, v70, v25
v_sub_f32 v71, v71, v25
v_sub_f32 v72, v72, v25
v_sub_f32 v73, v73, v25
v_sub_f32 v74, v74, v25
v_sub_f32 v75, v75, v25
v_exp_f32 v64, v64
v_exp_f32 v65, v65
v_exp_f32 v66, v66
v_exp_f32 v67, v67
v_exp_f32 v68, v68
v_exp_f32 v69, v69
v_exp_f32 v70, v70
v_exp_f32 v71, v71
v_exp_f32 v72, v72
v_exp_f32 v73, v73
v_exp_f32 v74, v74
v_exp_f32 v75, v75
s_nop 0
v_add_f32 v25, v64, v65
v_add_f32 v25, v25, v66
v_add_f32 v25, v25, v67
v_add_f32 v25, v25, v68
v_add_f32 v25, v25, v69
v_add_f32 v25, v25, v70
v_add_f32 v25, v25, v71
v_add_f32 v25, v25, v72
v_add_f32 v25, v25, v73
v_add_f32 v25, v25, v74
v_add_f32 v25, v25, v75
v_mov_b32 v26, v25
v_mov_b32 v27, v25
s_nop 1
v_permlane32_swap_b32 v26, v27
s_nop 0
v_add_f32 v25, v26, v27
v_mov_b32 v26, v25
v_mov_b32 v27, v25
s_nop 1
v_permlane16_swap_b32 v26, v27
s_nop 0
v_add_f32 v25, v26, v27
v_rcp_f32 v25, v25
s_nop 0
v_mul_f32 v64, v64, v25
v_mul_f32 v65, v65, v25
v_mul_f32 v66, v66, v25
v_mul_f32 v67, v67, v25
v_mul_f32 v68, v68, v25
v_mul_f32 v69, v69, v25
v_mul_f32 v70, v70, v25
v_mul_f32 v71, v71, v25
v_mul_f32 v72, v72, v25
v_mul_f32 v73, v73, v25
v_mul_f32 v74, v74, v25
v_mul_f32 v75, v75, v25
cvp 34,64,65
cvp 35,66,67
cvp 30,68,69
cvp 31,70,71
cvp 32,72,73
cvp 33,74,75
s_mul_i32 s38, s5, 81920
buffer_store_dwordx4 v[30:33], v17, s[28:31], s38 offen sc1
buffer_store_dwordx2 v[34:35], v18, s[28:31], s38 offen sc1
L_qkj_30:
sad 5,5,1
s_cmp_lt_u32 s5, 64
s_cbranch_scc1 L_qk_16
wv 0
s_barrier
sad 39,3,1792
s_lshl_b32 s38, s39, 7
v_and_b32 v2, 1, v1
v_cmp_eq_u32 vcc, 1, v2
v_mov_b32 v2, s100
v_mov_b32 v3, s101
v_cndmask_b32 v3, v2, v3, vcc
v_and_b32 v2, 31, v1
v_lshlrev_b32 v2, 2, v2
buffer_store_dword v3, v2, s[32:35], s38 offen sc1
s_endpgm
L_rt_26:
s_cmp_lt_u32 s43, s42
s_cbranch_scc1 L_poll_24
s_mov_b32 s42, 0
s_branch L_pd_25
L_rt_36:
s_cmp_lt_u32 s43, s42
s_cbranch_scc1 L_tf_33
s_mov_b32 s42, 0
s_branch L_tfd_34
L_notqk:
s_cmp_lt_u32 s2, 128
s_cbranch_scc1 L_recside
s_sub_u32 s3, s2, 64
s_cmp_lt_u32 s2, 160
s_cbranch_scc1 L_wvo
s_getpc_b64 s[80:81]
L_tr_40:
s_add_u32 s80, s80, L_qtab-L_tr_40
s_addc_u32 s81, s81, 0
s_and_b32 s76, s2, 7
s_mov_b32 s77, 0
s_mov_b32 s92, 0
s_mov_b32 s70, -1
s_mov_b32 s68, 0
s_load_dwordx2 s[36:37], s[0:1], 104
s_load_dwordx2 s[42:43], s[0:1], 40
v_and_b32 v1, 63, v0
v_lshrrev_b32 v2, 6, v0
s_nop 0
v_readfirstlane_b32 s4, v2
v_lshlrev_b32 v20, 4, v1
v_lshrrev_b32 v2, 4, v1
v_bfe_u32 v3, v1, 2, 2
v_lshlrev_b32 v4, 2, v2
v_add_u32 v4, v4, v3
v_lshlrev_b32 v4, 7, v4
v_and_b32 v5, 3, v1
v_lshl_add_u32 v4, v5, 3, v4
v_lshrrev_b32 v3, 1, v3
v_and_b32 v2, 1, v2
v_lshl_or_b32 v3, v2, 1, v3
v_xor_b32 v2, 0, v3
v_lshl_add_u32 v8, v2, 5, v4
v_xor_b32 v2, 1, v3
v_lshl_add_u32 v9, v2, 5, v4
v_xor_b32 v2, 2, v3
v_lshl_add_u32 v10, v2, 5, v4
v_xor_b32 v2, 3, v3
v_lshl_add_u32 v11, v2, 5, v4
v_add_u32 v12, 49152, v8
v_add_u32 v24, 98304, v8
v_add_u32 v13, 49152, v9
v_add_u32 v25, 98304, v9
v_add_u32 v14, 49152, v10
v_add_u32 v26, 98304, v10
v_add_u32 v15, 49152, v11
v_add_u32 v27, 98304, v11
s_lshl_b32 s29, s4, 11
v_lshrrev_b32 v2, 3, v1
v_lshrrev_b32 v3, 1, v2
v_bfe_u32 v4, v1, 1, 2
v_xor_b32 v4, v4, v3
v_and_b32 v5, 1, v1
v_lshl_or_b32 v4, v4, 1, v5
v_lshlrev_b32 v4, 4, v4
s_lshl_b32 s32, s4, 4
sad 32,32,0
v_add_u32 v2, s32, v2
s_mov_b32 s33, 12288
v_mul_lo_u32 v2, v2, s33
v_add_u32 v6, v2, v4
v_lshrrev_b32 v2, 3, v1
v_lshrrev_b32 v3, 1, v2
v_bfe_u32 v4, v1, 1, 2
v_xor_b32 v4, v4, v3
v_and_b32 v5, 1, v1
v_lshl_or_b32 v4, v4, 1, v5
v_lshlrev_b32 v4, 4, v4
s_lshl_b32 s32, s4, 4
sad 32,32,8
v_add_u32 v2, s32, v2
s_mov_b32 s33, 12288
v_mul_lo_u32 v2, v2, s33
v_add_u32 v7, v2, v4
v_mov_b32 v28, v6
v_mov_b32 v29, v7
v_lshrrev_b32 v2, 3, v1
v_lshrrev_b32 v3, 1, v2
v_bfe_u32 v4, v1, 1, 2
v_xor_b32 v4, v4, v3
v_and_b32 v5, 1, v1
v_lshl_or_b32 v4, v4, 1, v5
v_lshlrev_b32 v4, 4, v4
s_lshl_b32 s32, s4, 4
sad 32,32,0
v_add_u32 v2, s32, v2
s_mov_b32 s33, 1280
v_mul_lo_u32 v2, v2, s33
v_add_u32 v6, v2, v4
v_lshrrev_b32 v2, 3, v1
v_lshrrev_b32 v3, 1, v2
v_bfe_u32 v4, v1, 1, 2
v_xor_b32 v4, v4, v3
v_and_b32 v5, 1, v1
v_lshl_or_b32 v4, v4, 1, v5
v_lshlrev_b32 v4, 4, v4
s_lshl_b32 s32, s4, 4
sad 32,32,8
v_add_u32 v2, s32, v2
s_mov_b32 s33, 1280
v_mul_lo_u32 v2, v2, s33
v_add_u32 v7, v2, v4
v_mov_b32 v30, v6
v_mov_b32 v31, v7
v_lshrrev_b32 v2, 3, v1
v_lshrrev_b32 v3, 1, v2
v_bfe_u32 v4, v1, 1, 2
v_xor_b32 v4, v4, v3
v_and_b32 v5, 1, v1
v_lshl_or_b32 v4, v4, 1, v5
v_lshlrev_b32 v4, 4, v4
s_lshl_b32 s32, s4, 4
sad 32,32,0
v_add_u32 v2, s32, v2
s_mov_b32 s33, 3072
v_mul_lo_u32 v2, v2, s33
v_add_u32 v6, v2, v4
v_lshrrev_b32 v2, 3, v1
v_lshrrev_b32 v3, 1, v2
v_bfe_u32 v4, v1, 1, 2
v_xor_b32 v4, v4, v3
v_and_b32 v5, 1, v1
v_lshl_or_b32 v4, v4, 1, v5
v_lshlrev_b32 v4, 4, v4
s_lshl_b32 s32, s4, 4
sad 32,32,8
v_add_u32 v2, s32, v2
s_mov_b32 s33, 3072
v_mul_lo_u32 v2, v2, s33
v_add_u32 v7, v2, v4
v_mov_b32 v22, v6
v_mov_b32 v23, v7
wl 0
sad 8,36,8388608
s_addc_u32 s9, s37, 0
s_and_b32 s9, s9, 0xffff
s_mov_b32 s10, 2621440
s_mov_b32 s11, 0x00020000
sad 52,36,8388608
s_addc_u32 s53, s37, 0
s_and_b32 s53, s53, 0xffff
s_mov_b32 s54, 2621440
s_mov_b32 s55, 0x00020000
sad 56,36,8388608
s_addc_u32 s57, s37, 0
s_and_b32 s57, s57, 0xffff
s_mov_b32 s58, 2621440
s_mov_b32 s59, 0x00020000
sad 16,36,8388608
s_addc_u32 s17, s37, 0
s_and_b32 s17, s17, 0xffff
s_mov_b32 s18, 2621440
s_mov_b32 s19, 0x00020000
sad 20,36,8388608
s_addc_u32 s21, s37, 0
s_and_b32 s21, s21, 0xffff
s_mov_b32 s22, 2621440
s_mov_b32 s23, 0x00020000
s_mov_b32 s12, s42
s_and_b32 s13, s43, 0xffff
s_mov_b32 s14, 7864320
s_mov_b32 s15, 0x00020000
s_cmp_lt_u32 s2, 160
s_cbranch_scc1 L_noearly
s_sub_u32 s78, s2, 160
s_lshr_b32 s78, s78, 3
s_sub_u32 s78, s78, 12
s_mov_b32 s72, -1
s_getpc_b64 s[50:51]
L_c_41:
s_add_u32 s50, s50, L_sched-L_c_41
s_addc_u32 s51, s51, 0
s_swappc_b64 s[74:75], s[50:51]
L_noearly:
s_sub_u32 s30, s2, 128
s_xor_b32 s30, s30, 127
v_mov_b32 v100, v6
v_mov_b32 v101, v7
s_load_dwordx2 s[62:63], s[0:1], 0
s_load_dwordx2 s[64:65], s[0:1], 104
wl 0
s_mov_b32 s40, s62
s_and_b32 s41, s63, 0xffff
s_mov_b32 s42, 2621440
s_mov_b32 s43, 0x00020000
sad 44,64,8388608
s_addc_u32 s45, s65, 0
s_and_b32 s45, s45, 0xffff
s_mov_b32 s46, 2621440
s_mov_b32 s47, 0x00020000
v_lshrrev_b32 v1, 4, v0
v_and_b32 v2, 15, v0
v_mul_u32_u24 v3, 1280, v1
v_lshl_add_u32 v3, v2, 4, v3
s_mul_i32 s3, s30, 20480
buffer_load_dwordx4 v[8:11], v3, s[40:43], s3 offen offset:0
buffer_load_dwordx4 v[12:15], v3, s[40:43], s3 offen offset:256
buffer_load_dwordx4 v[16:19], v3, s[40:43], s3 offen offset:512
buffer_load_dwordx4 v[20:23], v3, s[40:43], s3 offen offset:768
buffer_load_dwordx4 v[24:27], v3, s[40:43], s3 offen offset:1024
wv 0
v_lshlrev_b32 v32, 16, v8
v_and_b32 v33, 0xffff0000, v8
v_lshlrev_b32 v34, 16, v9
v_and_b32 v35, 0xffff0000, v9
v_lshlrev_b32 v36, 16, v10
v_and_b32 v37, 0xffff0000, v10
v_lshlrev_b32 v38, 16, v11
v_and_b32 v39, 0xffff0000, v11
v_lshlrev_b32 v40, 16, v12
v_and_b32 v41, 0xffff0000, v12
v_lshlrev_b32 v42, 16, v13
v_and_b32 v43, 0xffff0000, v13
v_lshlrev_b32 v44, 16, v14
v_and_b32 v45, 0xffff0000, v14
v_lshlrev_b32 v46, 16, v15
v_and_b32 v47, 0xffff0000, v15
v_lshlrev_b32 v48, 16, v16
v_and_b32 v49, 0xffff0000, v16
v_lshlrev_b32 v50, 16, v17
v_and_b32 v51, 0xffff0000, v17
v_lshlrev_b32 v52, 16, v18
v_and_b32 v53, 0xffff0000, v18
v_lshlrev_b32 v54, 16, v19
v_and_b32 v55, 0xffff0000, v19
v_lshlrev_b32 v56, 16, v20
v_and_b32 v57, 0xffff0000, v20
v_lshlrev_b32 v58, 16, v21
v_and_b32 v59, 0xffff0000, v21
v_lshlrev_b32 v60, 16, v22
v_and_b32 v61, 0xffff0000, v22
v_lshlrev_b32 v62, 16, v23
v_and_b32 v63, 0xffff0000, v23
v_lshlrev_b32 v64, 16, v24
v_and_b32 v65, 0xffff0000, v24
v_lshlrev_b32 v66, 16, v25
v_and_b32 v67, 0xffff0000, v25
v_lshlrev_b32 v68, 16, v26
v_and_b32 v69, 0xffff0000, v26
v_lshlrev_b32 v70, 16, v27
v_and_b32 v71, 0xffff0000, v27
v_add_f32 v4, v32, v33
v_add_f32 v4, v4, v34
v_add_f32 v4, v4, v35
v_add_f32 v4, v4, v36
v_add_f32 v4, v4, v37
v_add_f32 v4, v4, v38
v_add_f32 v4, v4, v39
v_add_f32 v4, v4, v40
v_add_f32 v4, v4, v41
v_add_f32 v4, v4, v42
v_add_f32 v4, v4, v43
v_add_f32 v4, v4, v44
v_add_f32 v4, v4, v45
v_add_f32 v4, v4, v46
v_add_f32 v4, v4, v47
v_add_f32 v4, v4, v48
v_add_f32 v4, v4, v49
v_add_f32 v4, v4, v50
v_add_f32 v4, v4, v51
v_add_f32 v4, v4, v52
v_add_f32 v4, v4, v53
v_add_f32 v4, v4, v54
v_add_f32 v4, v4, v55
v_add_f32 v4, v4, v56
v_add_f32 v4, v4, v57
v_add_f32 v4, v4, v58
v_add_f32 v4, v4, v59
v_add_f32 v4, v4, v60
v_add_f32 v4, v4, v61
v_add_f32 v4, v4, v62
v_add_f32 v4, v4, v63
v_add_f32 v4, v4, v64
v_add_f32 v4, v4, v65
v_add_f32 v4, v4, v66
v_add_f32 v4, v4, v67
v_add_f32 v4, v4, v68
v_add_f32 v4, v4, v69
v_add_f32 v4, v4, v70
v_add_f32 v4, v4, v71
s_nop 1
v_add_f32_dpp v5, v4, v4 row_ror:8 row_mask:0xf bank_mask:0xf
v_mov_b32 v4, v5
s_nop 1
v_add_f32_dpp v5, v4, v4 row_ror:4 row_mask:0xf bank_mask:0xf
v_mov_b32 v4, v5
s_nop 1
v_add_f32_dpp v5, v4, v4 row_ror:2 row_mask:0xf bank_mask:0xf
v_mov_b32 v4, v5
s_nop 1
v_add_f32_dpp v5, v4, v4 row_ror:1 row_mask:0xf bank_mask:0xf
v_mov_b32 v4, v5
v_mul_f32 v4, 0x3acccccd, v4
v_mov_b32 v6, 0
v_sub_f32 v7, v32, v4
v_fmac_f32 v6, v7, v7
v_sub_f32 v7, v33, v4
v_fmac_f32 v6, v7, v7
v_sub_f32 v7, v34, v4
v_fmac_f32 v6, v7, v7
v_sub_f32 v7, v35, v4
v_fmac_f32 v6, v7, v7
v_sub_f32 v7, v36, v4
v_fmac_f32 v6, v7, v7
v_sub_f32 v7, v37, v4
v_fmac_f32 v6, v7, v7
v_sub_f32 v7, v38, v4
v_fmac_f32 v6, v7, v7
v_sub_f32 v7, v39, v4
v_fmac_f32 v6, v7, v7
v_sub_f32 v7, v40, v4
v_fmac_f32 v6, v7, v7
v_sub_f32 v7, v41, v4
v_fmac_f32 v6, v7, v7
v_sub_f32 v7, v42, v4
v_fmac_f32 v6, v7, v7
v_sub_f32 v7, v43, v4
v_fmac_f32 v6, v7, v7
v_sub_f32 v7, v44, v4
v_fmac_f32 v6, v7, v7
v_sub_f32 v7, v45, v4
v_fmac_f32 v6, v7, v7
v_sub_f32 v7, v46, v4
v_fmac_f32 v6, v7, v7
v_sub_f32 v7, v47, v4
v_fmac_f32 v6, v7, v7
v_sub_f32 v7, v48, v4
v_fmac_f32 v6, v7, v7
v_sub_f32 v7, v49, v4
v_fmac_f32 v6, v7, v7
v_sub_f32 v7, v50, v4
v_fmac_f32 v6, v7, v7
v_sub_f32 v7, v51, v4
v_fmac_f32 v6, v7, v7
v_sub_f32 v7, v52, v4
v_fmac_f32 v6, v7, v7
v_sub_f32 v7, v53, v4
v_fmac_f32 v6, v7, v7
v_sub_f32 v7, v54, v4
v_fmac_f32 v6, v7, v7
v_sub_f32 v7, v55, v4
v_fmac_f32 v6, v7, v7
v_sub_f32 v7, v56, v4
v_fmac_f32 v6, v7, v7
v_sub_f32 v7, v57, v4
v_fmac_f32 v6, v7, v7
v_sub_f32 v7, v58, v4
v_fmac_f32 v6, v7, v7
v_sub_f32 v7, v59, v4
v_fmac_f32 v6, v7, v7
v_sub_f32 v7, v60, v4
v_fmac_f32 v6, v7, v7
v_sub_f32 v7, v61, v4
v_fmac_f32 v6, v7, v7
v_sub_f32 v7, v62, v4
v_fmac_f32 v6, v7, v7
v_sub_f32 v7, v63, v4
v_fmac_f32 v6, v7, v7
v_sub_f32 v7, v64, v4
v_fmac_f32 v6, v7, v7
v_sub_f32 v7, v65, v4
v_fmac_f32 v6, v7, v7
v_sub_f32 v7, v66, v4
v_fmac_f32 v6, v7, v7
v_sub_f32 v7, v67, v4
v_fmac_f32 v6, v7, v7
v_sub_f32 v7, v68, v4
v_fmac_f32 v6, v7, v7
v_sub_f32 v7, v69, v4
v_fmac_f32 v6, v7, v7
v_sub_f32 v7, v70, v4
v_fmac_f32 v6, v7, v7
v_sub_f32 v7, v71, v4
v_fmac_f32 v6, v7, v7
s_nop 1
v_add_f32_dpp v5, v6, v6 row_ror:8 row_mask:0xf bank_mask:0xf
v_mov_b32 v6, v5
s_nop 1
v_add_f32_dpp v5, v6, v6 row_ror:4 row_mask:0xf bank_mask:0xf
v_mov_b32 v6, v5
s_nop 1
v_add_f32_dpp v5, v6, v6 row_ror:2 row_mask:0xf bank_mask:0xf
v_mov_b32 v6, v5
s_nop 1
v_add_f32_dpp v5, v6, v6 row_ror:1 row_mask:0xf bank_mask:0xf
v_mov_b32 v6, v5
v_mul_f32 v6, 0x3acccccd, v6
cvp 4,4,4
v_lshlrev_b32 v4, 16, v4
cvp 6,6,6
v_lshlrev_b32 v6, 16, v6
v_add_f32 v6, 0x3727c5ac, v6
cvp 6,6,6
v_lshlrev_b32 v6, 16, v6
v_sqrt_f32 v6, v6
s_nop 0
cvp 6,6,6
v_lshlrev_b32 v6, 16, v6
v_rcp_f32 v7, v6
s_nop 0
v_fma_f32 v5, -v6, v7, 2.0
v_mul_f32 v7, v7, v5
v_sub_f32 v32, v32, v4
v_sub_f32 v33, v33, v4
v_sub_f32 v34, v34, v4
v_sub_f32 v35, v35, v4
v_sub_f32 v36, v36, v4
v_sub_f32 v37, v37, v4
v_sub_f32 v38, v38, v4
v_sub_f32 v39, v39, v4
v_sub_f32 v40, v40, v4
v_sub_f32 v41, v41, v4
v_sub_f32 v42, v42, v4
v_sub_f32 v43, v43, v4
v_sub_f32 v44, v44, v4
v_sub_f32 v45, v45, v4
v_sub_f32 v46, v46, v4
v_sub_f32 v47, v47, v4
v_sub_f32 v48, v48, v4
v_sub_f32 v49, v49, v4
v_sub_f32 v50, v50, v4
v_sub_f32 v51, v51, v4
v_sub_f32 v52, v52, v4
v_sub_f32 v53, v53, v4
v_sub_f32 v54, v54, v4
v_sub_f32 v55, v55, v4
v_sub_f32 v56, v56, v4
v_sub_f32 v57, v57, v4
v_sub_f32 v58, v58, v4
v_sub_f32 v59, v59, v4
v_sub_f32 v60, v60, v4
v_sub_f32 v61, v61, v4
v_sub_f32 v62, v62, v4
v_sub_f32 v63, v63, v4
v_sub_f32 v64, v64, v4
v_sub_f32 v65, v65, v4
v_sub_f32 v66, v66, v4
v_sub_f32 v67, v67, v4
v_sub_f32 v68, v68, v4
v_sub_f32 v69, v69, v4
v_sub_f32 v70, v70, v4
v_sub_f32 v71, v71, v4
cvp 8,32,33
cvp 9,34,35
cvp 10,36,37
cvp 11,38,39
cvp 12,40,41
cvp 13,42,43
cvp 14,44,45
cvp 15,46,47
cvp 16,48,49
cvp 17,50,51
cvp 18,52,53
cvp 19,54,55
cvp 20,56,57
cvp 21,58,59
cvp 22,60,61
cvp 23,62,63
cvp 24,64,65
cvp 25,66,67
cvp 26,68,69
cvp 27,70,71
v_lshlrev_b32 v32, 16, v8
v_and_b32 v33, 0xffff0000, v8
v_lshlrev_b32 v34, 16, v9
v_and_b32 v35, 0xffff0000, v9
v_lshlrev_b32 v36, 16, v10
v_and_b32 v37, 0xffff0000, v10
v_lshlrev_b32 v38, 16, v11
v_and_b32 v39, 0xffff0000, v11
v_lshlrev_b32 v40, 16, v12
v_and_b32 v41, 0xffff0000, v12
v_lshlrev_b32 v42, 16, v13
v_and_b32 v43, 0xffff0000, v13
v_lshlrev_b32 v44, 16, v14
v_and_b32 v45, 0xffff0000, v14
v_lshlrev_b32 v46, 16, v15
v_and_b32 v47, 0xffff0000, v15
v_lshlrev_b32 v48, 16, v16
v_and_b32 v49, 0xffff0000, v16
v_lshlrev_b32 v50, 16, v17
v_and_b32 v51, 0xffff0000, v17
v_lshlrev_b32 v52, 16, v18
v_and_b32 v53, 0xffff0000, v18
v_lshlrev_b32 v54, 16, v19
v_and_b32 v55, 0xffff0000, v19
v_lshlrev_b32 v56, 16, v20
v_and_b32 v57, 0xffff0000, v20
v_lshlrev_b32 v58, 16, v21
v_and_b32 v59, 0xffff0000, v21
v_lshlrev_b32 v60, 16, v22
v_and_b32 v61, 0xffff0000, v22
v_lshlrev_b32 v62, 16, v23
v_and_b32 v63, 0xffff0000, v23
v_lshlrev_b32 v64, 16, v24
v_and_b32 v65, 0xffff0000, v24
v_lshlrev_b32 v66, 16, v25
v_and_b32 v67, 0xffff0000, v25
v_lshlrev_b32 v68, 16, v26
v_and_b32 v69, 0xffff0000, v26
v_lshlrev_b32 v70, 16, v27
v_and_b32 v71, 0xffff0000, v27
v_mul_f32 v5, v32, v7
v_fma_f32 v32, -v5, v6, v32
v_fma_f32 v32, v32, v7, v5
v_mul_f32 v5, v33, v7
v_fma_f32 v33, -v5, v6, v33
v_fma_f32 v33, v33, v7, v5
v_mul_f32 v5, v34, v7
v_fma_f32 v34, -v5, v6, v34
v_fma_f32 v34, v34, v7, v5
v_mul_f32 v5, v35, v7
v_fma_f32 v35, -v5, v6, v35
v_fma_f32 v35, v35, v7, v5
v_mul_f32 v5, v36, v7
v_fma_f32 v36, -v5, v6, v36
v_fma_f32 v36, v36, v7, v5
v_mul_f32 v5, v37, v7
v_fma_f32 v37, -v5, v6, v37
v_fma_f32 v37, v37, v7, v5
v_mul_f32 v5, v38, v7
v_fma_f32 v38, -v5, v6, v38
v_fma_f32 v38, v38, v7, v5
v_mul_f32 v5, v39, v7
v_fma_f32 v39, -v5, v6, v39
v_fma_f32 v39, v39, v7, v5
v_mul_f32 v5, v40, v7
v_fma_f32 v40, -v5, v6, v40
v_fma_f32 v40, v40, v7, v5
v_mul_f32 v5, v41, v7
v_fma_f32 v41, -v5, v6, v41
v_fma_f32 v41, v41, v7, v5
v_mul_f32 v5, v42, v7
v_fma_f32 v42, -v5, v6, v42
v_fma_f32 v42, v42, v7, v5
v_mul_f32 v5, v43, v7
v_fma_f32 v43, -v5, v6, v43
v_fma_f32 v43, v43, v7, v5
v_mul_f32 v5, v44, v7
v_fma_f32 v44, -v5, v6, v44
v_fma_f32 v44, v44, v7, v5
v_mul_f32 v5, v45, v7
v_fma_f32 v45, -v5, v6, v45
v_fma_f32 v45, v45, v7, v5
v_mul_f32 v5, v46, v7
v_fma_f32 v46, -v5, v6, v46
v_fma_f32 v46, v46, v7, v5
v_mul_f32 v5, v47, v7
v_fma_f32 v47, -v5, v6, v47
v_fma_f32 v47, v47, v7, v5
v_mul_f32 v5, v48, v7
v_fma_f32 v48, -v5, v6, v48
v_fma_f32 v48, v48, v7, v5
v_mul_f32 v5, v49, v7
v_fma_f32 v49, -v5, v6, v49
v_fma_f32 v49, v49, v7, v5
v_mul_f32 v5, v50, v7
v_fma_f32 v50, -v5, v6, v50
v_fma_f32 v50, v50, v7, v5
v_mul_f32 v5, v51, v7
v_fma_f32 v51, -v5, v6, v51
v_fma_f32 v51, v51, v7, v5
v_mul_f32 v5, v52, v7
v_fma_f32 v52, -v5, v6, v52
v_fma_f32 v52, v52, v7, v5
v_mul_f32 v5, v53, v7
v_fma_f32 v53, -v5, v6, v53
v_fma_f32 v53, v53, v7, v5
v_mul_f32 v5, v54, v7
v_fma_f32 v54, -v5, v6, v54
v_fma_f32 v54, v54, v7, v5
v_mul_f32 v5, v55, v7
v_fma_f32 v55, -v5, v6, v55
v_fma_f32 v55, v55, v7, v5
v_mul_f32 v5, v56, v7
v_fma_f32 v56, -v5, v6, v56
v_fma_f32 v56, v56, v7, v5
v_mul_f32 v5, v57, v7
v_fma_f32 v57, -v5, v6, v57
v_fma_f32 v57, v57, v7, v5
v_mul_f32 v5, v58, v7
v_fma_f32 v58, -v5, v6, v58
v_fma_f32 v58, v58, v7, v5
v_mul_f32 v5, v59, v7
v_fma_f32 v59, -v5, v6, v59
v_fma_f32 v59, v59, v7, v5
v_mul_f32 v5, v60, v7
v_fma_f32 v60, -v5, v6, v60
v_fma_f32 v60, v60, v7, v5
v_mul_f32 v5, v61, v7
v_fma_f32 v61, -v5, v6, v61
v_fma_f32 v61, v61, v7, v5
v_mul_f32 v5, v62, v7
v_fma_f32 v62, -v5, v6, v62
v_fma_f32 v62, v62, v7, v5
v_mul_f32 v5, v63, v7
v_fma_f32 v63, -v5, v6, v63
v_fma_f32 v63, v63, v7, v5
v_mul_f32 v5, v64, v7
v_fma_f32 v64, -v5, v6, v64
v_fma_f32 v64, v64, v7, v5
v_mul_f32 v5, v65, v7
v_fma_f32 v65, -v5, v6, v65
v_fma_f32 v65, v65, v7, v5
v_mul_f32 v5, v66, v7
v_fma_f32 v66, -v5, v6, v66
v_fma_f32 v66, v66, v7, v5
v_mul_f32 v5, v67, v7
v_fma_f32 v67, -v5, v6, v67
v_fma_f32 v67, v67, v7, v5
v_mul_f32 v5, v68, v7
v_fma_f32 v68, -v5, v6, v68
v_fma_f32 v68, v68, v7, v5
v_mul_f32 v5, v69, v7
v_fma_f32 v69, -v5, v6, v69
v_fma_f32 v69, v69, v7, v5
v_mul_f32 v5, v70, v7
v_fma_f32 v70, -v5, v6, v70
v_fma_f32 v70, v70, v7, v5
v_mul_f32 v5, v71, v7
v_fma_f32 v71, -v5, v6, v71
v_fma_f32 v71, v71, v7, v5
cvp 8,32,33
cvp 9,34,35
cvp 10,36,37
cvp 11,38,39
cvp 12,40,41
cvp 13,42,43
cvp 14,44,45
cvp 15,46,47
cvp 16,48,49
cvp 17,50,51
cvp 18,52,53
cvp 19,54,55
cvp 20,56,57
cvp 21,58,59
cvp 22,60,61
cvp 23,62,63
cvp 24,64,65
cvp 25,66,67
cvp 26,68,69
cvp 27,70,71
v_lshrrev_b32 v3, 2, v2
v_lshlrev_b32 v3, 10, v3
v_and_b32 v5, 1, v2
v_lshl_add_u32 v3, v5, 9, v3
v_bfe_u32 v5, v2, 1, 1
v_lshl_add_u32 v3, v5, 3, v3
v_lshl_add_u32 v3, v1, 4, v3
sad 48,3,0
buffer_store_dwordx2 v[8:9], v3, s[44:47], s48 offen sc1
buffer_store_dwordx2 v[10:11], v3, s[44:47], s48 offen offset:256 sc1
sad 48,3,4096
buffer_store_dwordx2 v[12:13], v3, s[44:47], s48 offen sc1
buffer_store_dwordx2 v[14:15], v3, s[44:47], s48 offen offset:256 sc1
sad 48,3,8192
buffer_store_dwordx2 v[16:17], v3, s[44:47], s48 offen sc1
buffer_store_dwordx2 v[18:19], v3, s[44:47], s48 offen offset:256 sc1
sad 48,3,12288
buffer_store_dwordx2 v[20:21], v3, s[44:47], s48 offen sc1
buffer_store_dwordx2 v[22:23], v3, s[44:47], s48 offen offset:256 sc1
sad 48,3,16384
buffer_store_dwordx2 v[24:25], v3, s[44:47], s48 offen sc1
buffer_store_dwordx2 v[26:27], v3, s[44:47], s48 offen offset:256 sc1
v_and_b32 v1, 63, v0
v_lshrrev_b32 v2, 6, v0
s_nop 0
v_readfirstlane_b32 s4, v2
v_lshlrev_b32 v20, 4, v1
v_mov_b32 v6, v100
v_mov_b32 v7, v101
sad 79,30,80
s_cmp_lt_u32 s2, 160
s_cbranch_scc1 L_ne2_42
s_mul_i32 s34, s60, 0
s_add_u32 s34, s34, s24
s_add_u32 m0, s29, 0
s_nop 0
buffer_load_dwordx4 v6, s[8:11], s34 offen lds
s_add_u32 m0, s29, 1024
s_nop 0
buffer_load_dwordx4 v7, s[8:11], s34 offen lds
s_mul_i32 s34, s60, 0
s_add_u32 s34, s34, s25
s_add_u32 m0, s29, 8192
s_nop 0
buffer_load_dwordx4 v6, s[52:55], s34 offen lds
s_add_u32 m0, s29, 9216
s_nop 0
buffer_load_dwordx4 v7, s[52:55], s34 offen lds
s_mul_i32 s34, s60, 0
s_add_u32 s34, s34, s26
s_add_u32 m0, s29, 16384
s_nop 0
buffer_load_dwordx4 v6, s[56:59], s34 offen lds
s_add_u32 m0, s29, 17408
s_nop 0
buffer_load_dwordx4 v7, s[56:59], s34 offen lds
s_mul_i32 s34, s60, 1
s_add_u32 s34, s34, s24
s_add_u32 m0, s29, 24576
s_nop 0
buffer_load_dwordx4 v6, s[8:11], s34 offen lds
s_add_u32 m0, s29, 25600
s_nop 0
buffer_load_dwordx4 v7, s[8:11], s34 offen lds
s_mul_i32 s34, s60, 1
s_add_u32 s34, s34, s25
s_add_u32 m0, s29, 32768
s_nop 0
buffer_load_dwordx4 v6, s[52:55], s34 offen lds
s_add_u32 m0, s29, 33792
s_nop 0
buffer_load_dwordx4 v7, s[52:55], s34 offen lds
s_mul_i32 s34, s60, 1
s_add_u32 s34, s34, s26
s_add_u32 m0, s29, 40960
s_nop 0
buffer_load_dwordx4 v6, s[56:59], s34 offen lds
s_add_u32 m0, s29, 41984
s_nop 0
buffer_load_dwordx4 v7, s[56:59], s34 offen lds
s_mul_i32 s34, s60, 2
s_add_u32 s34, s34, s24
s_add_u32 m0, s29, 49152
s_nop 0
buffer_load_dwordx4 v6, s[8:11], s34 offen lds
s_add_u32 m0, s29, 50176
s_nop 0
buffer_load_dwordx4 v7, s[8:11], s34 offen lds
s_mul_i32 s34, s60, 2
s_add_u32 s34, s34, s25
s_add_u32 m0, s29, 57344
s_nop 0
buffer_load_dwordx4 v6, s[52:55], s34 offen lds
s_add_u32 m0, s29, 58368
s_nop 0
buffer_load_dwordx4 v7, s[52:55], s34 offen lds
s_mul_i32 s34, s60, 2
s_add_u32 s34, s34, s26
s_add_u32 m0, s29, 65536
s_nop 0
buffer_load_dwordx4 v6, s[56:59], s34 offen lds
s_add_u32 m0, s29, 66560
s_nop 0
buffer_load_dwordx4 v7, s[56:59], s34 offen lds
s_mul_i32 s34, s60, 3
s_add_u32 s34, s34, s24
s_add_u32 m0, s29, 73728
s_nop 0
buffer_load_dwordx4 v6, s[8:11], s34 offen lds
s_add_u32 m0, s29, 74752
s_nop 0
buffer_load_dwordx4 v7, s[8:11], s34 offen lds
s_mul_i32 s34, s60, 3
s_add_u32 s34, s34, s25
s_add_u32 m0, s29, 81920
s_nop 0
buffer_load_dwordx4 v6, s[52:55], s34 offen lds
s_add_u32 m0, s29, 82944
s_nop 0
buffer_load_dwordx4 v7, s[52:55], s34 offen lds
s_mul_i32 s34, s60, 3
s_add_u32 s34, s34, s26
s_add_u32 m0, s29, 90112
s_nop 0
buffer_load_dwordx4 v6, s[56:59], s34 offen lds
s_add_u32 m0, s29, 91136
s_nop 0
buffer_load_dwordx4 v7, s[56:59], s34 offen lds
wv 24
s_branch L_ne3_43
L_ne2_42:
wv 0
L_ne3_43:
s_barrier
s_cmp_lg_u32 s4, 1
s_cbranch_scc1 L_nf_44
s_lshl_b32 s83, s79, 7
v_and_b32 v2, 1, v1
v_cmp_eq_u32 vcc, 1, v2
v_mov_b32 v2, s100
v_mov_b32 v3, s101
v_cndmask_b32 v3, v2, v3, vcc
v_and_b32 v2, 31, v1
v_lshlrev_b32 v2, 2, v2
buffer_store_dword v3, v2, s[88:91], s83 offen sc1
L_nf_44:
s_mov_b32 s92, 15
s_cmp_ge_u32 s2, 160
s_cbranch_scc1 L_worker1
s_sub_u32 s3, s2, 64
s_branch L_wvo
L_recside:
s_sub_u32 s3, s2, 32
s_cmp_lt_u32 s3, 64
s_cbranch_scc1 L_wvo
L_doinit:
s_load_dwordx2 s[6:7], s[0:1], 104
s_load_dwordx2 s[24:25], s[0:1], 8
s_sub_u32 s31, 127, s2
s_lshl_b32 s30, s31, 2
wl 0
s_cmp_ge_u32 s31, 32
s_cbranch_scc1 L_after
L_init:
sad 8,6,0
s_addc_u32 s9, s7, 0
s_and_b32 s9, s9, 0xffff
s_mov_b32 s10, 8388608
s_mov_b32 s11, 0x00020000
v_lshlrev_b32 v3, 4, v0
v_mov_b32 v8, -1
v_mov_b32 v9, -1
v_mov_b32 v10, -1
v_mov_b32 v11, -1
s_cmp_lg_u32 s30, 0
s_cbranch_scc1 L_if_45
s_mov_b32 s12, s24
s_and_b32 s13, s25, 0xffff
s_mov_b32 s14, 10240
s_mov_b32 s15, 0x00020000
v_and_b32 v4, 7, v0
v_mul_u32_u24 v4, 1280, v4
v_lshrrev_b32 v5, 3, v0
v_lshl_add_u32 v4, v5, 4, v4
buffer_load_dwordx4 v[12:15], v4, s[12:15], 0 offen offset:0
buffer_load_dwordx4 v[16:19], v4, s[12:15], 0 offen offset:512
buffer_load_dwordx4 v[20:23], v4, s[12:15], 0 offen offset:1024
wv 0
v_min_u32 v12, -2, v12
v_min_u32 v13, -2, v13
v_min_u32 v14, -2, v14
v_min_u32 v15, -2, v15
v_min_u32 v16, -2, v16
v_min_u32 v17, -2, v17
v_min_u32 v18, -2, v18
v_min_u32 v19, -2, v19
v_min_u32 v20, -2, v20
v_min_u32 v21, -2, v21
v_min_u32 v22, -2, v22
v_min_u32 v23, -2, v23
s_mov_b32 s16, 0
buffer_store_dwordx4 v[12:15], v3, s[8:11], s16 offen sc1
s_mov_b32 s16, 4096
buffer_store_dwordx4 v[16:19], v3, s[8:11], s16 offen sc1
s_mov_b32 s16, 16384
buffer_store_dwordx4 v[20:23], v3, s[8:11], s16 offen sc1
s_mov_b32 s16, 8192
buffer_store_dwordx4 v[12:15], v3, s[8:11], s16 offen sc1
s_mov_b32 s16, 12288
buffer_store_dwordx4 v[16:19], v3, s[8:11], s16 offen sc1
s_mov_b32 s16, 24576
buffer_store_dwordx4 v[20:23], v3, s[8:11], s16 offen sc1
s_mov_b32 s16, 32768
buffer_store_dwordx4 v[8:11], v3, s[8:11], s16 offen sc1
s_mov_b32 s16, 36864
buffer_store_dwordx4 v[8:11], v3, s[8:11], s16 offen sc1
s_mov_b32 s16, 40960
buffer_store_dwordx4 v[8:11], v3, s[8:11], s16 offen sc1
s_mov_b32 s16, 45056
buffer_store_dwordx4 v[8:11], v3, s[8:11], s16 offen sc1
s_branch L_ie_46
L_if_45:
s_lshl_b32 s3, s30, 16
s_bitcmp1_b32 s30, 0
s_cselect_b32 s17, 0, 0x40000000
sad 16,3,0
buffer_store_dwordx4 v[8:11], v3, s[8:11], s16 offen sc1
sad 16,3,4096
buffer_store_dwordx4 v[8:11], v3, s[8:11], s16 offen sc1
sad 16,3,8192
buffer_store_dwordx4 v[8:11], v3, s[8:11], s16 offen sc1
sad 16,3,12288
buffer_store_dwordx4 v[8:11], v3, s[8:11], s16 offen sc1
sad 16,3,16384
buffer_store_dwordx4 v[8:11], v3, s[8:11], s16 offen sc1
sad 16,3,20480
s_add_u32 s16, s16, s17
buffer_store_dwordx4 v[8:11], v3, s[8:11], s16 offen sc1
sad 16,3,24576
buffer_store_dwordx4 v[8:11], v3, s[8:11], s16 offen sc1
sad 16,3,28672
s_add_u32 s16, s16, s17
buffer_store_dwordx4 v[8:11], v3, s[8:11], s16 offen sc1
sad 16,3,32768
buffer_store_dwordx4 v[8:11], v3, s[8:11], s16 offen sc1
sad 16,3,36864
buffer_store_dwordx4 v[8:11], v3, s[8:11], s16 offen sc1
sad 16,3,40960
buffer_store_dwordx4 v[8:11], v3, s[8:11], s16 offen sc1
sad 16,3,45056
buffer_store_dwordx4 v[8:11], v3, s[8:11], s16 offen sc1
L_ie_46:
sad 30,30,1
s_and_b32 s29, s30, 3
s_cmp_lg_u32 s29, 0
s_cbranch_scc1 L_init
sad 79,31,208
wv 0
s_barrier
s_cmp_lg_u32 s4, 1
s_cbranch_scc1 L_nf_47
s_lshl_b32 s83, s79, 7
v_and_b32 v2, 1, v1
v_cmp_eq_u32 vcc, 1, v2
v_mov_b32 v2, s100
v_mov_b32 v3, s101
v_cndmask_b32 v3, v2, v3, vcc
v_and_b32 v2, 31, v1
v_lshlrev_b32 v2, 2, v2
buffer_store_dword v3, v2, s[88:91], s83 offen sc1
L_nf_47:
s_cmp_lt_u32 s2, 112
s_cbranch_scc1 L_nop
s_load_dwordx2 s[36:37], s[0:1], 104
v_and_b32 v1, 63, v0
v_lshrrev_b32 v2, 6, v0
s_nop 0
v_readfirstlane_b32 s4, v2
v_lshlrev_b32 v7, 4, v1
v_bfe_u32 v2, v1, 3, 1
v_mul_u32_u24 v2, 0xaaaa, v2
v_add_u32 v6, 0x4444, v2
s_mov_b32 s42, 400000
s_mov_b32 s3, s2
wl 0
sad 8,36,0
s_addc_u32 s9, s37, 0
s_and_b32 s9, s9, 0xffff
s_mov_b32 s10, 8388608
s_mov_b32 s11, 0x00020000
s_sub_u32 s3, s2, 112
s_and_b32 s38, s3, 15
s_lshl_b32 s39, s4, 4
s_add_u32 s38, s38, s39
s_lshl_b32 s38, s38, 17
s_lshr_b32 s39, s3, 4
s_lshl_b32 s39, s39, 10
s_add_u32 s38, s38, s39
sad 38,38,114688
sad 39,38,8192
v_mov_b32 v8, 0
v_mov_b32 v9, 0
v_mov_b32 v10, 0
v_mov_b32 v11, 0
buffer_store_dwordx4 v[8:11], v7, s[8:11], s38 offen sc1
buffer_store_dwordx4 v[8:11], v7, s[8:11], s39 offen sc1
wv 0
s_mov_b32 s40, 0xffff
s_mov_b32 s41, 0xffff
sad 39,38,0
s_memtime s[44:45]
wl 0
buffer_load_dword v12, v8, s[8:11], s39 offen sc1
wv 0
s_memtime s[46:47]
wl 0
s_sub_u32 s44, s46, s44
s_min_u32 s40, s40, s44
sad 39,38,8192
s_memtime s[44:45]
wl 0
buffer_load_dword v12, v8, s[8:11], s39 offen sc1
wv 0
s_memtime s[46:47]
wl 0
s_sub_u32 s44, s46, s44
s_min_u32 s41, s41, s44
sad 39,38,128
s_memtime s[44:45]
wl 0
buffer_load_dword v12, v8, s[8:11], s39 offen sc1
wv 0
s_memtime s[46:47]
wl 0
s_sub_u32 s44, s46, s44
s_min_u32 s40, s40, s44
sad 39,38,8320
s_memtime s[44:45]
wl 0
buffer_load_dword v12, v8, s[8:11], s39 offen sc1
wv 0
s_memtime s[46:47]
wl 0
s_sub_u32 s44, s46, s44
s_min_u32 s41, s41, s44
sad 39,38,256
s_memtime s[44:45]
wl 0
buffer_load_dword v12, v8, s[8:11], s39 offen sc1
wv 0
s_memtime s[46:47]
wl 0
s_sub_u32 s44, s46, s44
s_min_u32 s40, s40, s44
sad 39,38,8448
s_memtime s[44:45]
wl 0
buffer_load_dword v12, v8, s[8:11], s39 offen sc1
wv 0
s_memtime s[46:47]
wl 0
s_sub_u32 s44, s46, s44
s_min_u32 s41, s41, s44
sad 39,38,384
s_memtime s[44:45]
wl 0
buffer_load_dword v12, v8, s[8:11], s39 offen sc1
wv 0
s_memtime s[46:47]
wl 0
s_sub_u32 s44, s46, s44
s_min_u32 s40, s40, s44
sad 39,38,8576
s_memtime s[44:45]
wl 0
buffer_load_dword v12, v8, s[8:11], s39 offen sc1
wv 0
s_memtime s[46:47]
wl 0
s_sub_u32 s44, s46, s44
s_min_u32 s41, s41, s44
sad 39,38,512
s_memtime s[44:45]
wl 0
buffer_load_dword v12, v8, s[8:11], s39 offen sc1
wv 0
s_memtime s[46:47]
wl 0
s_sub_u32 s44, s46, s44
s_min_u32 s40, s40, s44
sad 39,38,8704
s_memtime s[44:45]
wl 0
buffer_load_dword v12, v8, s[8:11], s39 offen sc1
wv 0
s_memtime s[46:47]
wl 0
s_sub_u32 s44, s46, s44
s_min_u32 s41, s41, s44
sad 39,38,640
s_memtime s[44:45]
wl 0
buffer_load_dword v12, v8, s[8:11], s39 offen sc1
wv 0
s_memtime s[46:47]
wl 0
s_sub_u32 s44, s46, s44
s_min_u32 s40, s40, s44
sad 39,38,8832
s_memtime s[44:45]
wl 0
buffer_load_dword v12, v8, s[8:11], s39 offen sc1
wv 0
s_memtime s[46:47]
wl 0
s_sub_u32 s44, s46, s44
s_min_u32 s41, s41, s44
s_getreg_b32 s38, hwreg(HW_REG_XCC_ID)
s_and_b32 s38, s38, 7
s_lshl_b32 s41, s41, 16
s_or_b32 s40, s40, s41
v_mov_b32 v12, s100
v_mov_b32 v13, s101
v_mov_b32 v14, s38
v_mov_b32 v15, s40
sad 38,3,496
s_lshl_b32 s38, s38, 7
s_lshl_b32 s39, s4, 4
s_add_u32 s38, s38, s39
s_mov_b64 exec, 1
buffer_store_dwordx4 v[12:15], v8, s[88:91], s38 offen sc1
s_mov_b64 exec, -1
sad 79,3,512
wv 0
s_barrier
s_cmp_lg_u32 s4, 1
s_cbranch_scc1 L_nf_48
s_lshl_b32 s83, s79, 7
v_and_b32 v2, 1, v1
v_cmp_eq_u32 vcc, 1, v2
v_mov_b32 v2, s100
v_mov_b32 v3, s101
v_cndmask_b32 v3, v2, v3, vcc
v_and_b32 v2, 31, v1
v_lshlrev_b32 v2, 2, v2
buffer_store_dword v3, v2, s[88:91], s83 offen sc1
L_nf_48:
L_nop:
s_getpc_b64 s[80:81]
L_tr_49:
s_add_u32 s80, s80, L_qtab-L_tr_49
s_addc_u32 s81, s81, 0
s_and_b32 s76, s2, 7
s_mov_b32 s77, 0
s_mov_b32 s92, 0
s_mov_b32 s70, -1
s_mov_b32 s68, 0
s_load_dwordx2 s[36:37], s[0:1], 104
s_load_dwordx2 s[42:43], s[0:1], 40
v_and_b32 v1, 63, v0
v_lshrrev_b32 v2, 6, v0
s_nop 0
v_readfirstlane_b32 s4, v2
v_lshlrev_b32 v20, 4, v1
v_lshrrev_b32 v2, 4, v1
v_bfe_u32 v3, v1, 2, 2
v_lshlrev_b32 v4, 2, v2
v_add_u32 v4, v4, v3
v_lshlrev_b32 v4, 7, v4
v_and_b32 v5, 3, v1
v_lshl_add_u32 v4, v5, 3, v4
v_lshrrev_b32 v3, 1, v3
v_and_b32 v2, 1, v2
v_lshl_or_b32 v3, v2, 1, v3
v_xor_b32 v2, 0, v3
v_lshl_add_u32 v8, v2, 5, v4
v_xor_b32 v2, 1, v3
v_lshl_add_u32 v9, v2, 5, v4
v_xor_b32 v2, 2, v3
v_lshl_add_u32 v10, v2, 5, v4
v_xor_b32 v2, 3, v3
v_lshl_add_u32 v11, v2, 5, v4
v_add_u32 v12, 49152, v8
v_add_u32 v24, 98304, v8
v_add_u32 v13, 49152, v9
v_add_u32 v25, 98304, v9
v_add_u32 v14, 49152, v10
v_add_u32 v26, 98304, v10
v_add_u32 v15, 49152, v11
v_add_u32 v27, 98304, v11
s_lshl_b32 s29, s4, 11
v_lshrrev_b32 v2, 3, v1
v_lshrrev_b32 v3, 1, v2
v_bfe_u32 v4, v1, 1, 2
v_xor_b32 v4, v4, v3
v_and_b32 v5, 1, v1
v_lshl_or_b32 v4, v4, 1, v5
v_lshlrev_b32 v4, 4, v4
s_lshl_b32 s32, s4, 4
sad 32,32,0
v_add_u32 v2, s32, v2
s_mov_b32 s33, 12288
v_mul_lo_u32 v2, v2, s33
v_add_u32 v6, v2, v4
v_lshrrev_b32 v2, 3, v1
v_lshrrev_b32 v3, 1, v2
v_bfe_u32 v4, v1, 1, 2
v_xor_b32 v4, v4, v3
v_and_b32 v5, 1, v1
v_lshl_or_b32 v4, v4, 1, v5
v_lshlrev_b32 v4, 4, v4
s_lshl_b32 s32, s4, 4
sad 32,32,8
v_add_u32 v2, s32, v2
s_mov_b32 s33, 12288
v_mul_lo_u32 v2, v2, s33
v_add_u32 v7, v2, v4
v_mov_b32 v28, v6
v_mov_b32 v29, v7
v_lshrrev_b32 v2, 3, v1
v_lshrrev_b32 v3, 1, v2
v_bfe_u32 v4, v1, 1, 2
v_xor_b32 v4, v4, v3
v_and_b32 v5, 1, v1
v_lshl_or_b32 v4, v4, 1, v5
v_lshlrev_b32 v4, 4, v4
s_lshl_b32 s32, s4, 4
sad 32,32,0
v_add_u32 v2, s32, v2
s_mov_b32 s33, 1280
v_mul_lo_u32 v2, v2, s33
v_add_u32 v6, v2, v4
v_lshrrev_b32 v2, 3, v1
v_lshrrev_b32 v3, 1, v2
v_bfe_u32 v4, v1, 1, 2
v_xor_b32 v4, v4, v3
v_and_b32 v5, 1, v1
v_lshl_or_b32 v4, v4, 1, v5
v_lshlrev_b32 v4, 4, v4
s_lshl_b32 s32, s4, 4
sad 32,32,8
v_add_u32 v2, s32, v2
s_mov_b32 s33, 1280
v_mul_lo_u32 v2, v2, s33
v_add_u32 v7, v2, v4
v_mov_b32 v30, v6
v_mov_b32 v31, v7
v_lshrrev_b32 v2, 3, v1
v_lshrrev_b32 v3, 1, v2
v_bfe_u32 v4, v1, 1, 2
v_xor_b32 v4, v4, v3
v_and_b32 v5, 1, v1
v_lshl_or_b32 v4, v4, 1, v5
v_lshlrev_b32 v4, 4, v4
s_lshl_b32 s32, s4, 4
sad 32,32,0
v_add_u32 v2, s32, v2
s_mov_b32 s33, 3072
v_mul_lo_u32 v2, v2, s33
v_add_u32 v6, v2, v4
v_lshrrev_b32 v2, 3, v1
v_lshrrev_b32 v3, 1, v2
v_bfe_u32 v4, v1, 1, 2
v_xor_b32 v4, v4, v3
v_and_b32 v5, 1, v1
v_lshl_or_b32 v4, v4, 1, v5
v_lshlrev_b32 v4, 4, v4
s_lshl_b32 s32, s4, 4
sad 32,32,8
v_add_u32 v2, s32, v2
s_mov_b32 s33, 3072
v_mul_lo_u32 v2, v2, s33
v_add_u32 v7, v2, v4
v_mov_b32 v22, v6
v_mov_b32 v23, v7
wl 0
sad 8,36,8388608
s_addc_u32 s9, s37, 0
s_and_b32 s9, s9, 0xffff
s_mov_b32 s10, 2621440
s_mov_b32 s11, 0x00020000
sad 52,36,8388608
s_addc_u32 s53, s37, 0
s_and_b32 s53, s53, 0xffff
s_mov_b32 s54, 2621440
s_mov_b32 s55, 0x00020000
sad 56,36,8388608
s_addc_u32 s57, s37, 0
s_and_b32 s57, s57, 0xffff
s_mov_b32 s58, 2621440
s_mov_b32 s59, 0x00020000
sad 16,36,8388608
s_addc_u32 s17, s37, 0
s_and_b32 s17, s17, 0xffff
s_mov_b32 s18, 2621440
s_mov_b32 s19, 0x00020000
sad 20,36,8388608
s_addc_u32 s21, s37, 0
s_and_b32 s21, s21, 0xffff
s_mov_b32 s22, 2621440
s_mov_b32 s23, 0x00020000
s_mov_b32 s12, s42
s_and_b32 s13, s43, 0xffff
s_mov_b32 s14, 7864320
s_mov_b32 s15, 0x00020000
s_sub_u32 s78, s2, 96
s_lshr_b32 s78, s78, 3
sad 78,78,116
s_mov_b32 s72, 0
s_mov_b32 s68, 1
s_getpc_b64 s[50:51]
L_c_50:
s_add_u32 s50, s50, L_sched-L_c_50
s_addc_u32 s51, s51, 0
s_swappc_b64 s[74:75], s[50:51]
s_getpc_b64 s[50:51]
L_h_51:
s_add_u32 s50, s50, L_wk_issue-L_h_51
s_addc_u32 s51, s51, 0
s_setpc_b64 s[50:51]
s_branch L_after
L_wvo:
sad 79,3,336
s_load_dwordx2 s[40:41], s[0:1], 32
s_load_dwordx2 s[42:43], s[0:1], 40
s_load_dwordx2 s[36:37], s[0:1], 104
v_and_b32 v1, 63, v0
v_lshrrev_b32 v2, 6, v0
s_nop 0
v_readfirstlane_b32 s4, v2
v_lshlrev_b32 v20, 4, v1
v_lshrrev_b32 v2, 4, v1
v_bfe_u32 v3, v1, 2, 2
v_lshlrev_b32 v4, 3, v2
v_add_u32 v4, v4, v3
v_lshlrev_b32 v4, 7, v4
v_and_b32 v5, 3, v1
v_lshl_add_u32 v4, v5, 3, v4
v_lshrrev_b32 v3, 1, v3
v_and_b32 v2, 1, v2
v_lshl_or_b32 v3, v2, 1, v3
v_xor_b32 v2, 0, v3
v_lshl_add_u32 v8, v2, 5, v4
v_xor_b32 v2, 1, v3
v_lshl_add_u32 v9, v2, 5, v4
v_xor_b32 v2, 2, v3
v_lshl_add_u32 v10, v2, 5, v4
v_xor_b32 v2, 3, v3
v_lshl_add_u32 v11, v2, 5, v4
v_add_u32 v12, 49152, v8
v_add_u32 v24, 98304, v8
v_add_u32 v13, 49152, v9
v_add_u32 v25, 98304, v9
v_add_u32 v14, 49152, v10
v_add_u32 v26, 98304, v10
v_add_u32 v15, 49152, v11
v_add_u32 v27, 98304, v11
s_lshl_b32 s29, s4, 11
v_lshrrev_b32 v2, 3, v1
v_bfe_u32 v3, v2, 1, 1
v_bfe_u32 v4, v1, 1, 2
v_xor_b32 v4, v4, v3
v_and_b32 v5, 1, v1
v_lshl_or_b32 v4, v4, 1, v5
v_lshlrev_b32 v4, 4, v4
s_lshl_b32 s32, s4, 4
sad 32,32,0
v_add_u32 v2, s32, v2
s_mov_b32 s33, 1280
v_mul_lo_u32 v2, v2, s33
v_add_u32 v6, v2, v4
v_lshrrev_b32 v2, 3, v1
v_bfe_u32 v3, v2, 1, 1
v_or_b32 v3, 2, v3
v_bfe_u32 v4, v1, 1, 2
v_xor_b32 v4, v4, v3
v_and_b32 v5, 1, v1
v_lshl_or_b32 v4, v4, 1, v5
v_lshlrev_b32 v4, 4, v4
s_lshl_b32 s32, s4, 4
sad 32,32,8
v_add_u32 v2, s32, v2
s_mov_b32 s33, 1280
v_mul_lo_u32 v2, v2, s33
v_add_u32 v7, v2, v4
wl 0
s_mov_b32 s8, s40
s_and_b32 s9, s41, 0xffff
s_mov_b32 s10, 7864320
s_mov_b32 s11, 0x00020000
s_mov_b32 s12, s42
s_and_b32 s13, s43, 0xffff
s_mov_b32 s14, 7864320
s_mov_b32 s15, 0x00020000
sad 20,36,33554432
s_addc_u32 s21, s37, 0
s_and_b32 s21, s21, 0xffff
s_mov_b32 s22, 26214400
s_mov_b32 s23, 0x00020000
s_and_b32 s45, s3, 31
s_mul_i32 s25, s45, 245760
s_lshr_b32 s46, s3, 5
s_lshl_b32 s46, s46, 2
s_add_u32 s46, s46, s4
s_cmp_lt_u32 s46, 10
s_cselect_b32 s22, s22, 0
v_lshrrev_b32 v2, 3, v1
v_mul_u32_u24 v2, 12288, v2
v_and_b32 v3, 7, v1
v_lshl_add_u32 v22, v3, 4, v2
s_mul_i32 s44, s46, 786432
s_mul_i32 s33, s45, 384
s_add_u32 s44, s44, s33
s_mul_i32 s48, s4, 24576
sad 48,48,49152
v_bfe_u32 v2, v1, 3, 1
v_lshlrev_b32 v3, 4, v2
v_bfe_u32 v2, v1, 1, 1
v_lshl_add_u32 v3, v2, 3, v3
v_bfe_u32 v2, v1, 2, 1
v_lshl_add_u32 v3, v2, 2, v3
v_and_b32 v2, 1, v1
v_add_u32 v3, v3, v2
v_lshlrev_b32 v3, 7, v3
v_lshrrev_b32 v2, 4, v1
v_lshl_add_u32 v3, v2, 4, v3
v_add_u32 v23, s48, v3
v_bfe_u32 v2, v1, 3, 1
v_mul_u32_u24 v21, 327680, v2
v_lshrrev_b32 v2, 4, v1
v_lshl_add_u32 v21, v2, 8, v21
v_and_b32 v2, 7, v1
v_lshl_add_u32 v21, v2, 4, v21
s_lshr_b32 s47, s45, 1
s_mul_i32 s47, s47, 20480
s_lshl_b32 s32, s46, 11
s_add_u32 s47, s47, s32
s_and_b32 s32, s45, 1
s_lshl_b32 s32, s32, 7
s_add_u32 s47, s47, s32
sad 34,25,0
s_add_u32 m0, s29, 0
s_nop 0
buffer_load_dwordx4 v6, s[12:15], s34 offen lds
s_add_u32 m0, s29, 1024
s_nop 0
buffer_load_dwordx4 v7, s[12:15], s34 offen lds
sad 34,25,81920
s_add_u32 m0, s29, 8192
s_nop 0
buffer_load_dwordx4 v6, s[12:15], s34 offen lds
s_add_u32 m0, s29, 9216
s_nop 0
buffer_load_dwordx4 v7, s[12:15], s34 offen lds
sad 34,25,163840
s_add_u32 m0, s29, 16384
s_nop 0
buffer_load_dwordx4 v6, s[12:15], s34 offen lds
s_add_u32 m0, s29, 17408
s_nop 0
buffer_load_dwordx4 v7, s[12:15], s34 offen lds
s_add_u32 m0, s48, 0
sad 33,44,0
buffer_load_dwordx4 v22, s[8:11], s33 offen lds
s_add_u32 m0, s48, 8192
sad 33,44,128
buffer_load_dwordx4 v22, s[8:11], s33 offen lds
s_add_u32 m0, s48, 16384
sad 33,44,256
buffer_load_dwordx4 v22, s[8:11], s33 offen lds
s_add_u32 m0, s48, 1024
sad 33,44,98304
buffer_load_dwordx4 v22, s[8:11], s33 offen lds
s_add_u32 m0, s48, 9216
sad 33,44,98432
buffer_load_dwordx4 v22, s[8:11], s33 offen lds
s_add_u32 m0, s48, 17408
sad 33,44,98560
buffer_load_dwordx4 v22, s[8:11], s33 offen lds
s_add_u32 m0, s48, 2048
sad 33,44,196608
buffer_load_dwordx4 v22, s[8:11], s33 offen lds
s_add_u32 m0, s48, 10240
sad 33,44,196736
buffer_load_dwordx4 v22, s[8:11], s33 offen lds
s_add_u32 m0, s48, 18432
sad 33,44,196864
buffer_load_dwordx4 v22, s[8:11], s33 offen lds
s_add_u32 m0, s48, 3072
sad 33,44,294912
buffer_load_dwordx4 v22, s[8:11], s33 offen lds
s_add_u32 m0, s48, 11264
sad 33,44,295040
buffer_load_dwordx4 v22, s[8:11], s33 offen lds
s_add_u32 m0, s48, 19456
sad 33,44,295168
buffer_load_dwordx4 v22, s[8:11], s33 offen lds
s_add_u32 m0, s48, 4096
sad 33,44,393216
buffer_load_dwordx4 v22, s[8:11], s33 offen lds
s_add_u32 m0, s48, 12288
sad 33,44,393344
buffer_load_dwordx4 v22, s[8:11], s33 offen lds
s_add_u32 m0, s48, 20480
sad 33,44,393472
buffer_load_dwordx4 v22, s[8:11], s33 offen lds
s_add_u32 m0, s48, 5120
sad 33,44,491520
buffer_load_dwordx4 v22, s[8:11], s33 offen lds
s_add_u32 m0, s48, 13312
sad 33,44,491648
buffer_load_dwordx4 v22, s[8:11], s33 offen lds
s_add_u32 m0, s48, 21504
sad 33,44,491776
buffer_load_dwordx4 v22, s[8:11], s33 offen lds
s_add_u32 m0, s48, 6144
sad 33,44,589824
buffer_load_dwordx4 v22, s[8:11], s33 offen lds
s_add_u32 m0, s48, 14336
sad 33,44,589952
buffer_load_dwordx4 v22, s[8:11], s33 offen lds
s_add_u32 m0, s48, 22528
sad 33,44,590080
buffer_load_dwordx4 v22, s[8:11], s33 offen lds
s_add_u32 m0, s48, 7168
sad 33,44,688128
buffer_load_dwordx4 v22, s[8:11], s33 offen lds
s_add_u32 m0, s48, 15360
sad 33,44,688256
buffer_load_dwordx4 v22, s[8:11], s33 offen lds
s_add_u32 m0, s48, 23552
sad 33,44,688384
buffer_load_dwordx4 v22, s[8:11], s33 offen lds
sad 34,25,128
s_add_u32 m0, s29, 24576
s_nop 0
buffer_load_dwordx4 v6, s[12:15], s34 offen lds
s_add_u32 m0, s29, 25600
s_nop 0
buffer_load_dwordx4 v7, s[12:15], s34 offen lds
sad 34,25,82048
s_add_u32 m0, s29, 32768
s_nop 0
buffer_load_dwordx4 v6, s[12:15], s34 offen lds
s_add_u32 m0, s29, 33792
s_nop 0
buffer_load_dwordx4 v7, s[12:15], s34 offen lds
sad 34,25,163968
s_add_u32 m0, s29, 40960
s_nop 0
buffer_load_dwordx4 v6, s[12:15], s34 offen lds
s_add_u32 m0, s29, 41984
s_nop 0
buffer_load_dwordx4 v7, s[12:15], s34 offen lds
wv 6
ds_read_b128 v[32:35], v23 offset:0
ds_read_b128 v[36:39], v23 offset:256
ds_read_b128 v[40:43], v23 offset:4096
ds_read_b128 v[44:47], v23 offset:4352
ds_read_b128 v[48:51], v23 offset:64
ds_read_b128 v[52:55], v23 offset:320
ds_read_b128 v[56:59], v23 offset:4160
ds_read_b128 v[60:63], v23 offset:4416
ds_read_b128 v[64:67], v23 offset:8192
ds_read_b128 v[68:71], v23 offset:8448
ds_read_b128 v[72:75], v23 offset:12288
ds_read_b128 v[76:79], v23 offset:12544
ds_read_b128 v[80:83], v23 offset:8256
ds_read_b128 v[84:87], v23 offset:8512
ds_read_b128 v[88:91], v23 offset:12352
ds_read_b128 v[92:95], v23 offset:12608
ds_read_b128 v[96:99], v23 offset:16384
ds_read_b128 v[100:103], v23 offset:16640
ds_read_b128 v[104:107], v23 offset:20480
ds_read_b128 v[108:111], v23 offset:20736
ds_read_b128 v[112:115], v23 offset:16448
ds_read_b128 v[116:119], v23 offset:16704
ds_read_b128 v[120:123], v23 offset:20544
ds_read_b128 v[124:127], v23 offset:20800
wl 0
s_barrier
tra 64,8,0
tra 66,8,512
tra 68,9,0
tra 70,9,512
tra 72,10,0
tra 74,10,512
tra 76,11,0
tra 78,11,512
wl 6
mfw 128,32,64
tra 80,8,4096
tra 82,8,4608
mfw 132,36,64
sad 34,25,256
s_add_u32 m0, s29, 49152
s_nop 0
buffer_load_dwordx4 v6, s[12:15], s34 offen lds
mfw 136,40,64
mfw 140,44,64
s_add_u32 m0, s29, 50176
s_nop 0
buffer_load_dwordx4 v7, s[12:15], s34 offen lds
wl 6
mfw 144,32,68
tra 84,9,4096
tra 86,9,4608
mfw 148,36,68
mfw 152,40,68
sad 34,25,82176
s_add_u32 m0, s29, 57344
s_nop 0
buffer_load_dwordx4 v6, s[12:15], s34 offen lds
mfw 156,44,68
wl 6
mfw 160,32,72
tra 88,10,4096
tra 90,10,4608
mfw 164,36,72
s_add_u32 m0, s29, 58368
s_nop 0
buffer_load_dwordx4 v7, s[12:15], s34 offen lds
mfw 168,40,72
mfw 172,44,72
sad 34,25,164096
s_add_u32 m0, s29, 65536
s_nop 0
buffer_load_dwordx4 v6, s[12:15], s34 offen lds
wl 6
mfw 176,32,76
tra 92,11,4096
tra 94,11,4608
mfw 180,36,76
mfw 184,40,76
s_add_u32 m0, s29, 66560
s_nop 0
buffer_load_dwordx4 v7, s[12:15], s34 offen lds
mfw 188,44,76
wl 6
mfv 128,48,80
tra 64,8,8192
tra 66,8,8704
mfv 132,52,80
sad 34,25,384
s_add_u32 m0, s29, 73728
s_nop 0
buffer_load_dwordx4 v6, s[12:15], s34 offen lds
mfv 136,56,80
mfv 140,60,80
s_add_u32 m0, s29, 74752
s_nop 0
buffer_load_dwordx4 v7, s[12:15], s34 offen lds
wl 6
mfv 144,48,84
tra 68,9,8192
tra 70,9,8704
mfv 148,52,84
mfv 152,56,84
sad 34,25,82304
s_add_u32 m0, s29, 81920
s_nop 0
buffer_load_dwordx4 v6, s[12:15], s34 offen lds
mfv 156,60,84
wl 6
mfv 160,48,88
tra 72,10,8192
tra 74,10,8704
mfv 164,52,88
s_add_u32 m0, s29, 82944
s_nop 0
buffer_load_dwordx4 v7, s[12:15], s34 offen lds
mfv 168,56,88
mfv 172,60,88
sad 34,25,164224
s_add_u32 m0, s29, 90112
s_nop 0
buffer_load_dwordx4 v6, s[12:15], s34 offen lds
wl 6
mfv 176,48,92
tra 76,11,8192
tra 78,11,8704
mfv 180,52,92
mfv 184,56,92
s_add_u32 m0, s29, 91136
s_nop 0
buffer_load_dwordx4 v7, s[12:15], s34 offen lds
mfv 188,60,92
wl 6
mfv 128,64,64
tra 80,8,12288
tra 82,8,12800
mfv 132,68,64
sad 34,25,512
s_add_u32 m0, s29, 98304
s_nop 0
buffer_load_dwordx4 v6, s[12:15], s34 offen lds
mfv 136,72,64
mfv 140,76,64
s_add_u32 m0, s29, 99328
s_nop 0
buffer_load_dwordx4 v7, s[12:15], s34 offen lds
wl 6
mfv 144,64,68
tra 84,9,12288
tra 86,9,12800
mfv 148,68,68
mfv 152,72,68
sad 34,25,82432
s_add_u32 m0, s29, 106496
s_nop 0
buffer_load_dwordx4 v6, s[12:15], s34 offen lds
mfv 156,76,68
wl 6
mfv 160,64,72
tra 88,10,12288
tra 90,10,12800
mfv 164,68,72
s_add_u32 m0, s29, 107520
s_nop 0
buffer_load_dwordx4 v7, s[12:15], s34 offen lds
mfv 168,72,72
mfv 172,76,72
sad 34,25,164352
s_add_u32 m0, s29, 114688
s_nop 0
buffer_load_dwordx4 v6, s[12:15], s34 offen lds
wl 6
mfv 176,64,76
tra 92,11,12288
tra 94,11,12800
mfv 180,68,76
mfv 184,72,76
s_add_u32 m0, s29, 115712
s_nop 0
buffer_load_dwordx4 v7, s[12:15], s34 offen lds
mfv 188,76,76
wl 6
mfv 128,80,80
tra 64,8,16384
tra 66,8,16896
mfv 132,84,80
sad 34,25,640
s_add_u32 m0, s29, 122880
s_nop 0
buffer_load_dwordx4 v6, s[12:15], s34 offen lds
mfv 136,88,80
mfv 140,92,80
s_add_u32 m0, s29, 123904
s_nop 0
buffer_load_dwordx4 v7, s[12:15], s34 offen lds
wl 6
mfv 144,80,84
tra 68,9,16384
tra 70,9,16896
mfv 148,84,84
mfv 152,88,84
sad 34,25,82560
s_add_u32 m0, s29, 131072
s_nop 0
buffer_load_dwordx4 v6, s[12:15], s34 offen lds
mfv 156,92,84
wl 6
mfv 160,80,88
tra 72,10,16384
tra 74,10,16896
mfv 164,84,88
s_add_u32 m0, s29, 132096
s_nop 0
buffer_load_dwordx4 v7, s[12:15], s34 offen lds
mfv 168,88,88
mfv 172,92,88
sad 34,25,164480
s_add_u32 m0, s29, 139264
s_nop 0
buffer_load_dwordx4 v6, s[12:15], s34 offen lds
wl 6
mfv 176,80,92
tra 76,11,16384
tra 78,11,16896
mfv 180,84,92
mfv 184,88,92
s_add_u32 m0, s29, 140288
s_nop 0
buffer_load_dwordx4 v7, s[12:15], s34 offen lds
mfv 188,92,92
wl 6
mfv 128,96,64
tra 80,8,20480
tra 82,8,20992
mfv 132,100,64
mfv 136,104,64
mfv 140,108,64
wl 6
mfv 144,96,68
tra 84,9,20480
tra 86,9,20992
mfv 148,100,68
mfv 152,104,68
mfv 156,108,68
wl 6
mfv 160,96,72
tra 88,10,20480
tra 90,10,20992
mfv 164,100,72
mfv 168,104,72
mfv 172,108,72
wl 6
mfv 176,96,76
tra 92,11,20480
tra 94,11,20992
mfv 180,100,76
mfv 184,104,76
mfv 188,108,76
s_waitcnt vmcnt(24) lgkmcnt(0)
s_barrier
mfv 128,112,80
tra 64,8,24576
tra 66,8,25088
mfv 132,116,80
sad 34,25,768
s_add_u32 m0, s29, 0
s_nop 0
buffer_load_dwordx4 v6, s[12:15], s34 offen lds
mfv 136,120,80
mfv 140,124,80
s_add_u32 m0, s29, 1024
s_nop 0
buffer_load_dwordx4 v7, s[12:15], s34 offen lds
mfv 144,112,84
tra 68,9,24576
tra 70,9,25088
mfv 148,116,84
mfv 152,120,84
sad 34,25,82688
s_add_u32 m0, s29, 8192
s_nop 0
buffer_load_dwordx4 v6, s[12:15], s34 offen lds
mfv 156,124,84
mfv 160,112,88
tra 72,10,24576
tra 74,10,25088
mfv 164,116,88
s_add_u32 m0, s29, 9216
s_nop 0
buffer_load_dwordx4 v7, s[12:15], s34 offen lds
mfv 168,120,88
mfv 172,124,88
sad 34,25,164608
s_add_u32 m0, s29, 16384
s_nop 0
buffer_load_dwordx4 v6, s[12:15], s34 offen lds
mfv 176,112,92
tra 76,11,24576
tra 78,11,25088
mfv 180,116,92
mfv 184,120,92
s_add_u32 m0, s29, 17408
s_nop 0
buffer_load_dwordx4 v7, s[12:15], s34 offen lds
mfv 188,124,92
wl 6
mfw 192,32,64
tra 80,8,28672
tra 82,8,29184
mfw 196,36,64
mfw 200,40,64
mfw 204,44,64
wl 6
mfw 208,32,68
tra 84,9,28672
tra 86,9,29184
mfw 212,36,68
mfw 216,40,68
mfw 220,44,68
wl 6
mfw 224,32,72
tra 88,10,28672
tra 90,10,29184
mfw 228,36,72
mfw 232,40,72
mfw 236,44,72
wl 6
mfw 240,32,76
tra 92,11,28672
tra 94,11,29184
mfw 244,36,76
cvp 128,128,129
cvp 129,130,131
mfw 248,40,76
cvp 130,132,133
cvp 131,134,135
mfw 252,44,76
sad 32,47,0
buffer_store_dwordx4 v[128:131], v21, s[20:23], s32 offen sc1
wl 6
mfv 192,48,80
tra 64,8,32768
tra 66,8,33280
mfv 196,52,80
cvp 136,136,137
cvp 137,138,139
mfv 200,56,80
cvp 138,140,141
cvp 139,142,143
mfv 204,60,80
sad 32,47,1024
buffer_store_dwordx4 v[136:139], v21, s[20:23], s32 offen sc1
wl 6
mfv 208,48,84
tra 68,9,32768
tra 70,9,33280
mfv 212,52,84
cvp 144,144,145
cvp 145,146,147
mfv 216,56,84
cvp 146,148,149
cvp 147,150,151
mfv 220,60,84
sad 32,47,655360
buffer_store_dwordx4 v[144:147], v21, s[20:23], s32 offen sc1
wl 6
mfv 224,48,88
tra 72,10,32768
tra 74,10,33280
mfv 228,52,88
cvp 152,152,153
cvp 153,154,155
mfv 232,56,88
cvp 154,156,157
cvp 155,158,159
mfv 236,60,88
sad 32,47,656384
buffer_store_dwordx4 v[152:155], v21, s[20:23], s32 offen sc1
wl 6
mfv 240,48,92
tra 76,11,32768
tra 78,11,33280
mfv 244,52,92
cvp 160,160,161
cvp 161,162,163
mfv 248,56,92
cvp 162,164,165
cvp 163,166,167
mfv 252,60,92
sad 32,47,1310720
buffer_store_dwordx4 v[160:163], v21, s[20:23], s32 offen sc1
wl 6
mfv 192,64,64
tra 80,8,36864
tra 82,8,37376
mfv 196,68,64
cvp 168,168,169
cvp 169,170,171
mfv 200,72,64
cvp 170,172,173
cvp 171,174,175
mfv 204,76,64
sad 32,47,1311744
buffer_store_dwordx4 v[168:171], v21, s[20:23], s32 offen sc1
wl 6
mfv 208,64,68
tra 84,9,36864
tra 86,9,37376
mfv 212,68,68
cvp 176,176,177
cvp 177,178,179
mfv 216,72,68
cvp 178,180,181
cvp 179,182,183
mfv 220,76,68
sad 32,47,1966080
buffer_store_dwordx4 v[176:179], v21, s[20:23], s32 offen sc1
wl 6
mfv 224,64,72
tra 88,10,36864
tra 90,10,37376
mfv 228,68,72
cvp 184,184,185
cvp 185,186,187
mfv 232,72,72
cvp 186,188,189
cvp 187,190,191
mfv 236,76,72
sad 32,47,1967104
buffer_store_dwordx4 v[184:187], v21, s[20:23], s32 offen sc1
wl 6
mfv 240,64,76
tra 92,11,36864
tra 94,11,37376
mfv 244,68,76
mfv 248,72,76
mfv 252,76,76
wl 6
mfv 192,80,80
tra 64,8,40960
tra 66,8,41472
mfv 196,84,80
mfv 200,88,80
mfv 204,92,80
wl 6
mfv 208,80,84
tra 68,9,40960
tra 70,9,41472
mfv 212,84,84
mfv 216,88,84
mfv 220,92,84
wl 6
mfv 224,80,88
tra 72,10,40960
tra 74,10,41472
mfv 228,84,88
mfv 232,88,88
mfv 236,92,88
wl 6
mfv 240,80,92
tra 76,11,40960
tra 78,11,41472
mfv 244,84,92
mfv 248,88,92
mfv 252,92,92
wl 6
mfv 192,96,64
tra 80,8,45056
tra 82,8,45568
mfv 196,100,64
mfv 200,104,64
mfv 204,108,64
wl 6
mfv 208,96,68
tra 84,9,45056
tra 86,9,45568
mfv 212,100,68
mfv 216,104,68
mfv 220,108,68
wl 6
mfv 224,96,72
tra 88,10,45056
tra 90,10,45568
mfv 228,100,72
mfv 232,104,72
mfv 236,108,72
wl 6
mfv 240,96,76
tra 92,11,45056
tra 94,11,45568
mfv 244,100,76
mfv 248,104,76
mfv 252,108,76
s_waitcnt vmcnt(32) lgkmcnt(0)
s_barrier
mfv 192,112,80
tra 64,8,49152
tra 66,8,49664
mfv 196,116,80
sad 34,25,896
s_add_u32 m0, s29, 24576
s_nop 0
buffer_load_dwordx4 v6, s[12:15], s34 offen lds
mfv 200,120,80
mfv 204,124,80
s_add_u32 m0, s29, 25600
s_nop 0
buffer_load_dwordx4 v7, s[12:15], s34 offen lds
mfv 208,112,84
tra 68,9,49152
tra 70,9,49664
mfv 212,116,84
mfv 216,120,84
sad 34,25,82816
s_add_u32 m0, s29, 32768
s_nop 0
buffer_load_dwordx4 v6, s[12:15], s34 offen lds
mfv 220,124,84
mfv 224,112,88
tra 72,10,49152
tra 74,10,49664
mfv 228,116,88
s_add_u32 m0, s29, 33792
s_nop 0
buffer_load_dwordx4 v7, s[12:15], s34 offen lds
mfv 232,120,88
mfv 236,124,88
sad 34,25,164736
s_add_u32 m0, s29, 40960
s_nop 0
buffer_load_dwordx4 v6, s[12:15], s34 offen lds
mfv 240,112,92
tra 76,11,49152
tra 78,11,49664
mfv 244,116,92
mfv 248,120,92
s_add_u32 m0, s29, 41984
s_nop 0
buffer_load_dwordx4 v7, s[12:15], s34 offen lds
mfv 252,124,92
s_nop 1
wl 6
mfw 128,32,64
tra 80,8,53248
tra 82,8,53760
mfw 132,36,64
mfw 136,40,64
mfw 140,44,64
wl 6
mfw 144,32,68
tra 84,9,53248
tra 86,9,53760
mfw 148,36,68
mfw 152,40,68
mfw 156,44,68
wl 6
mfw 160,32,72
tra 88,10,53248
tra 90,10,53760
mfw 164,36,72
mfw 168,40,72
mfw 172,44,72
wl 6
mfw 176,32,76
tra 92,11,53248
tra 94,11,53760
mfw 180,36,76
cvp 192,192,193
cvp 193,194,195
mfw 184,40,76
cvp 194,196,197
cvp 195,198,199
mfw 188,44,76
sad 32,47,2621440
buffer_store_dwordx4 v[192:195], v21, s[20:23], s32 offen sc1
wl 6
mfv 128,48,80
tra 64,8,57344
tra 66,8,57856
mfv 132,52,80
cvp 200,200,201
cvp 201,202,203
mfv 136,56,80
cvp 202,204,205
cvp 203,206,207
mfv 140,60,80
sad 32,47,2622464
buffer_store_dwordx4 v[200:203], v21, s[20:23], s32 offen sc1
wl 6
mfv 144,48,84
tra 68,9,57344
tra 70,9,57856
mfv 148,52,84
cvp 208,208,209
cvp 209,210,211
mfv 152,56,84
cvp 210,212,213
cvp 211,214,215
mfv 156,60,84
sad 32,47,3276800
buffer_store_dwordx4 v[208:211], v21, s[20:23], s32 offen sc1
wl 6
mfv 160,48,88
tra 72,10,57344
tra 74,10,57856
mfv 164,52,88
cvp 216,216,217
cvp 217,218,219
mfv 168,56,88
cvp 218,220,221
cvp 219,222,223
mfv 172,60,88
sad 32,47,3277824
buffer_store_dwordx4 v[216:219], v21, s[20:23], s32 offen sc1
wl 6
mfv 176,48,92
tra 76,11,57344
tra 78,11,57856
mfv 180,52,92
cvp 224,224,225
cvp 225,226,227
mfv 184,56,92
cvp 226,228,229
cvp 227,230,231
mfv 188,60,92
sad 32,47,3932160
buffer_store_dwordx4 v[224:227], v21, s[20:23], s32 offen sc1
wl 6
mfv 128,64,64
tra 80,8,61440
tra 82,8,61952
mfv 132,68,64
cvp 232,232,233
cvp 233,234,235
mfv 136,72,64
cvp 234,236,237
cvp 235,238,239
mfv 140,76,64
sad 32,47,3933184
buffer_store_dwordx4 v[232:235], v21, s[20:23], s32 offen sc1
wl 6
mfv 144,64,68
tra 84,9,61440
tra 86,9,61952
mfv 148,68,68
cvp 240,240,241
cvp 241,242,243
mfv 152,72,68
cvp 242,244,245
cvp 243,246,247
mfv 156,76,68
sad 32,47,4587520
buffer_store_dwordx4 v[240:243], v21, s[20:23], s32 offen sc1
wl 6
mfv 160,64,72
tra 88,10,61440
tra 90,10,61952
mfv 164,68,72
cvp 248,248,249
cvp 249,250,251
mfv 168,72,72
cvp 250,252,253
cvp 251,254,255
mfv 172,76,72
sad 32,47,4588544
buffer_store_dwordx4 v[248:251], v21, s[20:23], s32 offen sc1
wl 6
mfv 176,64,76
tra 92,11,61440
tra 94,11,61952
mfv 180,68,76
mfv 184,72,76
mfv 188,76,76
wl 6
mfv 128,80,80
tra 64,12,16384
tra 66,12,16896
mfv 132,84,80
mfv 136,88,80
mfv 140,92,80
wl 6
mfv 144,80,84
tra 68,13,16384
tra 70,13,16896
mfv 148,84,84
mfv 152,88,84
mfv 156,92,84
wl 6
mfv 160,80,88
tra 72,14,16384
tra 74,14,16896
mfv 164,84,88
mfv 168,88,88
mfv 172,92,88
wl 6
mfv 176,80,92
tra 76,15,16384
tra 78,15,16896
mfv 180,84,92
mfv 184,88,92
mfv 188,92,92
wl 6
mfv 128,96,64
tra 80,12,20480
tra 82,12,20992
mfv 132,100,64
mfv 136,104,64
mfv 140,108,64
wl 6
mfv 144,96,68
tra 84,13,20480
tra 86,13,20992
mfv 148,100,68
mfv 152,104,68
mfv 156,108,68
wl 6
mfv 160,96,72
tra 88,14,20480
tra 90,14,20992
mfv 164,100,72
mfv 168,104,72
mfv 172,108,72
wl 6
mfv 176,96,76
tra 92,15,20480
tra 94,15,20992
mfv 180,100,76
mfv 184,104,76
mfv 188,108,76
s_waitcnt vmcnt(40) lgkmcnt(0)
s_barrier
mfv 128,112,80
tra 64,12,24576
tra 66,12,25088
mfv 132,116,80
sad 34,25,1024
s_add_u32 m0, s29, 49152
s_nop 0
buffer_load_dwordx4 v6, s[12:15], s34 offen lds
mfv 136,120,80
mfv 140,124,80
mfv 144,112,84
tra 68,13,24576
tra 70,13,25088
mfv 148,116,84
s_add_u32 m0, s29, 50176
s_nop 0
buffer_load_dwordx4 v7, s[12:15], s34 offen lds
mfv 152,120,84
mfv 156,124,84
mfv 160,112,88
tra 72,14,24576
tra 74,14,25088
mfv 164,116,88
sad 34,25,82944
s_add_u32 m0, s29, 57344
s_nop 0
buffer_load_dwordx4 v6, s[12:15], s34 offen lds
mfv 168,120,88
mfv 172,124,88
mfv 176,112,92
tra 76,15,24576
tra 78,15,25088
mfv 180,116,92
s_add_u32 m0, s29, 58368
s_nop 0
buffer_load_dwordx4 v7, s[12:15], s34 offen lds
mfv 184,120,92
mfv 188,124,92
s_nop 1
wl 6
mfw 192,32,64
tra 80,12,28672
tra 82,12,29184
mfw 196,36,64
sad 34,25,164864
s_add_u32 m0, s29, 65536
s_nop 0
buffer_load_dwordx4 v6, s[12:15], s34 offen lds
mfw 200,40,64
mfw 204,44,64
wl 6
mfw 208,32,68
tra 84,13,28672
tra 86,13,29184
mfw 212,36,68
s_add_u32 m0, s29, 66560
s_nop 0
buffer_load_dwordx4 v7, s[12:15], s34 offen lds
mfw 216,40,68
mfw 220,44,68
wl 6
mfw 224,32,72
tra 88,14,28672
tra 90,14,29184
mfw 228,36,72
mfw 232,40,72
mfw 236,44,72
wl 6
mfw 240,32,76
tra 92,15,28672
tra 94,15,29184
mfw 244,36,76
cvp 128,128,129
cvp 129,130,131
mfw 248,40,76
cvp 130,132,133
cvp 131,134,135
mfw 252,44,76
sad 32,47,5242880
buffer_store_dwordx4 v[128:131], v21, s[20:23], s32 offen sc1
wl 6
mfv 192,48,80
tra 64,12,32768
tra 66,12,33280
mfv 196,52,80
cvp 136,136,137
cvp 137,138,139
mfv 200,56,80
cvp 138,140,141
cvp 139,142,143
mfv 204,60,80
sad 32,47,5243904
buffer_store_dwordx4 v[136:139], v21, s[20:23], s32 offen sc1
wl 6
mfv 208,48,84
tra 68,13,32768
tra 70,13,33280
mfv 212,52,84
cvp 144,144,145
cvp 145,146,147
mfv 216,56,84
cvp 146,148,149
cvp 147,150,151
mfv 220,60,84
sad 32,47,5898240
buffer_store_dwordx4 v[144:147], v21, s[20:23], s32 offen sc1
wl 6
mfv 224,48,88
tra 72,14,32768
tra 74,14,33280
mfv 228,52,88
cvp 152,152,153
cvp 153,154,155
mfv 232,56,88
cvp 154,156,157
cvp 155,158,159
mfv 236,60,88
sad 32,47,5899264
buffer_store_dwordx4 v[152:155], v21, s[20:23], s32 offen sc1
wl 6
mfv 240,48,92
tra 76,15,32768
tra 78,15,33280
mfv 244,52,92
cvp 160,160,161
cvp 161,162,163
mfv 248,56,92
cvp 162,164,165
cvp 163,166,167
mfv 252,60,92
sad 32,47,6553600
buffer_store_dwordx4 v[160:163], v21, s[20:23], s32 offen sc1
wl 6
mfv 192,64,64
tra 80,12,36864
tra 82,12,37376
mfv 196,68,64
cvp 168,168,169
cvp 169,170,171
mfv 200,72,64
cvp 170,172,173
cvp 171,174,175
mfv 204,76,64
sad 32,47,6554624
buffer_store_dwordx4 v[168:171], v21, s[20:23], s32 offen sc1
wl 6
mfv 208,64,68
tra 84,13,36864
tra 86,13,37376
mfv 212,68,68
cvp 176,176,177
cvp 177,178,179
mfv 216,72,68
cvp 178,180,181
cvp 179,182,183
mfv 220,76,68
sad 32,47,7208960
buffer_store_dwordx4 v[176:179], v21, s[20:23], s32 offen sc1
wl 6
mfv 224,64,72
tra 88,14,36864
tra 90,14,37376
mfv 228,68,72
cvp 184,184,185
cvp 185,186,187
mfv 232,72,72
cvp 186,188,189
cvp 187,190,191
mfv 236,76,72
sad 32,47,7209984
buffer_store_dwordx4 v[184:187], v21, s[20:23], s32 offen sc1
wl 6
mfv 240,64,76
tra 92,15,36864
tra 94,15,37376
mfv 244,68,76
mfv 248,72,76
mfv 252,76,76
wl 6
mfv 192,80,80
tra 64,12,40960
tra 66,12,41472
mfv 196,84,80
mfv 200,88,80
mfv 204,92,80
wl 6
mfv 208,80,84
tra 68,13,40960
tra 70,13,41472
mfv 212,84,84
mfv 216,88,84
mfv 220,92,84
wl 6
mfv 224,80,88
tra 72,14,40960
tra 74,14,41472
mfv 228,84,88
mfv 232,88,88
mfv 236,92,88
wl 6
mfv 240,80,92
tra 76,15,40960
tra 78,15,41472
mfv 244,84,92
mfv 248,88,92
mfv 252,92,92
wl 6
mfv 192,96,64
tra 80,12,45056
tra 82,12,45568
mfv 196,100,64
mfv 200,104,64
mfv 204,108,64
wl 6
mfv 208,96,68
tra 84,13,45056
tra 86,13,45568
mfv 212,100,68
mfv 216,104,68
mfv 220,108,68
wl 6
mfv 224,96,72
tra 88,14,45056
tra 90,14,45568
mfv 228,100,72
mfv 232,104,72
mfv 236,108,72
wl 6
mfv 240,96,76
tra 92,15,45056
tra 94,15,45568
mfv 244,100,76
mfv 248,104,76
mfv 252,108,76
s_waitcnt vmcnt(48) lgkmcnt(0)
s_barrier
mfv 192,112,80
tra 64,12,49152
tra 66,12,49664
mfv 196,116,80
sad 34,25,1152
s_add_u32 m0, s29, 73728
s_nop 0
buffer_load_dwordx4 v6, s[12:15], s34 offen lds
mfv 200,120,80
mfv 204,124,80
mfv 208,112,84
tra 68,13,49152
tra 70,13,49664
mfv 212,116,84
s_add_u32 m0, s29, 74752
s_nop 0
buffer_load_dwordx4 v7, s[12:15], s34 offen lds
mfv 216,120,84
mfv 220,124,84
mfv 224,112,88
tra 72,14,49152
tra 74,14,49664
mfv 228,116,88
sad 34,25,83072
s_add_u32 m0, s29, 81920
s_nop 0
buffer_load_dwordx4 v6, s[12:15], s34 offen lds
mfv 232,120,88
mfv 236,124,88
mfv 240,112,92
tra 76,15,49152
tra 78,15,49664
mfv 244,116,92
s_add_u32 m0, s29, 82944
s_nop 0
buffer_load_dwordx4 v7, s[12:15], s34 offen lds
mfv 248,120,92
mfv 252,124,92
s_nop 1
wl 6
mfw 128,32,64
tra 80,12,53248
tra 82,12,53760
mfw 132,36,64
sad 34,25,164992
s_add_u32 m0, s29, 90112
s_nop 0
buffer_load_dwordx4 v6, s[12:15], s34 offen lds
mfw 136,40,64
mfw 140,44,64
wl 6
mfw 144,32,68
tra 84,13,53248
tra 86,13,53760
mfw 148,36,68
s_add_u32 m0, s29, 91136
s_nop 0
buffer_load_dwordx4 v7, s[12:15], s34 offen lds
mfw 152,40,68
mfw 156,44,68
wl 6
mfw 160,32,72
tra 88,14,53248
tra 90,14,53760
mfw 164,36,72
mfw 168,40,72
mfw 172,44,72
wl 6
mfw 176,32,76
tra 92,15,53248
tra 94,15,53760
mfw 180,36,76
cvp 192,192,193
cvp 193,194,195
mfw 184,40,76
cvp 194,196,197
cvp 195,198,199
mfw 188,44,76
sad 32,47,7864320
buffer_store_dwordx4 v[192:195], v21, s[20:23], s32 offen sc1
wl 6
mfv 128,48,80
tra 64,12,57344
tra 66,12,57856
mfv 132,52,80
cvp 200,200,201
cvp 201,202,203
mfv 136,56,80
cvp 202,204,205
cvp 203,206,207
mfv 140,60,80
sad 32,47,7865344
buffer_store_dwordx4 v[200:203], v21, s[20:23], s32 offen sc1
wl 6
mfv 144,48,84
tra 68,13,57344
tra 70,13,57856
mfv 148,52,84
cvp 208,208,209
cvp 209,210,211
mfv 152,56,84
cvp 210,212,213
cvp 211,214,215
mfv 156,60,84
sad 32,47,8519680
buffer_store_dwordx4 v[208:211], v21, s[20:23], s32 offen sc1
wl 6
mfv 160,48,88
tra 72,14,57344
tra 74,14,57856
mfv 164,52,88
cvp 216,216,217
cvp 217,218,219
mfv 168,56,88
cvp 218,220,221
cvp 219,222,223
mfv 172,60,88
sad 32,47,8520704
buffer_store_dwordx4 v[216:219], v21, s[20:23], s32 offen sc1
wl 6
mfv 176,48,92
tra 76,15,57344
tra 78,15,57856
mfv 180,52,92
cvp 224,224,225
cvp 225,226,227
mfv 184,56,92
cvp 226,228,229
cvp 227,230,231
mfv 188,60,92
sad 32,47,9175040
buffer_store_dwordx4 v[224:227], v21, s[20:23], s32 offen sc1
wl 6
mfv 128,64,64
tra 80,12,61440
tra 82,12,61952
mfv 132,68,64
cvp 232,232,233
cvp 233,234,235
mfv 136,72,64
cvp 234,236,237
cvp 235,238,239
mfv 140,76,64
sad 32,47,9176064
buffer_store_dwordx4 v[232:235], v21, s[20:23], s32 offen sc1
wl 6
mfv 144,64,68
tra 84,13,61440
tra 86,13,61952
mfv 148,68,68
cvp 240,240,241
cvp 241,242,243
mfv 152,72,68
cvp 242,244,245
cvp 243,246,247
mfv 156,76,68
sad 32,47,9830400
buffer_store_dwordx4 v[240:243], v21, s[20:23], s32 offen sc1
wl 6
mfv 160,64,72
tra 88,14,61440
tra 90,14,61952
mfv 164,68,72
cvp 248,248,249
cvp 249,250,251
mfv 168,72,72
cvp 250,252,253
cvp 251,254,255
mfv 172,76,72
sad 32,47,9831424
buffer_store_dwordx4 v[248:251], v21, s[20:23], s32 offen sc1
wl 6
mfv 176,64,76
tra 92,15,61440
tra 94,15,61952
mfv 180,68,76
mfv 184,72,76
mfv 188,76,76
wl 6
mfv 128,80,80
tra 64,24,16384
tra 66,24,16896
mfv 132,84,80
mfv 136,88,80
mfv 140,92,80
wl 6
mfv 144,80,84
tra 68,25,16384
tra 70,25,16896
mfv 148,84,84
mfv 152,88,84
mfv 156,92,84
wl 6
mfv 160,80,88
tra 72,26,16384
tra 74,26,16896
mfv 164,84,88
mfv 168,88,88
mfv 172,92,88
wl 6
mfv 176,80,92
tra 76,27,16384
tra 78,27,16896
mfv 180,84,92
mfv 184,88,92
mfv 188,92,92
wl 6
mfv 128,96,64
tra 80,24,20480
tra 82,24,20992
mfv 132,100,64
mfv 136,104,64
mfv 140,108,64
wl 6
mfv 144,96,68
tra 84,25,20480
tra 86,25,20992
mfv 148,100,68
mfv 152,104,68
mfv 156,108,68
wl 6
mfv 160,96,72
tra 88,26,20480
tra 90,26,20992
mfv 164,100,72
mfv 168,104,72
mfv 172,108,72
wl 6
mfv 176,96,76
tra 92,27,20480
tra 94,27,20992
mfv 180,100,76
mfv 184,104,76
mfv 188,108,76
s_waitcnt vmcnt(56) lgkmcnt(0)
s_barrier
mfv 128,112,80
tra 64,24,24576
tra 66,24,25088
mfv 132,116,80
mfv 136,120,80
mfv 140,124,80
mfv 144,112,84
tra 68,25,24576
tra 70,25,25088
mfv 148,116,84
mfv 152,120,84
mfv 156,124,84
mfv 160,112,88
tra 72,26,24576
tra 74,26,25088
mfv 164,116,88
mfv 168,120,88
mfv 172,124,88
mfv 176,112,92
tra 76,27,24576
tra 78,27,25088
mfv 180,116,92
mfv 184,120,92
mfv 188,124,92
s_nop 1
wl 6
mfw 192,32,64
tra 80,24,28672
tra 82,24,29184
mfw 196,36,64
mfw 200,40,64
mfw 204,44,64
wl 6
mfw 208,32,68
tra 84,25,28672
tra 86,25,29184
mfw 212,36,68
mfw 216,40,68
mfw 220,44,68
wl 6
mfw 224,32,72
tra 88,26,28672
tra 90,26,29184
mfw 228,36,72
mfw 232,40,72
mfw 236,44,72
wl 6
mfw 240,32,76
tra 92,27,28672
tra 94,27,29184
mfw 244,36,76
cvp 128,128,129
cvp 129,130,131
mfw 248,40,76
cvp 130,132,133
cvp 131,134,135
mfw 252,44,76
sad 32,47,10485760
buffer_store_dwordx4 v[128:131], v21, s[20:23], s32 offen sc1
wl 6
mfv 192,48,80
tra 64,24,32768
tra 66,24,33280
mfv 196,52,80
cvp 136,136,137
cvp 137,138,139
mfv 200,56,80
cvp 138,140,141
cvp 139,142,143
mfv 204,60,80
sad 32,47,10486784
buffer_store_dwordx4 v[136:139], v21, s[20:23], s32 offen sc1
wl 6
mfv 208,48,84
tra 68,25,32768
tra 70,25,33280
mfv 212,52,84
cvp 144,144,145
cvp 145,146,147
mfv 216,56,84
cvp 146,148,149
cvp 147,150,151
mfv 220,60,84
sad 32,47,11141120
buffer_store_dwordx4 v[144:147], v21, s[20:23], s32 offen sc1
wl 6
mfv 224,48,88
tra 72,26,32768
tra 74,26,33280
mfv 228,52,88
cvp 152,152,153
cvp 153,154,155
mfv 232,56,88
cvp 154,156,157
cvp 155,158,159
mfv 236,60,88
sad 32,47,11142144
buffer_store_dwordx4 v[152:155], v21, s[20:23], s32 offen sc1
wl 6
mfv 240,48,92
tra 76,27,32768
tra 78,27,33280
mfv 244,52,92
cvp 160,160,161
cvp 161,162,163
mfv 248,56,92
cvp 162,164,165
cvp 163,166,167
mfv 252,60,92
sad 32,47,11796480
buffer_store_dwordx4 v[160:163], v21, s[20:23], s32 offen sc1
wl 6
mfv 192,64,64
tra 80,24,36864
tra 82,24,37376
mfv 196,68,64
cvp 168,168,169
cvp 169,170,171
mfv 200,72,64
cvp 170,172,173
cvp 171,174,175
mfv 204,76,64
sad 32,47,11797504
buffer_store_dwordx4 v[168:171], v21, s[20:23], s32 offen sc1
wl 6
mfv 208,64,68
tra 84,25,36864
tra 86,25,37376
mfv 212,68,68
cvp 176,176,177
cvp 177,178,179
mfv 216,72,68
cvp 178,180,181
cvp 179,182,183
mfv 220,76,68
sad 32,47,12451840
buffer_store_dwordx4 v[176:179], v21, s[20:23], s32 offen sc1
wl 6
mfv 224,64,72
tra 88,26,36864
tra 90,26,37376
mfv 228,68,72
cvp 184,184,185
cvp 185,186,187
mfv 232,72,72
cvp 186,188,189
cvp 187,190,191
mfv 236,76,72
sad 32,47,12452864
buffer_store_dwordx4 v[184:187], v21, s[20:23], s32 offen sc1
wl 6
mfv 240,64,76
tra 92,27,36864
tra 94,27,37376
mfv 244,68,76
mfv 248,72,76
mfv 252,76,76
wl 6
mfv 192,80,80
tra 64,24,40960
tra 66,24,41472
mfv 196,84,80
mfv 200,88,80
mfv 204,92,80
wl 6
mfv 208,80,84
tra 68,25,40960
tra 70,25,41472
mfv 212,84,84
mfv 216,88,84
mfv 220,92,84
wl 6
mfv 224,80,88
tra 72,26,40960
tra 74,26,41472
mfv 228,84,88
mfv 232,88,88
mfv 236,92,88
wl 6
mfv 240,80,92
tra 76,27,40960
tra 78,27,41472
mfv 244,84,92
mfv 248,88,92
mfv 252,92,92
wl 6
mfv 192,96,64
tra 80,24,45056
tra 82,24,45568
mfv 196,100,64
mfv 200,104,64
mfv 204,108,64
wl 6
mfv 208,96,68
tra 84,25,45056
tra 86,25,45568
mfv 212,100,68
mfv 216,104,68
mfv 220,108,68
wl 6
mfv 224,96,72
tra 88,26,45056
tra 90,26,45568
mfv 228,100,72
mfv 232,104,72
mfv 236,108,72
wl 6
mfv 240,96,76
tra 92,27,45056
tra 94,27,45568
mfv 244,100,76
mfv 248,104,76
mfv 252,108,76
s_waitcnt vmcnt(58) lgkmcnt(0)
s_barrier
mfv 192,112,80
tra 64,8,0
tra 66,8,512
mfv 196,116,80
mfv 200,120,80
mfv 204,124,80
mfv 208,112,84
tra 68,9,0
tra 70,9,512
mfv 212,116,84
mfv 216,120,84
mfv 220,124,84
mfv 224,112,88
tra 72,10,0
tra 74,10,512
mfv 228,116,88
mfv 232,120,88
mfv 236,124,88
mfv 240,112,92
tra 76,11,0
tra 78,11,512
mfv 244,116,92
mfv 248,120,92
mfv 252,124,92
s_nop 1
wl 6
mfw 128,32,64
tra 80,8,4096
tra 82,8,4608
mfw 132,36,64
mfw 136,40,64
mfw 140,44,64
wl 6
mfw 144,32,68
tra 84,9,4096
tra 86,9,4608
mfw 148,36,68
mfw 152,40,68
mfw 156,44,68
wl 6
mfw 160,32,72
tra 88,10,4096
tra 90,10,4608
mfw 164,36,72
mfw 168,40,72
mfw 172,44,72
wl 6
mfw 176,32,76
tra 92,11,4096
tra 94,11,4608
mfw 180,36,76
cvp 192,192,193
cvp 193,194,195
mfw 184,40,76
cvp 194,196,197
cvp 195,198,199
mfw 188,44,76
sad 32,47,13107200
buffer_store_dwordx4 v[192:195], v21, s[20:23], s32 offen sc1
wl 6
mfv 128,48,80
tra 64,8,8192
tra 66,8,8704
mfv 132,52,80
cvp 200,200,201
cvp 201,202,203
mfv 136,56,80
cvp 202,204,205
cvp 203,206,207
mfv 140,60,80
sad 32,47,13108224
buffer_store_dwordx4 v[200:203], v21, s[20:23], s32 offen sc1
wl 6
mfv 144,48,84
tra 68,9,8192
tra 70,9,8704
mfv 148,52,84
cvp 208,208,209
cvp 209,210,211
mfv 152,56,84
cvp 210,212,213
cvp 211,214,215
mfv 156,60,84
sad 32,47,13762560
buffer_store_dwordx4 v[208:211], v21, s[20:23], s32 offen sc1
wl 6
mfv 160,48,88
tra 72,10,8192
tra 74,10,8704
mfv 164,52,88
cvp 216,216,217
cvp 217,218,219
mfv 168,56,88
cvp 218,220,221
cvp 219,222,223
mfv 172,60,88
sad 32,47,13763584
buffer_store_dwordx4 v[216:219], v21, s[20:23], s32 offen sc1
wl 6
mfv 176,48,92
tra 76,11,8192
tra 78,11,8704
mfv 180,52,92
cvp 224,224,225
cvp 225,226,227
mfv 184,56,92
cvp 226,228,229
cvp 227,230,231
mfv 188,60,92
sad 32,47,14417920
buffer_store_dwordx4 v[224:227], v21, s[20:23], s32 offen sc1
wl 6
mfv 128,64,64
tra 80,8,12288
tra 82,8,12800
mfv 132,68,64
cvp 232,232,233
cvp 233,234,235
mfv 136,72,64
cvp 234,236,237
cvp 235,238,239
mfv 140,76,64
sad 32,47,14418944
buffer_store_dwordx4 v[232:235], v21, s[20:23], s32 offen sc1
wl 6
mfv 144,64,68
tra 84,9,12288
tra 86,9,12800
mfv 148,68,68
cvp 240,240,241
cvp 241,242,243
mfv 152,72,68
cvp 242,244,245
cvp 243,246,247
mfv 156,76,68
sad 32,47,15073280
buffer_store_dwordx4 v[240:243], v21, s[20:23], s32 offen sc1
wl 6
mfv 160,64,72
tra 88,10,12288
tra 90,10,12800
mfv 164,68,72
cvp 248,248,249
cvp 249,250,251
mfv 168,72,72
cvp 250,252,253
cvp 251,254,255
mfv 172,76,72
sad 32,47,15074304
buffer_store_dwordx4 v[248:251], v21, s[20:23], s32 offen sc1
wl 6
mfv 176,64,76
tra 92,11,12288
tra 94,11,12800
mfv 180,68,76
mfv 184,72,76
mfv 188,76,76
wl 6
mfv 128,80,80
tra 64,8,16384
tra 66,8,16896
mfv 132,84,80
mfv 136,88,80
mfv 140,92,80
wl 6
mfv 144,80,84
tra 68,9,16384
tra 70,9,16896
mfv 148,84,84
mfv 152,88,84
mfv 156,92,84
wl 6
mfv 160,80,88
tra 72,10,16384
tra 74,10,16896
mfv 164,84,88
mfv 168,88,88
mfv 172,92,88
wl 6
mfv 176,80,92
tra 76,11,16384
tra 78,11,16896
mfv 180,84,92
mfv 184,88,92
mfv 188,92,92
wl 6
mfv 128,96,64
tra 80,8,20480
tra 82,8,20992
mfv 132,100,64
mfv 136,104,64
mfv 140,108,64
wl 6
mfv 144,96,68
tra 84,9,20480
tra 86,9,20992
mfv 148,100,68
mfv 152,104,68
mfv 156,108,68
wl 6
mfv 160,96,72
tra 88,10,20480
tra 90,10,20992
mfv 164,100,72
mfv 168,104,72
mfv 172,108,72
wl 6
mfv 176,96,76
tra 92,11,20480
tra 94,11,20992
mfv 180,100,76
mfv 184,104,76
mfv 188,108,76
s_waitcnt vmcnt(52) lgkmcnt(0)
s_barrier
mfv 128,112,80
tra 64,8,24576
tra 66,8,25088
mfv 132,116,80
mfv 136,120,80
mfv 140,124,80
mfv 144,112,84
tra 68,9,24576
tra 70,9,25088
mfv 148,116,84
mfv 152,120,84
mfv 156,124,84
mfv 160,112,88
tra 72,10,24576
tra 74,10,25088
mfv 164,116,88
mfv 168,120,88
mfv 172,124,88
mfv 176,112,92
tra 76,11,24576
tra 78,11,25088
mfv 180,116,92
mfv 184,120,92
mfv 188,124,92
s_nop 1
wl 6
mfw 192,32,64
tra 80,8,28672
tra 82,8,29184
mfw 196,36,64
mfw 200,40,64
mfw 204,44,64
wl 6
mfw 208,32,68
tra 84,9,28672
tra 86,9,29184
mfw 212,36,68
mfw 216,40,68
mfw 220,44,68
wl 6
mfw 224,32,72
tra 88,10,28672
tra 90,10,29184
mfw 228,36,72
mfw 232,40,72
mfw 236,44,72
wl 6
mfw 240,32,76
tra 92,11,28672
tra 94,11,29184
mfw 244,36,76
cvp 128,128,129
cvp 129,130,131
mfw 248,40,76
cvp 130,132,133
cvp 131,134,135
mfw 252,44,76
sad 32,47,15728640
buffer_store_dwordx4 v[128:131], v21, s[20:23], s32 offen sc1
wl 6
mfv 192,48,80
tra 64,8,32768
tra 66,8,33280
mfv 196,52,80
cvp 136,136,137
cvp 137,138,139
mfv 200,56,80
cvp 138,140,141
cvp 139,142,143
mfv 204,60,80
sad 32,47,15729664
buffer_store_dwordx4 v[136:139], v21, s[20:23], s32 offen sc1
wl 6
mfv 208,48,84
tra 68,9,32768
tra 70,9,33280
mfv 212,52,84
cvp 144,144,145
cvp 145,146,147
mfv 216,56,84
cvp 146,148,149
cvp 147,150,151
mfv 220,60,84
sad 32,47,16384000
buffer_store_dwordx4 v[144:147], v21, s[20:23], s32 offen sc1
wl 6
mfv 224,48,88
tra 72,10,32768
tra 74,10,33280
mfv 228,52,88
cvp 152,152,153
cvp 153,154,155
mfv 232,56,88
cvp 154,156,157
cvp 155,158,159
mfv 236,60,88
sad 32,47,16385024
buffer_store_dwordx4 v[152:155], v21, s[20:23], s32 offen sc1
wl 6
mfv 240,48,92
tra 76,11,32768
tra 78,11,33280
mfv 244,52,92
cvp 160,160,161
cvp 161,162,163
mfv 248,56,92
cvp 162,164,165
cvp 163,166,167
mfv 252,60,92
sad 32,47,17039360
buffer_store_dwordx4 v[160:163], v21, s[20:23], s32 offen sc1
wl 6
mfv 192,64,64
tra 80,8,36864
tra 82,8,37376
mfv 196,68,64
cvp 168,168,169
cvp 169,170,171
mfv 200,72,64
cvp 170,172,173
cvp 171,174,175
mfv 204,76,64
sad 32,47,17040384
buffer_store_dwordx4 v[168:171], v21, s[20:23], s32 offen sc1
wl 6
mfv 208,64,68
tra 84,9,36864
tra 86,9,37376
mfv 212,68,68
cvp 176,176,177
cvp 177,178,179
mfv 216,72,68
cvp 178,180,181
cvp 179,182,183
mfv 220,76,68
sad 32,47,17694720
buffer_store_dwordx4 v[176:179], v21, s[20:23], s32 offen sc1
wl 6
mfv 224,64,72
tra 88,10,36864
tra 90,10,37376
mfv 228,68,72
cvp 184,184,185
cvp 185,186,187
mfv 232,72,72
cvp 186,188,189
cvp 187,190,191
mfv 236,76,72
sad 32,47,17695744
buffer_store_dwordx4 v[184:187], v21, s[20:23], s32 offen sc1
wl 6
mfv 240,64,76
tra 92,11,36864
tra 94,11,37376
mfv 244,68,76
mfv 248,72,76
mfv 252,76,76
wl 6
mfv 192,80,80
tra 64,8,40960
tra 66,8,41472
mfv 196,84,80
mfv 200,88,80
mfv 204,92,80
wl 6
mfv 208,80,84
tra 68,9,40960
tra 70,9,41472
mfv 212,84,84
mfv 216,88,84
mfv 220,92,84
wl 6
mfv 224,80,88
tra 72,10,40960
tra 74,10,41472
mfv 228,84,88
mfv 232,88,88
mfv 236,92,88
wl 6
mfv 240,80,92
tra 76,11,40960
tra 78,11,41472
mfv 244,84,92
mfv 248,88,92
mfv 252,92,92
wl 6
mfv 192,96,64
tra 80,8,45056
tra 82,8,45568
mfv 196,100,64
mfv 200,104,64
mfv 204,108,64
wl 6
mfv 208,96,68
tra 84,9,45056
tra 86,9,45568
mfv 212,100,68
mfv 216,104,68
mfv 220,108,68
wl 6
mfv 224,96,72
tra 88,10,45056
tra 90,10,45568
mfv 228,100,72
mfv 232,104,72
mfv 236,108,72
wl 6
mfv 240,96,76
tra 92,11,45056
tra 94,11,45568
mfv 244,100,76
mfv 248,104,76
mfv 252,108,76
s_waitcnt vmcnt(46) lgkmcnt(0)
s_barrier
mfv 192,112,80
tra 64,8,49152
tra 66,8,49664
mfv 196,116,80
mfv 200,120,80
mfv 204,124,80
mfv 208,112,84
tra 68,9,49152
tra 70,9,49664
mfv 212,116,84
mfv 216,120,84
mfv 220,124,84
mfv 224,112,88
tra 72,10,49152
tra 74,10,49664
mfv 228,116,88
mfv 232,120,88
mfv 236,124,88
mfv 240,112,92
tra 76,11,49152
tra 78,11,49664
mfv 244,116,92
mfv 248,120,92
mfv 252,124,92
s_nop 1
wl 6
mfw 128,32,64
tra 80,8,53248
tra 82,8,53760
mfw 132,36,64
mfw 136,40,64
mfw 140,44,64
wl 6
mfw 144,32,68
tra 84,9,53248
tra 86,9,53760
mfw 148,36,68
mfw 152,40,68
mfw 156,44,68
wl 6
mfw 160,32,72
tra 88,10,53248
tra 90,10,53760
mfw 164,36,72
mfw 168,40,72
mfw 172,44,72
wl 6
mfw 176,32,76
tra 92,11,53248
tra 94,11,53760
mfw 180,36,76
cvp 192,192,193
cvp 193,194,195
mfw 184,40,76
cvp 194,196,197
cvp 195,198,199
mfw 188,44,76
sad 32,47,18350080
buffer_store_dwordx4 v[192:195], v21, s[20:23], s32 offen sc1
wl 6
mfv 128,48,80
tra 64,8,57344
tra 66,8,57856
mfv 132,52,80
cvp 200,200,201
cvp 201,202,203
mfv 136,56,80
cvp 202,204,205
cvp 203,206,207
mfv 140,60,80
sad 32,47,18351104
buffer_store_dwordx4 v[200:203], v21, s[20:23], s32 offen sc1
wl 6
mfv 144,48,84
tra 68,9,57344
tra 70,9,57856
mfv 148,52,84
cvp 208,208,209
cvp 209,210,211
mfv 152,56,84
cvp 210,212,213
cvp 211,214,215
mfv 156,60,84
sad 32,47,19005440
buffer_store_dwordx4 v[208:211], v21, s[20:23], s32 offen sc1
wl 6
mfv 160,48,88
tra 72,10,57344
tra 74,10,57856
mfv 164,52,88
cvp 216,216,217
cvp 217,218,219
mfv 168,56,88
cvp 218,220,221
cvp 219,222,223
mfv 172,60,88
sad 32,47,19006464
buffer_store_dwordx4 v[216:219], v21, s[20:23], s32 offen sc1
wl 6
mfv 176,48,92
tra 76,11,57344
tra 78,11,57856
mfv 180,52,92
cvp 224,224,225
cvp 225,226,227
mfv 184,56,92
cvp 226,228,229
cvp 227,230,231
mfv 188,60,92
sad 32,47,19660800
buffer_store_dwordx4 v[224:227], v21, s[20:23], s32 offen sc1
wl 6
mfv 128,64,64
tra 80,8,61440
tra 82,8,61952
mfv 132,68,64
cvp 232,232,233
cvp 233,234,235
mfv 136,72,64
cvp 234,236,237
cvp 235,238,239
mfv 140,76,64
sad 32,47,19661824
buffer_store_dwordx4 v[232:235], v21, s[20:23], s32 offen sc1
wl 6
mfv 144,64,68
tra 84,9,61440
tra 86,9,61952
mfv 148,68,68
cvp 240,240,241
cvp 241,242,243
mfv 152,72,68
cvp 242,244,245
cvp 243,246,247
mfv 156,76,68
sad 32,47,20316160
buffer_store_dwordx4 v[240:243], v21, s[20:23], s32 offen sc1
wl 6
mfv 160,64,72
tra 88,10,61440
tra 90,10,61952
mfv 164,68,72
cvp 248,248,249
cvp 249,250,251
mfv 168,72,72
cvp 250,252,253
cvp 251,254,255
mfv 172,76,72
sad 32,47,20317184
buffer_store_dwordx4 v[248:251], v21, s[20:23], s32 offen sc1
wl 6
mfv 176,64,76
tra 92,11,61440
tra 94,11,61952
mfv 180,68,76
mfv 184,72,76
mfv 188,76,76
wl 6
mfv 128,80,80
tra 64,12,16384
tra 66,12,16896
mfv 132,84,80
mfv 136,88,80
mfv 140,92,80
wl 6
mfv 144,80,84
tra 68,13,16384
tra 70,13,16896
mfv 148,84,84
mfv 152,88,84
mfv 156,92,84
wl 6
mfv 160,80,88
tra 72,14,16384
tra 74,14,16896
mfv 164,84,88
mfv 168,88,88
mfv 172,92,88
wl 6
mfv 176,80,92
tra 76,15,16384
tra 78,15,16896
mfv 180,84,92
mfv 184,88,92
mfv 188,92,92
wl 6
mfv 128,96,64
tra 80,12,20480
tra 82,12,20992
mfv 132,100,64
mfv 136,104,64
mfv 140,108,64
wl 6
mfv 144,96,68
tra 84,13,20480
tra 86,13,20992
mfv 148,100,68
mfv 152,104,68
mfv 156,108,68
wl 6
mfv 160,96,72
tra 88,14,20480
tra 90,14,20992
mfv 164,100,72
mfv 168,104,72
mfv 172,108,72
wl 6
mfv 176,96,76
tra 92,15,20480
tra 94,15,20992
mfv 180,100,76
mfv 184,104,76
mfv 188,108,76
s_waitcnt vmcnt(40) lgkmcnt(0)
s_barrier
mfv 128,112,80
tra 64,12,24576
tra 66,12,25088
mfv 132,116,80
mfv 136,120,80
mfv 140,124,80
mfv 144,112,84
tra 68,13,24576
tra 70,13,25088
mfv 148,116,84
mfv 152,120,84
mfv 156,124,84
mfv 160,112,88
tra 72,14,24576
tra 74,14,25088
mfv 164,116,88
mfv 168,120,88
mfv 172,124,88
mfv 176,112,92
tra 76,15,24576
tra 78,15,25088
mfv 180,116,92
mfv 184,120,92
mfv 188,124,92
s_nop 1
wl 6
mfw 192,32,64
tra 80,12,28672
tra 82,12,29184
mfw 196,36,64
mfw 200,40,64
mfw 204,44,64
wl 6
mfw 208,32,68
tra 84,13,28672
tra 86,13,29184
mfw 212,36,68
mfw 216,40,68
mfw 220,44,68
wl 6
mfw 224,32,72
tra 88,14,28672
tra 90,14,29184
mfw 228,36,72
mfw 232,40,72
mfw 236,44,72
wl 6
mfw 240,32,76
tra 92,15,28672
tra 94,15,29184
mfw 244,36,76
cvp 128,128,129
cvp 129,130,131
mfw 248,40,76
cvp 130,132,133
cvp 131,134,135
mfw 252,44,76
sad 32,47,20971520
buffer_store_dwordx4 v[128:131], v21, s[20:23], s32 offen sc1
wl 6
mfv 192,48,80
tra 64,12,32768
tra 66,12,33280
mfv 196,52,80
cvp 136,136,137
cvp 137,138,139
mfv 200,56,80
cvp 138,140,141
cvp 139,142,143
mfv 204,60,80
sad 32,47,20972544
buffer_store_dwordx4 v[136:139], v21, s[20:23], s32 offen sc1
wl 6
mfv 208,48,84
tra 68,13,32768
tra 70,13,33280
mfv 212,52,84
cvp 144,144,145
cvp 145,146,147
mfv 216,56,84
cvp 146,148,149
cvp 147,150,151
mfv 220,60,84
sad 32,47,21626880
buffer_store_dwordx4 v[144:147], v21, s[20:23], s32 offen sc1
wl 6
mfv 224,48,88
tra 72,14,32768
tra 74,14,33280
mfv 228,52,88
cvp 152,152,153
cvp 153,154,155
mfv 232,56,88
cvp 154,156,157
cvp 155,158,159
mfv 236,60,88
sad 32,47,21627904
buffer_store_dwordx4 v[152:155], v21, s[20:23], s32 offen sc1
wl 6
mfv 240,48,92
tra 76,15,32768
tra 78,15,33280
mfv 244,52,92
cvp 160,160,161
cvp 161,162,163
mfv 248,56,92
cvp 162,164,165
cvp 163,166,167
mfv 252,60,92
sad 32,47,22282240
buffer_store_dwordx4 v[160:163], v21, s[20:23], s32 offen sc1
wl 6
mfv 192,64,64
tra 80,12,36864
tra 82,12,37376
mfv 196,68,64
cvp 168,168,169
cvp 169,170,171
mfv 200,72,64
cvp 170,172,173
cvp 171,174,175
mfv 204,76,64
sad 32,47,22283264
buffer_store_dwordx4 v[168:171], v21, s[20:23], s32 offen sc1
wl 6
mfv 208,64,68
tra 84,13,36864
tra 86,13,37376
mfv 212,68,68
cvp 176,176,177
cvp 177,178,179
mfv 216,72,68
cvp 178,180,181
cvp 179,182,183
mfv 220,76,68
sad 32,47,22937600
buffer_store_dwordx4 v[176:179], v21, s[20:23], s32 offen sc1
wl 6
mfv 224,64,72
tra 88,14,36864
tra 90,14,37376
mfv 228,68,72
cvp 184,184,185
cvp 185,186,187
mfv 232,72,72
cvp 186,188,189
cvp 187,190,191
mfv 236,76,72
sad 32,47,22938624
buffer_store_dwordx4 v[184:187], v21, s[20:23], s32 offen sc1
wl 6
mfv 240,64,76
tra 92,15,36864
tra 94,15,37376
mfv 244,68,76
mfv 248,72,76
mfv 252,76,76
wl 6
mfv 192,80,80
tra 64,12,40960
tra 66,12,41472
mfv 196,84,80
mfv 200,88,80
mfv 204,92,80
wl 6
mfv 208,80,84
tra 68,13,40960
tra 70,13,41472
mfv 212,84,84
mfv 216,88,84
mfv 220,92,84
wl 6
mfv 224,80,88
tra 72,14,40960
tra 74,14,41472
mfv 228,84,88
mfv 232,88,88
mfv 236,92,88
wl 6
mfv 240,80,92
tra 76,15,40960
tra 78,15,41472
mfv 244,84,92
mfv 248,88,92
mfv 252,92,92
wl 6
mfv 192,96,64
tra 80,12,45056
tra 82,12,45568
mfv 196,100,64
mfv 200,104,64
mfv 204,108,64
wl 6
mfv 208,96,68
tra 84,13,45056
tra 86,13,45568
mfv 212,100,68
mfv 216,104,68
mfv 220,108,68
wl 6
mfv 224,96,72
tra 88,14,45056
tra 90,14,45568
mfv 228,100,72
mfv 232,104,72
mfv 236,108,72
wl 6
mfv 240,96,76
tra 92,15,45056
tra 94,15,45568
mfv 244,100,76
mfv 248,104,76
mfv 252,108,76
wl 6
mfv 192,112,80
mfv 196,116,80
mfv 200,120,80
mfv 204,124,80
wl 4
mfv 208,112,84
mfv 212,116,84
mfv 216,120,84
mfv 220,124,84
wl 2
mfv 224,112,88
mfv 228,116,88
mfv 232,120,88
mfv 236,124,88
wl 0
mfv 240,112,92
mfv 244,116,92
mfv 248,120,92
mfv 252,124,92
s_nop 1
s_nop 7
cvp 192,192,193
cvp 193,194,195
cvp 194,196,197
cvp 195,198,199
sad 32,47,23592960
buffer_store_dwordx4 v[192:195], v21, s[20:23], s32 offen sc1
cvp 200,200,201
cvp 201,202,203
cvp 202,204,205
cvp 203,206,207
sad 32,47,23593984
buffer_store_dwordx4 v[200:203], v21, s[20:23], s32 offen sc1
cvp 208,208,209
cvp 209,210,211
cvp 210,212,213
cvp 211,214,215
sad 32,47,24248320
buffer_store_dwordx4 v[208:211], v21, s[20:23], s32 offen sc1
cvp 216,216,217
cvp 217,218,219
cvp 218,220,221
cvp 219,222,223
sad 32,47,24249344
buffer_store_dwordx4 v[216:219], v21, s[20:23], s32 offen sc1
cvp 224,224,225
cvp 225,226,227
cvp 226,228,229
cvp 227,230,231
sad 32,47,24903680
buffer_store_dwordx4 v[224:227], v21, s[20:23], s32 offen sc1
cvp 232,232,233
cvp 233,234,235
cvp 234,236,237
cvp 235,238,239
sad 32,47,24904704
buffer_store_dwordx4 v[232:235], v21, s[20:23], s32 offen sc1
cvp 240,240,241
cvp 241,242,243
cvp 242,244,245
cvp 243,246,247
sad 32,47,25559040
buffer_store_dwordx4 v[240:243], v21, s[20:23], s32 offen sc1
cvp 248,248,249
cvp 249,250,251
cvp 250,252,253
cvp 251,254,255
sad 32,47,25560064
buffer_store_dwordx4 v[248:251], v21, s[20:23], s32 offen sc1
wv 0
s_barrier
s_cmp_lg_u32 s4, 1
s_cbranch_scc1 L_nf_52
s_lshl_b32 s83, s79, 7
v_and_b32 v2, 1, v1
v_cmp_eq_u32 vcc, 1, v2
v_mov_b32 v2, s100
v_mov_b32 v3, s101
v_cndmask_b32 v3, v2, v3, vcc
v_and_b32 v2, 31, v1
v_lshlrev_b32 v2, 2, v2
buffer_store_dword v3, v2, s[88:91], s83 offen sc1
L_nf_52:
s_mov_b32 s92, 15
s_cmp_ge_u32 s2, 128
s_cbranch_scc1 L_worker
s_branch L_doinit
L_after:
s_barrier
s_load_dwordx2 s[36:37], s[0:1], 104
v_and_b32 v1, 63, v0
v_lshrrev_b32 v2, 6, v0
s_nop 0
v_readfirstlane_b32 s4, v2
v_lshlrev_b32 v7, 4, v1
v_bfe_u32 v2, v1, 3, 1
v_mul_u32_u24 v2, 0xaaaa, v2
v_add_u32 v6, 0x4444, v2
s_mov_b32 s42, 400000
s_mov_b32 s3, s2
wl 0
sad 8,36,0
s_addc_u32 s9, s37, 0
s_and_b32 s9, s9, 0xffff
s_mov_b32 s10, 8388608
s_mov_b32 s11, 0x00020000
s_cmp_lt_u32 s2, 112
s_cbranch_scc1 L_red
s_sub_u32 s3, s2, 112
sad 12,36,67108864
s_addc_u32 s13, s37, 0
s_and_b32 s13, s13, 0xffff
s_mov_b32 s14, 25165824
s_mov_b32 s15, 0x00020000
sad 16,36,100663296
s_addc_u32 s17, s37, 0
s_and_b32 s17, s17, 0xffff
s_mov_b32 s18, 25165824
s_mov_b32 s19, 0x00020000
sad 20,36,134217728
s_addc_u32 s21, s37, 0
s_and_b32 s21, s21, 0xffff
s_mov_b32 s22, 83886080
s_mov_b32 s23, 0x00020000
s_mov_b32 s39, 26624
v_min_u32 v3, 31, v1
v_mul_u32_u24 v3, 128, v3
s_mov_b32 s43, 0
L_fw_53:
buffer_load_dwordx2 v[4:5], v3, s[88:91], s39 offen sc1
wv 0
v_xor_b32 v4, s100, v4
v_xor_b32 v5, s101, v5
v_or_b32 v4, v4, v5
v_cmp_ne_u32 vcc, 0, v4
sad 43,43,1
s_cbranch_vccz L_fwd_54
s_sleep 4
s_cmp_lt_u32 s43, 400000
s_cbranch_scc1 L_fw_53
L_fwd_54:
s_and_b32 s48, s3, 3
s_lshr_b32 s49, s3, 2
s_lshl_b32 s38, s49, 1
s_lshr_b32 s39, s4, 1
s_add_u32 s38, s38, s39
s_lshl_b32 s38, s38, 2
s_add_u32 s50, s38, s48
s_mul_i32 s51, s50, 12288
s_mul_i32 s38, s49, 20
s_add_u32 s38, s38, s48
s_lshl_b32 s38, s38, 14
s_lshl_b32 s39, s4, 12
s_add_u32 s52, s38, s39
sad 24,36,25165824
s_addc_u32 s25, s37, 0
s_and_b32 s25, s25, 0xffff
s_mov_b32 s26, 5242880
s_mov_b32 s27, 0x00020000
s_lshl_b32 s38, s49, 2
s_add_u32 s38, s38, s4
s_mul_i32 s53, s38, 5120
s_bitcmp1_b32 s4, 0
s_cselect_b32 s12, s16, s12
s_cselect_b32 s13, s17, s13
s_cselect_b32 s14, s18, s14
s_cselect_b32 s15, s19, s15
s_mov_b32 s5, 2
L_pf_55:
s_cmp_lt_u32 s5, 5
s_cbranch_scc1 L_pg_58
s_sub_u32 s41, s5, 4
s_lshl_b32 s41, s41, 17
sad 41,41,102400
s_mov_b32 s43, 0
v_mov_b32 v3, 0
L_pw_56:
buffer_load_dword v2, v3, s[8:11], s41 offen sc1
wv 0
v_cmp_eq_u32 vcc, -1, v2
sad 43,43,1
s_cbranch_vccz L_pg_58
s_sleep 4
s_cmp_lt_u32 s43, s42
s_cbranch_scc1 L_pw_56
s_mov_b32 s42, 0
L_pg_58:
s_cmp_lg_u32 s5, 2
s_cbranch_scc1 L_p2_59
s_add_u32 s38, s5, -2
s_and_b32 s39, s38, 7
s_cmp_lg_u32 s39, 0
s_cbranch_scc1 L_gwd_60
s_cmp_ge_u32 s38, 64
s_cbranch_scc1 L_gwd_60
s_lshl_b32 s38, s38, 4
s_add_u32 s38, s38, s50
sad 38,38,640
s_lshl_b32 s39, s38, 7
v_min_u32 v3, 1, v1
v_mul_u32_u24 v3, 4096, v3
s_mov_b32 s43, 0
L_fw_61:
buffer_load_dwordx2 v[4:5], v3, s[88:91], s39 offen sc1
wv 0
v_xor_b32 v4, s100, v4
v_xor_b32 v5, s101, v5
v_or_b32 v4, v4, v5
v_cmp_ne_u32 vcc, 0, v4
sad 43,43,1
s_cbranch_vccz L_fwd_62
s_sleep 2
s_cmp_lt_u32 s43, 400000
s_cbranch_scc1 L_fw_61
L_fwd_62:
L_gwd_60:
s_add_u32 s38, s5, -2
s_cmp_eq_u32 s38, 4
s_cselect_b32 s38, 64, s38
s_cselect_b32 s40, 72, 64
s_and_b32 s39, s38, 7
s_cmp_lg_u32 s39, 0
s_cbranch_scc1 L_gwd_63
s_cmp_ge_u32 s38, s40
s_cbranch_scc1 L_gwd_63
s_lshl_b32 s38, s38, 4
sad 38,38,64
sad 38,38,640
s_lshl_b32 s39, s38, 7
v_min_u32 v3, 31, v1
v_mul_u32_u24 v3, 128, v3
s_mov_b32 s43, 0
L_fw_64:
buffer_load_dwordx2 v[4:5], v3, s[88:91], s39 offen sc1
wv 0
v_xor_b32 v4, s100, v4
v_xor_b32 v5, s101, v5
v_or_b32 v4, v4, v5
v_cmp_ne_u32 vcc, 0, v4
sad 43,43,1
s_cbranch_vccz L_fwd_65
s_sleep 2
s_cmp_lt_u32 s43, 400000
s_cbranch_scc1 L_fw_64
L_fwd_65:
L_gwd_63:
L_p2_59:
sad 38,5,0
s_and_b32 s39, s38, 7
s_cmp_lg_u32 s39, 0
s_cbranch_scc1 L_gwd_66
s_cmp_ge_u32 s38, 64
s_cbranch_scc1 L_gwd_66
s_lshl_b32 s38, s38, 4
s_add_u32 s38, s38, s50
sad 38,38,640
s_lshl_b32 s39, s38, 7
v_min_u32 v3, 1, v1
v_mul_u32_u24 v3, 4096, v3
s_mov_b32 s43, 0
L_fw_67:
buffer_load_dwordx2 v[4:5], v3, s[88:91], s39 offen sc1
wv 0
v_xor_b32 v4, s100, v4
v_xor_b32 v5, s101, v5
v_or_b32 v4, v4, v5
v_cmp_ne_u32 vcc, 0, v4
sad 43,43,1
s_cbranch_vccz L_fwd_68
s_sleep 2
s_cmp_lt_u32 s43, 400000
s_cbranch_scc1 L_fw_67
L_fwd_68:
L_gwd_66:
s_mul_i32 s41, s5, 393216
s_add_u32 s41, s41, s51
buffer_load_dwordx4 v[24:27], v7, s[12:15], s41 offen offset:0 sc1
buffer_load_dwordx4 v[28:31], v7, s[12:15], s41 offen offset:1024 sc1
buffer_load_dwordx4 v[32:35], v7, s[12:15], s41 offen offset:2048 sc1
buffer_load_dwordx4 v[36:39], v7, s[12:15], s41 offen offset:3072 sc1
sad 41,41,4096
buffer_load_dwordx4 v[40:43], v7, s[12:15], s41 offen offset:0 sc1
buffer_load_dwordx4 v[44:47], v7, s[12:15], s41 offen offset:1024 sc1
buffer_load_dwordx4 v[48:51], v7, s[12:15], s41 offen offset:2048 sc1
buffer_load_dwordx4 v[52:55], v7, s[12:15], s41 offen offset:3072 sc1
sad 41,41,4096
buffer_load_dwordx4 v[56:59], v7, s[12:15], s41 offen offset:0 sc1
buffer_load_dwordx4 v[60:63], v7, s[12:15], s41 offen offset:1024 sc1
buffer_load_dwordx4 v[64:67], v7, s[12:15], s41 offen offset:2048 sc1
buffer_load_dwordx4 v[68:71], v7, s[12:15], s41 offen offset:3072 sc1
sad 38,5,0
s_cmp_eq_u32 s38, 4
s_cselect_b32 s38, 64, s38
s_cselect_b32 s40, 72, 64
s_and_b32 s39, s38, 7
s_cmp_lg_u32 s39, 0
s_cbranch_scc1 L_gwd_69
s_cmp_ge_u32 s38, s40
s_cbranch_scc1 L_gwd_69
s_lshl_b32 s38, s38, 4
sad 38,38,64
sad 38,38,640
s_lshl_b32 s39, s38, 7
v_min_u32 v3, 31, v1
v_mul_u32_u24 v3, 128, v3
s_mov_b32 s43, 0
L_fw_70:
buffer_load_dwordx2 v[4:5], v3, s[88:91], s39 offen sc1
wv 0
v_xor_b32 v4, s100, v4
v_xor_b32 v5, s101, v5
v_or_b32 v4, v4, v5
v_cmp_ne_u32 vcc, 0, v4
sad 43,43,1
s_cbranch_vccz L_fwd_71
s_sleep 2
s_cmp_lt_u32 s43, 400000
s_cbranch_scc1 L_fw_70
L_fwd_71:
L_gwd_69:
s_mul_i32 s41, s5, 1310720
s_add_u32 s41, s41, s52
buffer_load_dwordx4 v[72:75], v7, s[20:23], s41 offen offset:0 sc1
buffer_load_dwordx4 v[76:79], v7, s[20:23], s41 offen offset:1024 sc1
buffer_load_dwordx4 v[80:83], v7, s[20:23], s41 offen offset:2048 sc1
buffer_load_dwordx4 v[84:87], v7, s[20:23], s41 offen offset:3072 sc1
sad 41,41,65536
buffer_load_dwordx4 v[88:91], v7, s[20:23], s41 offen offset:0 sc1
buffer_load_dwordx4 v[92:95], v7, s[20:23], s41 offen offset:1024 sc1
buffer_load_dwordx4 v[96:99], v7, s[20:23], s41 offen offset:2048 sc1
buffer_load_dwordx4 v[100:103], v7, s[20:23], s41 offen offset:3072 sc1
sad 41,41,65536
buffer_load_dwordx4 v[104:107], v7, s[20:23], s41 offen offset:0 sc1
buffer_load_dwordx4 v[108:111], v7, s[20:23], s41 offen offset:1024 sc1
buffer_load_dwordx4 v[112:115], v7, s[20:23], s41 offen offset:2048 sc1
buffer_load_dwordx4 v[116:119], v7, s[20:23], s41 offen offset:3072 sc1
sad 41,41,65536
buffer_load_dwordx4 v[120:123], v7, s[20:23], s41 offen offset:0 sc1
buffer_load_dwordx4 v[124:127], v7, s[20:23], s41 offen offset:1024 sc1
buffer_load_dwordx4 v[128:131], v7, s[20:23], s41 offen offset:2048 sc1
buffer_load_dwordx4 v[132:135], v7, s[20:23], s41 offen offset:3072 sc1
sad 41,41,65536
buffer_load_dwordx4 v[136:139], v7, s[20:23], s41 offen offset:0 sc1
buffer_load_dwordx4 v[140:143], v7, s[20:23], s41 offen offset:1024 sc1
buffer_load_dwordx4 v[144:147], v7, s[20:23], s41 offen offset:2048 sc1
buffer_load_dwordx4 v[148:151], v7, s[20:23], s41 offen offset:3072 sc1
sad 41,41,65536
sad 5,5,1
s_cmp_lt_u32 s5, 64
s_cbranch_scc1 L_pf_55
wv 0
s_branch L_worker
L_red:
sad 12,36,33554432
s_addc_u32 s13, s37, 0
s_and_b32 s13, s13, 0xffff
s_mov_b32 s14, 26214400
s_mov_b32 s15, 0x00020000
sad 24,36,11534336
s_addc_u32 s25, s37, 0
s_and_b32 s25, s25, 0xffff
s_mov_b32 s26, 294912
s_mov_b32 s27, 0x00020000
s_sub_u32 s3, s3, 32
s_mov_b32 s39, 26624
v_min_u32 v3, 31, v1
v_mul_u32_u24 v3, 128, v3
s_mov_b32 s43, 0
L_fw_72:
buffer_load_dwordx2 v[4:5], v3, s[24:27], s39 offen sc1
wv 0
v_xor_b32 v4, s100, v4
v_xor_b32 v5, s101, v5
v_or_b32 v4, v4, v5
v_cmp_ne_u32 vcc, 0, v4
sad 43,43,1
s_cbranch_vccz L_fwd_73
s_sleep 4
s_cmp_lt_u32 s43, 400000
s_cbranch_scc1 L_fw_72
L_fwd_73:
s_mov_b32 s39, 65536
v_min_u32 v3, 15, v1
v_mul_u32_u24 v3, 128, v3
s_mov_b32 s43, 0
L_fw_74:
buffer_load_dwordx2 v[4:5], v3, s[24:27], s39 offen sc1
wv 0
v_xor_b32 v4, s100, v4
v_xor_b32 v5, s101, v5
v_or_b32 v4, v4, v5
v_cmp_ne_u32 vcc, 0, v4
sad 43,43,1
s_cbranch_vccz L_fwd_75
s_sleep 4
s_cmp_lt_u32 s43, 400000
s_cbranch_scc1 L_fw_74
L_fwd_75:
v_lshlrev_b32 v2, 7, v1
s_lshl_b32 s38, s4, 4
sad 38,38,63488
sad 39,38,2048
buffer_load_dwordx4 v[24:27], v2, s[24:27], s38 offen sc1
buffer_load_dwordx4 v[28:31], v2, s[24:27], s39 offen sc1
s_getreg_b32 s40, hwreg(HW_REG_XCC_ID)
s_and_b32 s40, s40, 7
v_mov_b32 v32, -1
wv 0
v_xor_b32 v24, s100, v24
v_xor_b32 v25, s101, v25
v_xor_b32 v26, s40, v26
v_or3_b32 v24, v24, v25, v26
v_cmp_eq_u32 vcc, 0, v24
s_nop 1
v_cndmask_b32 v27, v32, v27, vcc
v_and_b32 v24, 0xffff, v27
v_lshrrev_b32 v25, 16, v27
v_xor_b32 v28, s100, v28
v_xor_b32 v29, s101, v29
v_xor_b32 v30, s40, v30
v_or3_b32 v28, v28, v29, v30
v_cmp_eq_u32 vcc, 0, v28
s_nop 1
v_cndmask_b32 v31, v32, v31, vcc
v_and_b32 v28, 0xffff, v31
v_lshrrev_b32 v29, 16, v31
v_min_u32 v24, v24, v28
v_min_u32 v25, v25, v29
s_nop 1
v_min_u32_dpp v24, v24, v24 row_ror:8 row_mask:0xf bank_mask:0xf
s_nop 1
v_min_u32_dpp v24, v24, v24 row_ror:4 row_mask:0xf bank_mask:0xf
s_nop 1
v_min_u32_dpp v24, v24, v24 row_ror:2 row_mask:0xf bank_mask:0xf
s_nop 1
v_min_u32_dpp v24, v24, v24 row_ror:1 row_mask:0xf bank_mask:0xf
s_nop 0
v_readlane_b32 s44, v24, 0
v_readlane_b32 s45, v24, 16
v_readlane_b32 s46, v24, 32
v_readlane_b32 s47, v24, 48
s_min_u32 s44, s44, s45
s_min_u32 s46, s46, s47
s_min_u32 s40, s44, s46
s_nop 1
v_min_u32_dpp v25, v25, v25 row_ror:8 row_mask:0xf bank_mask:0xf
s_nop 1
v_min_u32_dpp v25, v25, v25 row_ror:4 row_mask:0xf bank_mask:0xf
s_nop 1
v_min_u32_dpp v25, v25, v25 row_ror:2 row_mask:0xf bank_mask:0xf
s_nop 1
v_min_u32_dpp v25, v25, v25 row_ror:1 row_mask:0xf bank_mask:0xf
s_nop 0
v_readlane_b32 s44, v25, 0
v_readlane_b32 s45, v25, 16
v_readlane_b32 s46, v25, 32
v_readlane_b32 s47, v25, 48
s_min_u32 s44, s44, s45
s_min_u32 s46, s46, s47
s_min_u32 s41, s44, s46
v_mov_b32 v2, 163824
s_cmp_lt_u32 s41, s40
s_cselect_b32 s38, 1, 0
s_lshl_b32 s38, s38, s4
v_mov_b32 v3, s38
s_lshl_b32 s39, s4, 2
sad 39,39,163824
v_mov_b32 v4, s39
ds_write_b32 v4, v3
wl 0
s_barrier
ds_read_b128 v[24:27], v2
wl 0
v_or_b32 v24, v24, v25
v_or3_b32 v24, v24, v26, v27
s_nop 0
v_readfirstlane_b32 s6, v24
s_mul_i32 s41, s3, 327680
s_mul_i32 s39, s4, 81920
s_add_u32 s41, s41, s39
s_lshl_b32 s38, s4, 3
sad 38,38,400
s_lshl_b32 s39, s38, 7
v_min_u32 v3, 7, v1
v_mul_u32_u24 v3, 128, v3
s_mov_b32 s43, 0
L_fw_76:
buffer_load_dwordx2 v[4:5], v3, s[24:27], s39 offen sc1
wv 0
v_xor_b32 v4, s100, v4
v_xor_b32 v5, s101, v5
v_or_b32 v4, v4, v5
v_cmp_ne_u32 vcc, 0, v4
sad 43,43,1
s_cbranch_vccz L_fwd_77
s_sleep 2
s_cmp_lt_u32 s43, 400000
s_cbranch_scc1 L_fw_76
L_fwd_77:
sad 38,41,16384
buffer_load_dwordx4 a[0:3], v7, s[12:15], s38 offen offset:0 sc1
buffer_load_dwordx4 a[4:7], v7, s[12:15], s38 offen offset:1024 sc1
buffer_load_dwordx4 a[8:11], v7, s[12:15], s38 offen offset:2048 sc1
buffer_load_dwordx4 a[12:15], v7, s[12:15], s38 offen offset:3072 sc1
sad 38,41,36864
buffer_load_dwordx4 a[80:83], v7, s[12:15], s38 offen offset:0 sc1
buffer_load_dwordx4 a[84:87], v7, s[12:15], s38 offen offset:1024 sc1
buffer_load_dwordx4 a[88:91], v7, s[12:15], s38 offen offset:2048 sc1
buffer_load_dwordx4 a[92:95], v7, s[12:15], s38 offen offset:3072 sc1
sad 38,41,57344
buffer_load_dwordx4 a[160:163], v7, s[12:15], s38 offen offset:0 sc1
buffer_load_dwordx4 a[164:167], v7, s[12:15], s38 offen offset:1024 sc1
buffer_load_dwordx4 a[168:171], v7, s[12:15], s38 offen offset:2048 sc1
buffer_load_dwordx4 a[172:175], v7, s[12:15], s38 offen offset:3072 sc1
sad 38,41,77824
buffer_load_dwordx4 a[240:243], v7, s[12:15], s38 offen offset:0 sc1
buffer_load_dwordx4 a[244:247], v7, s[12:15], s38 offen offset:1024 sc1
buffer_load_dwordx4 a[248:251], v7, s[12:15], s38 offen offset:2048 sc1
buffer_load_dwordx4 a[252:255], v7, s[12:15], s38 offen offset:3072 sc1
s_lshl_b32 s38, s4, 3
sad 38,38,336
s_lshl_b32 s39, s38, 7
v_min_u32 v3, 7, v1
v_mul_u32_u24 v3, 128, v3
s_mov_b32 s43, 0
L_fw_78:
buffer_load_dwordx2 v[4:5], v3, s[24:27], s39 offen sc1
wv 0
v_xor_b32 v4, s100, v4
v_xor_b32 v5, s101, v5
v_or_b32 v4, v4, v5
v_cmp_ne_u32 vcc, 0, v4
sad 43,43,1
s_cbranch_vccz L_fwd_79
s_sleep 2
s_cmp_lt_u32 s43, 400000
s_cbranch_scc1 L_fw_78
L_fwd_79:
sad 38,41,0
buffer_load_dwordx4 v[192:195], v7, s[12:15], s38 offen offset:0 sc1
buffer_load_dwordx4 v[196:199], v7, s[12:15], s38 offen offset:1024 sc1
buffer_load_dwordx4 v[200:203], v7, s[12:15], s38 offen offset:2048 sc1
buffer_load_dwordx4 v[204:207], v7, s[12:15], s38 offen offset:3072 sc1
sad 38,41,4096
buffer_load_dwordx4 v[208:211], v7, s[12:15], s38 offen offset:0 sc1
buffer_load_dwordx4 v[212:215], v7, s[12:15], s38 offen offset:1024 sc1
buffer_load_dwordx4 v[216:219], v7, s[12:15], s38 offen offset:2048 sc1
buffer_load_dwordx4 v[220:223], v7, s[12:15], s38 offen offset:3072 sc1
sad 38,41,20480
buffer_load_dwordx4 a[16:19], v7, s[12:15], s38 offen offset:0 sc1
buffer_load_dwordx4 a[20:23], v7, s[12:15], s38 offen offset:1024 sc1
buffer_load_dwordx4 a[24:27], v7, s[12:15], s38 offen offset:2048 sc1
buffer_load_dwordx4 a[28:31], v7, s[12:15], s38 offen offset:3072 sc1
sad 38,41,24576
buffer_load_dwordx4 a[32:35], v7, s[12:15], s38 offen offset:0 sc1
buffer_load_dwordx4 a[36:39], v7, s[12:15], s38 offen offset:1024 sc1
buffer_load_dwordx4 a[40:43], v7, s[12:15], s38 offen offset:2048 sc1
buffer_load_dwordx4 a[44:47], v7, s[12:15], s38 offen offset:3072 sc1
sad 38,41,40960
buffer_load_dwordx4 a[96:99], v7, s[12:15], s38 offen offset:0 sc1
buffer_load_dwordx4 a[100:103], v7, s[12:15], s38 offen offset:1024 sc1
buffer_load_dwordx4 a[104:107], v7, s[12:15], s38 offen offset:2048 sc1
buffer_load_dwordx4 a[108:111], v7, s[12:15], s38 offen offset:3072 sc1
sad 38,41,45056
buffer_load_dwordx4 a[112:115], v7, s[12:15], s38 offen offset:0 sc1
buffer_load_dwordx4 a[116:119], v7, s[12:15], s38 offen offset:1024 sc1
buffer_load_dwordx4 a[120:123], v7, s[12:15], s38 offen offset:2048 sc1
buffer_load_dwordx4 a[124:127], v7, s[12:15], s38 offen offset:3072 sc1
sad 38,41,61440
buffer_load_dwordx4 a[176:179], v7, s[12:15], s38 offen offset:0 sc1
buffer_load_dwordx4 a[180:183], v7, s[12:15], s38 offen offset:1024 sc1
buffer_load_dwordx4 a[184:187], v7, s[12:15], s38 offen offset:2048 sc1
buffer_load_dwordx4 a[188:191], v7, s[12:15], s38 offen offset:3072 sc1
sad 38,41,65536
buffer_load_dwordx4 a[192:195], v7, s[12:15], s38 offen offset:0 sc1
buffer_load_dwordx4 a[196:199], v7, s[12:15], s38 offen offset:1024 sc1
buffer_load_dwordx4 a[200:203], v7, s[12:15], s38 offen offset:2048 sc1
buffer_load_dwordx4 a[204:207], v7, s[12:15], s38 offen offset:3072 sc1
s_lshl_b32 s38, s4, 3
sad 38,38,368
s_lshl_b32 s39, s38, 7
v_min_u32 v3, 7, v1
v_mul_u32_u24 v3, 128, v3
s_mov_b32 s43, 0
L_fw_80:
buffer_load_dwordx2 v[4:5], v3, s[24:27], s39 offen sc1
wv 0
v_xor_b32 v4, s100, v4
v_xor_b32 v5, s101, v5
v_or_b32 v4, v4, v5
v_cmp_ne_u32 vcc, 0, v4
sad 43,43,1
s_cbranch_vccz L_fwd_81
s_sleep 2
s_cmp_lt_u32 s43, 400000
s_cbranch_scc1 L_fw_80
L_fwd_81:
sad 38,41,8192
buffer_load_dwordx4 v[224:227], v7, s[12:15], s38 offen offset:0 sc1
buffer_load_dwordx4 v[228:231], v7, s[12:15], s38 offen offset:1024 sc1
buffer_load_dwordx4 v[232:235], v7, s[12:15], s38 offen offset:2048 sc1
buffer_load_dwordx4 v[236:239], v7, s[12:15], s38 offen offset:3072 sc1
sad 38,41,12288
buffer_load_dwordx4 v[240:243], v7, s[12:15], s38 offen offset:0 sc1
buffer_load_dwordx4 v[244:247], v7, s[12:15], s38 offen offset:1024 sc1
buffer_load_dwordx4 v[248:251], v7, s[12:15], s38 offen offset:2048 sc1
buffer_load_dwordx4 v[252:255], v7, s[12:15], s38 offen offset:3072 sc1
sad 38,41,28672
buffer_load_dwordx4 a[48:51], v7, s[12:15], s38 offen offset:0 sc1
buffer_load_dwordx4 a[52:55], v7, s[12:15], s38 offen offset:1024 sc1
buffer_load_dwordx4 a[56:59], v7, s[12:15], s38 offen offset:2048 sc1
buffer_load_dwordx4 a[60:63], v7, s[12:15], s38 offen offset:3072 sc1
sad 38,41,32768
buffer_load_dwordx4 a[64:67], v7, s[12:15], s38 offen offset:0 sc1
buffer_load_dwordx4 a[68:71], v7, s[12:15], s38 offen offset:1024 sc1
buffer_load_dwordx4 a[72:75], v7, s[12:15], s38 offen offset:2048 sc1
buffer_load_dwordx4 a[76:79], v7, s[12:15], s38 offen offset:3072 sc1
sad 38,41,49152
buffer_load_dwordx4 a[128:131], v7, s[12:15], s38 offen offset:0 sc1
buffer_load_dwordx4 a[132:135], v7, s[12:15], s38 offen offset:1024 sc1
buffer_load_dwordx4 a[136:139], v7, s[12:15], s38 offen offset:2048 sc1
buffer_load_dwordx4 a[140:143], v7, s[12:15], s38 offen offset:3072 sc1
sad 38,41,53248
buffer_load_dwordx4 a[144:147], v7, s[12:15], s38 offen offset:0 sc1
buffer_load_dwordx4 a[148:151], v7, s[12:15], s38 offen offset:1024 sc1
buffer_load_dwordx4 a[152:155], v7, s[12:15], s38 offen offset:2048 sc1
buffer_load_dwordx4 a[156:159], v7, s[12:15], s38 offen offset:3072 sc1
sad 38,41,69632
buffer_load_dwordx4 a[208:211], v7, s[12:15], s38 offen offset:0 sc1
buffer_load_dwordx4 a[212:215], v7, s[12:15], s38 offen offset:1024 sc1
buffer_load_dwordx4 a[216:219], v7, s[12:15], s38 offen offset:2048 sc1
buffer_load_dwordx4 a[220:223], v7, s[12:15], s38 offen offset:3072 sc1
sad 38,41,73728
buffer_load_dwordx4 a[224:227], v7, s[12:15], s38 offen offset:0 sc1
buffer_load_dwordx4 a[228:231], v7, s[12:15], s38 offen offset:1024 sc1
buffer_load_dwordx4 a[232:235], v7, s[12:15], s38 offen offset:2048 sc1
buffer_load_dwordx4 a[236:239], v7, s[12:15], s38 offen offset:3072 sc1
sad 16,36,134217728
s_addc_u32 s17, s37, 0
s_and_b32 s17, s17, 0xffff
s_mov_b32 s18, 83886080
s_mov_b32 s19, 0x00020000
sad 20,36,226492416
s_addc_u32 s21, s37, 0
s_and_b32 s21, s21, 0xffff
s_mov_b32 s22, 20971520
s_mov_b32 s23, 0x00020000
sad 24,36,11534336
s_addc_u32 s25, s37, 0
s_and_b32 s25, s25, 0xffff
s_mov_b32 s26, 294912
s_mov_b32 s27, 0x00020000
v_and_b32 v2, 7, v1
v_bfe_u32 v3, v1, 3, 1
v_lshrrev_b32 v4, 4, v1
v_and_b32 v5, 1, v4
v_lshrrev_b32 v21, 5, v1
v_lshl_add_u32 v20, v21, 1, v3
v_lshlrev_b32 v17, 8, v20
v_lshl_add_u32 v17, v2, 4, v17
v_lshl_add_u32 v17, v5, 3, v17
s_lshr_b32 s50, s3, 2
s_and_b32 s50, s50, 0
s_sub_u32 s48, s4, s50
s_and_b32 s48, s48, 3
s_mul_i32 s48, s48, 5120
s_sub_u32 s49, 0, s50
s_and_b32 s49, s49, 3
s_mul_i32 s49, s49, 5120
v_add_u32 v8, s48, v17
s_lshr_b32 s38, s3, 3
s_lshr_b32 s39, s38, 3
s_lshl_b32 s39, s39, 14
s_and_b32 s38, s38, 7
s_lshl_b32 s38, s38, 10
s_add_u32 s38, s38, s39
s_and_b32 s39, s3, 7
s_lshl_b32 s39, s39, 7
s_add_u32 s38, s38, s39
v_lshlrev_b32 v9, 4, v2
v_lshl_add_u32 v9, v5, 3, v9
v_lshl_add_u32 v9, v21, 2, v9
v_add_u32 v9, s38, v9
v_cmp_eq_u32 vcc, 0, v3
v_mov_b32 v20, 0x7ffffff0
s_nop 0
v_cndmask_b32 v9, v20, v9, vcc
sad 38,38,32768
v_lshlrev_b32 v22, 13, v21
v_add_u32 v22, s38, v22
v_mov_b32 v15, 0
v_and_b32 v10, 31, v1
v_lshl_add_u32 v10, v10, 2, v22
v_lshlrev_b32 v11, 7, v1
v_add_u32 v11, 32768, v11
v_and_b32 v22, 15, v1
v_lshlrev_b32 v12, 7, v22
v_add_u32 v12, 49152, v12
v_and_b32 v20, 31, v1
v_lshlrev_b32 v13, 7, v20
v_add_u32 v13, 102400, v13
v_add_u32 v14, 40960, v7
s_lshl_b32 s52, s3, 14
s_lshl_b32 s57, s3, 12
s_lshl_b32 s38, s4, 10
s_add_u32 s57, s57, s38
s_lshl_b32 s55, s50, 2
sad 38,55,0
s_and_b32 s38, s38, 15
s_lshr_b32 s39, s38, 2
s_add_u32 s38, s38, s39
sad 38,38,1
s_lshr_b32 s39, s38, 3
s_lshl_b32 s39, s39, 14
s_and_b32 s38, s38, 7
s_lshl_b32 s38, s38, 10
s_add_u32 s66, s38, s39
sad 66,66,65536
sad 38,55,1
s_and_b32 s38, s38, 15
s_lshr_b32 s39, s38, 2
s_add_u32 s38, s38, s39
sad 38,38,1
s_lshr_b32 s39, s38, 3
s_lshl_b32 s39, s39, 14
s_and_b32 s38, s38, 7
s_lshl_b32 s38, s38, 10
s_add_u32 s67, s38, s39
sad 67,67,65536
sad 38,55,2
s_and_b32 s38, s38, 15
s_lshr_b32 s39, s38, 2
s_add_u32 s38, s38, s39
sad 38,38,1
s_lshr_b32 s39, s38, 3
s_lshl_b32 s39, s39, 14
s_and_b32 s38, s38, 7
s_lshl_b32 s38, s38, 10
s_add_u32 s68, s38, s39
sad 68,68,65536
sad 38,55,3
s_and_b32 s38, s38, 15
s_lshr_b32 s39, s38, 2
s_add_u32 s38, s38, s39
sad 38,38,1
s_lshr_b32 s39, s38, 3
s_lshl_b32 s39, s39, 14
s_and_b32 s38, s38, 7
s_lshl_b32 s38, s38, 10
s_add_u32 s69, s38, s39
sad 69,69,65536
sad 38,55,4
s_and_b32 s38, s38, 15
s_lshr_b32 s39, s38, 2
s_add_u32 s38, s38, s39
sad 38,38,1
s_lshr_b32 s39, s38, 3
s_lshl_b32 s39, s39, 14
s_and_b32 s38, s38, 7
s_lshl_b32 s38, s38, 10
s_add_u32 s70, s38, s39
sad 70,70,65536
sad 38,55,5
s_and_b32 s38, s38, 15
s_lshr_b32 s39, s38, 2
s_add_u32 s38, s38, s39
sad 38,38,1
s_lshr_b32 s39, s38, 3
s_lshl_b32 s39, s39, 14
s_and_b32 s38, s38, 7
s_lshl_b32 s38, s38, 10
s_add_u32 s71, s38, s39
sad 71,71,65536
sad 38,55,6
s_and_b32 s38, s38, 15
s_lshr_b32 s39, s38, 2
s_add_u32 s38, s38, s39
sad 38,38,1
s_lshr_b32 s39, s38, 3
s_lshl_b32 s39, s39, 14
s_and_b32 s38, s38, 7
s_lshl_b32 s38, s38, 10
s_add_u32 s72, s38, s39
sad 72,72,65536
sad 38,55,7
s_and_b32 s38, s38, 15
s_lshr_b32 s39, s38, 2
s_add_u32 s38, s38, s39
sad 38,38,1
s_lshr_b32 s39, s38, 3
s_lshl_b32 s39, s39, 14
s_and_b32 s38, s38, 7
s_lshl_b32 s38, s38, 10
s_add_u32 s73, s38, s39
sad 73,73,65536
sad 38,55,8
s_and_b32 s38, s38, 15
s_lshr_b32 s39, s38, 2
s_add_u32 s38, s38, s39
sad 38,38,1
s_lshr_b32 s39, s38, 3
s_lshl_b32 s39, s39, 14
s_and_b32 s38, s38, 7
s_lshl_b32 s38, s38, 10
s_add_u32 s74, s38, s39
sad 74,74,65536
sad 38,55,9
s_and_b32 s38, s38, 15
s_lshr_b32 s39, s38, 2
s_add_u32 s38, s38, s39
sad 38,38,1
s_lshr_b32 s39, s38, 3
s_lshl_b32 s39, s39, 14
s_and_b32 s38, s38, 7
s_lshl_b32 s38, s38, 10
s_add_u32 s75, s38, s39
sad 75,75,65536
sad 38,55,10
s_and_b32 s38, s38, 15
s_lshr_b32 s39, s38, 2
s_add_u32 s38, s38, s39
sad 38,38,1
s_lshr_b32 s39, s38, 3
s_lshl_b32 s39, s39, 14
s_and_b32 s38, s38, 7
s_lshl_b32 s38, s38, 10
s_add_u32 s76, s38, s39
sad 76,76,65536
sad 38,55,11
s_and_b32 s38, s38, 15
s_lshr_b32 s39, s38, 2
s_add_u32 s38, s38, s39
sad 38,38,1
s_lshr_b32 s39, s38, 3
s_lshl_b32 s39, s39, 14
s_and_b32 s38, s38, 7
s_lshl_b32 s38, s38, 10
s_add_u32 s77, s38, s39
sad 77,77,65536
sad 38,55,12
s_and_b32 s38, s38, 15
s_lshr_b32 s39, s38, 2
s_add_u32 s38, s38, s39
sad 38,38,1
s_lshr_b32 s39, s38, 3
s_lshl_b32 s39, s39, 14
s_and_b32 s38, s38, 7
s_lshl_b32 s38, s38, 10
s_add_u32 s78, s38, s39
sad 78,78,65536
sad 38,55,13
s_and_b32 s38, s38, 15
s_lshr_b32 s39, s38, 2
s_add_u32 s38, s38, s39
sad 38,38,1
s_lshr_b32 s39, s38, 3
s_lshl_b32 s39, s39, 14
s_and_b32 s38, s38, 7
s_lshl_b32 s38, s38, 10
s_add_u32 s79, s38, s39
sad 79,79,65536
sad 38,55,14
s_and_b32 s38, s38, 15
s_lshr_b32 s39, s38, 2
s_add_u32 s38, s38, s39
sad 38,38,1
s_lshr_b32 s39, s38, 3
s_lshl_b32 s39, s39, 14
s_and_b32 s38, s38, 7
s_lshl_b32 s38, s38, 10
s_add_u32 s80, s38, s39
sad 80,80,65536
sad 38,55,15
s_and_b32 s38, s38, 15
s_lshr_b32 s39, s38, 2
s_add_u32 s38, s38, s39
sad 38,38,1
s_lshr_b32 s39, s38, 3
s_lshl_b32 s39, s39, 14
s_and_b32 s38, s38, 7
s_lshl_b32 s38, s38, 10
s_add_u32 s81, s38, s39
sad 81,81,65536
sad 38,50,16
s_and_b32 s38, s38, 3
s_mul_i32 s38, s38, 5
s_lshr_b32 s39, s38, 3
s_lshl_b32 s39, s39, 14
s_and_b32 s38, s38, 7
s_lshl_b32 s38, s38, 10
s_add_u32 s82, s38, s39
sad 82,82,65536
sad 38,50,17
s_and_b32 s38, s38, 3
s_mul_i32 s38, s38, 5
s_lshr_b32 s39, s38, 3
s_lshl_b32 s39, s39, 14
s_and_b32 s38, s38, 7
s_lshl_b32 s38, s38, 10
s_add_u32 s83, s38, s39
sad 83,83,65536
sad 38,50,18
s_and_b32 s38, s38, 3
s_mul_i32 s38, s38, 5
s_lshr_b32 s39, s38, 3
s_lshl_b32 s39, s39, 14
s_and_b32 s38, s38, 7
s_lshl_b32 s38, s38, 10
s_add_u32 s53, s38, s39
sad 53,53,65536
sad 38,50,19
s_and_b32 s38, s38, 3
s_mul_i32 s38, s38, 5
s_lshr_b32 s39, s38, 3
s_lshl_b32 s39, s39, 14
s_and_b32 s38, s38, 7
s_lshl_b32 s38, s38, 10
s_add_u32 s54, s38, s39
sad 54,54,65536
s_mov_b32 s5, 0
s_mov_b32 s65, 360
s_mov_b32 s51, 0
sad 38,5,0
s_cmp_eq_u32 s38, 4
s_cselect_b32 s38, 64, s38
s_cselect_b32 s40, 72, 64
s_and_b32 s39, s38, 7
s_cmp_lg_u32 s39, 0
s_cbranch_scc1 L_gwd_82
s_cmp_ge_u32 s38, s40
s_cbranch_scc1 L_gwd_82
s_lshl_b32 s38, s38, 4
sad 38,38,64
sad 38,38,640
s_lshl_b32 s39, s38, 7
v_min_u32 v3, 31, v1
v_mul_u32_u24 v3, 128, v3
s_mov_b32 s43, 0
L_fw_83:
buffer_load_dwordx2 v[4:5], v3, s[24:27], s39 offen sc1
wv 0
v_xor_b32 v4, s100, v4
v_xor_b32 v5, s101, v5
v_or_b32 v4, v4, v5
v_cmp_ne_u32 vcc, 0, v4
sad 43,43,1
s_cbranch_vccz L_fwd_84
s_sleep 2
s_cmp_lt_u32 s43, 400000
s_cbranch_scc1 L_fw_83
L_fwd_84:
L_gwd_82:
sad 38,5,0
sad 39,51,0
s_cmp_ge_u32 s39, 2
s_cselect_b32 s44, 2, 0
s_sub_u32 s39, s39, s44
s_mul_i32 s39, s39, 20480
s_mul_i32 s38, s38, 1310720
s_add_u32 s38, s38, s52
s_add_u32 s40, s48, s39
s_add_u32 m0, s40, 1024
s_lshl_b32 s40, s4, 12
s_add_u32 s40, s40, s38
buffer_load_dwordx4 v7, s[16:19], s40 offen offset:0 sc1 lds
buffer_load_dwordx4 v7, s[16:19], s40 offen offset:1024 sc1 lds
buffer_load_dwordx4 v7, s[16:19], s40 offen offset:2048 sc1 lds
buffer_load_dwordx4 v7, s[16:19], s40 offen offset:3072 sc1 lds
sad 38,5,1
s_cmp_eq_u32 s38, 4
s_cselect_b32 s38, 64, s38
s_cselect_b32 s40, 72, 64
s_and_b32 s39, s38, 7
s_cmp_lg_u32 s39, 0
s_cbranch_scc1 L_gwd_85
s_cmp_ge_u32 s38, s40
s_cbranch_scc1 L_gwd_85
s_lshl_b32 s38, s38, 4
sad 38,38,64
sad 38,38,640
s_lshl_b32 s39, s38, 7
v_min_u32 v3, 31, v1
v_mul_u32_u24 v3, 128, v3
s_mov_b32 s43, 0
L_fw_86:
buffer_load_dwordx2 v[4:5], v3, s[24:27], s39 offen sc1
wv 0
v_xor_b32 v4, s100, v4
v_xor_b32 v5, s101, v5
v_or_b32 v4, v4, v5
v_cmp_ne_u32 vcc, 0, v4
sad 43,43,1
s_cbranch_vccz L_fwd_87
s_sleep 2
s_cmp_lt_u32 s43, 400000
s_cbranch_scc1 L_fw_86
L_fwd_87:
L_gwd_85:
sad 38,5,1
sad 39,51,1
s_cmp_ge_u32 s39, 2
s_cselect_b32 s44, 2, 0
s_sub_u32 s39, s39, s44
s_mul_i32 s39, s39, 20480
s_mul_i32 s38, s38, 1310720
s_add_u32 s38, s38, s52
s_add_u32 s40, s48, s39
s_add_u32 m0, s40, 1024
s_lshl_b32 s40, s4, 12
s_add_u32 s40, s40, s38
buffer_load_dwordx4 v7, s[16:19], s40 offen offset:0 sc1 lds
buffer_load_dwordx4 v7, s[16:19], s40 offen offset:1024 sc1 lds
buffer_load_dwordx4 v7, s[16:19], s40 offen offset:2048 sc1 lds
buffer_load_dwordx4 v7, s[16:19], s40 offen offset:3072 sc1 lds
wv 0
s_barrier
s_cmp_eq_u32 s4, 0
s_cselect_b32 s73, s73, 0
s_branch L_red_88
.p2align 6
L_red_88:
s_lshr_b32 s38, s5, 4
s_lshr_b32 s38, s6, s38
s_and_b32 s38, s38, 1
s_lshl_b32 s38, s38, 13
s_lshl_b32 s7, s5, 17
s_add_u32 s7, s7, s38
s_mul_i32 s56, s51, 20480
v_mov_b32 v64, 0
v_mov_b32 v65, 0
v_mov_b32 v66, 0
v_mov_b32 v67, 0
v_mov_b32 v68, 0
v_mov_b32 v69, 0
v_mov_b32 v70, 0
v_mov_b32 v71, 0
v_mov_b32 v72, 0
v_mov_b32 v73, 0
v_mov_b32 v74, 0
v_mov_b32 v75, 0
v_mov_b32 v76, 0
v_mov_b32 v77, 0
v_mov_b32 v78, 0
v_mov_b32 v79, 0
s_cmp_eq_u32 s4, 0
s_cbranch_scc1 L_w0_90
s_barrier
ds_read_b128 v[24:27], v14 offset:0
ds_read_b128 v[28:31], v14 offset:1024
ds_read_b128 v[32:35], v14 offset:2048
ds_read_b128 v[36:39], v14 offset:3072
ds_read_b128 v[40:43], v14 offset:4096
ds_read_b128 v[44:47], v14 offset:5120
ds_read_b128 v[48:51], v14 offset:6144
ds_read_b128 v[52:55], v14 offset:7168
ds_read_b128 v[56:59], v14 offset:8192
ds_read_b128 v[60:63], v14 offset:9216
v_add_u32 v16, s56, v8
s_mul_i32 s41, s5, 327680
s_add_u32 s41, s41, s57
wl 9
v_smfmac_f32_16x16x64_bf16 v[64:67], v[24:27], v[192:199], v6
v_smfmac_f32_16x16x64_bf16 v[68:71], v[24:27], a[16:23], v6
wl 8
v_smfmac_f32_16x16x64_bf16 v[64:67], v[28:31], v[200:207], v6
v_smfmac_f32_16x16x64_bf16 v[68:71], v[28:31], a[24:31], v6
wl 7
v_smfmac_f32_16x16x64_bf16 v[64:67], v[32:35], v[208:215], v6
v_smfmac_f32_16x16x64_bf16 v[68:71], v[32:35], a[32:39], v6
wl 6
v_smfmac_f32_16x16x64_bf16 v[64:67], v[36:39], v[216:223], v6
v_smfmac_f32_16x16x64_bf16 v[68:71], v[36:39], a[40:47], v6
wl 5
v_smfmac_f32_16x16x64_bf16 v[64:67], v[40:43], v[224:231], v6
v_smfmac_f32_16x16x64_bf16 v[68:71], v[40:43], a[48:55], v6
wl 4
v_smfmac_f32_16x16x64_bf16 v[64:67], v[44:47], v[232:239], v6
v_smfmac_f32_16x16x64_bf16 v[68:71], v[44:47], a[56:63], v6
wl 3
v_smfmac_f32_16x16x64_bf16 v[64:67], v[48:51], v[240:247], v6
v_smfmac_f32_16x16x64_bf16 v[68:71], v[48:51], a[64:71], v6
wl 2
v_smfmac_f32_16x16x64_bf16 v[64:67], v[52:55], v[248:255], v6
v_smfmac_f32_16x16x64_bf16 v[68:71], v[52:55], a[72:79], v6
wl 1
v_smfmac_f32_16x16x64_bf16 v[64:67], v[56:59], a[0:7], v6
v_smfmac_f32_16x16x64_bf16 v[68:71], v[56:59], a[80:87], v6
wl 0
v_smfmac_f32_16x16x64_bf16 v[64:67], v[60:63], a[8:15], v6
v_smfmac_f32_16x16x64_bf16 v[68:71], v[60:63], a[88:95], v6
v_smfmac_f32_16x16x64_bf16 v[72:75], v[24:27], a[96:103], v6
v_smfmac_f32_16x16x64_bf16 v[76:79], v[24:27], a[176:183], v6
v_smfmac_f32_16x16x64_bf16 v[72:75], v[28:31], a[104:111], v6
v_smfmac_f32_16x16x64_bf16 v[76:79], v[28:31], a[184:191], v6
v_smfmac_f32_16x16x64_bf16 v[72:75], v[32:35], a[112:119], v6
v_permlane32_swap_b32 v64, v68
v_smfmac_f32_16x16x64_bf16 v[76:79], v[32:35], a[192:199], v6
v_permlane32_swap_b32 v65, v69
v_smfmac_f32_16x16x64_bf16 v[72:75], v[36:39], a[120:127], v6
v_permlane32_swap_b32 v66, v70
v_smfmac_f32_16x16x64_bf16 v[76:79], v[36:39], a[200:207], v6
v_permlane32_swap_b32 v67, v71
v_smfmac_f32_16x16x64_bf16 v[72:75], v[40:43], a[128:135], v6
s_nop 0
v_smfmac_f32_16x16x64_bf16 v[76:79], v[40:43], a[208:215], v6
v_add_f32 v64, v64, v68
v_smfmac_f32_16x16x64_bf16 v[72:75], v[44:47], a[136:143], v6
v_add_f32 v65, v65, v69
v_smfmac_f32_16x16x64_bf16 v[76:79], v[44:47], a[216:223], v6
v_add_f32 v66, v66, v70
v_smfmac_f32_16x16x64_bf16 v[72:75], v[48:51], a[144:151], v6
v_add_f32 v67, v67, v71
v_smfmac_f32_16x16x64_bf16 v[76:79], v[48:51], a[224:231], v6
cvp 68,64,65
v_smfmac_f32_16x16x64_bf16 v[72:75], v[52:55], a[152:159], v6
cvp 69,66,67
v_smfmac_f32_16x16x64_bf16 v[76:79], v[52:55], a[232:239], v6
ds_write_b64 v16, v[68:69] offset:0
v_smfmac_f32_16x16x64_bf16 v[72:75], v[56:59], a[160:167], v6
buffer_store_dwordx2 v[68:69], v17, s[20:23], s41 offen offset:0 sc1
v_smfmac_f32_16x16x64_bf16 v[76:79], v[56:59], a[240:247], v6
v_smfmac_f32_16x16x64_bf16 v[72:75], v[60:63], a[168:175], v6
v_smfmac_f32_16x16x64_bf16 v[76:79], v[60:63], a[248:255], v6
s_nop 7
v_permlane32_swap_b32 v72, v76
v_permlane32_swap_b32 v73, v77
v_permlane32_swap_b32 v74, v78
v_permlane32_swap_b32 v75, v79
s_nop 0
v_add_f32 v72, v72, v76
v_add_f32 v73, v73, v77
v_add_f32 v74, v74, v78
v_add_f32 v75, v75, v79
cvp 76,72,73
cvp 77,74,75
ds_write_b64 v16, v[76:77] offset:128
buffer_store_dwordx2 v[76:77], v17, s[20:23], s41 offen offset:128 sc1
s_waitcnt lgkmcnt(0) vmcnt(0)
s_barrier
s_cmp_lg_u32 s4, 1
s_cbranch_scc1 L_u0_92
s_add_u32 s38, s56, s49
v_add_u32 v16, s38, v7
ds_read_b128 v[24:27], v16
s_sub_u32 s41, s41, 1024
wl 0
buffer_store_dwordx4 v[24:27], v7, s[20:23], s41 offen sc1
L_u0_92:
s_cmp_eq_u32 s73, 0
s_cbranch_scc1 L_zp0_93
sad 38,5,1
s_cmp_eq_u32 s38, 4
s_cselect_b32 s38, 64, s38
s_cselect_b32 s40, 72, 64
s_and_b32 s39, s38, 7
s_cmp_lg_u32 s39, 0
s_cbranch_scc1 L_gwd_97
s_cmp_ge_u32 s38, s40
s_cbranch_scc1 L_gwd_97
s_lshl_b32 s38, s38, 4
sad 38,38,64
sad 38,38,640
s_lshl_b32 s39, s38, 7
v_min_u32 v3, 31, v1
v_mul_u32_u24 v3, 128, v3
s_mov_b32 s43, 0
L_fw_98:
buffer_load_dwordx2 v[4:5], v3, s[24:27], s39 offen sc1
wv 0
v_xor_b32 v4, s100, v4
v_xor_b32 v5, s101, v5
v_or_b32 v4, v4, v5
v_cmp_ne_u32 vcc, 0, v4
sad 43,43,1
s_cbranch_vccz L_fwd_99
s_sleep 2
s_cmp_lt_u32 s43, 400000
s_cbranch_scc1 L_fw_98
L_fwd_99:
L_gwd_97:
sad 38,5,1
sad 39,51,1
s_cmp_ge_u32 s39, 2
s_cselect_b32 s44, 2, 0
s_sub_u32 s39, s39, s44
s_mul_i32 s39, s39, 20480
s_mul_i32 s38, s38, 1310720
s_add_u32 s38, s38, s52
s_add_u32 s40, s48, s39
s_add_u32 m0, s40, 1024
s_lshl_b32 s40, s4, 12
s_add_u32 s40, s40, s38
buffer_load_dwordx4 v7, s[16:19], s40 offen offset:0 sc1 lds
buffer_load_dwordx4 v7, s[16:19], s40 offen offset:1024 sc1 lds
buffer_load_dwordx4 v7, s[16:19], s40 offen offset:2048 sc1 lds
buffer_load_dwordx4 v7, s[16:19], s40 offen offset:3072 sc1 lds
s_cmp_lg_u32 s4, 3
s_cbranch_scc1 L_z_96
sad 38,5,1
sad 39,51,1
s_cmp_ge_u32 s39, 2
s_cselect_b32 s44, 2, 0
s_sub_u32 s39, s39, s44
s_mul_i32 s39, s39, 20480
s_mul_i32 s38, s38, 1310720
s_add_u32 s38, s38, s52
s_add_u32 s40, s49, s39
s_add_u32 m0, s40, 1024
sad 40,38,0
buffer_load_dwordx4 v7, s[16:19], s40 offen offset:0 sc1 lds
buffer_load_dwordx4 v7, s[16:19], s40 offen offset:1024 sc1 lds
buffer_load_dwordx4 v7, s[16:19], s40 offen offset:2048 sc1 lds
buffer_load_dwordx4 v7, s[16:19], s40 offen offset:3072 sc1 lds
L_z_96:
wv 0
s_mov_b32 s73, 0
L_zp0_93:
sad 38,5,2
s_cmp_eq_u32 s38, 4
s_cselect_b32 s38, 64, s38
s_cselect_b32 s40, 72, 64
s_and_b32 s39, s38, 7
s_cmp_lg_u32 s39, 0
s_cbranch_scc1 L_gwd_101
s_cmp_ge_u32 s38, s40
s_cbranch_scc1 L_gwd_101
s_lshl_b32 s38, s38, 4
sad 38,38,64
sad 38,38,640
s_lshl_b32 s39, s38, 7
v_min_u32 v3, 31, v1
v_mul_u32_u24 v3, 128, v3
s_mov_b32 s43, 0
L_fw_102:
buffer_load_dwordx2 v[4:5], v3, s[24:27], s39 offen sc1
wv 0
v_xor_b32 v4, s100, v4
v_xor_b32 v5, s101, v5
v_or_b32 v4, v4, v5
v_cmp_ne_u32 vcc, 0, v4
s_nop 0
s_cbranch_vccnz L_zpf_94
L_gwd_101:
sad 38,5,2
sad 39,51,0
s_cmp_ge_u32 s39, 2
s_cselect_b32 s44, 2, 0
s_sub_u32 s39, s39, s44
s_mul_i32 s39, s39, 20480
s_mul_i32 s38, s38, 1310720
s_add_u32 s38, s38, s52
s_add_u32 s40, s48, s39
s_add_u32 m0, s40, 1024
s_lshl_b32 s40, s4, 12
s_add_u32 s40, s40, s38
buffer_load_dwordx4 v7, s[16:19], s40 offen offset:0 sc1 lds
buffer_load_dwordx4 v7, s[16:19], s40 offen offset:1024 sc1 lds
buffer_load_dwordx4 v7, s[16:19], s40 offen offset:2048 sc1 lds
buffer_load_dwordx4 v7, s[16:19], s40 offen offset:3072 sc1 lds
s_cmp_lg_u32 s4, 3
s_cbranch_scc1 L_z_100
sad 38,5,2
sad 39,51,0
s_cmp_ge_u32 s39, 2
s_cselect_b32 s44, 2, 0
s_sub_u32 s39, s39, s44
s_mul_i32 s39, s39, 20480
s_mul_i32 s38, s38, 1310720
s_add_u32 s38, s38, s52
s_add_u32 s40, s49, s39
s_add_u32 m0, s40, 1024
sad 40,38,0
buffer_load_dwordx4 v7, s[16:19], s40 offen offset:0 sc1 lds
buffer_load_dwordx4 v7, s[16:19], s40 offen offset:1024 sc1 lds
buffer_load_dwordx4 v7, s[16:19], s40 offen offset:2048 sc1 lds
buffer_load_dwordx4 v7, s[16:19], s40 offen offset:3072 sc1 lds
L_z_100:
s_branch L_zpd_95
L_zpf_94:
s_mov_b32 s73, 1
L_zpd_95:
s_cmp_lt_u32 s5, 63
s_cbranch_scc1 L_rb_91
s_branch L_rn_89
L_w0_90:
v_add_u32 v18, s56, v7
ds_read_b128 v[80:83], v18 offset:1024
ds_read_b128 v[84:87], v18 offset:2048
ds_read_b128 v[88:91], v18 offset:3072
ds_read_b128 v[92:95], v18 offset:4096
ds_read_b128 v[96:99], v18 offset:6144
ds_read_b128 v[100:103], v18 offset:7168
ds_read_b128 v[104:107], v18 offset:8192
ds_read_b128 v[108:111], v18 offset:9216
ds_read_b128 v[112:115], v18 offset:11264
ds_read_b128 v[116:119], v18 offset:12288
ds_read_b128 v[120:123], v18 offset:13312
ds_read_b128 v[124:127], v18 offset:14336
ds_read_b128 v[128:131], v18 offset:16384
ds_read_b128 v[132:135], v18 offset:17408
ds_read_b128 v[136:139], v18 offset:18432
ds_read_b128 v[140:143], v18 offset:19456
s_cmp_eq_u32 s5, 0
s_cbranch_scc1 L_s0_104
sad 43,64,100
L_wu_105:
s_memrealtime s[32:33]
wl 0
s_mul_i32 s32, s32, 6
s_sub_u32 s32, s43, s32
s_cmp_gt_i32 s32, 2400
s_cbranch_scc1 L_wud_106
s_cmp_lt_i32 s32, 150
s_cbranch_scc1 L_wf_107
s_sleep 1
s_branch L_wu_105
L_wf_107:
s_cmp_lt_i32 s32, 40
s_cbranch_scc1 L_wud_106
s_memrealtime s[32:33]
s_nop 2
s_memrealtime s[34:35]
s_nop 2
s_memrealtime s[44:45]
s_nop 2
s_memrealtime s[46:47]
s_nop 2
s_memrealtime s[58:59]
s_nop 2
s_memrealtime s[60:61]
s_nop 2
wl 0
s_add_u32 s32, s32, s34
s_add_u32 s44, s44, s46
s_add_u32 s58, s58, s60
s_add_u32 s32, s32, s44
s_add_u32 s32, s32, s58
s_sub_u32 s32, s43, s32
s_sub_u32 s32, s32, 50
L_wl_108:
s_sub_u32 s32, s32, 8
s_cmp_gt_i32 s32, 0
s_cbranch_scc1 L_wl_108
L_wud_106:
L_s0_104:
sad 39,7,4096
sad 40,7,16384
s_mov_b32 s43, 0
L_poll_109:
buffer_load_dwordx4 v[24:27], v7, s[8:11], s7 offen offset:0 sc1
buffer_load_dwordx4 v[28:31], v7, s[8:11], s7 offen offset:1024 sc1
buffer_load_dwordx4 v[32:35], v7, s[8:11], s7 offen offset:2048 sc1
buffer_load_dwordx4 v[36:39], v7, s[8:11], s7 offen offset:3072 sc1
buffer_load_dwordx4 v[40:43], v7, s[8:11], s39 offen offset:0 sc1
buffer_load_dwordx4 v[44:47], v7, s[8:11], s39 offen offset:1024 sc1
buffer_load_dwordx4 v[48:51], v7, s[8:11], s39 offen offset:2048 sc1
buffer_load_dwordx4 v[52:55], v7, s[8:11], s39 offen offset:3072 sc1
buffer_load_dwordx4 v[56:59], v7, s[8:11], s40 offen offset:0 sc1
buffer_load_dwordx4 v[60:63], v7, s[8:11], s40 offen offset:1024 sc1
wv 9
v_max3_u32 v2, v24, v25, v26
v_max_u32 v2, v2, v27
wv 8
v_max3_u32 v2, v2, v28, v29
v_max3_u32 v2, v2, v30, v31
wv 7
v_max3_u32 v2, v2, v32, v33
v_max3_u32 v2, v2, v34, v35
wv 6
v_max3_u32 v2, v2, v36, v37
v_max3_u32 v2, v2, v38, v39
wv 5
v_max3_u32 v2, v2, v40, v41
v_max3_u32 v2, v2, v42, v43
wv 4
v_max3_u32 v2, v2, v44, v45
v_max3_u32 v2, v2, v46, v47
wv 3
v_max3_u32 v2, v2, v48, v49
v_max3_u32 v2, v2, v50, v51
wv 2
v_max3_u32 v2, v2, v52, v53
v_max3_u32 v2, v2, v54, v55
wv 1
v_max3_u32 v2, v2, v56, v57
v_max3_u32 v2, v2, v58, v59
wv 0
v_max3_u32 v2, v2, v60, v61
v_max3_u32 v2, v2, v62, v63
v_cmp_eq_u32 vcc, -1, v2
sad 43,43,1
s_cbranch_vccnz L_rt_111
L_pd_110:
v_add_u32 v16, s56, v8
s_mul_i32 s41, s5, 327680
s_add_u32 s41, s41, s57
v_smfmac_f32_16x16x64_bf16 v[64:67], v[24:27], v[192:199], v6
ds_write_b128 v14, v[24:27] offset:0
v_smfmac_f32_16x16x64_bf16 v[68:71], v[24:27], a[16:23], v6
ds_write_b128 v14, v[28:31] offset:1024
v_smfmac_f32_16x16x64_bf16 v[64:67], v[28:31], v[200:207], v6
ds_write_b128 v14, v[32:35] offset:2048
v_smfmac_f32_16x16x64_bf16 v[68:71], v[28:31], a[24:31], v6
ds_write_b128 v14, v[36:39] offset:3072
v_smfmac_f32_16x16x64_bf16 v[64:67], v[32:35], v[208:215], v6
ds_write_b128 v14, v[40:43] offset:4096
v_smfmac_f32_16x16x64_bf16 v[68:71], v[32:35], a[32:39], v6
ds_write_b128 v14, v[44:47] offset:5120
v_smfmac_f32_16x16x64_bf16 v[64:67], v[36:39], v[216:223], v6
ds_write_b128 v14, v[48:51] offset:6144
v_smfmac_f32_16x16x64_bf16 v[68:71], v[36:39], a[40:47], v6
ds_write_b128 v14, v[52:55] offset:7168
v_smfmac_f32_16x16x64_bf16 v[64:67], v[40:43], v[224:231], v6
ds_write_b128 v14, v[56:59] offset:8192
v_smfmac_f32_16x16x64_bf16 v[68:71], v[40:43], a[48:55], v6
ds_write_b128 v14, v[60:63] offset:9216
v_smfmac_f32_16x16x64_bf16 v[64:67], v[44:47], v[232:239], v6
v_smfmac_f32_16x16x64_bf16 v[68:71], v[44:47], a[56:63], v6
v_smfmac_f32_16x16x64_bf16 v[64:67], v[48:51], v[240:247], v6
wl 0
s_barrier
v_smfmac_f32_16x16x64_bf16 v[68:71], v[48:51], a[64:71], v6
v_smfmac_f32_16x16x64_bf16 v[64:67], v[52:55], v[248:255], v6
v_smfmac_f32_16x16x64_bf16 v[68:71], v[52:55], a[72:79], v6
v_smfmac_f32_16x16x64_bf16 v[64:67], v[56:59], a[0:7], v6
v_smfmac_f32_16x16x64_bf16 v[68:71], v[56:59], a[80:87], v6
v_smfmac_f32_16x16x64_bf16 v[64:67], v[60:63], a[8:15], v6
v_smfmac_f32_16x16x64_bf16 v[68:71], v[60:63], a[88:95], v6
v_smfmac_f32_16x16x64_bf16 v[72:75], v[24:27], a[96:103], v6
v_smfmac_f32_16x16x64_bf16 v[76:79], v[24:27], a[176:183], v6
v_smfmac_f32_16x16x64_bf16 v[72:75], v[28:31], a[104:111], v6
v_smfmac_f32_16x16x64_bf16 v[76:79], v[28:31], a[184:191], v6
v_smfmac_f32_16x16x64_bf16 v[72:75], v[32:35], a[112:119], v6
v_permlane32_swap_b32 v64, v68
v_smfmac_f32_16x16x64_bf16 v[76:79], v[32:35], a[192:199], v6
v_permlane32_swap_b32 v65, v69
v_smfmac_f32_16x16x64_bf16 v[72:75], v[36:39], a[120:127], v6
v_permlane32_swap_b32 v66, v70
v_smfmac_f32_16x16x64_bf16 v[76:79], v[36:39], a[200:207], v6
v_permlane32_swap_b32 v67, v71
v_smfmac_f32_16x16x64_bf16 v[72:75], v[40:43], a[128:135], v6
s_nop 0
v_smfmac_f32_16x16x64_bf16 v[76:79], v[40:43], a[208:215], v6
v_add_f32 v64, v64, v68
v_smfmac_f32_16x16x64_bf16 v[72:75], v[44:47], a[136:143], v6
v_add_f32 v65, v65, v69
v_smfmac_f32_16x16x64_bf16 v[76:79], v[44:47], a[216:223], v6
v_add_f32 v66, v66, v70
v_smfmac_f32_16x16x64_bf16 v[72:75], v[48:51], a[144:151], v6
v_add_f32 v67, v67, v71
v_smfmac_f32_16x16x64_bf16 v[76:79], v[48:51], a[224:231], v6
cvp 68,64,65
v_smfmac_f32_16x16x64_bf16 v[72:75], v[52:55], a[152:159], v6
cvp 69,66,67
v_smfmac_f32_16x16x64_bf16 v[76:79], v[52:55], a[232:239], v6
ds_write_b64 v16, v[68:69] offset:0
v_smfmac_f32_16x16x64_bf16 v[72:75], v[56:59], a[160:167], v6
buffer_load_dword v20, v11, s[8:11], s7 offen sc1
buffer_load_dword v21, v13, s[8:11], s7 offen sc1
v_smfmac_f32_16x16x64_bf16 v[76:79], v[56:59], a[240:247], v6
v_smfmac_f32_16x16x64_bf16 v[72:75], v[60:63], a[168:175], v6
v_smfmac_f32_16x16x64_bf16 v[76:79], v[60:63], a[248:255], v6
s_nop 7
v_permlane32_swap_b32 v72, v76
v_permlane32_swap_b32 v73, v77
v_permlane32_swap_b32 v74, v78
v_permlane32_swap_b32 v75, v79
s_nop 0
v_add_f32 v72, v72, v76
v_add_f32 v73, v73, v77
v_add_f32 v74, v74, v78
v_add_f32 v75, v75, v79
cvp 76,72,73
cvp 77,74,75
ds_write_b64 v16, v[76:77] offset:128
s_cmp_lt_u32 s5, 63
s_cbranch_scc1 L_go_112
wl 0
s_barrier
s_branch L_rn_89
L_go_112:
sad 63,5,1
s_lshr_b32 s62, s63, 4
s_lshr_b32 s62, s6, s62
s_and_b32 s62, s62, 1
s_lshl_b32 s62, s62, 13
s_lshl_b32 s63, s63, 17
s_add_u32 s62, s62, s63
wv 0
s_mov_b32 s43, 0
v_mov_b32 v3, v21
s_branch L_tfc_115
L_tf_113:
s_sleep 1
buffer_load_dword v3, v13, s[8:11], s7 offen sc1
wv 0
L_tfc_115:
v_cmp_eq_u32 vcc, -1, v3
sad 43,43,1
s_cbranch_vccnz L_rt_116
L_tfd_114:
v_readfirstlane_b32 s85, v3
s_nop 0
v_subrev_u32 v3, s85, v3
s_nop 1
v_max_i32_dpp v3, v3, v3 row_ror:8 row_mask:0xf bank_mask:0xf
s_nop 1
v_max_i32_dpp v3, v3, v3 row_ror:4 row_mask:0xf bank_mask:0xf
s_nop 1
v_max_i32_dpp v3, v3, v3 row_ror:2 row_mask:0xf bank_mask:0xf
s_nop 1
v_max_i32_dpp v3, v3, v3 row_ror:1 row_mask:0xf bank_mask:0xf
s_nop 0
v_readlane_b32 s44, v3, 0
v_readlane_b32 s45, v3, 16
s_max_i32 s44, s44, s45
s_add_u32 s85, s85, s44
s_nop 1
v_max_i32_dpp v20, v20, v20 row_ror:8 row_mask:0xf bank_mask:0xf
s_nop 1
v_max_i32_dpp v20, v20, v20 row_ror:4 row_mask:0xf bank_mask:0xf
s_nop 1
v_max_i32_dpp v20, v20, v20 row_ror:2 row_mask:0xf bank_mask:0xf
s_nop 1
v_max_i32_dpp v20, v20, v20 row_ror:1 row_mask:0xf bank_mask:0xf
s_nop 0
v_readlane_b32 s44, v20, 0
v_readlane_b32 s45, v20, 16
v_readlane_b32 s46, v20, 32
v_readlane_b32 s47, v20, 48
s_max_i32 s44, s44, s45
s_max_i32 s46, s46, s47
s_max_i32 s44, s44, s46
s_add_u32 s64, s85, s44
v_add_u32 v19, s7, v7
sad 43,85,60
L_wu_117:
s_memrealtime s[32:33]
wl 0
s_mul_i32 s32, s32, 6
s_sub_u32 s32, s43, s32
s_cmp_gt_i32 s32, 2400
s_cbranch_scc1 L_wud_118
s_cmp_lt_i32 s32, 150
s_cbranch_scc1 L_wf_119
s_sleep 1
s_branch L_wu_117
L_wf_119:
s_cmp_lt_i32 s32, 40
s_cbranch_scc1 L_wud_118
s_memrealtime s[32:33]
s_nop 2
s_memrealtime s[34:35]
s_nop 2
s_memrealtime s[44:45]
s_nop 2
s_memrealtime s[46:47]
s_nop 2
s_memrealtime s[58:59]
s_nop 2
s_memrealtime s[60:61]
s_nop 2
wl 0
s_add_u32 s32, s32, s34
s_add_u32 s44, s44, s46
s_add_u32 s58, s58, s60
s_add_u32 s32, s32, s44
s_add_u32 s32, s32, s58
s_sub_u32 s32, s43, s32
s_sub_u32 s32, s32, 50
L_wl_120:
s_sub_u32 s32, s32, 8
s_cmp_gt_i32 s32, 0
s_cbranch_scc1 L_wl_120
L_wud_118:
s_min_i32 s32, s32, 0
s_sub_u32 s55, s43, s32
s_mov_b32 s43, 0
v_mov_b32 v5, v10
L_pp_121:
buffer_load_dwordx4 v[144:147], v19, s[8:11], s66 offen sc1
buffer_load_dwordx4 v[148:151], v19, s[8:11], s67 offen sc1
buffer_load_dwordx4 v[152:155], v19, s[8:11], s68 offen sc1
buffer_load_dwordx4 v[156:159], v19, s[8:11], s69 offen sc1
buffer_load_dwordx4 v[160:163], v19, s[8:11], s70 offen sc1
buffer_load_dwordx4 v[164:167], v19, s[8:11], s71 offen sc1
buffer_load_dwordx4 v[168:171], v19, s[8:11], s72 offen sc1
buffer_load_dwordx4 v[172:175], v19, s[8:11], s73 offen sc1
buffer_load_dwordx4 v[176:179], v19, s[8:11], s74 offen sc1
buffer_load_dwordx4 v[180:183], v19, s[8:11], s75 offen sc1
buffer_load_dwordx4 v[184:187], v19, s[8:11], s76 offen sc1
buffer_load_dwordx4 v[188:191], v19, s[8:11], s77 offen sc1
buffer_load_dwordx4 v[24:27], v19, s[8:11], s78 offen sc1
buffer_load_dwordx4 v[28:31], v19, s[8:11], s79 offen sc1
buffer_load_dwordx4 v[32:35], v19, s[8:11], s80 offen sc1
buffer_load_dwordx4 v[36:39], v19, s[8:11], s81 offen sc1
buffer_load_dwordx4 v[40:43], v19, s[8:11], s82 offen sc1
buffer_load_dwordx4 v[44:47], v19, s[8:11], s83 offen sc1
buffer_load_dwordx4 v[48:51], v19, s[8:11], s53 offen sc1
buffer_load_dwordx4 v[52:55], v19, s[8:11], s54 offen sc1
s_cmp_lg_u32 s43, 0
s_cbranch_scc1 L_na_123
s_barrier
ds_read_b128 v[64:67], v18 offset:0
ds_read_b128 v[68:71], v18 offset:5120
ds_read_b128 v[72:75], v18 offset:10240
ds_read_b128 v[76:79], v18 offset:15360
L_na_123:
wv 19
v_mfma_f32_16x16x32_bf16 v[56:59], v[80:83], v[144:147], 0
v_max3_u32 v2, v144, v145, v146
v_max_u32 v2, v2, v147
wv 18
mfx 56,84,148
v_max3_u32 v2, v2, v148, v149
v_max3_u32 v2, v2, v150, v151
wv 17
mfx 56,88,152
v_max3_u32 v2, v2, v152, v153
v_max3_u32 v2, v2, v154, v155
wv 16
mfx 56,92,156
v_max3_u32 v2, v2, v156, v157
v_max3_u32 v2, v2, v158, v159
wv 15
mfx 56,96,160
v_max3_u32 v2, v2, v160, v161
v_max3_u32 v2, v2, v162, v163
wv 14
mfx 56,100,164
v_max3_u32 v2, v2, v164, v165
v_max3_u32 v2, v2, v166, v167
wv 13
mfx 56,104,168
v_max3_u32 v2, v2, v168, v169
v_max3_u32 v2, v2, v170, v171
wv 12
mfx 56,108,172
v_max3_u32 v2, v2, v172, v173
v_max3_u32 v2, v2, v174, v175
wv 11
mfx 56,112,176
v_max3_u32 v2, v2, v176, v177
v_max3_u32 v2, v2, v178, v179
wv 10
mfx 56,116,180
v_max3_u32 v2, v2, v180, v181
v_max3_u32 v2, v2, v182, v183
wv 9
mfx 56,120,184
v_max3_u32 v2, v2, v184, v185
v_max3_u32 v2, v2, v186, v187
wv 8
mfx 56,124,188
v_max3_u32 v2, v2, v188, v189
v_max3_u32 v2, v2, v190, v191
wv 7
mfx 56,128,24
v_max3_u32 v2, v2, v24, v25
v_max3_u32 v2, v2, v26, v27
wv 6
mfx 56,132,28
v_max3_u32 v2, v2, v28, v29
v_max3_u32 v2, v2, v30, v31
wv 5
mfx 56,136,32
v_max3_u32 v2, v2, v32, v33
v_max3_u32 v2, v2, v34, v35
wv 4
mfx 56,140,36
v_max3_u32 v2, v2, v36, v37
v_max3_u32 v2, v2, v38, v39
s_waitcnt vmcnt(3) lgkmcnt(0)
mfx 56,64,40
v_max3_u32 v2, v2, v40, v41
v_max3_u32 v2, v2, v42, v43
wv 2
mfx 56,68,44
v_max3_u32 v2, v2, v44, v45
v_max3_u32 v2, v2, v46, v47
wv 1
mfx 56,72,48
v_max3_u32 v2, v2, v48, v49
v_max3_u32 v2, v2, v50, v51
wv 0
mfx 56,76,52
v_max3_u32 v2, v2, v52, v53
v_max3_u32 v2, v2, v54, v55
v_cmp_eq_u32 vcc, -1, v2
sad 43,43,1
s_cbranch_vccnz L_rt_124
L_ppd_122:
s_nop 2
v_permlane32_swap_b32 v56, v58
v_permlane32_swap_b32 v57, v59
s_nop 0
v_add_f32_dpp v56, v58, v56 row_ror:8 row_mask:0xf bank_mask:0xf
v_add_f32_dpp v57, v59, v57 row_ror:8 row_mask:0xf bank_mask:0xf
cvp 60,56,57
v_min_u32 v60, -2, v60
buffer_store_dword v60, v9, s[8:11], s62 offen sc1
s_xor_b32 s62, s62, 8192
buffer_store_dword v60, v9, s[8:11], s62 offen sc1
s_memrealtime s[32:33]
s_nop 2
s_memrealtime s[34:35]
s_nop 2
s_memrealtime s[44:45]
s_nop 2
s_memrealtime s[46:47]
s_nop 2
s_memrealtime s[58:59]
s_nop 2
s_memrealtime s[60:61]
s_nop 2
wl 0
s_add_u32 s32, s32, s34
s_add_u32 s44, s44, s46
s_add_u32 s58, s58, s60
s_add_u32 s32, s32, s44
s_add_u32 s44, s32, s58
s_sub_u32 s44, s44, s55
sad 44,44,60
sad 45,65,18
s_min_u32 s44, s44, s45
s_cmp_eq_u32 s43, 1
s_cselect_b32 s65, s44, s65
v_mov_b32 v5, s65
buffer_store_dword v5, v10, s[8:11], s63 offen sc1
s_branch L_rb_91
L_rn_89:
wv 0
L_rb_91:
s_barrier
sad 51,51,1
s_cmp_ge_u32 s51, 2
s_cselect_b32 s51, 0, s51
sad 5,5,1
s_cmp_lt_u32 s5, 64
s_cbranch_scc1 L_red_88
s_lshl_b32 s38, s3, 7
v_and_b32 v2, 1, v1
v_cmp_eq_u32 vcc, 1, v2
v_mov_b32 v2, s100
v_mov_b32 v3, s101
v_cndmask_b32 v3, v2, v3, vcc
v_and_b32 v2, 31, v1
v_lshlrev_b32 v2, 2, v2
buffer_store_dword v3, v2, s[24:27], s38 offen sc1
s_endpgm
L_rt_111:
s_cmp_lt_u32 s43, s42
s_cbranch_scc1 L_poll_109
s_mov_b32 s42, 0
s_branch L_pd_110
L_rt_116:
s_cmp_lt_u32 s43, s42
s_cbranch_scc1 L_tf_113
s_mov_b32 s42, 0
s_branch L_tfd_114
L_rt_124:
s_cmp_lt_u32 s43, s42
s_cbranch_scc1 L_pp_121
s_mov_b32 s42, 0
s_branch L_ppd_122
L_worker1:
s_getpc_b64 s[80:81]
L_tr_125:
s_add_u32 s80, s80, L_qtab-L_tr_125
s_addc_u32 s81, s81, 0
s_and_b32 s76, s2, 7
s_mov_b32 s77, 0
s_mov_b32 s92, 0
s_mov_b32 s70, -1
s_mov_b32 s68, 0
s_load_dwordx2 s[36:37], s[0:1], 104
s_load_dwordx2 s[42:43], s[0:1], 40
v_and_b32 v1, 63, v0
v_lshrrev_b32 v2, 6, v0
s_nop 0
v_readfirstlane_b32 s4, v2
v_lshlrev_b32 v20, 4, v1
v_lshrrev_b32 v2, 4, v1
v_bfe_u32 v3, v1, 2, 2
v_lshlrev_b32 v4, 2, v2
v_add_u32 v4, v4, v3
v_lshlrev_b32 v4, 7, v4
v_and_b32 v5, 3, v1
v_lshl_add_u32 v4, v5, 3, v4
v_lshrrev_b32 v3, 1, v3
v_and_b32 v2, 1, v2
v_lshl_or_b32 v3, v2, 1, v3
v_xor_b32 v2, 0, v3
v_lshl_add_u32 v8, v2, 5, v4
v_xor_b32 v2, 1, v3
v_lshl_add_u32 v9, v2, 5, v4
v_xor_b32 v2, 2, v3
v_lshl_add_u32 v10, v2, 5, v4
v_xor_b32 v2, 3, v3
v_lshl_add_u32 v11, v2, 5, v4
v_add_u32 v12, 49152, v8
v_add_u32 v24, 98304, v8
v_add_u32 v13, 49152, v9
v_add_u32 v25, 98304, v9
v_add_u32 v14, 49152, v10
v_add_u32 v26, 98304, v10
v_add_u32 v15, 49152, v11
v_add_u32 v27, 98304, v11
s_lshl_b32 s29, s4, 11
v_lshrrev_b32 v2, 3, v1
v_lshrrev_b32 v3, 1, v2
v_bfe_u32 v4, v1, 1, 2
v_xor_b32 v4, v4, v3
v_and_b32 v5, 1, v1
v_lshl_or_b32 v4, v4, 1, v5
v_lshlrev_b32 v4, 4, v4
s_lshl_b32 s32, s4, 4
sad 32,32,0
v_add_u32 v2, s32, v2
s_mov_b32 s33, 12288
v_mul_lo_u32 v2, v2, s33
v_add_u32 v6, v2, v4
v_lshrrev_b32 v2, 3, v1
v_lshrrev_b32 v3, 1, v2
v_bfe_u32 v4, v1, 1, 2
v_xor_b32 v4, v4, v3
v_and_b32 v5, 1, v1
v_lshl_or_b32 v4, v4, 1, v5
v_lshlrev_b32 v4, 4, v4
s_lshl_b32 s32, s4, 4
sad 32,32,8
v_add_u32 v2, s32, v2
s_mov_b32 s33, 12288
v_mul_lo_u32 v2, v2, s33
v_add_u32 v7, v2, v4
v_mov_b32 v28, v6
v_mov_b32 v29, v7
v_lshrrev_b32 v2, 3, v1
v_lshrrev_b32 v3, 1, v2
v_bfe_u32 v4, v1, 1, 2
v_xor_b32 v4, v4, v3
v_and_b32 v5, 1, v1
v_lshl_or_b32 v4, v4, 1, v5
v_lshlrev_b32 v4, 4, v4
s_lshl_b32 s32, s4, 4
sad 32,32,0
v_add_u32 v2, s32, v2
s_mov_b32 s33, 1280
v_mul_lo_u32 v2, v2, s33
v_add_u32 v6, v2, v4
v_lshrrev_b32 v2, 3, v1
v_lshrrev_b32 v3, 1, v2
v_bfe_u32 v4, v1, 1, 2
v_xor_b32 v4, v4, v3
v_and_b32 v5, 1, v1
v_lshl_or_b32 v4, v4, 1, v5
v_lshlrev_b32 v4, 4, v4
s_lshl_b32 s32, s4, 4
sad 32,32,8
v_add_u32 v2, s32, v2
s_mov_b32 s33, 1280
v_mul_lo_u32 v2, v2, s33
v_add_u32 v7, v2, v4
v_mov_b32 v30, v6
v_mov_b32 v31, v7
v_lshrrev_b32 v2, 3, v1
v_lshrrev_b32 v3, 1, v2
v_bfe_u32 v4, v1, 1, 2
v_xor_b32 v4, v4, v3
v_and_b32 v5, 1, v1
v_lshl_or_b32 v4, v4, 1, v5
v_lshlrev_b32 v4, 4, v4
s_lshl_b32 s32, s4, 4
sad 32,32,0
v_add_u32 v2, s32, v2
s_mov_b32 s33, 3072
v_mul_lo_u32 v2, v2, s33
v_add_u32 v6, v2, v4
v_lshrrev_b32 v2, 3, v1
v_lshrrev_b32 v3, 1, v2
v_bfe_u32 v4, v1, 1, 2
v_xor_b32 v4, v4, v3
v_and_b32 v5, 1, v1
v_lshl_or_b32 v4, v4, 1, v5
v_lshlrev_b32 v4, 4, v4
s_lshl_b32 s32, s4, 4
sad 32,32,8
v_add_u32 v2, s32, v2
s_mov_b32 s33, 3072
v_mul_lo_u32 v2, v2, s33
v_add_u32 v7, v2, v4
v_mov_b32 v22, v6
v_mov_b32 v23, v7
wl 0
sad 8,36,8388608
s_addc_u32 s9, s37, 0
s_and_b32 s9, s9, 0xffff
s_mov_b32 s10, 2621440
s_mov_b32 s11, 0x00020000
sad 52,36,8388608
s_addc_u32 s53, s37, 0
s_and_b32 s53, s53, 0xffff
s_mov_b32 s54, 2621440
s_mov_b32 s55, 0x00020000
sad 56,36,8388608
s_addc_u32 s57, s37, 0
s_and_b32 s57, s57, 0xffff
s_mov_b32 s58, 2621440
s_mov_b32 s59, 0x00020000
sad 16,36,8388608
s_addc_u32 s17, s37, 0
s_and_b32 s17, s17, 0xffff
s_mov_b32 s18, 2621440
s_mov_b32 s19, 0x00020000
sad 20,36,8388608
s_addc_u32 s21, s37, 0
s_and_b32 s21, s21, 0xffff
s_mov_b32 s22, 2621440
s_mov_b32 s23, 0x00020000
s_mov_b32 s12, s42
s_and_b32 s13, s43, 0xffff
s_mov_b32 s14, 7864320
s_mov_b32 s15, 0x00020000
s_sub_u32 s78, s2, 160
s_lshr_b32 s78, s78, 3
s_sub_u32 s78, s78, 12
s_mov_b32 s72, 0
s_getpc_b64 s[50:51]
L_c_126:
s_add_u32 s50, s50, L_sched-L_c_126
s_addc_u32 s51, s51, 0
s_swappc_b64 s[74:75], s[50:51]
sad 33,28,0
buffer_load_dwordx4 a[96:99], v20, s[16:19], s33 offen sc1
sad 33,28,20480
buffer_load_dwordx4 a[100:103], v20, s[16:19], s33 offen sc1
sad 33,28,40960
buffer_load_dwordx4 a[104:107], v20, s[16:19], s33 offen sc1
sad 33,28,61440
buffer_load_dwordx4 a[108:111], v20, s[16:19], s33 offen sc1
sad 33,28,1024
buffer_load_dwordx4 a[112:115], v20, s[16:19], s33 offen sc1
sad 33,28,21504
buffer_load_dwordx4 a[116:119], v20, s[16:19], s33 offen sc1
sad 33,28,41984
buffer_load_dwordx4 a[120:123], v20, s[16:19], s33 offen sc1
sad 33,28,62464
buffer_load_dwordx4 a[124:127], v20, s[16:19], s33 offen sc1
sad 33,28,2048
buffer_load_dwordx4 a[128:131], v20, s[16:19], s33 offen sc1
sad 33,28,22528
buffer_load_dwordx4 a[132:135], v20, s[16:19], s33 offen sc1
sad 33,28,43008
buffer_load_dwordx4 a[136:139], v20, s[16:19], s33 offen sc1
sad 33,28,63488
buffer_load_dwordx4 a[140:143], v20, s[16:19], s33 offen sc1
sad 33,28,3072
buffer_load_dwordx4 a[144:147], v20, s[16:19], s33 offen sc1
sad 33,28,23552
buffer_load_dwordx4 a[148:151], v20, s[16:19], s33 offen sc1
sad 33,28,44032
buffer_load_dwordx4 a[152:155], v20, s[16:19], s33 offen sc1
sad 33,28,64512
buffer_load_dwordx4 a[156:159], v20, s[16:19], s33 offen sc1
sad 33,28,4096
buffer_load_dwordx4 a[160:163], v20, s[16:19], s33 offen sc1
sad 33,28,24576
buffer_load_dwordx4 a[164:167], v20, s[16:19], s33 offen sc1
sad 33,28,45056
buffer_load_dwordx4 a[168:171], v20, s[16:19], s33 offen sc1
sad 33,28,65536
buffer_load_dwordx4 a[172:175], v20, s[16:19], s33 offen sc1
sad 33,28,5120
buffer_load_dwordx4 a[176:179], v20, s[16:19], s33 offen sc1
sad 33,28,25600
buffer_load_dwordx4 a[180:183], v20, s[16:19], s33 offen sc1
sad 33,28,46080
buffer_load_dwordx4 a[184:187], v20, s[16:19], s33 offen sc1
sad 33,28,66560
buffer_load_dwordx4 a[188:191], v20, s[16:19], s33 offen sc1
sad 33,28,6144
buffer_load_dwordx4 a[192:195], v20, s[16:19], s33 offen sc1
sad 33,28,26624
buffer_load_dwordx4 a[196:199], v20, s[16:19], s33 offen sc1
sad 33,28,47104
buffer_load_dwordx4 a[200:203], v20, s[16:19], s33 offen sc1
sad 33,28,67584
buffer_load_dwordx4 a[204:207], v20, s[16:19], s33 offen sc1
sad 33,28,7168
buffer_load_dwordx4 a[208:211], v20, s[16:19], s33 offen sc1
sad 33,28,27648
buffer_load_dwordx4 a[212:215], v20, s[16:19], s33 offen sc1
sad 33,28,48128
buffer_load_dwordx4 a[216:219], v20, s[16:19], s33 offen sc1
sad 33,28,68608
buffer_load_dwordx4 a[220:223], v20, s[16:19], s33 offen sc1
wv 16
s_branch L_wk_go
L_worker:
s_getpc_b64 s[80:81]
L_tr_127:
s_add_u32 s80, s80, L_qtab-L_tr_127
s_addc_u32 s81, s81, 0
s_and_b32 s76, s2, 7
s_mov_b32 s77, 0
s_mov_b32 s92, 0
s_mov_b32 s70, -1
s_mov_b32 s68, 0
s_load_dwordx2 s[36:37], s[0:1], 104
s_load_dwordx2 s[42:43], s[0:1], 40
v_and_b32 v1, 63, v0
v_lshrrev_b32 v2, 6, v0
s_nop 0
v_readfirstlane_b32 s4, v2
v_lshlrev_b32 v20, 4, v1
v_lshrrev_b32 v2, 4, v1
v_bfe_u32 v3, v1, 2, 2
v_lshlrev_b32 v4, 2, v2
v_add_u32 v4, v4, v3
v_lshlrev_b32 v4, 7, v4
v_and_b32 v5, 3, v1
v_lshl_add_u32 v4, v5, 3, v4
v_lshrrev_b32 v3, 1, v3
v_and_b32 v2, 1, v2
v_lshl_or_b32 v3, v2, 1, v3
v_xor_b32 v2, 0, v3
v_lshl_add_u32 v8, v2, 5, v4
v_xor_b32 v2, 1, v3
v_lshl_add_u32 v9, v2, 5, v4
v_xor_b32 v2, 2, v3
v_lshl_add_u32 v10, v2, 5, v4
v_xor_b32 v2, 3, v3
v_lshl_add_u32 v11, v2, 5, v4
v_add_u32 v12, 49152, v8
v_add_u32 v24, 98304, v8
v_add_u32 v13, 49152, v9
v_add_u32 v25, 98304, v9
v_add_u32 v14, 49152, v10
v_add_u32 v26, 98304, v10
v_add_u32 v15, 49152, v11
v_add_u32 v27, 98304, v11
s_lshl_b32 s29, s4, 11
v_lshrrev_b32 v2, 3, v1
v_lshrrev_b32 v3, 1, v2
v_bfe_u32 v4, v1, 1, 2
v_xor_b32 v4, v4, v3
v_and_b32 v5, 1, v1
v_lshl_or_b32 v4, v4, 1, v5
v_lshlrev_b32 v4, 4, v4
s_lshl_b32 s32, s4, 4
sad 32,32,0
v_add_u32 v2, s32, v2
s_mov_b32 s33, 12288
v_mul_lo_u32 v2, v2, s33
v_add_u32 v6, v2, v4
v_lshrrev_b32 v2, 3, v1
v_lshrrev_b32 v3, 1, v2
v_bfe_u32 v4, v1, 1, 2
v_xor_b32 v4, v4, v3
v_and_b32 v5, 1, v1
v_lshl_or_b32 v4, v4, 1, v5
v_lshlrev_b32 v4, 4, v4
s_lshl_b32 s32, s4, 4
sad 32,32,8
v_add_u32 v2, s32, v2
s_mov_b32 s33, 12288
v_mul_lo_u32 v2, v2, s33
v_add_u32 v7, v2, v4
v_mov_b32 v28, v6
v_mov_b32 v29, v7
v_lshrrev_b32 v2, 3, v1
v_lshrrev_b32 v3, 1, v2
v_bfe_u32 v4, v1, 1, 2
v_xor_b32 v4, v4, v3
v_and_b32 v5, 1, v1
v_lshl_or_b32 v4, v4, 1, v5
v_lshlrev_b32 v4, 4, v4
s_lshl_b32 s32, s4, 4
sad 32,32,0
v_add_u32 v2, s32, v2
s_mov_b32 s33, 1280
v_mul_lo_u32 v2, v2, s33
v_add_u32 v6, v2, v4
v_lshrrev_b32 v2, 3, v1
v_lshrrev_b32 v3, 1, v2
v_bfe_u32 v4, v1, 1, 2
v_xor_b32 v4, v4, v3
v_and_b32 v5, 1, v1
v_lshl_or_b32 v4, v4, 1, v5
v_lshlrev_b32 v4, 4, v4
s_lshl_b32 s32, s4, 4
sad 32,32,8
v_add_u32 v2, s32, v2
s_mov_b32 s33, 1280
v_mul_lo_u32 v2, v2, s33
v_add_u32 v7, v2, v4
v_mov_b32 v30, v6
v_mov_b32 v31, v7
v_lshrrev_b32 v2, 3, v1
v_lshrrev_b32 v3, 1, v2
v_bfe_u32 v4, v1, 1, 2
v_xor_b32 v4, v4, v3
v_and_b32 v5, 1, v1
v_lshl_or_b32 v4, v4, 1, v5
v_lshlrev_b32 v4, 4, v4
s_lshl_b32 s32, s4, 4
sad 32,32,0
v_add_u32 v2, s32, v2
s_mov_b32 s33, 3072
v_mul_lo_u32 v2, v2, s33
v_add_u32 v6, v2, v4
v_lshrrev_b32 v2, 3, v1
v_lshrrev_b32 v3, 1, v2
v_bfe_u32 v4, v1, 1, 2
v_xor_b32 v4, v4, v3
v_and_b32 v5, 1, v1
v_lshl_or_b32 v4, v4, 1, v5
v_lshlrev_b32 v4, 4, v4
s_lshl_b32 s32, s4, 4
sad 32,32,8
v_add_u32 v2, s32, v2
s_mov_b32 s33, 3072
v_mul_lo_u32 v2, v2, s33
v_add_u32 v7, v2, v4
v_mov_b32 v22, v6
v_mov_b32 v23, v7
wl 0
sad 8,36,8388608
s_addc_u32 s9, s37, 0
s_and_b32 s9, s9, 0xffff
s_mov_b32 s10, 2621440
s_mov_b32 s11, 0x00020000
sad 52,36,8388608
s_addc_u32 s53, s37, 0
s_and_b32 s53, s53, 0xffff
s_mov_b32 s54, 2621440
s_mov_b32 s55, 0x00020000
sad 56,36,8388608
s_addc_u32 s57, s37, 0
s_and_b32 s57, s57, 0xffff
s_mov_b32 s58, 2621440
s_mov_b32 s59, 0x00020000
sad 16,36,8388608
s_addc_u32 s17, s37, 0
s_and_b32 s17, s17, 0xffff
s_mov_b32 s18, 2621440
s_mov_b32 s19, 0x00020000
sad 20,36,8388608
s_addc_u32 s21, s37, 0
s_and_b32 s21, s21, 0xffff
s_mov_b32 s22, 2621440
s_mov_b32 s23, 0x00020000
s_mov_b32 s12, s42
s_and_b32 s13, s43, 0xffff
s_mov_b32 s14, 7864320
s_mov_b32 s15, 0x00020000
s_mov_b32 s72, 0
L_wk_sync:
s_cmp_lg_u32 s4, 0
s_cbranch_scc1 L_ti_128
s_lshl_b32 s83, s76, 2
v_mov_b32 v18, 1
v_mov_b32 v2, 0
s_mov_b64 exec, 1
buffer_atomic_add v18, v2, s[84:87], s83 offen sc0 sc1
s_mov_b64 exec, -1
L_ti_128:
wv 0
v_mov_b32 v2, 155648
s_cmp_lg_u32 s4, 0
s_cbranch_scc1 L_ts_129
s_mov_b64 exec, 1
ds_write_b32 v2, v18
s_mov_b64 exec, -1
L_ts_129:
wl 0
s_barrier
ds_read_b32 v3, v2
wl 0
v_readfirstlane_b32 s78, v3
s_barrier
s_getpc_b64 s[50:51]
L_c_130:
s_add_u32 s50, s50, L_sched-L_c_130
s_addc_u32 s51, s51, 0
s_swappc_b64 s[74:75], s[50:51]
L_wk_issue:
s_cmp_lt_i32 s73, 0
s_cbranch_scc1 L_wk_none
s_mul_i32 s34, s60, 0
s_add_u32 s34, s34, s24
s_add_u32 m0, s29, 0
s_nop 0
buffer_load_dwordx4 v6, s[8:11], s34 offen lds
s_add_u32 m0, s29, 1024
s_nop 0
buffer_load_dwordx4 v7, s[8:11], s34 offen lds
s_mul_i32 s34, s60, 0
s_add_u32 s34, s34, s25
s_add_u32 m0, s29, 8192
s_nop 0
buffer_load_dwordx4 v6, s[52:55], s34 offen lds
s_add_u32 m0, s29, 9216
s_nop 0
buffer_load_dwordx4 v7, s[52:55], s34 offen lds
s_mul_i32 s34, s60, 0
s_add_u32 s34, s34, s26
s_add_u32 m0, s29, 16384
s_nop 0
buffer_load_dwordx4 v6, s[56:59], s34 offen lds
s_add_u32 m0, s29, 17408
s_nop 0
buffer_load_dwordx4 v7, s[56:59], s34 offen lds
sad 33,28,0
buffer_load_dwordx4 a[96:99], v20, s[16:19], s33 offen sc1
sad 33,28,20480
buffer_load_dwordx4 a[100:103], v20, s[16:19], s33 offen sc1
sad 33,28,40960
buffer_load_dwordx4 a[104:107], v20, s[16:19], s33 offen sc1
sad 33,28,61440
buffer_load_dwordx4 a[108:111], v20, s[16:19], s33 offen sc1
sad 33,28,1024
buffer_load_dwordx4 a[112:115], v20, s[16:19], s33 offen sc1
sad 33,28,21504
buffer_load_dwordx4 a[116:119], v20, s[16:19], s33 offen sc1
sad 33,28,41984
buffer_load_dwordx4 a[120:123], v20, s[16:19], s33 offen sc1
sad 33,28,62464
buffer_load_dwordx4 a[124:127], v20, s[16:19], s33 offen sc1
s_mul_i32 s34, s60, 1
s_add_u32 s34, s34, s24
s_add_u32 m0, s29, 24576
s_nop 0
buffer_load_dwordx4 v6, s[8:11], s34 offen lds
s_add_u32 m0, s29, 25600
s_nop 0
buffer_load_dwordx4 v7, s[8:11], s34 offen lds
s_mul_i32 s34, s60, 1
s_add_u32 s34, s34, s25
s_add_u32 m0, s29, 32768
s_nop 0
buffer_load_dwordx4 v6, s[52:55], s34 offen lds
s_add_u32 m0, s29, 33792
s_nop 0
buffer_load_dwordx4 v7, s[52:55], s34 offen lds
s_mul_i32 s34, s60, 1
s_add_u32 s34, s34, s26
s_add_u32 m0, s29, 40960
s_nop 0
buffer_load_dwordx4 v6, s[56:59], s34 offen lds
s_add_u32 m0, s29, 41984
s_nop 0
buffer_load_dwordx4 v7, s[56:59], s34 offen lds
sad 33,28,2048
buffer_load_dwordx4 a[128:131], v20, s[16:19], s33 offen sc1
sad 33,28,22528
buffer_load_dwordx4 a[132:135], v20, s[16:19], s33 offen sc1
sad 33,28,43008
buffer_load_dwordx4 a[136:139], v20, s[16:19], s33 offen sc1
sad 33,28,63488
buffer_load_dwordx4 a[140:143], v20, s[16:19], s33 offen sc1
sad 33,28,3072
buffer_load_dwordx4 a[144:147], v20, s[16:19], s33 offen sc1
sad 33,28,23552
buffer_load_dwordx4 a[148:151], v20, s[16:19], s33 offen sc1
sad 33,28,44032
buffer_load_dwordx4 a[152:155], v20, s[16:19], s33 offen sc1
sad 33,28,64512
buffer_load_dwordx4 a[156:159], v20, s[16:19], s33 offen sc1
s_mul_i32 s34, s60, 2
s_add_u32 s34, s34, s24
s_add_u32 m0, s29, 49152
s_nop 0
buffer_load_dwordx4 v6, s[8:11], s34 offen lds
s_add_u32 m0, s29, 50176
s_nop 0
buffer_load_dwordx4 v7, s[8:11], s34 offen lds
s_mul_i32 s34, s60, 2
s_add_u32 s34, s34, s25
s_add_u32 m0, s29, 57344
s_nop 0
buffer_load_dwordx4 v6, s[52:55], s34 offen lds
s_add_u32 m0, s29, 58368
s_nop 0
buffer_load_dwordx4 v7, s[52:55], s34 offen lds
s_mul_i32 s34, s60, 2
s_add_u32 s34, s34, s26
s_add_u32 m0, s29, 65536
s_nop 0
buffer_load_dwordx4 v6, s[56:59], s34 offen lds
s_add_u32 m0, s29, 66560
s_nop 0
buffer_load_dwordx4 v7, s[56:59], s34 offen lds
sad 33,28,4096
buffer_load_dwordx4 a[160:163], v20, s[16:19], s33 offen sc1
sad 33,28,24576
buffer_load_dwordx4 a[164:167], v20, s[16:19], s33 offen sc1
sad 33,28,45056
buffer_load_dwordx4 a[168:171], v20, s[16:19], s33 offen sc1
sad 33,28,65536
buffer_load_dwordx4 a[172:175], v20, s[16:19], s33 offen sc1
sad 33,28,5120
buffer_load_dwordx4 a[176:179], v20, s[16:19], s33 offen sc1
sad 33,28,25600
buffer_load_dwordx4 a[180:183], v20, s[16:19], s33 offen sc1
sad 33,28,46080
buffer_load_dwordx4 a[184:187], v20, s[16:19], s33 offen sc1
sad 33,28,66560
buffer_load_dwordx4 a[188:191], v20, s[16:19], s33 offen sc1
s_mul_i32 s34, s60, 3
s_add_u32 s34, s34, s24
s_add_u32 m0, s29, 73728
s_nop 0
buffer_load_dwordx4 v6, s[8:11], s34 offen lds
s_add_u32 m0, s29, 74752
s_nop 0
buffer_load_dwordx4 v7, s[8:11], s34 offen lds
s_mul_i32 s34, s60, 3
s_add_u32 s34, s34, s25
s_add_u32 m0, s29, 81920
s_nop 0
buffer_load_dwordx4 v6, s[52:55], s34 offen lds
s_add_u32 m0, s29, 82944
s_nop 0
buffer_load_dwordx4 v7, s[52:55], s34 offen lds
s_mul_i32 s34, s60, 3
s_add_u32 s34, s34, s26
s_add_u32 m0, s29, 90112
s_nop 0
buffer_load_dwordx4 v6, s[56:59], s34 offen lds
s_add_u32 m0, s29, 91136
s_nop 0
buffer_load_dwordx4 v7, s[56:59], s34 offen lds
sad 33,28,6144
buffer_load_dwordx4 a[192:195], v20, s[16:19], s33 offen sc1
sad 33,28,26624
buffer_load_dwordx4 a[196:199], v20, s[16:19], s33 offen sc1
sad 33,28,47104
buffer_load_dwordx4 a[200:203], v20, s[16:19], s33 offen sc1
sad 33,28,67584
buffer_load_dwordx4 a[204:207], v20, s[16:19], s33 offen sc1
sad 33,28,7168
buffer_load_dwordx4 a[208:211], v20, s[16:19], s33 offen sc1
sad 33,28,27648
buffer_load_dwordx4 a[212:215], v20, s[16:19], s33 offen sc1
sad 33,28,48128
buffer_load_dwordx4 a[216:219], v20, s[16:19], s33 offen sc1
sad 33,28,68608
buffer_load_dwordx4 a[220:223], v20, s[16:19], s33 offen sc1
wv 28
L_wk_go:
s_mov_b32 s3, s5
s_mov_b32 s79, s49
s_cmp_lg_u32 s73, 0
s_cbranch_scc1 L_nx_131
s_getpc_b64 s[50:51]
L_h_132:
s_add_u32 s50, s50, L_main_vz-L_h_132
s_addc_u32 s51, s51, 0
s_setpc_b64 s[50:51]
L_nx_131:
s_cmp_lg_u32 s73, 1
s_cbranch_scc1 L_nx_133
s_getpc_b64 s[50:51]
L_h_134:
s_add_u32 s50, s50, L_main_qk-L_h_134
s_addc_u32 s51, s51, 0
s_setpc_b64 s[50:51]
L_nx_133:
s_cmp_lg_u32 s73, 2
s_cbranch_scc1 L_nx_135
s_getpc_b64 s[50:51]
L_h_136:
s_add_u32 s50, s50, L_main_b1-L_h_136
s_addc_u32 s51, s51, 0
s_setpc_b64 s[50:51]
L_nx_135:
s_cmp_lg_u32 s73, 3
s_cbranch_scc1 L_nx_137
s_getpc_b64 s[50:51]
L_h_138:
s_add_u32 s50, s50, L_main_b2-L_h_138
s_addc_u32 s51, s51, 0
s_setpc_b64 s[50:51]
L_nx_137:
s_cmp_lg_u32 s73, 4
s_cbranch_scc1 L_nx_139
s_getpc_b64 s[50:51]
L_h_140:
s_add_u32 s50, s50, L_main_vz2-L_h_140
s_addc_u32 s51, s51, 0
s_setpc_b64 s[50:51]
L_nx_139:
s_cmp_lg_u32 s73, 5
s_cbranch_scc1 L_nx_141
s_getpc_b64 s[50:51]
L_h_142:
s_add_u32 s50, s50, L_main_qk2-L_h_142
s_addc_u32 s51, s51, 0
s_setpc_b64 s[50:51]
L_nx_141:
s_endpgm
L_wk_done:
s_mov_b32 s70, s79
s_cmp_eq_u32 s69, 0
s_cbranch_scc1 L_wk_flush
s_cmp_lt_i32 s73, 0
s_cbranch_scc1 L_wk_flush
s_cmp_lt_u32 s78, 44
s_cbranch_scc1 L_wk_pub
s_cmp_lg_u32 s73, 3
s_cbranch_scc1 L_wk_go
L_wk_pub:
wv 0
s_barrier
s_cmp_lt_i32 s70, 0
s_cbranch_scc1 L_pp_143
s_cmp_lg_u32 s4, 1
s_cbranch_scc1 L_pp_143
s_lshl_b32 s83, s70, 7
v_and_b32 v2, 1, v1
v_cmp_eq_u32 vcc, 1, v2
v_mov_b32 v2, s100
v_mov_b32 v3, s101
v_cndmask_b32 v3, v2, v3, vcc
v_and_b32 v2, 31, v1
v_lshlrev_b32 v2, 2, v2
buffer_store_dword v3, v2, s[88:91], s83 offen sc1
L_pp_143:
s_mov_b32 s70, -1
s_branch L_wk_go
L_wk_flush:
wv 0
s_barrier
s_cmp_lt_i32 s70, 0
s_cbranch_scc1 L_pp_144
s_cmp_lg_u32 s4, 1
s_cbranch_scc1 L_pp_144
s_lshl_b32 s83, s70, 7
v_and_b32 v2, 1, v1
v_cmp_eq_u32 vcc, 1, v2
v_mov_b32 v2, s100
v_mov_b32 v3, s101
v_cndmask_b32 v3, v2, v3, vcc
v_and_b32 v2, 31, v1
v_lshlrev_b32 v2, 2, v2
buffer_store_dword v3, v2, s[88:91], s83 offen sc1
L_pp_144:
s_mov_b32 s70, -1
s_branch L_wk_issue
L_wk_none:
s_cmp_eq_u32 s68, 0
s_cbranch_scc1 L_wk_n2
s_getpc_b64 s[50:51]
L_h_145:
s_add_u32 s50, s50, L_after-L_h_145
s_addc_u32 s51, s51, -1
s_setpc_b64 s[50:51]
L_wk_n2:
s_cmp_eq_u32 s73, -2
s_cbranch_scc1 L_wk_sync
sad 76,76,1
s_and_b32 s76, s76, 7
sad 77,77,1
s_cmp_lt_u32 s77, 8
s_cbranch_scc1 L_wk_sync
s_getpc_b64 s[50:51]
L_h_146:
s_add_u32 s50, s50, L_wk_x-L_h_146
s_addc_u32 s51, s51, 0
s_setpc_b64 s[50:51]
L_sched:
sad 78,78,12
s_mov_b32 s73, -1
s_mov_b32 s10, 0
s_mov_b32 s54, 0
s_mov_b32 s58, 0
s_mov_b32 s18, 0
s_mul_i32 s32, s68, 4
sad 32,32,128
s_cmp_lt_u32 s78, s32
s_cbranch_scc1 L_sc_go
s_setpc_b64 s[74:75]
L_sc_go:
s_lshl_b32 s32, s78, 3
s_load_dwordx2 s[34:35], s[80:81], s32
wl 0
s_bfe_u32 s32, s34, 0x80010
s_mul_i32 s32, s32, s76
s_and_b32 s5, s35, 0xffff
s_add_u32 s5, s5, s32
s_lshr_b32 s32, s34, 24
s_mul_i32 s32, s32, s76
s_lshr_b32 s49, s35, 16
s_add_u32 s49, s49, s32
s_bfe_u32 s71, s34, 0x80008
s_and_b32 s73, s34, 0xff
s_cmp_lg_u32 s73, 3
s_cbranch_scc1 L_sc_ln
s_cmp_lt_u32 s76, 5
s_cbranch_scc1 L_pre_b2
s_mov_b32 s73, -2
s_setpc_b64 s[74:75]
L_sc_ln:
s_bitcmp1_b32 s72, s71
s_cbranch_scc1 L_sc_d
s_lshl_b32 s82, s71, 4
sad 82,82,80
s_lshl_b32 s83, s82, 7
v_min_u32 v3, 15, v1
v_mul_u32_u24 v3, 128, v3
s_mov_b32 s33, 0
L_fw_147:
buffer_load_dwordx2 v[4:5], v3, s[88:91], s83 offen sc1
wv 0
v_xor_b32 v4, s100, v4
v_xor_b32 v5, s101, v5
v_or_b32 v4, v4, v5
v_cmp_ne_u32 vcc, 0, v4
sad 33,33,1
s_cbranch_vccz L_fwd_148
s_sleep 2
s_cmp_lt_u32 s33, 400000
s_cbranch_scc1 L_fw_147
L_fwd_148:
s_bitset1_b32 s72, s71
L_sc_d:
s_cmp_eq_u32 s73, 1
s_cbranch_scc1 L_pre_qk
s_cmp_eq_u32 s73, 2
s_cbranch_scc1 L_pre_b1
s_cmp_eq_u32 s73, 4
s_cbranch_scc1 L_pre_vz2
s_cmp_eq_u32 s73, 5
s_cbranch_scc1 L_pre_qk2
L_pre_vz:
s_load_dwordx2 s[40:41], s[0:1], 32
v_mov_b32 v6, v28
v_mov_b32 v7, v29
sad 16,36,8388608
s_addc_u32 s17, s37, 0
s_and_b32 s17, s17, 0xffff
s_mov_b32 s18, 2621440
s_mov_b32 s19, 0x00020000
s_lshr_b32 s44, s5, 5
s_lshl_b32 s44, s44, 2
s_add_u32 s44, s44, s4
s_mul_i32 s44, s44, 4
s_mul_i32 s28, s44, 20480
s_and_b32 s44, s5, 31
s_mul_i32 s44, s44, 384
wl 0
s_mov_b32 s8, s40
s_and_b32 s9, s41, 0xffff
s_mov_b32 s10, 7864320
s_mov_b32 s11, 0x00020000
sad 24,44,0
s_mov_b32 s52, s40
s_and_b32 s53, s41, 0xffff
s_mov_b32 s54, 7864320
s_mov_b32 s55, 0x00020000
sad 25,44,128
s_mov_b32 s56, s40
s_and_b32 s57, s41, 0xffff
s_mov_b32 s58, 7864320
s_mov_b32 s59, 0x00020000
sad 26,44,256
s_mov_b32 s60, 786432
s_setpc_b64 s[74:75]
L_pre_qk:
s_load_dwordx2 s[40:41], s[0:1], 16
s_load_dwordx2 s[42:43], s[0:1], 24
v_mov_b32 v6, v28
v_mov_b32 v7, v29
sad 16,36,8388608
s_addc_u32 s17, s37, 0
s_and_b32 s17, s17, 0xffff
s_mov_b32 s18, 2621440
s_mov_b32 s19, 0x00020000
s_lshr_b32 s44, s5, 6
s_lshl_b32 s44, s44, 2
s_add_u32 s44, s44, s4
s_mul_i32 s44, s44, 4
s_mul_i32 s28, s44, 20480
s_and_b32 s44, s5, 31
s_mul_i32 s44, s44, 384
wl 0
s_bitcmp1_b32 s5, 5
s_cselect_b32 s40, s42, s40
s_cselect_b32 s41, s43, s41
s_mov_b32 s8, s40
s_and_b32 s9, s41, 0xffff
s_mov_b32 s10, 7864320
s_mov_b32 s11, 0x00020000
sad 24,44,0
s_mov_b32 s52, s40
s_and_b32 s53, s41, 0xffff
s_mov_b32 s54, 7864320
s_mov_b32 s55, 0x00020000
sad 25,44,128
s_mov_b32 s56, s40
s_and_b32 s57, s41, 0xffff
s_mov_b32 s58, 7864320
s_mov_b32 s59, 0x00020000
sad 26,44,256
s_mov_b32 s60, 786432
s_setpc_b64 s[74:75]
L_pre_b1:
s_load_dwordx2 s[40:41], s[0:1], 64
s_load_dwordx2 s[42:43], s[0:1], 72
v_mov_b32 v6, v22
v_mov_b32 v7, v23
sad 16,36,8388608
s_addc_u32 s17, s37, 0
s_and_b32 s17, s17, 0xffff
s_mov_b32 s18, 2621440
s_mov_b32 s19, 0x00020000
s_mul_hi_u32 s44, s5, 178956971
s_mul_i32 s35, s44, 24
s_sub_u32 s35, s5, s35
s_lshr_b32 s44, s44, 0
s_lshl_b32 s44, s44, 2
s_add_u32 s44, s44, s4
s_mul_i32 s44, s44, 4
s_mul_i32 s28, s44, 20480
s_lshl_b32 s44, s35, 7
wl 0
s_mov_b32 s8, s40
s_and_b32 s9, s41, 0xffff
s_mov_b32 s10, 1966080
s_mov_b32 s11, 0x00020000
sad 24,44,0
s_mov_b32 s52, s42
s_and_b32 s53, s43, 0xffff
s_mov_b32 s54, 1966080
s_mov_b32 s55, 0x00020000
sad 25,44,0
s_mov_b32 s58, 0
sad 26,44,0
s_mov_b32 s60, 196608
s_setpc_b64 s[74:75]
L_pre_b2:
s_load_dwordx2 s[40:41], s[0:1], 80
v_mov_b32 v6, v30
v_mov_b32 v7, v31
s_mov_b32 s18, 0
s_mul_hi_u32 s44, s5, 858993460
s_mul_i32 s35, s44, 5
s_sub_u32 s35, s5, s35
s_lshr_b32 s44, s44, 0
s_lshl_b32 s44, s44, 2
s_add_u32 s44, s44, s4
s_mul_i32 s44, s44, 4
s_mul_i32 s28, s44, 49152
s_lshl_b32 s44, s35, 8
wl 0
s_mov_b32 s8, s40
s_and_b32 s9, s41, 0xffff
s_mov_b32 s10, 1966080
s_mov_b32 s11, 0x00020000
sad 24,44,0
s_mov_b32 s52, s40
s_and_b32 s53, s41, 0xffff
s_mov_b32 s54, 1966080
s_mov_b32 s55, 0x00020000
sad 25,44,128
s_mov_b32 s58, 0
sad 26,44,0
s_mov_b32 s60, 81920
s_setpc_b64 s[74:75]
L_pre_vz2:
s_load_dwordx2 s[40:41], s[0:1], 32
v_mov_b32 v6, v28
v_mov_b32 v7, v29
sad 16,36,8388608
s_addc_u32 s17, s37, 0
s_and_b32 s17, s17, 0xffff
s_mov_b32 s18, 0
s_mov_b32 s19, 0x00020000
s_lshr_b32 s44, s5, 5
s_lshl_b32 s44, s44, 2
s_add_u32 s44, s44, s4
s_mul_i32 s44, s44, 2
s_mul_i32 s28, s44, 20480
s_and_b32 s44, s5, 31
s_mul_i32 s44, s44, 384
wl 0
s_mov_b32 s8, s40
s_and_b32 s9, s41, 0xffff
s_mov_b32 s10, 7864320
s_mov_b32 s11, 0x00020000
sad 24,44,0
s_mov_b32 s52, s40
s_and_b32 s53, s41, 0xffff
s_mov_b32 s54, 7864320
s_mov_b32 s55, 0x00020000
sad 25,44,128
s_mov_b32 s56, s40
s_and_b32 s57, s41, 0xffff
s_mov_b32 s58, 7864320
s_mov_b32 s59, 0x00020000
sad 26,44,256
s_mov_b32 s60, 786432
s_setpc_b64 s[74:75]
L_pre_qk2:
s_load_dwordx2 s[40:41], s[0:1], 16
s_load_dwordx2 s[42:43], s[0:1], 24
v_mov_b32 v6, v28
v_mov_b32 v7, v29
sad 16,36,8388608
s_addc_u32 s17, s37, 0
s_and_b32 s17, s17, 0xffff
s_mov_b32 s18, 0
s_mov_b32 s19, 0x00020000
s_lshr_b32 s44, s5, 6
s_lshl_b32 s44, s44, 2
s_add_u32 s44, s44, s4
s_mul_i32 s44, s44, 2
s_mul_i32 s28, s44, 20480
s_and_b32 s44, s5, 31
s_mul_i32 s44, s44, 384
wl 0
s_bitcmp1_b32 s5, 5
s_cselect_b32 s40, s42, s40
s_cselect_b32 s41, s43, s41
s_mov_b32 s8, s40
s_and_b32 s9, s41, 0xffff
s_mov_b32 s10, 7864320
s_mov_b32 s11, 0x00020000
sad 24,44,0
s_mov_b32 s52, s40
s_and_b32 s53, s41, 0xffff
s_mov_b32 s54, 7864320
s_mov_b32 s55, 0x00020000
sad 25,44,128
s_mov_b32 s56, s40
s_and_b32 s57, s41, 0xffff
s_mov_b32 s58, 7864320
s_mov_b32 s59, 0x00020000
sad 26,44,256
s_mov_b32 s60, 786432
s_setpc_b64 s[74:75]
.p2align 6
L_main_vz:
s_mov_b32 s18, 2621440
sad 20,36,134217728
s_addc_u32 s21, s37, 0
s_and_b32 s21, s21, 0xffff
s_mov_b32 s22, 83886080
s_mov_b32 s23, 0x00020000
s_and_b32 s45, s3, 31
s_mul_i32 s27, s45, 245760
s_lshr_b32 s46, s3, 5
s_lshl_b32 s46, s46, 2
s_add_u32 s46, s46, s4
s_mul_i32 s46, s46, 4
v_bfe_u32 v2, v1, 3, 1
v_lshlrev_b32 v21, 14, v2
v_lshrrev_b32 v2, 4, v1
v_lshl_add_u32 v21, v2, 10, v21
v_and_b32 v2, 7, v1
v_lshl_add_u32 v21, v2, 4, v21
s_lshr_b32 s47, s46, 1
s_mul_i32 s47, s47, 1310720
s_lshr_b32 s32, s45, 3
s_lshl_b32 s32, s32, 12
s_add_u32 s47, s47, s32
s_and_b32 s32, s45, 3
s_lshl_b32 s32, s32, 8
s_add_u32 s47, s47, s32
s_bfe_u32 s32, s45, 0x10002
s_lshl_b32 s32, s32, 7
s_add_u32 s47, s47, s32
s_barrier
tra 64,8,0
tra 66,8,2048
tra 68,9,0
tra 70,9,2048
tra 72,10,0
tra 74,10,2048
tra 76,11,0
tra 78,11,2048
wl 6
mfz 64,64,96
tra 80,8,8192
tra 82,8,10240
mfz 68,64,100
sad 34,24,3145728
s_add_u32 m0, s29, 98304
s_nop 0
buffer_load_dwordx4 v6, s[8:11], s34 offen lds
mfz 72,64,104
mfz 76,64,108
wl 6
mfz 80,68,96
tra 84,9,8192
tra 86,9,10240
mfz 84,68,100
mfz 88,68,104
mfz 92,68,108
s_add_u32 m0, s29, 99328
s_nop 0
buffer_load_dwordx4 v7, s[8:11], s34 offen lds
wl 6
mfz 96,72,96
tra 88,10,8192
tra 90,10,10240
mfz 100,72,100
mfz 104,72,104
mfz 108,72,108
wl 6
mfz 112,76,96
tra 92,11,8192
tra 94,11,10240
mfz 116,76,100
mfz 120,76,104
sad 34,25,3145728
s_add_u32 m0, s29, 106496
s_nop 0
buffer_load_dwordx4 v6, s[52:55], s34 offen lds
mfz 124,76,108
wl 6
mfz 128,80,96
tra 64,8,16384
tra 66,8,18432
mfz 132,80,100
mfz 136,80,104
mfz 140,80,108
wl 6
mfz 144,84,96
tra 68,9,16384
tra 70,9,18432
mfz 148,84,100
s_add_u32 m0, s29, 107520
s_nop 0
buffer_load_dwordx4 v7, s[52:55], s34 offen lds
mfz 152,84,104
mfz 156,84,108
wl 6
mfz 160,88,96
tra 72,10,16384
tra 74,10,18432
mfz 164,88,100
mfz 168,88,104
mfz 172,88,108
sad 34,26,3145728
s_add_u32 m0, s29, 114688
s_nop 0
buffer_load_dwordx4 v6, s[56:59], s34 offen lds
wl 6
mfz 176,92,96
tra 76,11,16384
tra 78,11,18432
mfz 180,92,100
mfz 184,92,104
mfz 188,92,108
wl 6
mfz 192,64,96
tra 80,8,4096
tra 82,8,6144
mfz 196,64,100
mfz 200,64,104
s_add_u32 m0, s29, 115712
s_nop 0
buffer_load_dwordx4 v7, s[56:59], s34 offen lds
mfz 204,64,108
wl 6
mfz 208,68,96
tra 84,9,4096
tra 86,9,6144
mfz 212,68,100
mfz 216,68,104
mfz 220,68,108
wl 6
mfz 224,72,96
tra 88,10,4096
tra 90,10,6144
mfz 228,72,100
sad 33,28,8192
buffer_load_dwordx4 a[224:227], v20, s[16:19], s33 offen sc1
mfz 232,72,104
mfz 236,72,108
wl 6
mfz 240,76,96
tra 92,11,4096
tra 94,11,6144
mfz 244,76,100
mfz 248,76,104
mfz 252,76,108
sad 33,28,28672
buffer_load_dwordx4 a[228:231], v20, s[16:19], s33 offen sc1
wl 6
mfa 64,80,112
tra 64,8,12288
tra 66,8,14336
mfa 68,80,116
mfa 72,80,120
mfa 76,80,124
wl 6
mfa 80,84,112
tra 68,9,12288
tra 70,9,14336
mfa 84,84,116
mfa 88,84,120
sad 33,28,49152
buffer_load_dwordx4 a[232:235], v20, s[16:19], s33 offen sc1
mfa 92,84,124
wl 6
mfa 96,88,112
tra 72,10,12288
tra 74,10,14336
mfa 100,88,116
mfa 104,88,120
mfa 108,88,124
wl 6
mfa 112,92,112
tra 76,11,12288
tra 78,11,14336
mfa 116,92,116
sad 33,28,69632
buffer_load_dwordx4 a[236:239], v20, s[16:19], s33 offen sc1
mfa 120,92,120
mfa 124,92,124
wl 6
mfa 128,64,112
tra 80,8,20480
tra 82,8,22528
mfa 132,64,116
mfa 136,64,120
mfa 140,64,124
sad 33,28,9216
buffer_load_dwordx4 a[240:243], v20, s[16:19], s33 offen sc1
wl 6
mfa 144,68,112
tra 84,9,20480
tra 86,9,22528
mfa 148,68,116
mfa 152,68,120
mfa 156,68,124
wl 6
mfa 160,72,112
tra 88,10,20480
tra 90,10,22528
mfa 164,72,116
mfa 168,72,120
sad 33,28,29696
buffer_load_dwordx4 a[244:247], v20, s[16:19], s33 offen sc1
mfa 172,72,124
wl 6
mfa 176,76,112
tra 92,11,20480
tra 94,11,22528
mfa 180,76,116
mfa 184,76,120
mfa 188,76,124
wl 0
s_barrier
mfa 192,80,112
tra 64,8,24576
tra 66,8,26624
mfa 196,80,116
sad 33,28,50176
buffer_load_dwordx4 a[248:251], v20, s[16:19], s33 offen sc1
mfa 200,80,120
mfa 204,80,124
mfa 208,84,112
tra 68,9,24576
tra 70,9,26624
mfa 212,84,116
mfa 216,84,120
mfa 220,84,124
sad 33,28,70656
buffer_load_dwordx4 a[252:255], v20, s[16:19], s33 offen sc1
mfa 224,88,112
tra 72,10,24576
tra 74,10,26624
mfa 228,88,116
mfa 232,88,120
mfa 236,88,124
mfa 240,92,112
tra 76,11,24576
tra 78,11,26624
mfa 244,92,116
mfa 248,92,120
sad 34,24,3932160
s_add_u32 m0, s29, 0
s_nop 0
buffer_load_dwordx4 v6, s[8:11], s34 offen lds
mfa 252,92,124
wl 6
mfa 64,64,128
tra 80,8,32768
tra 82,8,34816
mfa 68,64,132
mfa 72,64,136
mfa 76,64,140
wl 6
mfa 80,68,128
tra 84,9,32768
tra 86,9,34816
mfa 84,68,132
s_add_u32 m0, s29, 1024
s_nop 0
buffer_load_dwordx4 v7, s[8:11], s34 offen lds
mfa 88,68,136
mfa 92,68,140
wl 6
mfa 96,72,128
tra 88,10,32768
tra 90,10,34816
mfa 100,72,132
mfa 104,72,136
mfa 108,72,140
sad 34,25,3932160
s_add_u32 m0, s29, 8192
s_nop 0
buffer_load_dwordx4 v6, s[52:55], s34 offen lds
wl 6
mfa 112,76,128
tra 92,11,32768
tra 94,11,34816
mfa 116,76,132
mfa 120,76,136
mfa 124,76,140
wl 6
mfa 128,80,128
tra 64,8,40960
tra 66,8,43008
mfa 132,80,132
mfa 136,80,136
s_add_u32 m0, s29, 9216
s_nop 0
buffer_load_dwordx4 v7, s[52:55], s34 offen lds
mfa 140,80,140
wl 6
mfa 144,84,128
tra 68,9,40960
tra 70,9,43008
mfa 148,84,132
mfa 152,84,136
mfa 156,84,140
wl 6
mfa 160,88,128
tra 72,10,40960
tra 74,10,43008
mfa 164,88,132
sad 34,26,3932160
s_add_u32 m0, s29, 16384
s_nop 0
buffer_load_dwordx4 v6, s[56:59], s34 offen lds
mfa 168,88,136
mfa 172,88,140
wl 6
mfa 176,92,128
tra 76,11,40960
tra 78,11,43008
mfa 180,92,132
mfa 184,92,136
mfa 188,92,140
s_add_u32 m0, s29, 17408
s_nop 0
buffer_load_dwordx4 v7, s[56:59], s34 offen lds
wl 6
mfa 192,64,128
tra 80,8,28672
tra 82,8,30720
mfa 196,64,132
mfa 200,64,136
mfa 204,64,140
wl 6
mfa 208,68,128
tra 84,9,28672
tra 86,9,30720
mfa 212,68,132
mfa 216,68,136
sad 33,28,10240
buffer_load_dwordx4 a[96:99], v20, s[16:19], s33 offen sc1
mfa 220,68,140
wl 6
mfa 224,72,128
tra 88,10,28672
tra 90,10,30720
mfa 228,72,132
mfa 232,72,136
mfa 236,72,140
wl 6
mfa 240,76,128
tra 92,11,28672
tra 94,11,30720
mfa 244,76,132
sad 33,28,30720
buffer_load_dwordx4 a[100:103], v20, s[16:19], s33 offen sc1
mfa 248,76,136
mfa 252,76,140
wl 6
mfa 64,80,144
tra 64,8,36864
tra 66,8,38912
mfa 68,80,148
mfa 72,80,152
mfa 76,80,156
sad 33,28,51200
buffer_load_dwordx4 a[104:107], v20, s[16:19], s33 offen sc1
wl 6
mfa 80,84,144
tra 68,9,36864
tra 70,9,38912
mfa 84,84,148
mfa 88,84,152
mfa 92,84,156
wl 6
mfa 96,88,144
tra 72,10,36864
tra 74,10,38912
mfa 100,88,148
mfa 104,88,152
sad 33,28,71680
buffer_load_dwordx4 a[108:111], v20, s[16:19], s33 offen sc1
mfa 108,88,156
wl 6
mfa 112,92,144
tra 76,11,36864
tra 78,11,38912
mfa 116,92,148
mfa 120,92,152
mfa 124,92,156
wl 6
mfa 128,64,144
tra 80,8,45056
tra 82,8,47104
mfa 132,64,148
sad 33,28,11264
buffer_load_dwordx4 a[112:115], v20, s[16:19], s33 offen sc1
mfa 136,64,152
mfa 140,64,156
wl 6
mfa 144,68,144
tra 84,9,45056
tra 86,9,47104
mfa 148,68,148
mfa 152,68,152
mfa 156,68,156
sad 33,28,31744
buffer_load_dwordx4 a[116:119], v20, s[16:19], s33 offen sc1
wl 6
mfa 160,72,144
tra 88,10,45056
tra 90,10,47104
mfa 164,72,148
mfa 168,72,152
mfa 172,72,156
wl 6
mfa 176,76,144
tra 92,11,45056
tra 94,11,47104
mfa 180,76,148
mfa 184,76,152
sad 33,28,52224
buffer_load_dwordx4 a[120:123], v20, s[16:19], s33 offen sc1
mfa 188,76,156
s_waitcnt vmcnt(27) lgkmcnt(0)
s_barrier
s_cmp_lt_i32 s70, 0
s_cbranch_scc1 L_pp_149
s_cmp_lg_u32 s4, 1
s_cbranch_scc1 L_pp_149
s_lshl_b32 s83, s70, 7
v_and_b32 v2, 1, v1
v_cmp_eq_u32 vcc, 1, v2
v_mov_b32 v2, s100
v_mov_b32 v3, s101
v_cndmask_b32 v3, v2, v3, vcc
v_and_b32 v2, 31, v1
v_lshlrev_b32 v2, 2, v2
buffer_store_dword v3, v2, s[88:91], s83 offen sc1
L_pp_149:
s_mov_b32 s70, -1
mfa 192,80,144
tra 64,8,49152
tra 66,8,51200
mfa 196,80,148
mfa 200,80,152
mfa 204,80,156
mfa 208,84,144
tra 68,9,49152
tra 70,9,51200
mfa 212,84,148
sad 33,28,72704
buffer_load_dwordx4 a[124:127], v20, s[16:19], s33 offen sc1
mfa 216,84,152
mfa 220,84,156
mfa 224,88,144
tra 72,10,49152
tra 74,10,51200
mfa 228,88,148
mfa 232,88,152
mfa 236,88,156
sad 34,24,4718592
s_add_u32 m0, s29, 24576
s_nop 0
buffer_load_dwordx4 v6, s[8:11], s34 offen lds
mfa 240,92,144
tra 76,11,49152
tra 78,11,51200
mfa 244,92,148
mfa 248,92,152
mfa 252,92,156
wl 6
mfa 64,64,160
tra 80,8,57344
tra 82,8,59392
mfa 68,64,164
mfa 72,64,168
s_add_u32 m0, s29, 25600
s_nop 0
buffer_load_dwordx4 v7, s[8:11], s34 offen lds
mfa 76,64,172
wl 6
mfa 80,68,160
tra 84,9,57344
tra 86,9,59392
mfa 84,68,164
mfa 88,68,168
mfa 92,68,172
wl 6
mfa 96,72,160
tra 88,10,57344
tra 90,10,59392
mfa 100,72,164
sad 34,25,4718592
s_add_u32 m0, s29, 32768
s_nop 0
buffer_load_dwordx4 v6, s[52:55], s34 offen lds
mfa 104,72,168
mfa 108,72,172
wl 6
mfa 112,76,160
tra 92,11,57344
tra 94,11,59392
mfa 116,76,164
mfa 120,76,168
mfa 124,76,172
s_add_u32 m0, s29, 33792
s_nop 0
buffer_load_dwordx4 v7, s[52:55], s34 offen lds
wl 6
mfa 128,80,160
tra 64,12,16384
tra 66,12,18432
mfa 132,80,164
mfa 136,80,168
mfa 140,80,172
wl 6
mfa 144,84,160
tra 68,13,16384
tra 70,13,18432
mfa 148,84,164
mfa 152,84,168
sad 34,26,4718592
s_add_u32 m0, s29, 40960
s_nop 0
buffer_load_dwordx4 v6, s[56:59], s34 offen lds
mfa 156,84,172
wl 6
mfa 160,88,160
tra 72,14,16384
tra 74,14,18432
mfa 164,88,164
mfa 168,88,168
mfa 172,88,172
wl 6
mfa 176,92,160
tra 76,15,16384
tra 78,15,18432
mfa 180,92,164
s_add_u32 m0, s29, 41984
s_nop 0
buffer_load_dwordx4 v7, s[56:59], s34 offen lds
mfa 184,92,168
mfa 188,92,172
wl 6
mfa 192,64,160
tra 80,8,53248
tra 82,8,55296
mfa 196,64,164
mfa 200,64,168
mfa 204,64,172
sad 33,28,12288
buffer_load_dwordx4 a[128:131], v20, s[16:19], s33 offen sc1
wl 6
mfa 208,68,160
tra 84,9,53248
tra 86,9,55296
mfa 212,68,164
mfa 216,68,168
mfa 220,68,172
wl 6
mfa 224,72,160
tra 88,10,53248
tra 90,10,55296
mfa 228,72,164
mfa 232,72,168
sad 33,28,32768
buffer_load_dwordx4 a[132:135], v20, s[16:19], s33 offen sc1
mfa 236,72,172
wl 6
mfa 240,76,160
tra 92,11,53248
tra 94,11,55296
mfa 244,76,164
mfa 248,76,168
mfa 252,76,172
wl 6
mfa 64,80,176
tra 64,8,61440
tra 66,8,63488
mfa 68,80,180
sad 33,28,53248
buffer_load_dwordx4 a[136:139], v20, s[16:19], s33 offen sc1
mfa 72,80,184
mfa 76,80,188
wl 6
mfa 80,84,176
tra 68,9,61440
tra 70,9,63488
mfa 84,84,180
mfa 88,84,184
mfa 92,84,188
sad 33,28,73728
buffer_load_dwordx4 a[140:143], v20, s[16:19], s33 offen sc1
wl 6
mfa 96,88,176
tra 72,10,61440
tra 74,10,63488
mfa 100,88,180
mfa 104,88,184
mfa 108,88,188
wl 6
mfa 112,92,176
tra 76,11,61440
tra 78,11,63488
mfa 116,92,180
mfa 120,92,184
sad 33,28,13312
buffer_load_dwordx4 a[144:147], v20, s[16:19], s33 offen sc1
mfa 124,92,188
wl 6
mfa 128,64,176
tra 80,12,20480
tra 82,12,22528
mfa 132,64,180
mfa 136,64,184
mfa 140,64,188
wl 6
mfa 144,68,176
tra 84,13,20480
tra 86,13,22528
mfa 148,68,180
sad 33,28,33792
buffer_load_dwordx4 a[148:151], v20, s[16:19], s33 offen sc1
mfa 152,68,184
mfa 156,68,188
wl 6
mfa 160,72,176
tra 88,14,20480
tra 90,14,22528
mfa 164,72,180
mfa 168,72,184
mfa 172,72,188
sad 33,28,54272
buffer_load_dwordx4 a[152:155], v20, s[16:19], s33 offen sc1
wl 6
mfa 176,76,176
tra 92,15,20480
tra 94,15,22528
mfa 180,76,180
mfa 184,76,184
mfa 188,76,188
wl 0
s_barrier
mfa 192,80,176
tra 64,12,24576
tra 66,12,26624
mfa 196,80,180
mfa 200,80,184
sad 33,28,74752
buffer_load_dwordx4 a[156:159], v20, s[16:19], s33 offen sc1
mfa 204,80,188
mfa 208,84,176
tra 68,13,24576
tra 70,13,26624
mfa 212,84,180
mfa 216,84,184
mfa 220,84,188
mfa 224,88,176
tra 72,14,24576
tra 74,14,26624
mfa 228,88,180
sad 34,24,5505024
s_add_u32 m0, s29, 49152
s_nop 0
buffer_load_dwordx4 v6, s[8:11], s34 offen lds
mfa 232,88,184
mfa 236,88,188
mfa 240,92,176
tra 76,15,24576
tra 78,15,26624
mfa 244,92,180
mfa 248,92,184
mfa 252,92,188
s_add_u32 m0, s29, 50176
s_nop 0
buffer_load_dwordx4 v7, s[8:11], s34 offen lds
wl 6
mfa 64,64,192
tra 80,12,32768
tra 82,12,34816
mfa 68,64,196
mfa 72,64,200
mfa 76,64,204
wl 6
mfa 80,68,192
tra 84,13,32768
tra 86,13,34816
mfa 84,68,196
mfa 88,68,200
sad 34,25,5505024
s_add_u32 m0, s29, 57344
s_nop 0
buffer_load_dwordx4 v6, s[52:55], s34 offen lds
mfa 92,68,204
wl 6
mfa 96,72,192
tra 88,14,32768
tra 90,14,34816
mfa 100,72,196
mfa 104,72,200
mfa 108,72,204
wl 6
mfa 112,76,192
tra 92,15,32768
tra 94,15,34816
mfa 116,76,196
s_add_u32 m0, s29, 58368
s_nop 0
buffer_load_dwordx4 v7, s[52:55], s34 offen lds
mfa 120,76,200
mfa 124,76,204
wl 6
mfa 128,80,192
tra 64,12,40960
tra 66,12,43008
mfa 132,80,196
mfa 136,80,200
mfa 140,80,204
sad 34,26,5505024
s_add_u32 m0, s29, 65536
s_nop 0
buffer_load_dwordx4 v6, s[56:59], s34 offen lds
wl 6
mfa 144,84,192
tra 68,13,40960
tra 70,13,43008
mfa 148,84,196
mfa 152,84,200
mfa 156,84,204
wl 6
mfa 160,88,192
tra 72,14,40960
tra 74,14,43008
mfa 164,88,196
mfa 168,88,200
s_add_u32 m0, s29, 66560
s_nop 0
buffer_load_dwordx4 v7, s[56:59], s34 offen lds
mfa 172,88,204
wl 6
mfa 176,92,192
tra 76,15,40960
tra 78,15,43008
mfa 180,92,196
mfa 184,92,200
mfa 188,92,204
wl 6
mfa 192,64,192
tra 80,12,28672
tra 82,12,30720
mfa 196,64,196
sad 33,28,14336
buffer_load_dwordx4 a[160:163], v20, s[16:19], s33 offen sc1
mfa 200,64,200
mfa 204,64,204
wl 6
mfa 208,68,192
tra 84,13,28672
tra 86,13,30720
mfa 212,68,196
mfa 216,68,200
mfa 220,68,204
sad 33,28,34816
buffer_load_dwordx4 a[164:167], v20, s[16:19], s33 offen sc1
wl 6
mfa 224,72,192
tra 88,14,28672
tra 90,14,30720
mfa 228,72,196
mfa 232,72,200
mfa 236,72,204
wl 6
mfa 240,76,192
tra 92,15,28672
tra 94,15,30720
mfa 244,76,196
mfa 248,76,200
sad 33,28,55296
buffer_load_dwordx4 a[168:171], v20, s[16:19], s33 offen sc1
mfa 252,76,204
wl 6
mfa 64,80,208
tra 64,12,36864
tra 66,12,38912
mfa 68,80,212
mfa 72,80,216
mfa 76,80,220
wl 6
mfa 80,84,208
tra 68,13,36864
tra 70,13,38912
mfa 84,84,212
sad 33,28,75776
buffer_load_dwordx4 a[172:175], v20, s[16:19], s33 offen sc1
mfa 88,84,216
mfa 92,84,220
wl 6
mfa 96,88,208
tra 72,14,36864
tra 74,14,38912
mfa 100,88,212
mfa 104,88,216
mfa 108,88,220
sad 33,28,15360
buffer_load_dwordx4 a[176:179], v20, s[16:19], s33 offen sc1
wl 6
mfa 112,92,208
tra 76,15,36864
tra 78,15,38912
mfa 116,92,212
mfa 120,92,216
mfa 124,92,220
wl 6
mfa 128,64,208
tra 80,12,45056
tra 82,12,47104
mfa 132,64,212
mfa 136,64,216
sad 33,28,35840
buffer_load_dwordx4 a[180:183], v20, s[16:19], s33 offen sc1
mfa 140,64,220
wl 6
mfa 144,68,208
tra 84,13,45056
tra 86,13,47104
mfa 148,68,212
mfa 152,68,216
mfa 156,68,220
wl 6
mfa 160,72,208
tra 88,14,45056
tra 90,14,47104
mfa 164,72,212
sad 33,28,56320
buffer_load_dwordx4 a[184:187], v20, s[16:19], s33 offen sc1
mfa 168,72,216
mfa 172,72,220
wl 6
mfa 176,76,208
tra 92,15,45056
tra 94,15,47104
mfa 180,76,212
mfa 184,76,216
mfa 188,76,220
sad 33,28,76800
buffer_load_dwordx4 a[188:191], v20, s[16:19], s33 offen sc1
s_waitcnt vmcnt(50) lgkmcnt(0)
s_barrier
mfa 192,80,208
tra 64,12,49152
tra 66,12,51200
mfa 196,80,212
mfa 200,80,216
mfa 204,80,220
mfa 208,84,208
tra 68,13,49152
tra 70,13,51200
mfa 212,84,212
mfa 216,84,216
sad 34,24,6291456
s_add_u32 m0, s29, 73728
s_nop 0
buffer_load_dwordx4 v6, s[8:11], s34 offen lds
mfa 220,84,220
mfa 224,88,208
tra 72,14,49152
tra 74,14,51200
mfa 228,88,212
mfa 232,88,216
mfa 236,88,220
mfa 240,92,208
tra 76,15,49152
tra 78,15,51200
mfa 244,92,212
s_add_u32 m0, s29, 74752
s_nop 0
buffer_load_dwordx4 v7, s[8:11], s34 offen lds
mfa 248,92,216
mfa 252,92,220
wv 48
wl 6
mfa 64,64,224
tra 80,12,57344
tra 82,12,59392
mfa 68,64,228
mfa 72,64,232
mfa 76,64,236
sad 34,25,6291456
s_add_u32 m0, s29, 81920
s_nop 0
buffer_load_dwordx4 v6, s[52:55], s34 offen lds
wl 6
mfa 80,68,224
tra 84,13,57344
tra 86,13,59392
mfa 84,68,228
mfa 88,68,232
mfa 92,68,236
wl 6
mfa 96,72,224
tra 88,14,57344
tra 90,14,59392
mfa 100,72,228
mfa 104,72,232
s_add_u32 m0, s29, 82944
s_nop 0
buffer_load_dwordx4 v7, s[52:55], s34 offen lds
mfa 108,72,236
wl 6
mfa 112,76,224
tra 92,15,57344
tra 94,15,59392
mfa 116,76,228
mfa 120,76,232
mfa 124,76,236
wl 6
mfa 128,80,224
tra 64,24,16384
tra 66,24,18432
mfa 132,80,228
sad 34,26,6291456
s_add_u32 m0, s29, 90112
s_nop 0
buffer_load_dwordx4 v6, s[56:59], s34 offen lds
mfa 136,80,232
mfa 140,80,236
wl 6
mfa 144,84,224
tra 68,25,16384
tra 70,25,18432
mfa 148,84,228
mfa 152,84,232
mfa 156,84,236
s_add_u32 m0, s29, 91136
s_nop 0
buffer_load_dwordx4 v7, s[56:59], s34 offen lds
wl 6
mfa 160,88,224
tra 72,26,16384
tra 74,26,18432
mfa 164,88,228
mfa 168,88,232
mfa 172,88,236
wl 6
mfa 176,92,224
tra 76,27,16384
tra 78,27,18432
mfa 180,92,228
mfa 184,92,232
sad 33,28,16384
buffer_load_dwordx4 a[192:195], v20, s[16:19], s33 offen sc1
mfa 188,92,236
wl 6
mfa 192,64,224
tra 80,12,53248
tra 82,12,55296
mfa 196,64,228
mfa 200,64,232
mfa 204,64,236
wl 6
mfa 208,68,224
tra 84,13,53248
tra 86,13,55296
mfa 212,68,228
sad 33,28,36864
buffer_load_dwordx4 a[196:199], v20, s[16:19], s33 offen sc1
mfa 216,68,232
mfa 220,68,236
wl 6
mfa 224,72,224
tra 88,14,53248
tra 90,14,55296
mfa 228,72,228
mfa 232,72,232
mfa 236,72,236
sad 33,28,57344
buffer_load_dwordx4 a[200:203], v20, s[16:19], s33 offen sc1
wl 6
mfa 240,76,224
tra 92,15,53248
tra 94,15,55296
mfa 244,76,228
mfa 248,76,232
mfa 252,76,236
wv 51
wl 6
mfa 64,80,240
tra 64,12,61440
tra 66,12,63488
mfa 68,80,244
mfa 72,80,248
sad 33,28,77824
buffer_load_dwordx4 a[204:207], v20, s[16:19], s33 offen sc1
mfa 76,80,252
wl 6
mfa 80,84,240
tra 68,13,61440
tra 70,13,63488
mfa 84,84,244
mfa 88,84,248
mfa 92,84,252
wl 6
mfa 96,88,240
tra 72,14,61440
tra 74,14,63488
mfa 100,88,244
sad 33,28,17408
buffer_load_dwordx4 a[208:211], v20, s[16:19], s33 offen sc1
mfa 104,88,248
mfa 108,88,252
wl 6
mfa 112,92,240
tra 76,15,61440
tra 78,15,63488
mfa 116,92,244
mfa 120,92,248
mfa 124,92,252
sad 33,28,37888
buffer_load_dwordx4 a[212:215], v20, s[16:19], s33 offen sc1
wl 6
mfa 128,64,240
tra 80,24,20480
tra 82,24,22528
mfa 132,64,244
mfa 136,64,248
mfa 140,64,252
wl 6
mfa 144,68,240
tra 84,25,20480
tra 86,25,22528
mfa 148,68,244
mfa 152,68,248
sad 33,28,58368
buffer_load_dwordx4 a[216:219], v20, s[16:19], s33 offen sc1
mfa 156,68,252
wl 6
mfa 160,72,240
tra 88,26,20480
tra 90,26,22528
mfa 164,72,244
mfa 168,72,248
mfa 172,72,252
wl 6
mfa 176,76,240
tra 92,27,20480
tra 94,27,22528
mfa 180,76,244
sad 33,28,78848
buffer_load_dwordx4 a[220:223], v20, s[16:19], s33 offen sc1
mfa 184,76,248
mfa 188,76,252
s_waitcnt vmcnt(50) lgkmcnt(0)
s_barrier
mfa 192,80,240
tra 64,8,0
tra 66,8,2048
mfa 196,80,244
mfa 200,80,248
mfa 204,80,252
sad 34,24,7077888
s_add_u32 m0, s29, 98304
s_nop 0
buffer_load_dwordx4 v6, s[8:11], s34 offen lds
mfa 208,84,240
tra 68,9,0
tra 70,9,2048
mfa 212,84,244
mfa 216,84,248
mfa 220,84,252
mfa 224,88,240
tra 72,10,0
tra 74,10,2048
mfa 228,88,244
mfa 232,88,248
s_add_u32 m0, s29, 99328
s_nop 0
buffer_load_dwordx4 v7, s[8:11], s34 offen lds
mfa 236,88,252
mfa 240,92,240
tra 76,11,0
tra 78,11,2048
mfa 244,92,244
mfa 248,92,248
mfa 252,92,252
wv 48
wl 6
mfa 64,64,96
tra 80,8,8192
tra 82,8,10240
mfa 68,64,100
sad 34,25,7077888
s_add_u32 m0, s29, 106496
s_nop 0
buffer_load_dwordx4 v6, s[52:55], s34 offen lds
mfa 72,64,104
mfa 76,64,108
wl 6
mfa 80,68,96
tra 84,9,8192
tra 86,9,10240
mfa 84,68,100
mfa 88,68,104
mfa 92,68,108
s_add_u32 m0, s29, 107520
s_nop 0
buffer_load_dwordx4 v7, s[52:55], s34 offen lds
wl 6
mfa 96,72,96
tra 88,10,8192
tra 90,10,10240
mfa 100,72,100
mfa 104,72,104
mfa 108,72,108
wl 6
mfa 112,76,96
tra 92,11,8192
tra 94,11,10240
mfa 116,76,100
mfa 120,76,104
sad 34,26,7077888
s_add_u32 m0, s29, 114688
s_nop 0
buffer_load_dwordx4 v6, s[56:59], s34 offen lds
mfa 124,76,108
wl 6
mfa 128,80,96
tra 64,8,16384
tra 66,8,18432
mfa 132,80,100
mfa 136,80,104
mfa 140,80,108
wl 6
mfa 144,84,96
tra 68,9,16384
tra 70,9,18432
mfa 148,84,100
s_add_u32 m0, s29, 115712
s_nop 0
buffer_load_dwordx4 v7, s[56:59], s34 offen lds
mfa 152,84,104
mfa 156,84,108
wl 6
mfa 160,88,96
tra 72,10,16384
tra 74,10,18432
mfa 164,88,100
mfa 168,88,104
mfa 172,88,108
sad 33,28,18432
buffer_load_dwordx4 a[224:227], v20, s[16:19], s33 offen sc1
wl 6
mfa 176,92,96
tra 76,11,16384
tra 78,11,18432
mfa 180,92,100
mfa 184,92,104
mfa 188,92,108
wl 6
mfa 192,64,96
tra 80,8,4096
tra 82,8,6144
mfa 196,64,100
mfa 200,64,104
sad 33,28,38912
buffer_load_dwordx4 a[228:231], v20, s[16:19], s33 offen sc1
mfa 204,64,108
wl 6
mfa 208,68,96
tra 84,9,4096
tra 86,9,6144
mfa 212,68,100
mfa 216,68,104
mfa 220,68,108
wl 6
mfa 224,72,96
tra 88,10,4096
tra 90,10,6144
mfa 228,72,100
sad 33,28,59392
buffer_load_dwordx4 a[232:235], v20, s[16:19], s33 offen sc1
mfa 232,72,104
mfa 236,72,108
wl 6
mfa 240,76,96
tra 92,11,4096
tra 94,11,6144
mfa 244,76,100
mfa 248,76,104
mfa 252,76,108
sad 33,28,79872
buffer_load_dwordx4 a[236:239], v20, s[16:19], s33 offen sc1
wv 52
wl 6
mfa 64,80,112
tra 64,8,12288
tra 66,8,14336
mfa 68,80,116
mfa 72,80,120
mfa 76,80,124
wl 6
mfa 80,84,112
tra 68,9,12288
tra 70,9,14336
mfa 84,84,116
mfa 88,84,120
sad 33,28,19456
buffer_load_dwordx4 a[240:243], v20, s[16:19], s33 offen sc1
mfa 92,84,124
wl 6
mfa 96,88,112
tra 72,10,12288
tra 74,10,14336
mfa 100,88,116
mfa 104,88,120
mfa 108,88,124
wl 6
mfa 112,92,112
tra 76,11,12288
tra 78,11,14336
mfa 116,92,116
sad 33,28,39936
buffer_load_dwordx4 a[244:247], v20, s[16:19], s33 offen sc1
mfa 120,92,120
mfa 124,92,124
wl 6
mfa 128,64,112
tra 80,8,20480
tra 82,8,22528
mfa 132,64,116
mfa 136,64,120
mfa 140,64,124
sad 33,28,60416
buffer_load_dwordx4 a[248:251], v20, s[16:19], s33 offen sc1
wl 6
mfa 144,68,112
tra 84,9,20480
tra 86,9,22528
mfa 148,68,116
mfa 152,68,120
mfa 156,68,124
wl 6
mfa 160,72,112
tra 88,10,20480
tra 90,10,22528
mfa 164,72,116
mfa 168,72,120
sad 33,28,80896
buffer_load_dwordx4 a[252:255], v20, s[16:19], s33 offen sc1
mfa 172,72,124
wl 6
mfa 176,76,112
tra 92,11,20480
tra 94,11,22528
mfa 180,76,116
mfa 184,76,120
mfa 188,76,124
s_waitcnt vmcnt(50) lgkmcnt(0)
s_barrier
mfa 192,80,112
tra 64,8,24576
tra 66,8,26624
mfa 196,80,116
sad 34,27,0
s_add_u32 m0, s29, 0
s_nop 0
buffer_load_dwordx4 v30, s[12:15], s34 offen lds
mfa 200,80,120
mfa 204,80,124
mfa 208,84,112
tra 68,9,24576
tra 70,9,26624
mfa 212,84,116
mfa 216,84,120
mfa 220,84,124
s_add_u32 m0, s29, 1024
s_nop 0
buffer_load_dwordx4 v31, s[12:15], s34 offen lds
mfa 224,88,112
tra 72,10,24576
tra 74,10,26624
mfa 228,88,116
mfa 232,88,120
mfa 236,88,124
mfa 240,92,112
tra 76,11,24576
tra 78,11,26624
mfa 244,92,116
mfa 248,92,120
sad 34,27,81920
s_add_u32 m0, s29, 8192
s_nop 0
buffer_load_dwordx4 v30, s[12:15], s34 offen lds
mfa 252,92,124
wv 49
wl 6
mfa 64,64,128
tra 80,8,32768
tra 82,8,34816
mfa 68,64,132
mfa 72,64,136
mfa 76,64,140
wl 6
mfa 80,68,128
tra 84,9,32768
tra 86,9,34816
mfa 84,68,132
s_add_u32 m0, s29, 9216
s_nop 0
buffer_load_dwordx4 v31, s[12:15], s34 offen lds
mfa 88,68,136
mfa 92,68,140
wl 6
mfa 96,72,128
tra 88,10,32768
tra 90,10,34816
mfa 100,72,132
mfa 104,72,136
mfa 108,72,140
sad 34,27,163840
s_add_u32 m0, s29, 16384
s_nop 0
buffer_load_dwordx4 v30, s[12:15], s34 offen lds
wl 6
mfa 112,76,128
tra 92,11,32768
tra 94,11,34816
mfa 116,76,132
mfa 120,76,136
mfa 124,76,140
wl 6
mfa 128,80,128
tra 64,8,40960
tra 66,8,43008
mfa 132,80,132
mfa 136,80,136
s_add_u32 m0, s29, 17408
s_nop 0
buffer_load_dwordx4 v31, s[12:15], s34 offen lds
mfa 140,80,140
wl 6
mfa 144,84,128
tra 68,9,40960
tra 70,9,43008
mfa 148,84,132
mfa 152,84,136
mfa 156,84,140
wl 6
mfa 160,88,128
tra 72,10,40960
tra 74,10,43008
mfa 164,88,132
mfa 168,88,136
mfa 172,88,140
wl 6
mfa 176,92,128
tra 76,11,40960
tra 78,11,43008
mfa 180,92,132
mfa 184,92,136
mfa 188,92,140
wl 6
mfa 192,64,128
tra 80,8,28672
tra 82,8,30720
mfa 196,64,132
mfa 200,64,136
mfa 204,64,140
wl 6
mfa 208,68,128
tra 84,9,28672
tra 86,9,30720
mfa 212,68,132
mfa 216,68,136
mfa 220,68,140
wl 6
mfa 224,72,128
tra 88,10,28672
tra 90,10,30720
mfa 228,72,132
mfa 232,72,136
mfa 236,72,140
wl 6
mfa 240,76,128
tra 92,11,28672
tra 94,11,30720
mfa 244,76,132
mfa 248,76,136
mfa 252,76,140
wv 48
wl 6
mfa 64,80,144
tra 64,8,36864
tra 66,8,38912
mfa 68,80,148
mfa 72,80,152
mfa 76,80,156
wl 6
mfa 80,84,144
tra 68,9,36864
tra 70,9,38912
mfa 84,84,148
mfa 88,84,152
mfa 92,84,156
wl 6
mfa 96,88,144
tra 72,10,36864
tra 74,10,38912
mfa 100,88,148
mfa 104,88,152
mfa 108,88,156
wl 6
mfa 112,92,144
tra 76,11,36864
tra 78,11,38912
mfa 116,92,148
mfa 120,92,152
mfa 124,92,156
wl 6
mfa 128,64,144
tra 80,8,45056
tra 82,8,47104
mfa 132,64,148
mfa 136,64,152
mfa 140,64,156
wl 6
mfa 144,68,144
tra 84,9,45056
tra 86,9,47104
mfa 148,68,148
mfa 152,68,152
mfa 156,68,156
wl 6
mfa 160,72,144
tra 88,10,45056
tra 90,10,47104
mfa 164,72,148
mfa 168,72,152
mfa 172,72,156
wl 6
mfa 176,76,144
tra 92,11,45056
tra 94,11,47104
mfa 180,76,148
mfa 184,76,152
mfa 188,76,156
s_waitcnt vmcnt(42) lgkmcnt(0)
s_barrier
mfa 192,80,144
tra 64,8,49152
tra 66,8,51200
mfa 196,80,148
sad 34,27,128
s_add_u32 m0, s29, 24576
s_nop 0
buffer_load_dwordx4 v30, s[12:15], s34 offen lds
mfa 200,80,152
mfa 204,80,156
mfa 208,84,144
tra 68,9,49152
tra 70,9,51200
mfa 212,84,148
mfa 216,84,152
mfa 220,84,156
s_add_u32 m0, s29, 25600
s_nop 0
buffer_load_dwordx4 v31, s[12:15], s34 offen lds
mfa 224,88,144
tra 72,10,49152
tra 74,10,51200
mfa 228,88,148
mfa 232,88,152
mfa 236,88,156
mfa 240,92,144
tra 76,11,49152
tra 78,11,51200
mfa 244,92,148
mfa 248,92,152
sad 34,27,82048
s_add_u32 m0, s29, 32768
s_nop 0
buffer_load_dwordx4 v30, s[12:15], s34 offen lds
mfa 252,92,156
wv 41
wl 6
mfa 64,64,160
tra 80,8,57344
tra 82,8,59392
mfa 68,64,164
mfa 72,64,168
mfa 76,64,172
wl 6
mfa 80,68,160
tra 84,9,57344
tra 86,9,59392
mfa 84,68,164
s_add_u32 m0, s29, 33792
s_nop 0
buffer_load_dwordx4 v31, s[12:15], s34 offen lds
mfa 88,68,168
mfa 92,68,172
wl 6
mfa 96,72,160
tra 88,10,57344
tra 90,10,59392
mfa 100,72,164
mfa 104,72,168
mfa 108,72,172
sad 34,27,163968
s_add_u32 m0, s29, 40960
s_nop 0
buffer_load_dwordx4 v30, s[12:15], s34 offen lds
wl 6
mfa 112,76,160
tra 92,11,57344
tra 94,11,59392
mfa 116,76,164
mfa 120,76,168
mfa 124,76,172
wl 6
mfa 128,80,160
tra 64,12,16384
tra 66,12,18432
mfa 132,80,164
mfa 136,80,168
s_add_u32 m0, s29, 41984
s_nop 0
buffer_load_dwordx4 v31, s[12:15], s34 offen lds
mfa 140,80,172
wl 6
mfa 144,84,160
tra 68,13,16384
tra 70,13,18432
mfa 148,84,164
mfa 152,84,168
mfa 156,84,172
wl 6
mfa 160,88,160
tra 72,14,16384
tra 74,14,18432
mfa 164,88,164
mfa 168,88,168
mfa 172,88,172
wl 6
mfa 176,92,160
tra 76,15,16384
tra 78,15,18432
mfa 180,92,164
mfa 184,92,168
mfa 188,92,172
wl 6
mfa 192,64,160
tra 80,8,53248
tra 82,8,55296
mfa 196,64,164
mfa 200,64,168
mfa 204,64,172
wl 6
mfa 208,68,160
tra 84,9,53248
tra 86,9,55296
mfa 212,68,164
mfa 216,68,168
mfa 220,68,172
wl 6
mfa 224,72,160
tra 88,10,53248
tra 90,10,55296
mfa 228,72,164
mfa 232,72,168
mfa 236,72,172
wl 6
mfa 240,76,160
tra 92,11,53248
tra 94,11,55296
mfa 244,76,164
mfa 248,76,168
mfa 252,76,172
wv 40
wl 6
mfa 64,80,176
tra 64,8,61440
tra 66,8,63488
mfa 68,80,180
mfa 72,80,184
mfa 76,80,188
wl 6
mfa 80,84,176
tra 68,9,61440
tra 70,9,63488
mfa 84,84,180
mfa 88,84,184
mfa 92,84,188
wl 6
mfa 96,88,176
tra 72,10,61440
tra 74,10,63488
mfa 100,88,180
mfa 104,88,184
mfa 108,88,188
wl 6
mfa 112,92,176
tra 76,11,61440
tra 78,11,63488
mfa 116,92,180
mfa 120,92,184
mfa 124,92,188
wl 6
mfa 128,64,176
tra 80,12,20480
tra 82,12,22528
mfa 132,64,180
mfa 136,64,184
mfa 140,64,188
wl 6
mfa 144,68,176
tra 84,13,20480
tra 86,13,22528
mfa 148,68,180
mfa 152,68,184
mfa 156,68,188
wl 6
mfa 160,72,176
tra 88,14,20480
tra 90,14,22528
mfa 164,72,180
mfa 168,72,184
mfa 172,72,188
wl 6
mfa 176,76,176
tra 92,15,20480
tra 94,15,22528
mfa 180,76,180
mfa 184,76,184
mfa 188,76,188
s_waitcnt vmcnt(34) lgkmcnt(0)
s_barrier
mfa 192,80,176
tra 64,12,24576
tra 66,12,26624
mfa 196,80,180
sad 34,27,256
s_add_u32 m0, s29, 49152
s_nop 0
buffer_load_dwordx4 v30, s[12:15], s34 offen lds
mfa 200,80,184
mfa 204,80,188
mfa 208,84,176
tra 68,13,24576
tra 70,13,26624
mfa 212,84,180
mfa 216,84,184
mfa 220,84,188
s_add_u32 m0, s29, 50176
s_nop 0
buffer_load_dwordx4 v31, s[12:15], s34 offen lds
mfa 224,88,176
tra 72,14,24576
tra 74,14,26624
mfa 228,88,180
mfa 232,88,184
mfa 236,88,188
mfa 240,92,176
tra 76,15,24576
tra 78,15,26624
mfa 244,92,180
mfa 248,92,184
sad 34,27,82176
s_add_u32 m0, s29, 57344
s_nop 0
buffer_load_dwordx4 v30, s[12:15], s34 offen lds
mfa 252,92,188
wv 33
wl 6
mfa 64,64,192
tra 80,12,32768
tra 82,12,34816
mfa 68,64,196
mfa 72,64,200
mfa 76,64,204
wl 6
mfa 80,68,192
tra 84,13,32768
tra 86,13,34816
mfa 84,68,196
s_add_u32 m0, s29, 58368
s_nop 0
buffer_load_dwordx4 v31, s[12:15], s34 offen lds
mfa 88,68,200
mfa 92,68,204
wl 6
mfa 96,72,192
tra 88,14,32768
tra 90,14,34816
mfa 100,72,196
mfa 104,72,200
mfa 108,72,204
sad 34,27,164096
s_add_u32 m0, s29, 65536
s_nop 0
buffer_load_dwordx4 v30, s[12:15], s34 offen lds
wl 6
mfa 112,76,192
tra 92,15,32768
tra 94,15,34816
mfa 116,76,196
mfa 120,76,200
mfa 124,76,204
wl 6
mfa 128,80,192
tra 64,12,40960
tra 66,12,43008
mfa 132,80,196
mfa 136,80,200
s_add_u32 m0, s29, 66560
s_nop 0
buffer_load_dwordx4 v31, s[12:15], s34 offen lds
mfa 140,80,204
wl 6
mfa 144,84,192
tra 68,13,40960
tra 70,13,43008
mfa 148,84,196
mfa 152,84,200
mfa 156,84,204
wl 6
mfa 160,88,192
tra 72,14,40960
tra 74,14,43008
mfa 164,88,196
mfa 168,88,200
mfa 172,88,204
wl 6
mfa 176,92,192
tra 76,15,40960
tra 78,15,43008
mfa 180,92,196
mfa 184,92,200
mfa 188,92,204
wl 6
mfa 192,64,192
tra 80,12,28672
tra 82,12,30720
mfa 196,64,196
mfa 200,64,200
mfa 204,64,204
wl 6
mfa 208,68,192
tra 84,13,28672
tra 86,13,30720
mfa 212,68,196
mfa 216,68,200
mfa 220,68,204
wl 6
mfa 224,72,192
tra 88,14,28672
tra 90,14,30720
mfa 228,72,196
mfa 232,72,200
mfa 236,72,204
wl 6
mfa 240,76,192
tra 92,15,28672
tra 94,15,30720
mfa 244,76,196
mfa 248,76,200
mfa 252,76,204
wv 32
wl 6
mfa 64,80,208
tra 64,12,36864
tra 66,12,38912
mfa 68,80,212
mfa 72,80,216
mfa 76,80,220
wl 6
mfa 80,84,208
tra 68,13,36864
tra 70,13,38912
mfa 84,84,212
mfa 88,84,216
mfa 92,84,220
wl 6
mfa 96,88,208
tra 72,14,36864
tra 74,14,38912
mfa 100,88,212
mfa 104,88,216
mfa 108,88,220
wl 6
mfa 112,92,208
tra 76,15,36864
tra 78,15,38912
mfa 116,92,212
mfa 120,92,216
mfa 124,92,220
wl 6
mfa 128,64,208
tra 80,12,45056
tra 82,12,47104
mfa 132,64,212
mfa 136,64,216
mfa 140,64,220
wl 6
mfa 144,68,208
tra 84,13,45056
tra 86,13,47104
mfa 148,68,212
mfa 152,68,216
mfa 156,68,220
wl 6
mfa 160,72,208
tra 88,14,45056
tra 90,14,47104
mfa 164,72,212
mfa 168,72,216
mfa 172,72,220
wl 6
mfa 176,76,208
tra 92,15,45056
tra 94,15,47104
mfa 180,76,212
mfa 184,76,216
mfa 188,76,220
s_waitcnt vmcnt(26) lgkmcnt(0)
s_barrier
mfa 192,80,208
tra 64,12,49152
tra 66,12,51200
mfa 196,80,212
sad 34,27,384
s_add_u32 m0, s29, 73728
s_nop 0
buffer_load_dwordx4 v30, s[12:15], s34 offen lds
mfa 200,80,216
mfa 204,80,220
mfa 208,84,208
tra 68,13,49152
tra 70,13,51200
mfa 212,84,212
mfa 216,84,216
mfa 220,84,220
s_add_u32 m0, s29, 74752
s_nop 0
buffer_load_dwordx4 v31, s[12:15], s34 offen lds
mfa 224,88,208
tra 72,14,49152
tra 74,14,51200
mfa 228,88,212
mfa 232,88,216
mfa 236,88,220
mfa 240,92,208
tra 76,15,49152
tra 78,15,51200
mfa 244,92,212
mfa 248,92,216
sad 34,27,82304
s_add_u32 m0, s29, 81920
s_nop 0
buffer_load_dwordx4 v30, s[12:15], s34 offen lds
mfa 252,92,220
wv 25
wl 6
mfa 64,64,224
tra 80,12,57344
tra 82,12,59392
mfa 68,64,228
mfa 72,64,232
mfa 76,64,236
wl 6
mfa 80,68,224
tra 84,13,57344
tra 86,13,59392
mfa 84,68,228
s_add_u32 m0, s29, 82944
s_nop 0
buffer_load_dwordx4 v31, s[12:15], s34 offen lds
mfa 88,68,232
mfa 92,68,236
wl 6
mfa 96,72,224
tra 88,14,57344
tra 90,14,59392
mfa 100,72,228
mfa 104,72,232
mfa 108,72,236
sad 34,27,164224
s_add_u32 m0, s29, 90112
s_nop 0
buffer_load_dwordx4 v30, s[12:15], s34 offen lds
wl 6
mfa 112,76,224
tra 92,15,57344
tra 94,15,59392
mfa 116,76,228
mfa 120,76,232
mfa 124,76,236
wl 6
mfa 128,80,224
tra 64,24,16384
tra 66,24,18432
mfa 132,80,228
mfa 136,80,232
s_add_u32 m0, s29, 91136
s_nop 0
buffer_load_dwordx4 v31, s[12:15], s34 offen lds
mfa 140,80,236
wl 6
mfa 144,84,224
tra 68,25,16384
tra 70,25,18432
mfa 148,84,228
mfa 152,84,232
mfa 156,84,236
wl 6
mfa 160,88,224
tra 72,26,16384
tra 74,26,18432
mfa 164,88,228
mfa 168,88,232
mfa 172,88,236
wl 6
mfa 176,92,224
tra 76,27,16384
tra 78,27,18432
mfa 180,92,228
mfa 184,92,232
mfa 188,92,236
wl 6
mfa 192,64,224
tra 80,12,53248
tra 82,12,55296
mfa 196,64,228
mfa 200,64,232
mfa 204,64,236
wl 6
mfa 208,68,224
tra 84,13,53248
tra 86,13,55296
mfa 212,68,228
mfa 216,68,232
mfa 220,68,236
wl 6
mfa 224,72,224
tra 88,14,53248
tra 90,14,55296
mfa 228,72,228
mfa 232,72,232
mfa 236,72,236
wl 6
mfa 240,76,224
tra 92,15,53248
tra 94,15,55296
mfa 244,76,228
mfa 248,76,232
mfa 252,76,236
wv 24
wl 6
mfa 64,80,240
tra 64,12,61440
tra 66,12,63488
mfa 68,80,244
mfa 72,80,248
mfa 76,80,252
wl 6
mfa 80,84,240
tra 68,13,61440
tra 70,13,63488
mfa 84,84,244
mfa 88,84,248
mfa 92,84,252
wl 6
mfa 96,88,240
tra 72,14,61440
tra 74,14,63488
mfa 100,88,244
mfa 104,88,248
mfa 108,88,252
wl 6
mfa 112,92,240
tra 76,15,61440
tra 78,15,63488
mfa 116,92,244
mfa 120,92,248
mfa 124,92,252
wl 6
mfa 128,64,240
tra 80,24,20480
tra 82,24,22528
mfa 132,64,244
cvp 64,64,65
cvp 65,66,67
mfa 136,64,248
cvp 66,80,81
cvp 67,82,83
mfa 140,64,252
cvp 68,68,69
cvp 69,70,71
wl 6
mfa 144,68,240
tra 84,25,20480
tra 86,25,22528
mfa 148,68,244
cvp 70,84,85
cvp 71,86,87
mfa 152,68,248
cvp 72,72,73
cvp 73,74,75
mfa 156,68,252
cvp 74,88,89
cvp 75,90,91
wl 6
mfa 160,72,240
tra 88,26,20480
tra 90,26,22528
mfa 164,72,244
cvp 76,76,77
cvp 77,78,79
mfa 168,72,248
cvp 78,92,93
cvp 79,94,95
mfa 172,72,252
cvp 96,96,97
cvp 97,98,99
wl 6
mfa 176,76,240
tra 92,27,20480
tra 94,27,22528
mfa 180,76,244
cvp 98,112,113
cvp 99,114,115
mfa 184,76,248
cvp 100,100,101
cvp 101,102,103
mfa 188,76,252
cvp 102,116,117
cvp 103,118,119
s_waitcnt vmcnt(18) lgkmcnt(0)
s_barrier
mfa 192,80,240
tra 64,8,0
tra 66,8,2048
mfa 196,80,244
cvp 104,104,105
cvp 105,106,107
mfa 200,80,248
cvp 106,120,121
cvp 107,122,123
mfa 204,80,252
cvp 108,108,109
cvp 109,110,111
mfa 208,84,240
tra 68,9,0
tra 70,9,2048
mfa 212,84,244
cvp 110,124,125
cvp 111,126,127
mfa 216,84,248
cvp 128,128,129
cvp 129,130,131
mfa 220,84,252
cvp 130,144,145
cvp 131,146,147
mfa 224,88,240
tra 72,10,0
tra 74,10,2048
mfa 228,88,244
cvp 132,132,133
cvp 133,134,135
mfa 232,88,248
cvp 134,148,149
cvp 135,150,151
mfa 236,88,252
cvp 136,136,137
cvp 137,138,139
mfa 240,92,240
tra 76,11,0
tra 78,11,2048
mfa 244,92,244
cvp 138,152,153
cvp 139,154,155
mfa 248,92,248
cvp 140,140,141
cvp 141,142,143
mfa 252,92,252
cvp 142,156,157
cvp 143,158,159
sad 34,27,512
s_add_u32 m0, s29, 98304
s_nop 0
buffer_load_dwordx4 v30, s[12:15], s34 offen lds
s_add_u32 m0, s29, 99328
s_nop 0
buffer_load_dwordx4 v31, s[12:15], s34 offen lds
sad 34,27,82432
s_add_u32 m0, s29, 106496
s_nop 0
buffer_load_dwordx4 v30, s[12:15], s34 offen lds
s_add_u32 m0, s29, 107520
s_nop 0
buffer_load_dwordx4 v31, s[12:15], s34 offen lds
sad 34,27,164352
s_add_u32 m0, s29, 114688
s_nop 0
buffer_load_dwordx4 v30, s[12:15], s34 offen lds
s_add_u32 m0, s29, 115712
s_nop 0
buffer_load_dwordx4 v31, s[12:15], s34 offen lds
cvp 160,160,161
cvp 161,162,163
cvp 162,176,177
cvp 163,178,179
cvp 164,164,165
cvp 165,166,167
cvp 166,180,181
cvp 167,182,183
cvp 168,168,169
cvp 169,170,171
cvp 170,184,185
cvp 171,186,187
cvp 172,172,173
cvp 173,174,175
cvp 174,188,189
cvp 175,190,191
cvp 192,192,193
cvp 193,194,195
cvp 194,208,209
cvp 195,210,211
cvp 196,196,197
cvp 197,198,199
cvp 198,212,213
cvp 199,214,215
cvp 200,200,201
cvp 201,202,203
cvp 202,216,217
cvp 203,218,219
cvp 204,204,205
cvp 205,206,207
cvp 206,220,221
cvp 207,222,223
s_nop 7
cvp 224,224,225
cvp 225,226,227
cvp 226,240,241
cvp 227,242,243
cvp 228,228,229
cvp 229,230,231
cvp 230,244,245
cvp 231,246,247
cvp 232,232,233
cvp 233,234,235
cvp 234,248,249
cvp 235,250,251
cvp 236,236,237
cvp 237,238,239
cvp 238,252,253
cvp 239,254,255
s_nop 1
wl 6
mfw 80,64,64
tra 80,8,4096
tra 82,8,6144
mfw 84,68,64
mfw 88,72,64
mfw 92,76,64
wl 6
mfw 112,64,68
tra 84,9,4096
tra 86,9,6144
mfw 116,68,68
mfw 120,72,68
mfw 124,76,68
wl 6
mfw 144,64,72
tra 88,10,4096
tra 90,10,6144
mfw 148,68,72
mfw 152,72,72
mfw 156,76,72
wl 6
mfw 176,64,76
tra 92,11,4096
tra 94,11,6144
mfw 180,68,76
mfw 184,72,76
mfw 188,76,76
wl 6
mfv 80,96,80
tra 64,8,8192
tra 66,8,10240
mfv 84,100,80
mfv 88,104,80
mfv 92,108,80
wl 6
mfv 112,96,84
tra 68,9,8192
tra 70,9,10240
mfv 116,100,84
mfv 120,104,84
mfv 124,108,84
wl 6
mfv 144,96,88
tra 72,10,8192
tra 74,10,10240
mfv 148,100,88
mfv 152,104,88
mfv 156,108,88
wl 6
mfv 176,96,92
tra 76,11,8192
tra 78,11,10240
mfv 180,100,92
mfv 184,104,92
mfv 188,108,92
wl 6
mfv 80,128,64
tra 80,8,12288
tra 82,8,14336
mfv 84,132,64
mfv 88,136,64
mfv 92,140,64
wl 6
mfv 112,128,68
tra 84,9,12288
tra 86,9,14336
mfv 116,132,68
mfv 120,136,68
mfv 124,140,68
wl 6
mfv 144,128,72
tra 88,10,12288
tra 90,10,14336
mfv 148,132,72
mfv 152,136,72
mfv 156,140,72
wl 6
mfv 176,128,76
tra 92,11,12288
tra 94,11,14336
mfv 180,132,76
mfv 184,136,76
mfv 188,140,76
wl 6
mfv 80,160,80
tra 64,8,16384
tra 66,8,18432
mfv 84,164,80
mfv 88,168,80
mfv 92,172,80
wl 6
mfv 112,160,84
tra 68,9,16384
tra 70,9,18432
mfv 116,164,84
mfv 120,168,84
mfv 124,172,84
wl 6
mfv 144,160,88
tra 72,10,16384
tra 74,10,18432
mfv 148,164,88
mfv 152,168,88
mfv 156,172,88
wl 6
mfv 176,160,92
tra 76,11,16384
tra 78,11,18432
mfv 180,164,92
mfv 184,168,92
mfv 188,172,92
wl 6
mfv 80,192,64
tra 80,8,20480
tra 82,8,22528
mfv 84,196,64
mfv 88,200,64
mfv 92,204,64
wl 6
mfv 112,192,68
tra 84,9,20480
tra 86,9,22528
mfv 116,196,68
mfv 120,200,68
mfv 124,204,68
wl 6
mfv 144,192,72
tra 88,10,20480
tra 90,10,22528
mfv 148,196,72
mfv 152,200,72
mfv 156,204,72
wl 6
mfv 176,192,76
tra 92,11,20480
tra 94,11,22528
mfv 180,196,76
mfv 184,200,76
mfv 188,204,76
s_waitcnt vmcnt(18) lgkmcnt(0)
s_barrier
mfv 80,224,80
tra 64,8,24576
tra 66,8,26624
mfv 84,228,80
sad 34,27,640
s_add_u32 m0, s29, 0
s_nop 0
buffer_load_dwordx4 v30, s[12:15], s34 offen lds
mfv 88,232,80
mfv 92,236,80
mfv 112,224,84
tra 68,9,24576
tra 70,9,26624
mfv 116,228,84
mfv 120,232,84
s_add_u32 m0, s29, 1024
s_nop 0
buffer_load_dwordx4 v31, s[12:15], s34 offen lds
mfv 124,236,84
mfv 144,224,88
tra 72,10,24576
tra 74,10,26624
mfv 148,228,88
mfv 152,232,88
mfv 156,236,88
sad 34,27,82560
s_add_u32 m0, s29, 8192
s_nop 0
buffer_load_dwordx4 v30, s[12:15], s34 offen lds
mfv 176,224,92
tra 76,11,24576
tra 78,11,26624
mfv 180,228,92
mfv 184,232,92
mfv 188,236,92
wl 6
mfw 208,64,64
tra 80,8,28672
tra 82,8,30720
mfw 212,68,64
s_add_u32 m0, s29, 9216
s_nop 0
buffer_load_dwordx4 v31, s[12:15], s34 offen lds
mfw 216,72,64
mfw 220,76,64
wl 6
mfw 240,64,68
tra 84,9,28672
tra 86,9,30720
mfw 244,68,68
mfw 248,72,68
sad 34,27,164480
s_add_u32 m0, s29, 16384
s_nop 0
buffer_load_dwordx4 v30, s[12:15], s34 offen lds
mfw 252,76,68
wl 6
mfw 32,64,72
tra 88,10,28672
tra 90,10,30720
mfw 36,68,72
mfw 40,72,72
mfw 44,76,72
s_add_u32 m0, s29, 17408
s_nop 0
buffer_load_dwordx4 v31, s[12:15], s34 offen lds
wl 6
mfw 48,64,76
tra 92,11,28672
tra 94,11,30720
mfw 52,68,76
cvp 80,80,81
cvp 81,82,83
mfw 56,72,76
cvp 82,84,85
cvp 83,86,87
mfw 60,76,76
wl 6
mfv 208,96,80
tra 64,8,32768
tra 66,8,34816
mfv 212,100,80
sad 32,47,0
buffer_store_dwordx4 v[80:83], v21, s[20:23], s32 offen sc1
mfv 216,104,80
cvp 88,88,89
cvp 89,90,91
mfv 220,108,80
cvp 90,92,93
cvp 91,94,95
wl 6
mfv 240,96,84
tra 68,9,32768
tra 70,9,34816
mfv 244,100,84
mfv 248,104,84
sad 32,47,1310720
buffer_store_dwordx4 v[88:91], v21, s[20:23], s32 offen sc1
mfv 252,108,84
cvp 112,112,113
cvp 113,114,115
wl 6
mfv 32,96,88
tra 72,10,32768
tra 74,10,34816
mfv 36,100,88
cvp 114,116,117
cvp 115,118,119
mfv 40,104,88
mfv 44,108,88
sad 32,47,32768
buffer_store_dwordx4 v[112:115], v21, s[20:23], s32 offen sc1
wl 6
mfv 48,96,92
tra 76,11,32768
tra 78,11,34816
mfv 52,100,92
cvp 120,120,121
cvp 121,122,123
mfv 56,104,92
cvp 122,124,125
cvp 123,126,127
mfv 60,108,92
wl 6
mfv 208,128,64
tra 80,8,36864
tra 82,8,38912
mfv 212,132,64
sad 32,47,1343488
buffer_store_dwordx4 v[120:123], v21, s[20:23], s32 offen sc1
mfv 216,136,64
cvp 144,144,145
cvp 145,146,147
mfv 220,140,64
cvp 146,148,149
cvp 147,150,151
wl 6
mfv 240,128,68
tra 84,9,36864
tra 86,9,38912
mfv 244,132,68
mfv 248,136,68
sad 32,47,65536
buffer_store_dwordx4 v[144:147], v21, s[20:23], s32 offen sc1
mfv 252,140,68
cvp 152,152,153
cvp 153,154,155
wl 6
mfv 32,128,72
tra 88,10,36864
tra 90,10,38912
mfv 36,132,72
cvp 154,156,157
cvp 155,158,159
mfv 40,136,72
mfv 44,140,72
sad 32,47,1376256
buffer_store_dwordx4 v[152:155], v21, s[20:23], s32 offen sc1
wl 6
mfv 48,128,76
tra 92,11,36864
tra 94,11,38912
mfv 52,132,76
cvp 176,176,177
cvp 177,178,179
mfv 56,136,76
cvp 178,180,181
cvp 179,182,183
mfv 60,140,76
wl 6
mfv 208,160,80
tra 64,8,40960
tra 66,8,43008
mfv 212,164,80
sad 32,47,98304
buffer_store_dwordx4 v[176:179], v21, s[20:23], s32 offen sc1
mfv 216,168,80
cvp 184,184,185
cvp 185,186,187
mfv 220,172,80
cvp 186,188,189
cvp 187,190,191
wl 6
mfv 240,160,84
tra 68,9,40960
tra 70,9,43008
mfv 244,164,84
mfv 248,168,84
sad 32,47,1409024
buffer_store_dwordx4 v[184:187], v21, s[20:23], s32 offen sc1
mfv 252,172,84
wl 6
mfv 32,160,88
tra 72,10,40960
tra 74,10,43008
mfv 36,164,88
mfv 40,168,88
mfv 44,172,88
wl 6
mfv 48,160,92
tra 76,11,40960
tra 78,11,43008
mfv 52,164,92
mfv 56,168,92
mfv 60,172,92
wl 6
mfv 208,192,64
tra 80,8,45056
tra 82,8,47104
mfv 212,196,64
mfv 216,200,64
mfv 220,204,64
wl 6
mfv 240,192,68
tra 84,9,45056
tra 86,9,47104
mfv 244,196,68
mfv 248,200,68
mfv 252,204,68
wl 6
mfv 32,192,72
tra 88,10,45056
tra 90,10,47104
mfv 36,196,72
mfv 40,200,72
mfv 44,204,72
wl 6
mfv 48,192,76
tra 92,11,45056
tra 94,11,47104
mfv 52,196,76
mfv 56,200,76
mfv 60,204,76
s_waitcnt vmcnt(26) lgkmcnt(0)
s_barrier
mfv 208,224,80
tra 64,8,49152
tra 66,8,51200
mfv 212,228,80
sad 34,27,768
s_add_u32 m0, s29, 24576
s_nop 0
buffer_load_dwordx4 v30, s[12:15], s34 offen lds
mfv 216,232,80
mfv 220,236,80
mfv 240,224,84
tra 68,9,49152
tra 70,9,51200
mfv 244,228,84
mfv 248,232,84
s_add_u32 m0, s29, 25600
s_nop 0
buffer_load_dwordx4 v31, s[12:15], s34 offen lds
mfv 252,236,84
mfv 32,224,88
tra 72,10,49152
tra 74,10,51200
mfv 36,228,88
mfv 40,232,88
mfv 44,236,88
sad 34,27,82688
s_add_u32 m0, s29, 32768
s_nop 0
buffer_load_dwordx4 v30, s[12:15], s34 offen lds
mfv 48,224,92
tra 76,11,49152
tra 78,11,51200
mfv 52,228,92
mfv 56,232,92
mfv 60,236,92
s_nop 1
wl 6
mfw 80,64,64
tra 80,8,53248
tra 82,8,55296
mfw 84,68,64
s_add_u32 m0, s29, 33792
s_nop 0
buffer_load_dwordx4 v31, s[12:15], s34 offen lds
mfw 88,72,64
mfw 92,76,64
wl 6
mfw 112,64,68
tra 84,9,53248
tra 86,9,55296
mfw 116,68,68
mfw 120,72,68
sad 34,27,164608
s_add_u32 m0, s29, 40960
s_nop 0
buffer_load_dwordx4 v30, s[12:15], s34 offen lds
mfw 124,76,68
wl 6
mfw 144,64,72
tra 88,10,53248
tra 90,10,55296
mfw 148,68,72
mfw 152,72,72
mfw 156,76,72
s_add_u32 m0, s29, 41984
s_nop 0
buffer_load_dwordx4 v31, s[12:15], s34 offen lds
wl 6
mfw 176,64,76
tra 92,11,53248
tra 94,11,55296
mfw 180,68,76
cvp 208,208,209
cvp 209,210,211
mfw 184,72,76
cvp 210,212,213
cvp 211,214,215
mfw 188,76,76
wl 6
mfv 80,96,80
tra 64,8,57344
tra 66,8,59392
mfv 84,100,80
sad 32,47,131072
buffer_store_dwordx4 v[208:211], v21, s[20:23], s32 offen sc1
mfv 88,104,80
cvp 216,216,217
cvp 217,218,219
mfv 92,108,80
cvp 218,220,221
cvp 219,222,223
wl 6
mfv 112,96,84
tra 68,9,57344
tra 70,9,59392
mfv 116,100,84
mfv 120,104,84
sad 32,47,1441792
buffer_store_dwordx4 v[216:219], v21, s[20:23], s32 offen sc1
mfv 124,108,84
cvp 240,240,241
cvp 241,242,243
wl 6
mfv 144,96,88
tra 72,10,57344
tra 74,10,59392
mfv 148,100,88
cvp 242,244,245
cvp 243,246,247
mfv 152,104,88
mfv 156,108,88
sad 32,47,163840
buffer_store_dwordx4 v[240:243], v21, s[20:23], s32 offen sc1
wl 6
mfv 176,96,92
tra 76,11,57344
tra 78,11,59392
mfv 180,100,92
cvp 248,248,249
cvp 249,250,251
mfv 184,104,92
cvp 250,252,253
cvp 251,254,255
mfv 188,108,92
wl 6
mfv 80,128,64
tra 80,8,61440
tra 82,8,63488
mfv 84,132,64
sad 32,47,1474560
buffer_store_dwordx4 v[248:251], v21, s[20:23], s32 offen sc1
mfv 88,136,64
cvp 32,32,33
cvp 33,34,35
mfv 92,140,64
cvp 34,36,37
cvp 35,38,39
wl 6
mfv 112,128,68
tra 84,9,61440
tra 86,9,63488
mfv 116,132,68
mfv 120,136,68
sad 32,47,196608
buffer_store_dwordx4 v[32:35], v21, s[20:23], s32 offen sc1
mfv 124,140,68
cvp 40,40,41
cvp 41,42,43
wl 6
mfv 144,128,72
tra 88,10,61440
tra 90,10,63488
mfv 148,132,72
cvp 42,44,45
cvp 43,46,47
mfv 152,136,72
mfv 156,140,72
sad 32,47,1507328
buffer_store_dwordx4 v[40:43], v21, s[20:23], s32 offen sc1
wl 6
mfv 176,128,76
tra 92,11,61440
tra 94,11,63488
mfv 180,132,76
cvp 48,48,49
cvp 49,50,51
mfv 184,136,76
cvp 50,52,53
cvp 51,54,55
mfv 188,140,76
wl 6
mfv 80,160,80
tra 64,12,16384
tra 66,12,18432
mfv 84,164,80
sad 32,47,229376
buffer_store_dwordx4 v[48:51], v21, s[20:23], s32 offen sc1
mfv 88,168,80
cvp 56,56,57
cvp 57,58,59
mfv 92,172,80
cvp 58,60,61
cvp 59,62,63
wl 6
mfv 112,160,84
tra 68,13,16384
tra 70,13,18432
mfv 116,164,84
mfv 120,168,84
sad 32,47,1540096
buffer_store_dwordx4 v[56:59], v21, s[20:23], s32 offen sc1
mfv 124,172,84
wl 6
mfv 144,160,88
tra 72,14,16384
tra 74,14,18432
mfv 148,164,88
mfv 152,168,88
mfv 156,172,88
wl 6
mfv 176,160,92
tra 76,15,16384
tra 78,15,18432
mfv 180,164,92
mfv 184,168,92
mfv 188,172,92
wl 6
mfv 80,192,64
tra 80,12,20480
tra 82,12,22528
mfv 84,196,64
mfv 88,200,64
mfv 92,204,64
wl 6
mfv 112,192,68
tra 84,13,20480
tra 86,13,22528
mfv 116,196,68
mfv 120,200,68
mfv 124,204,68
wl 6
mfv 144,192,72
tra 88,14,20480
tra 90,14,22528
mfv 148,196,72
mfv 152,200,72
mfv 156,204,72
wl 6
mfv 176,192,76
tra 92,15,20480
tra 94,15,22528
mfv 180,196,76
mfv 184,200,76
mfv 188,204,76
s_waitcnt vmcnt(34) lgkmcnt(0)
s_barrier
s_sub_u32 s83, s2, 128
s_lshr_b32 s83, s83, 3
s_mul_i32 s83, s83, 0
sad 83,83,36
s_cmp_eq_u32 s68, 1
s_cselect_b32 s83, 0, s83
s_cmp_ge_u32 s2, 144
s_cbranch_scc1 L_xd_150
s_cmp_lt_u32 s78, s83
s_cbranch_scc1 L_xd_150
v_mov_b32 v18, 0x7fff
s_mov_b32 s77, 7
s_branch L_xe_151
L_xd_150:
s_cmp_lg_u32 s4, 0
s_cbranch_scc1 L_ti_152
s_lshl_b32 s83, s76, 2
v_mov_b32 v18, 1
v_mov_b32 v2, 0
s_mov_b64 exec, 1
buffer_atomic_add v18, v2, s[84:87], s83 offen sc0 sc1
s_mov_b64 exec, -1
L_ti_152:
L_xe_151:
mfv 80,224,80
tra 64,12,24576
tra 66,12,26624
mfv 84,228,80
sad 34,27,896
s_add_u32 m0, s29, 49152
s_nop 0
buffer_load_dwordx4 v30, s[12:15], s34 offen lds
mfv 88,232,80
mfv 92,236,80
mfv 112,224,84
tra 68,13,24576
tra 70,13,26624
mfv 116,228,84
mfv 120,232,84
s_add_u32 m0, s29, 50176
s_nop 0
buffer_load_dwordx4 v31, s[12:15], s34 offen lds
mfv 124,236,84
mfv 144,224,88
tra 72,14,24576
tra 74,14,26624
mfv 148,228,88
mfv 152,232,88
mfv 156,236,88
sad 34,27,82816
s_add_u32 m0, s29, 57344
s_nop 0
buffer_load_dwordx4 v30, s[12:15], s34 offen lds
mfv 176,224,92
tra 76,15,24576
tra 78,15,26624
mfv 180,228,92
mfv 184,232,92
mfv 188,236,92
s_nop 1
wl 6
mfw 208,64,64
tra 80,12,28672
tra 82,12,30720
mfw 212,68,64
s_add_u32 m0, s29, 58368
s_nop 0
buffer_load_dwordx4 v31, s[12:15], s34 offen lds
mfw 216,72,64
mfw 220,76,64
wl 6
mfw 240,64,68
tra 84,13,28672
tra 86,13,30720
mfw 244,68,68
mfw 248,72,68
sad 34,27,164736
s_add_u32 m0, s29, 65536
s_nop 0
buffer_load_dwordx4 v30, s[12:15], s34 offen lds
mfw 252,76,68
wl 6
mfw 32,64,72
tra 88,14,28672
tra 90,14,30720
mfw 36,68,72
mfw 40,72,72
mfw 44,76,72
s_add_u32 m0, s29, 66560
s_nop 0
buffer_load_dwordx4 v31, s[12:15], s34 offen lds
wl 6
mfw 48,64,76
tra 92,15,28672
tra 94,15,30720
mfw 52,68,76
cvp 80,80,81
cvp 81,82,83
mfw 56,72,76
cvp 82,84,85
cvp 83,86,87
mfw 60,76,76
wl 6
mfv 208,96,80
tra 64,12,32768
tra 66,12,34816
mfv 212,100,80
sad 32,47,262144
buffer_store_dwordx4 v[80:83], v21, s[20:23], s32 offen sc1
mfv 216,104,80
cvp 88,88,89
cvp 89,90,91
mfv 220,108,80
cvp 90,92,93
cvp 91,94,95
wl 6
mfv 240,96,84
tra 68,13,32768
tra 70,13,34816
mfv 244,100,84
mfv 248,104,84
sad 32,47,1572864
buffer_store_dwordx4 v[88:91], v21, s[20:23], s32 offen sc1
mfv 252,108,84
cvp 112,112,113
cvp 113,114,115
wl 6
mfv 32,96,88
tra 72,14,32768
tra 74,14,34816
mfv 36,100,88
cvp 114,116,117
cvp 115,118,119
mfv 40,104,88
mfv 44,108,88
sad 32,47,294912
buffer_store_dwordx4 v[112:115], v21, s[20:23], s32 offen sc1
wl 6
mfv 48,96,92
tra 76,15,32768
tra 78,15,34816
mfv 52,100,92
cvp 120,120,121
cvp 121,122,123
mfv 56,104,92
cvp 122,124,125
cvp 123,126,127
mfv 60,108,92
wl 6
mfv 208,128,64
tra 80,12,36864
tra 82,12,38912
mfv 212,132,64
sad 32,47,1605632
buffer_store_dwordx4 v[120:123], v21, s[20:23], s32 offen sc1
mfv 216,136,64
cvp 144,144,145
cvp 145,146,147
mfv 220,140,64
cvp 146,148,149
cvp 147,150,151
wl 6
mfv 240,128,68
tra 84,13,36864
tra 86,13,38912
mfv 244,132,68
mfv 248,136,68
sad 32,47,327680
buffer_store_dwordx4 v[144:147], v21, s[20:23], s32 offen sc1
mfv 252,140,68
cvp 152,152,153
cvp 153,154,155
wl 6
mfv 32,128,72
tra 88,14,36864
tra 90,14,38912
mfv 36,132,72
cvp 154,156,157
cvp 155,158,159
mfv 40,136,72
mfv 44,140,72
sad 32,47,1638400
buffer_store_dwordx4 v[152:155], v21, s[20:23], s32 offen sc1
wl 6
mfv 48,128,76
tra 92,15,36864
tra 94,15,38912
mfv 52,132,76
cvp 176,176,177
cvp 177,178,179
mfv 56,136,76
cvp 178,180,181
cvp 179,182,183
mfv 60,140,76
wl 6
mfv 208,160,80
tra 64,12,40960
tra 66,12,43008
mfv 212,164,80
sad 32,47,360448
buffer_store_dwordx4 v[176:179], v21, s[20:23], s32 offen sc1
mfv 216,168,80
cvp 184,184,185
cvp 185,186,187
mfv 220,172,80
cvp 186,188,189
cvp 187,190,191
wl 6
mfv 240,160,84
tra 68,13,40960
tra 70,13,43008
mfv 244,164,84
mfv 248,168,84
sad 32,47,1671168
buffer_store_dwordx4 v[184:187], v21, s[20:23], s32 offen sc1
mfv 252,172,84
wl 6
mfv 32,160,88
tra 72,14,40960
tra 74,14,43008
mfv 36,164,88
mfv 40,168,88
mfv 44,172,88
wl 6
mfv 48,160,92
tra 76,15,40960
tra 78,15,43008
mfv 52,164,92
mfv 56,168,92
mfv 60,172,92
wl 6
mfv 208,192,64
tra 80,12,45056
tra 82,12,47104
mfv 212,196,64
mfv 216,200,64
mfv 220,204,64
wl 6
mfv 240,192,68
tra 84,13,45056
tra 86,13,47104
mfv 244,196,68
mfv 248,200,68
mfv 252,204,68
wl 6
mfv 32,192,72
tra 88,14,45056
tra 90,14,47104
mfv 36,196,72
mfv 40,200,72
mfv 44,204,72
wl 6
mfv 48,192,76
tra 92,15,45056
tra 94,15,47104
mfv 52,196,76
mfv 56,200,76
mfv 60,204,76
s_waitcnt vmcnt(42) lgkmcnt(0)
s_barrier
mfv 208,224,80
tra 64,12,49152
tra 66,12,51200
mfv 212,228,80
sad 34,27,1024
s_add_u32 m0, s29, 73728
s_nop 0
buffer_load_dwordx4 v30, s[12:15], s34 offen lds
mfv 216,232,80
mfv 220,236,80
mfv 240,224,84
tra 68,13,49152
tra 70,13,51200
mfv 244,228,84
mfv 248,232,84
s_add_u32 m0, s29, 74752
s_nop 0
buffer_load_dwordx4 v31, s[12:15], s34 offen lds
mfv 252,236,84
mfv 32,224,88
tra 72,14,49152
tra 74,14,51200
mfv 36,228,88
mfv 40,232,88
mfv 44,236,88
sad 34,27,82944
s_add_u32 m0, s29, 81920
s_nop 0
buffer_load_dwordx4 v30, s[12:15], s34 offen lds
mfv 48,224,92
tra 76,15,49152
tra 78,15,51200
mfv 52,228,92
mfv 56,232,92
mfv 60,236,92
s_nop 1
wl 6
mfw 80,64,64
tra 80,12,53248
tra 82,12,55296
mfw 84,68,64
s_add_u32 m0, s29, 82944
s_nop 0
buffer_load_dwordx4 v31, s[12:15], s34 offen lds
mfw 88,72,64
mfw 92,76,64
wl 6
mfw 112,64,68
tra 84,13,53248
tra 86,13,55296
mfw 116,68,68
mfw 120,72,68
sad 34,27,164864
s_add_u32 m0, s29, 90112
s_nop 0
buffer_load_dwordx4 v30, s[12:15], s34 offen lds
mfw 124,76,68
wl 6
mfw 144,64,72
tra 88,14,53248
tra 90,14,55296
mfw 148,68,72
mfw 152,72,72
mfw 156,76,72
s_add_u32 m0, s29, 91136
s_nop 0
buffer_load_dwordx4 v31, s[12:15], s34 offen lds
wl 6
mfw 176,64,76
tra 92,15,53248
tra 94,15,55296
mfw 180,68,76
cvp 208,208,209
cvp 209,210,211
mfw 184,72,76
cvp 210,212,213
cvp 211,214,215
mfw 188,76,76
wl 6
mfv 80,96,80
tra 64,12,57344
tra 66,12,59392
mfv 84,100,80
sad 32,47,393216
buffer_store_dwordx4 v[208:211], v21, s[20:23], s32 offen sc1
mfv 88,104,80
cvp 216,216,217
cvp 217,218,219
mfv 92,108,80
cvp 218,220,221
cvp 219,222,223
wl 6
mfv 112,96,84
tra 68,13,57344
tra 70,13,59392
mfv 116,100,84
mfv 120,104,84
sad 32,47,1703936
buffer_store_dwordx4 v[216:219], v21, s[20:23], s32 offen sc1
mfv 124,108,84
cvp 240,240,241
cvp 241,242,243
wl 6
mfv 144,96,88
tra 72,14,57344
tra 74,14,59392
mfv 148,100,88
cvp 242,244,245
cvp 243,246,247
mfv 152,104,88
mfv 156,108,88
sad 32,47,425984
buffer_store_dwordx4 v[240:243], v21, s[20:23], s32 offen sc1
wl 6
mfv 176,96,92
tra 76,15,57344
tra 78,15,59392
mfv 180,100,92
cvp 248,248,249
cvp 249,250,251
mfv 184,104,92
cvp 250,252,253
cvp 251,254,255
mfv 188,108,92
wl 6
mfv 80,128,64
tra 80,12,61440
tra 82,12,63488
mfv 84,132,64
sad 32,47,1736704
buffer_store_dwordx4 v[248:251], v21, s[20:23], s32 offen sc1
mfv 88,136,64
cvp 32,32,33
cvp 33,34,35
mfv 92,140,64
cvp 34,36,37
cvp 35,38,39
wl 6
mfv 112,128,68
tra 84,13,61440
tra 86,13,63488
mfv 116,132,68
mfv 120,136,68
sad 32,47,458752
buffer_store_dwordx4 v[32:35], v21, s[20:23], s32 offen sc1
mfv 124,140,68
cvp 40,40,41
cvp 41,42,43
wl 6
mfv 144,128,72
tra 88,14,61440
tra 90,14,63488
mfv 148,132,72
cvp 42,44,45
cvp 43,46,47
mfv 152,136,72
mfv 156,140,72
sad 32,47,1769472
buffer_store_dwordx4 v[40:43], v21, s[20:23], s32 offen sc1
wl 6
mfv 176,128,76
tra 92,15,61440
tra 94,15,63488
mfv 180,132,76
cvp 48,48,49
cvp 49,50,51
mfv 184,136,76
cvp 50,52,53
cvp 51,54,55
mfv 188,140,76
wl 6
mfv 80,160,80
tra 64,24,16384
tra 66,24,18432
mfv 84,164,80
sad 32,47,491520
buffer_store_dwordx4 v[48:51], v21, s[20:23], s32 offen sc1
mfv 88,168,80
cvp 56,56,57
cvp 57,58,59
mfv 92,172,80
cvp 58,60,61
cvp 59,62,63
wl 6
mfv 112,160,84
tra 68,25,16384
tra 70,25,18432
mfv 116,164,84
mfv 120,168,84
sad 32,47,1802240
buffer_store_dwordx4 v[56:59], v21, s[20:23], s32 offen sc1
mfv 124,172,84
wl 6
mfv 144,160,88
tra 72,26,16384
tra 74,26,18432
mfv 148,164,88
mfv 152,168,88
mfv 156,172,88
wl 6
mfv 176,160,92
tra 76,27,16384
tra 78,27,18432
mfv 180,164,92
mfv 184,168,92
mfv 188,172,92
wl 6
mfv 80,192,64
tra 80,24,20480
tra 82,24,22528
mfv 84,196,64
mfv 88,200,64
mfv 92,204,64
wl 6
mfv 112,192,68
tra 84,25,20480
tra 86,25,22528
mfv 116,196,68
mfv 120,200,68
mfv 124,204,68
wl 6
mfv 144,192,72
tra 88,26,20480
tra 90,26,22528
mfv 148,196,72
mfv 152,200,72
mfv 156,204,72
wl 6
mfv 176,192,76
tra 92,27,20480
tra 94,27,22528
mfv 180,196,76
mfv 184,200,76
mfv 188,204,76
v_mov_b32 v19, 155648
s_cmp_lg_u32 s4, 0
s_cbranch_scc1 L_ps_153
wv 28
s_mov_b64 exec, 1
ds_write_b32 v19, v18
s_mov_b64 exec, -1
wl 0
L_ps_153:
s_waitcnt vmcnt(50) lgkmcnt(0)
s_barrier
ds_read_b32 v18, v19
mfv 80,224,80
tra 64,8,0
tra 66,8,2048
mfv 84,228,80
sad 34,27,1152
s_add_u32 m0, s29, 98304
s_nop 0
buffer_load_dwordx4 v30, s[12:15], s34 offen lds
mfv 88,232,80
mfv 92,236,80
mfv 112,224,84
tra 68,9,0
tra 70,9,2048
mfv 116,228,84
mfv 120,232,84
s_add_u32 m0, s29, 99328
s_nop 0
buffer_load_dwordx4 v31, s[12:15], s34 offen lds
mfv 124,236,84
mfv 144,224,88
tra 72,10,0
tra 74,10,2048
mfv 148,228,88
mfv 152,232,88
mfv 156,236,88
sad 34,27,83072
s_add_u32 m0, s29, 106496
s_nop 0
buffer_load_dwordx4 v30, s[12:15], s34 offen lds
mfv 176,224,92
tra 76,11,0
tra 78,11,2048
mfv 180,228,92
mfv 184,232,92
mfv 188,236,92
s_nop 1
wl 6
mfw 208,64,64
tra 80,8,4096
tra 82,8,6144
mfw 212,68,64
s_add_u32 m0, s29, 107520
s_nop 0
buffer_load_dwordx4 v31, s[12:15], s34 offen lds
mfw 216,72,64
mfw 220,76,64
wl 6
mfw 240,64,68
tra 84,9,4096
tra 86,9,6144
mfw 244,68,68
mfw 248,72,68
sad 34,27,164992
s_add_u32 m0, s29, 114688
s_nop 0
buffer_load_dwordx4 v30, s[12:15], s34 offen lds
mfw 252,76,68
wl 6
mfw 32,64,72
tra 88,10,4096
tra 90,10,6144
mfw 36,68,72
mfw 40,72,72
mfw 44,76,72
s_add_u32 m0, s29, 115712
s_nop 0
buffer_load_dwordx4 v31, s[12:15], s34 offen lds
wl 6
mfw 48,64,76
tra 92,11,4096
tra 94,11,6144
mfw 52,68,76
cvp 80,80,81
cvp 81,82,83
mfw 56,72,76
cvp 82,84,85
cvp 83,86,87
mfw 60,76,76
wl 6
mfv 208,96,80
tra 64,8,8192
tra 66,8,10240
mfv 212,100,80
sad 32,47,524288
buffer_store_dwordx4 v[80:83], v21, s[20:23], s32 offen sc1
mfv 216,104,80
cvp 88,88,89
cvp 89,90,91
mfv 220,108,80
cvp 90,92,93
cvp 91,94,95
wl 6
mfv 240,96,84
tra 68,9,8192
tra 70,9,10240
mfv 244,100,84
mfv 248,104,84
sad 32,47,1835008
buffer_store_dwordx4 v[88:91], v21, s[20:23], s32 offen sc1
mfv 252,108,84
cvp 112,112,113
cvp 113,114,115
wl 6
mfv 32,96,88
tra 72,10,8192
tra 74,10,10240
mfv 36,100,88
cvp 114,116,117
cvp 115,118,119
mfv 40,104,88
mfv 44,108,88
sad 32,47,557056
buffer_store_dwordx4 v[112:115], v21, s[20:23], s32 offen sc1
wl 6
mfv 48,96,92
tra 76,11,8192
tra 78,11,10240
mfv 52,100,92
cvp 120,120,121
cvp 121,122,123
mfv 56,104,92
cvp 122,124,125
cvp 123,126,127
mfv 60,108,92
wl 6
mfv 208,128,64
tra 80,8,12288
tra 82,8,14336
mfv 212,132,64
sad 32,47,1867776
buffer_store_dwordx4 v[120:123], v21, s[20:23], s32 offen sc1
mfv 216,136,64
cvp 144,144,145
cvp 145,146,147
mfv 220,140,64
cvp 146,148,149
cvp 147,150,151
wl 6
mfv 240,128,68
tra 84,9,12288
tra 86,9,14336
mfv 244,132,68
mfv 248,136,68
sad 32,47,589824
buffer_store_dwordx4 v[144:147], v21, s[20:23], s32 offen sc1
mfv 252,140,68
cvp 152,152,153
cvp 153,154,155
wl 6
mfv 32,128,72
tra 88,10,12288
tra 90,10,14336
mfv 36,132,72
cvp 154,156,157
cvp 155,158,159
mfv 40,136,72
mfv 44,140,72
sad 32,47,1900544
buffer_store_dwordx4 v[152:155], v21, s[20:23], s32 offen sc1
wl 6
mfv 48,128,76
tra 92,11,12288
tra 94,11,14336
mfv 52,132,76
cvp 176,176,177
cvp 177,178,179
mfv 56,136,76
cvp 178,180,181
cvp 179,182,183
mfv 60,140,76
wl 6
mfv 208,160,80
tra 64,8,16384
tra 66,8,18432
mfv 212,164,80
sad 32,47,622592
buffer_store_dwordx4 v[176:179], v21, s[20:23], s32 offen sc1
mfv 216,168,80
cvp 184,184,185
cvp 185,186,187
mfv 220,172,80
cvp 186,188,189
cvp 187,190,191
wl 6
mfv 240,160,84
tra 68,9,16384
tra 70,9,18432
mfv 244,164,84
mfv 248,168,84
sad 32,47,1933312
buffer_store_dwordx4 v[184:187], v21, s[20:23], s32 offen sc1
mfv 252,172,84
wl 6
mfv 32,160,88
tra 72,10,16384
tra 74,10,18432
mfv 36,164,88
mfv 40,168,88
mfv 44,172,88
wl 6
mfv 48,160,92
tra 76,11,16384
tra 78,11,18432
mfv 52,164,92
mfv 56,168,92
mfv 60,172,92
wl 6
mfv 208,192,64
tra 80,8,20480
tra 82,8,22528
mfv 212,196,64
mfv 216,200,64
mfv 220,204,64
wl 6
mfv 240,192,68
tra 84,9,20480
tra 86,9,22528
mfv 244,196,68
mfv 248,200,68
mfv 252,204,68
wl 6
mfv 32,192,72
tra 88,10,20480
tra 90,10,22528
mfv 36,196,72
mfv 40,200,72
mfv 44,204,72
wl 6
mfv 48,192,76
tra 92,11,20480
tra 94,11,22528
mfv 52,196,76
mfv 56,200,76
mfv 60,204,76
s_waitcnt vmcnt(50) lgkmcnt(0)
s_barrier
v_readfirstlane_b32 s78, v18
s_mov_b32 s69, 1
s_getpc_b64 s[50:51]
L_c_154:
s_add_u32 s50, s50, L_sched-L_c_154
s_addc_u32 s51, s51, -1
s_swappc_b64 s[74:75], s[50:51]
mfv 208,224,80
tra 64,8,24576
tra 66,8,26624
mfv 212,228,80
s_mul_i32 s34, s60, 0
s_add_u32 s34, s34, s24
s_add_u32 m0, s29, 0
s_nop 0
buffer_load_dwordx4 v6, s[8:11], s34 offen lds
mfv 216,232,80
mfv 220,236,80
mfv 240,224,84
tra 68,9,24576
tra 70,9,26624
mfv 244,228,84
mfv 248,232,84
s_add_u32 m0, s29, 1024
s_nop 0
buffer_load_dwordx4 v7, s[8:11], s34 offen lds
mfv 252,236,84
mfv 32,224,88
tra 72,10,24576
tra 74,10,26624
mfv 36,228,88
mfv 40,232,88
mfv 44,236,88
s_mul_i32 s34, s60, 0
s_add_u32 s34, s34, s25
s_add_u32 m0, s29, 8192
s_nop 0
buffer_load_dwordx4 v6, s[52:55], s34 offen lds
mfv 48,224,92
tra 76,11,24576
tra 78,11,26624
mfv 52,228,92
mfv 56,232,92
mfv 60,236,92
s_nop 1
wl 6
mfw 80,64,64
tra 80,8,28672
tra 82,8,30720
mfw 84,68,64
s_add_u32 m0, s29, 9216
s_nop 0
buffer_load_dwordx4 v7, s[52:55], s34 offen lds
mfw 88,72,64
mfw 92,76,64
wl 6
mfw 112,64,68
tra 84,9,28672
tra 86,9,30720
mfw 116,68,68
s_mul_i32 s34, s60, 0
s_add_u32 s34, s34, s26
s_add_u32 m0, s29, 16384
s_nop 0
buffer_load_dwordx4 v6, s[56:59], s34 offen lds
mfw 120,72,68
mfw 124,76,68
wl 6
mfw 144,64,72
tra 88,10,28672
tra 90,10,30720
mfw 148,68,72
s_add_u32 m0, s29, 17408
s_nop 0
buffer_load_dwordx4 v7, s[56:59], s34 offen lds
mfw 152,72,72
mfw 156,76,72
wl 6
mfw 176,64,76
tra 92,11,28672
tra 94,11,30720
mfw 180,68,76
sad 33,28,0
buffer_load_dwordx4 a[96:99], v20, s[16:19], s33 offen sc1
mfw 184,72,76
mfw 188,76,76
wl 6
mfv 80,96,80
tra 64,8,32768
tra 66,8,34816
mfv 84,100,80
sad 33,28,20480
buffer_load_dwordx4 a[100:103], v20, s[16:19], s33 offen sc1
mfv 88,104,80
mfv 92,108,80
wl 6
mfv 112,96,84
tra 68,9,32768
tra 70,9,34816
mfv 116,100,84
sad 33,28,40960
buffer_load_dwordx4 a[104:107], v20, s[16:19], s33 offen sc1
mfv 120,104,84
mfv 124,108,84
wl 6
mfv 144,96,88
tra 72,10,32768
tra 74,10,34816
mfv 148,100,88
sad 33,28,61440
buffer_load_dwordx4 a[108:111], v20, s[16:19], s33 offen sc1
mfv 152,104,88
mfv 156,108,88
wl 6
mfv 176,96,92
tra 76,11,32768
tra 78,11,34816
mfv 180,100,92
sad 33,28,1024
buffer_load_dwordx4 a[112:115], v20, s[16:19], s33 offen sc1
mfv 184,104,92
mfv 188,108,92
wl 6
mfv 80,128,64
tra 80,8,36864
tra 82,8,38912
mfv 84,132,64
sad 33,28,21504
buffer_load_dwordx4 a[116:119], v20, s[16:19], s33 offen sc1
mfv 88,136,64
mfv 92,140,64
wl 6
mfv 112,128,68
tra 84,9,36864
tra 86,9,38912
mfv 116,132,68
sad 33,28,41984
buffer_load_dwordx4 a[120:123], v20, s[16:19], s33 offen sc1
mfv 120,136,68
mfv 124,140,68
wl 6
mfv 144,128,72
tra 88,10,36864
tra 90,10,38912
mfv 148,132,72
sad 33,28,62464
buffer_load_dwordx4 a[124:127], v20, s[16:19], s33 offen sc1
mfv 152,136,72
cvp 208,208,209
cvp 209,210,211
mfv 156,140,72
cvp 210,212,213
cvp 211,214,215
wl 6
mfv 176,128,76
tra 92,11,36864
tra 94,11,38912
mfv 180,132,76
sad 32,47,655360
buffer_store_dwordx4 v[208:211], v21, s[20:23], s32 offen sc1
mfv 184,136,76
cvp 216,216,217
cvp 217,218,219
mfv 188,140,76
cvp 218,220,221
cvp 219,222,223
wl 6
mfv 80,160,80
tra 64,8,40960
tra 66,8,43008
mfv 84,164,80
sad 32,47,1966080
buffer_store_dwordx4 v[216:219], v21, s[20:23], s32 offen sc1
mfv 88,168,80
cvp 240,240,241
cvp 241,242,243
mfv 92,172,80
cvp 242,244,245
cvp 243,246,247
wl 6
mfv 112,160,84
tra 68,9,40960
tra 70,9,43008
mfv 116,164,84
sad 32,47,688128
buffer_store_dwordx4 v[240:243], v21, s[20:23], s32 offen sc1
mfv 120,168,84
cvp 248,248,249
cvp 249,250,251
mfv 124,172,84
cvp 250,252,253
cvp 251,254,255
wl 6
mfv 144,160,88
tra 72,10,40960
tra 74,10,43008
mfv 148,164,88
sad 32,47,1998848
buffer_store_dwordx4 v[248:251], v21, s[20:23], s32 offen sc1
mfv 152,168,88
cvp 32,32,33
cvp 33,34,35
mfv 156,172,88
cvp 34,36,37
cvp 35,38,39
wl 6
mfv 176,160,92
tra 76,11,40960
tra 78,11,43008
mfv 180,164,92
sad 32,47,720896
buffer_store_dwordx4 v[32:35], v21, s[20:23], s32 offen sc1
mfv 184,168,92
cvp 40,40,41
cvp 41,42,43
mfv 188,172,92
cvp 42,44,45
cvp 43,46,47
wl 6
mfv 80,192,64
tra 80,8,45056
tra 82,8,47104
mfv 84,196,64
sad 32,47,2031616
buffer_store_dwordx4 v[40:43], v21, s[20:23], s32 offen sc1
mfv 88,200,64
cvp 48,48,49
cvp 49,50,51
mfv 92,204,64
cvp 50,52,53
cvp 51,54,55
wl 6
mfv 112,192,68
tra 84,9,45056
tra 86,9,47104
mfv 116,196,68
sad 32,47,753664
buffer_store_dwordx4 v[48:51], v21, s[20:23], s32 offen sc1
mfv 120,200,68
cvp 56,56,57
cvp 57,58,59
mfv 124,204,68
cvp 58,60,61
cvp 59,62,63
wl 6
mfv 144,192,72
tra 88,10,45056
tra 90,10,47104
mfv 148,196,72
sad 32,47,2064384
buffer_store_dwordx4 v[56:59], v21, s[20:23], s32 offen sc1
mfv 152,200,72
mfv 156,204,72
wl 6
mfv 176,192,76
tra 92,11,45056
tra 94,11,47104
mfv 180,196,76
mfv 184,200,76
mfv 188,204,76
s_waitcnt vmcnt(58) lgkmcnt(0)
s_barrier
mfv 80,224,80
tra 64,8,49152
tra 66,8,51200
mfv 84,228,80
s_mul_i32 s34, s60, 1
s_add_u32 s34, s34, s24
s_add_u32 m0, s29, 24576
s_nop 0
buffer_load_dwordx4 v6, s[8:11], s34 offen lds
mfv 88,232,80
mfv 92,236,80
mfv 112,224,84
tra 68,9,49152
tra 70,9,51200
mfv 116,228,84
s_add_u32 m0, s29, 25600
s_nop 0
buffer_load_dwordx4 v7, s[8:11], s34 offen lds
mfv 120,232,84
mfv 124,236,84
mfv 144,224,88
tra 72,10,49152
tra 74,10,51200
mfv 148,228,88
s_mul_i32 s34, s60, 1
s_add_u32 s34, s34, s25
s_add_u32 m0, s29, 32768
s_nop 0
buffer_load_dwordx4 v6, s[52:55], s34 offen lds
mfv 152,232,88
mfv 156,236,88
mfv 176,224,92
tra 76,11,49152
tra 78,11,51200
mfv 180,228,92
s_add_u32 m0, s29, 33792
s_nop 0
buffer_load_dwordx4 v7, s[52:55], s34 offen lds
mfv 184,232,92
mfv 188,236,92
s_nop 1
wl 6
mfw 208,64,64
tra 80,8,53248
tra 82,8,55296
mfw 212,68,64
s_mul_i32 s34, s60, 1
s_add_u32 s34, s34, s26
s_add_u32 m0, s29, 40960
s_nop 0
buffer_load_dwordx4 v6, s[56:59], s34 offen lds
mfw 216,72,64
mfw 220,76,64
wl 6
mfw 240,64,68
tra 84,9,53248
tra 86,9,55296
mfw 244,68,68
s_add_u32 m0, s29, 41984
s_nop 0
buffer_load_dwordx4 v7, s[56:59], s34 offen lds
mfw 248,72,68
mfw 252,76,68
wl 6
mfw 32,64,72
tra 88,10,53248
tra 90,10,55296
mfw 36,68,72
sad 33,28,2048
buffer_load_dwordx4 a[128:131], v20, s[16:19], s33 offen sc1
mfw 40,72,72
mfw 44,76,72
wl 6
mfw 48,64,76
tra 92,11,53248
tra 94,11,55296
mfw 52,68,76
sad 33,28,22528
buffer_load_dwordx4 a[132:135], v20, s[16:19], s33 offen sc1
mfw 56,72,76
mfw 60,76,76
wl 6
mfv 208,96,80
tra 64,8,57344
tra 66,8,59392
mfv 212,100,80
sad 33,28,43008
buffer_load_dwordx4 a[136:139], v20, s[16:19], s33 offen sc1
mfv 216,104,80
mfv 220,108,80
wl 6
mfv 240,96,84
tra 68,9,57344
tra 70,9,59392
mfv 244,100,84
sad 33,28,63488
buffer_load_dwordx4 a[140:143], v20, s[16:19], s33 offen sc1
mfv 248,104,84
mfv 252,108,84
wl 6
mfv 32,96,88
tra 72,10,57344
tra 74,10,59392
mfv 36,100,88
sad 33,28,3072
buffer_load_dwordx4 a[144:147], v20, s[16:19], s33 offen sc1
mfv 40,104,88
mfv 44,108,88
wl 6
mfv 48,96,92
tra 76,11,57344
tra 78,11,59392
mfv 52,100,92
sad 33,28,23552
buffer_load_dwordx4 a[148:151], v20, s[16:19], s33 offen sc1
mfv 56,104,92
mfv 60,108,92
wl 6
mfv 208,128,64
tra 80,8,61440
tra 82,8,63488
mfv 212,132,64
sad 33,28,44032
buffer_load_dwordx4 a[152:155], v20, s[16:19], s33 offen sc1
mfv 216,136,64
mfv 220,140,64
wl 6
mfv 240,128,68
tra 84,9,61440
tra 86,9,63488
mfv 244,132,68
sad 33,28,64512
buffer_load_dwordx4 a[156:159], v20, s[16:19], s33 offen sc1
mfv 248,136,68
cvp 80,80,81
cvp 81,82,83
mfv 252,140,68
cvp 82,84,85
cvp 83,86,87
wl 6
mfv 32,128,72
tra 88,10,61440
tra 90,10,63488
mfv 36,132,72
sad 32,47,786432
buffer_store_dwordx4 v[80:83], v21, s[20:23], s32 offen sc1
mfv 40,136,72
cvp 88,88,89
cvp 89,90,91
mfv 44,140,72
cvp 90,92,93
cvp 91,94,95
wl 6
mfv 48,128,76
tra 92,11,61440
tra 94,11,63488
mfv 52,132,76
sad 32,47,2097152
buffer_store_dwordx4 v[88:91], v21, s[20:23], s32 offen sc1
mfv 56,136,76
cvp 112,112,113
cvp 113,114,115
mfv 60,140,76
cvp 114,116,117
cvp 115,118,119
wl 6
mfv 208,160,80
tra 64,12,16384
tra 66,12,18432
mfv 212,164,80
sad 32,47,819200
buffer_store_dwordx4 v[112:115], v21, s[20:23], s32 offen sc1
mfv 216,168,80
cvp 120,120,121
cvp 121,122,123
mfv 220,172,80
cvp 122,124,125
cvp 123,126,127
wl 6
mfv 240,160,84
tra 68,13,16384
tra 70,13,18432
mfv 244,164,84
sad 32,47,2129920
buffer_store_dwordx4 v[120:123], v21, s[20:23], s32 offen sc1
mfv 248,168,84
cvp 144,144,145
cvp 145,146,147
mfv 252,172,84
cvp 146,148,149
cvp 147,150,151
wl 6
mfv 32,160,88
tra 72,14,16384
tra 74,14,18432
mfv 36,164,88
sad 32,47,851968
buffer_store_dwordx4 v[144:147], v21, s[20:23], s32 offen sc1
mfv 40,168,88
cvp 152,152,153
cvp 153,154,155
mfv 44,172,88
cvp 154,156,157
cvp 155,158,159
wl 6
mfv 48,160,92
tra 76,15,16384
tra 78,15,18432
mfv 52,164,92
sad 32,47,2162688
buffer_store_dwordx4 v[152:155], v21, s[20:23], s32 offen sc1
mfv 56,168,92
cvp 176,176,177
cvp 177,178,179
mfv 60,172,92
cvp 178,180,181
cvp 179,182,183
wl 6
mfv 208,192,64
tra 80,12,20480
tra 82,12,22528
mfv 212,196,64
sad 32,47,884736
buffer_store_dwordx4 v[176:179], v21, s[20:23], s32 offen sc1
mfv 216,200,64
cvp 184,184,185
cvp 185,186,187
mfv 220,204,64
cvp 186,188,189
cvp 187,190,191
wl 6
mfv 240,192,68
tra 84,13,20480
tra 86,13,22528
mfv 244,196,68
sad 32,47,2195456
buffer_store_dwordx4 v[184:187], v21, s[20:23], s32 offen sc1
mfv 248,200,68
mfv 252,204,68
wl 6
mfv 32,192,72
tra 88,14,20480
tra 90,14,22528
mfv 36,196,72
mfv 40,200,72
mfv 44,204,72
wl 6
mfv 48,192,76
tra 92,15,20480
tra 94,15,22528
mfv 52,196,76
mfv 56,200,76
mfv 60,204,76
s_waitcnt vmcnt(63) lgkmcnt(0)
s_barrier
mfv 208,224,80
tra 64,12,24576
tra 66,12,26624
mfv 212,228,80
s_mul_i32 s34, s60, 2
s_add_u32 s34, s34, s24
s_add_u32 m0, s29, 49152
s_nop 0
buffer_load_dwordx4 v6, s[8:11], s34 offen lds
mfv 216,232,80
mfv 220,236,80
mfv 240,224,84
tra 68,13,24576
tra 70,13,26624
mfv 244,228,84
s_add_u32 m0, s29, 50176
s_nop 0
buffer_load_dwordx4 v7, s[8:11], s34 offen lds
mfv 248,232,84
mfv 252,236,84
mfv 32,224,88
tra 72,14,24576
tra 74,14,26624
mfv 36,228,88
s_mul_i32 s34, s60, 2
s_add_u32 s34, s34, s25
s_add_u32 m0, s29, 57344
s_nop 0
buffer_load_dwordx4 v6, s[52:55], s34 offen lds
mfv 40,232,88
mfv 44,236,88
mfv 48,224,92
tra 76,15,24576
tra 78,15,26624
mfv 52,228,92
s_add_u32 m0, s29, 58368
s_nop 0
buffer_load_dwordx4 v7, s[52:55], s34 offen lds
mfv 56,232,92
mfv 60,236,92
s_nop 1
wl 6
mfw 80,64,64
tra 80,12,28672
tra 82,12,30720
mfw 84,68,64
s_mul_i32 s34, s60, 2
s_add_u32 s34, s34, s26
s_add_u32 m0, s29, 65536
s_nop 0
buffer_load_dwordx4 v6, s[56:59], s34 offen lds
mfw 88,72,64
mfw 92,76,64
wl 6
mfw 112,64,68
tra 84,13,28672
tra 86,13,30720
mfw 116,68,68
s_add_u32 m0, s29, 66560
s_nop 0
buffer_load_dwordx4 v7, s[56:59], s34 offen lds
mfw 120,72,68
mfw 124,76,68
wl 6
mfw 144,64,72
tra 88,14,28672
tra 90,14,30720
mfw 148,68,72
sad 33,28,4096
buffer_load_dwordx4 a[160:163], v20, s[16:19], s33 offen sc1
mfw 152,72,72
mfw 156,76,72
wl 6
mfw 176,64,76
tra 92,15,28672
tra 94,15,30720
mfw 180,68,76
sad 33,28,24576
buffer_load_dwordx4 a[164:167], v20, s[16:19], s33 offen sc1
mfw 184,72,76
mfw 188,76,76
wl 6
mfv 80,96,80
tra 64,12,32768
tra 66,12,34816
mfv 84,100,80
sad 33,28,45056
buffer_load_dwordx4 a[168:171], v20, s[16:19], s33 offen sc1
mfv 88,104,80
mfv 92,108,80
wl 6
mfv 112,96,84
tra 68,13,32768
tra 70,13,34816
mfv 116,100,84
sad 33,28,65536
buffer_load_dwordx4 a[172:175], v20, s[16:19], s33 offen sc1
mfv 120,104,84
mfv 124,108,84
wl 6
mfv 144,96,88
tra 72,14,32768
tra 74,14,34816
mfv 148,100,88
sad 33,28,5120
buffer_load_dwordx4 a[176:179], v20, s[16:19], s33 offen sc1
mfv 152,104,88
mfv 156,108,88
wl 6
mfv 176,96,92
tra 76,15,32768
tra 78,15,34816
mfv 180,100,92
sad 33,28,25600
buffer_load_dwordx4 a[180:183], v20, s[16:19], s33 offen sc1
mfv 184,104,92
mfv 188,108,92
wl 6
mfv 80,128,64
tra 80,12,36864
tra 82,12,38912
mfv 84,132,64
sad 33,28,46080
buffer_load_dwordx4 a[184:187], v20, s[16:19], s33 offen sc1
mfv 88,136,64
mfv 92,140,64
wl 6
mfv 112,128,68
tra 84,13,36864
tra 86,13,38912
mfv 116,132,68
sad 33,28,66560
buffer_load_dwordx4 a[188:191], v20, s[16:19], s33 offen sc1
mfv 120,136,68
cvp 208,208,209
cvp 209,210,211
mfv 124,140,68
cvp 210,212,213
cvp 211,214,215
wl 6
mfv 144,128,72
tra 88,14,36864
tra 90,14,38912
mfv 148,132,72
sad 32,47,917504
buffer_store_dwordx4 v[208:211], v21, s[20:23], s32 offen sc1
mfv 152,136,72
cvp 216,216,217
cvp 217,218,219
mfv 156,140,72
cvp 218,220,221
cvp 219,222,223
wl 6
mfv 176,128,76
tra 92,15,36864
tra 94,15,38912
mfv 180,132,76
sad 32,47,2228224
buffer_store_dwordx4 v[216:219], v21, s[20:23], s32 offen sc1
mfv 184,136,76
cvp 240,240,241
cvp 241,242,243
mfv 188,140,76
cvp 242,244,245
cvp 243,246,247
wl 6
mfv 80,160,80
tra 64,12,40960
tra 66,12,43008
mfv 84,164,80
sad 32,47,950272
buffer_store_dwordx4 v[240:243], v21, s[20:23], s32 offen sc1
mfv 88,168,80
cvp 248,248,249
cvp 249,250,251
mfv 92,172,80
cvp 250,252,253
cvp 251,254,255
wl 6
mfv 112,160,84
tra 68,13,40960
tra 70,13,43008
mfv 116,164,84
sad 32,47,2260992
buffer_store_dwordx4 v[248:251], v21, s[20:23], s32 offen sc1
mfv 120,168,84
cvp 32,32,33
cvp 33,34,35
mfv 124,172,84
cvp 34,36,37
cvp 35,38,39
wl 6
mfv 144,160,88
tra 72,14,40960
tra 74,14,43008
mfv 148,164,88
sad 32,47,983040
buffer_store_dwordx4 v[32:35], v21, s[20:23], s32 offen sc1
mfv 152,168,88
cvp 40,40,41
cvp 41,42,43
mfv 156,172,88
cvp 42,44,45
cvp 43,46,47
wl 6
mfv 176,160,92
tra 76,15,40960
tra 78,15,43008
mfv 180,164,92
sad 32,47,2293760
buffer_store_dwordx4 v[40:43], v21, s[20:23], s32 offen sc1
mfv 184,168,92
cvp 48,48,49
cvp 49,50,51
mfv 188,172,92
cvp 50,52,53
cvp 51,54,55
wl 6
mfv 80,192,64
tra 80,12,45056
tra 82,12,47104
mfv 84,196,64
sad 32,47,1015808
buffer_store_dwordx4 v[48:51], v21, s[20:23], s32 offen sc1
mfv 88,200,64
cvp 56,56,57
cvp 57,58,59
mfv 92,204,64
cvp 58,60,61
cvp 59,62,63
wl 6
mfv 112,192,68
tra 84,13,45056
tra 86,13,47104
mfv 116,196,68
sad 32,47,2326528
buffer_store_dwordx4 v[56:59], v21, s[20:23], s32 offen sc1
mfv 120,200,68
mfv 124,204,68
wl 6
mfv 144,192,72
tra 88,14,45056
tra 90,14,47104
mfv 148,196,72
mfv 152,200,72
mfv 156,204,72
wl 6
mfv 176,192,76
tra 92,15,45056
tra 94,15,47104
mfv 180,196,76
mfv 184,200,76
mfv 188,204,76
s_waitcnt vmcnt(63) lgkmcnt(0)
s_barrier
mfv 80,224,80
tra 64,12,49152
tra 66,12,51200
mfv 84,228,80
s_mul_i32 s34, s60, 3
s_add_u32 s34, s34, s24
s_add_u32 m0, s29, 73728
s_nop 0
buffer_load_dwordx4 v6, s[8:11], s34 offen lds
mfv 88,232,80
mfv 92,236,80
mfv 112,224,84
tra 68,13,49152
tra 70,13,51200
mfv 116,228,84
s_add_u32 m0, s29, 74752
s_nop 0
buffer_load_dwordx4 v7, s[8:11], s34 offen lds
mfv 120,232,84
mfv 124,236,84
mfv 144,224,88
tra 72,14,49152
tra 74,14,51200
mfv 148,228,88
s_mul_i32 s34, s60, 3
s_add_u32 s34, s34, s25
s_add_u32 m0, s29, 81920
s_nop 0
buffer_load_dwordx4 v6, s[52:55], s34 offen lds
mfv 152,232,88
mfv 156,236,88
mfv 176,224,92
tra 76,15,49152
tra 78,15,51200
mfv 180,228,92
s_add_u32 m0, s29, 82944
s_nop 0
buffer_load_dwordx4 v7, s[52:55], s34 offen lds
mfv 184,232,92
mfv 188,236,92
s_nop 1
wl 6
mfw 208,64,64
tra 80,12,53248
tra 82,12,55296
mfw 212,68,64
s_mul_i32 s34, s60, 3
s_add_u32 s34, s34, s26
s_add_u32 m0, s29, 90112
s_nop 0
buffer_load_dwordx4 v6, s[56:59], s34 offen lds
mfw 216,72,64
mfw 220,76,64
wl 6
mfw 240,64,68
tra 84,13,53248
tra 86,13,55296
mfw 244,68,68
s_add_u32 m0, s29, 91136
s_nop 0
buffer_load_dwordx4 v7, s[56:59], s34 offen lds
mfw 248,72,68
mfw 252,76,68
wl 6
mfw 32,64,72
tra 88,14,53248
tra 90,14,55296
mfw 36,68,72
sad 33,28,6144
buffer_load_dwordx4 a[192:195], v20, s[16:19], s33 offen sc1
mfw 40,72,72
mfw 44,76,72
wl 6
mfw 48,64,76
tra 92,15,53248
tra 94,15,55296
mfw 52,68,76
sad 33,28,26624
buffer_load_dwordx4 a[196:199], v20, s[16:19], s33 offen sc1
mfw 56,72,76
mfw 60,76,76
wl 6
mfv 208,96,80
tra 64,12,57344
tra 66,12,59392
mfv 212,100,80
sad 33,28,47104
buffer_load_dwordx4 a[200:203], v20, s[16:19], s33 offen sc1
mfv 216,104,80
mfv 220,108,80
wl 6
mfv 240,96,84
tra 68,13,57344
tra 70,13,59392
mfv 244,100,84
sad 33,28,67584
buffer_load_dwordx4 a[204:207], v20, s[16:19], s33 offen sc1
mfv 248,104,84
mfv 252,108,84
wl 6
mfv 32,96,88
tra 72,14,57344
tra 74,14,59392
mfv 36,100,88
sad 33,28,7168
buffer_load_dwordx4 a[208:211], v20, s[16:19], s33 offen sc1
mfv 40,104,88
mfv 44,108,88
wl 6
mfv 48,96,92
tra 76,15,57344
tra 78,15,59392
mfv 52,100,92
sad 33,28,27648
buffer_load_dwordx4 a[212:215], v20, s[16:19], s33 offen sc1
mfv 56,104,92
mfv 60,108,92
wl 6
mfv 208,128,64
tra 80,12,61440
tra 82,12,63488
mfv 212,132,64
sad 33,28,48128
buffer_load_dwordx4 a[216:219], v20, s[16:19], s33 offen sc1
mfv 216,136,64
mfv 220,140,64
wl 6
mfv 240,128,68
tra 84,13,61440
tra 86,13,63488
mfv 244,132,68
sad 33,28,68608
buffer_load_dwordx4 a[220:223], v20, s[16:19], s33 offen sc1
mfv 248,136,68
cvp 80,80,81
cvp 81,82,83
mfv 252,140,68
cvp 82,84,85
cvp 83,86,87
wl 6
mfv 32,128,72
tra 88,14,61440
tra 90,14,63488
mfv 36,132,72
sad 32,47,1048576
buffer_store_dwordx4 v[80:83], v21, s[20:23], s32 offen sc1
mfv 40,136,72
cvp 88,88,89
cvp 89,90,91
mfv 44,140,72
cvp 90,92,93
cvp 91,94,95
wl 6
mfv 48,128,76
tra 92,15,61440
tra 94,15,63488
mfv 52,132,76
sad 32,47,2359296
buffer_store_dwordx4 v[88:91], v21, s[20:23], s32 offen sc1
mfv 56,136,76
cvp 112,112,113
cvp 113,114,115
mfv 60,140,76
cvp 114,116,117
cvp 115,118,119
wl 6
mfv 208,160,80
tra 64,24,16384
tra 66,24,18432
mfv 212,164,80
sad 32,47,1081344
buffer_store_dwordx4 v[112:115], v21, s[20:23], s32 offen sc1
mfv 216,168,80
cvp 120,120,121
cvp 121,122,123
mfv 220,172,80
cvp 122,124,125
cvp 123,126,127
wl 6
mfv 240,160,84
tra 68,25,16384
tra 70,25,18432
mfv 244,164,84
sad 32,47,2392064
buffer_store_dwordx4 v[120:123], v21, s[20:23], s32 offen sc1
mfv 248,168,84
cvp 144,144,145
cvp 145,146,147
mfv 252,172,84
cvp 146,148,149
cvp 147,150,151
wl 6
mfv 32,160,88
tra 72,26,16384
tra 74,26,18432
mfv 36,164,88
sad 32,47,1114112
buffer_store_dwordx4 v[144:147], v21, s[20:23], s32 offen sc1
mfv 40,168,88
cvp 152,152,153
cvp 153,154,155
mfv 44,172,88
cvp 154,156,157
cvp 155,158,159
wl 6
mfv 48,160,92
tra 76,27,16384
tra 78,27,18432
mfv 52,164,92
sad 32,47,2424832
buffer_store_dwordx4 v[152:155], v21, s[20:23], s32 offen sc1
mfv 56,168,92
cvp 176,176,177
cvp 177,178,179
mfv 60,172,92
cvp 178,180,181
cvp 179,182,183
wl 6
mfv 208,192,64
tra 80,24,20480
tra 82,24,22528
mfv 212,196,64
sad 32,47,1146880
buffer_store_dwordx4 v[176:179], v21, s[20:23], s32 offen sc1
mfv 216,200,64
cvp 184,184,185
cvp 185,186,187
mfv 220,204,64
cvp 186,188,189
cvp 187,190,191
wl 6
mfv 240,192,68
tra 84,25,20480
tra 86,25,22528
mfv 244,196,68
sad 32,47,2457600
buffer_store_dwordx4 v[184:187], v21, s[20:23], s32 offen sc1
mfv 248,200,68
mfv 252,204,68
wl 6
mfv 32,192,72
tra 88,26,20480
tra 90,26,22528
mfv 36,196,72
mfv 40,200,72
mfv 44,204,72
wl 6
mfv 48,192,76
tra 92,27,20480
tra 94,27,22528
mfv 52,196,76
mfv 56,200,76
mfv 60,204,76
wl 6
mfv 208,224,80
mfv 212,228,80
mfv 216,232,80
mfv 220,236,80
wl 4
mfv 240,224,84
mfv 244,228,84
mfv 248,232,84
mfv 252,236,84
wl 2
mfv 32,224,88
mfv 36,228,88
mfv 40,232,88
mfv 44,236,88
wl 0
mfv 48,224,92
mfv 52,228,92
mfv 56,232,92
mfv 60,236,92
s_nop 1
wv 60
wv 52
s_nop 7
cvp 208,208,209
cvp 209,210,211
cvp 210,212,213
cvp 211,214,215
sad 32,47,1179648
buffer_store_dwordx4 v[208:211], v21, s[20:23], s32 offen sc1
cvp 216,216,217
cvp 217,218,219
cvp 218,220,221
cvp 219,222,223
sad 32,47,2490368
buffer_store_dwordx4 v[216:219], v21, s[20:23], s32 offen sc1
cvp 240,240,241
cvp 241,242,243
cvp 242,244,245
cvp 243,246,247
sad 32,47,1212416
buffer_store_dwordx4 v[240:243], v21, s[20:23], s32 offen sc1
cvp 248,248,249
cvp 249,250,251
cvp 250,252,253
cvp 251,254,255
sad 32,47,2523136
buffer_store_dwordx4 v[248:251], v21, s[20:23], s32 offen sc1
cvp 32,32,33
cvp 33,34,35
cvp 34,36,37
cvp 35,38,39
sad 32,47,1245184
buffer_store_dwordx4 v[32:35], v21, s[20:23], s32 offen sc1
cvp 40,40,41
cvp 41,42,43
cvp 42,44,45
cvp 43,46,47
sad 32,47,2555904
buffer_store_dwordx4 v[40:43], v21, s[20:23], s32 offen sc1
cvp 48,48,49
cvp 49,50,51
cvp 50,52,53
cvp 51,54,55
sad 32,47,1277952
buffer_store_dwordx4 v[48:51], v21, s[20:23], s32 offen sc1
cvp 56,56,57
cvp 57,58,59
cvp 58,60,61
cvp 59,62,63
sad 32,47,2588672
buffer_store_dwordx4 v[56:59], v21, s[20:23], s32 offen sc1
s_getpc_b64 s[50:51]
L_h_155:
s_add_u32 s50, s50, L_wk_done-L_h_155
s_addc_u32 s51, s51, -1
s_setpc_b64 s[50:51]
.p2align 6
L_main_qk:
s_mov_b32 s18, 2621440
s_bitcmp1_b32 s3, 5
s_mov_b32 s44, 100663296
s_cselect_b32 s44, 67108864, s44
s_add_u32 s20, s36, s44
s_addc_u32 s21, s37, 0
s_and_b32 s21, s21, 0xffff
s_mov_b32 s22, 25165824
s_mov_b32 s23, 0x00020000
s_and_b32 s45, s3, 31
s_lshr_b32 s46, s3, 6
s_lshl_b32 s46, s46, 2
s_add_u32 s46, s46, s4
s_mul_i32 s46, s46, 4
v_lshlrev_b32 v21, 3, v1
s_mul_i32 s47, s45, 12288
sad 32,46,0
s_lshr_b32 s33, s32, 1
s_mul_i32 s33, s33, 393216
s_and_b32 s32, s32, 1
s_mul_i32 s32, s32, 1536
s_add_u32 s33, s33, s32
s_add_u32 s61, s33, s47
sad 32,46,1
s_lshr_b32 s33, s32, 1
s_mul_i32 s33, s33, 393216
s_and_b32 s32, s32, 1
s_mul_i32 s32, s32, 1536
s_add_u32 s33, s33, s32
s_add_u32 s62, s33, s47
sad 32,46,2
s_lshr_b32 s33, s32, 1
s_mul_i32 s33, s33, 393216
s_and_b32 s32, s32, 1
s_mul_i32 s32, s32, 1536
s_add_u32 s33, s33, s32
s_add_u32 s63, s33, s47
sad 32,46,3
s_lshr_b32 s33, s32, 1
s_mul_i32 s33, s33, 393216
s_and_b32 s32, s32, 1
s_mul_i32 s32, s32, 1536
s_add_u32 s33, s33, s32
s_add_u32 s64, s33, s47
s_barrier
tra 64,8,0
tra 66,8,2048
tra 68,9,0
tra 70,9,2048
tra 72,10,0
tra 74,10,2048
tra 76,11,0
tra 78,11,2048
wl 6
mfz 64,64,96
tra 80,8,8192
tra 82,8,10240
mfz 68,64,100
sad 34,24,3145728
s_add_u32 m0, s29, 98304
s_nop 0
buffer_load_dwordx4 v6, s[8:11], s34 offen lds
mfz 72,64,104
mfz 76,64,108
wl 6
mfz 80,68,96
tra 84,9,8192
tra 86,9,10240
mfz 84,68,100
mfz 88,68,104
mfz 92,68,108
s_add_u32 m0, s29, 99328
s_nop 0
buffer_load_dwordx4 v7, s[8:11], s34 offen lds
wl 6
mfz 96,72,96
tra 88,10,8192
tra 90,10,10240
mfz 100,72,100
mfz 104,72,104
mfz 108,72,108
wl 6
mfz 112,76,96
tra 92,11,8192
tra 94,11,10240
mfz 116,76,100
mfz 120,76,104
sad 34,25,3145728
s_add_u32 m0, s29, 106496
s_nop 0
buffer_load_dwordx4 v6, s[52:55], s34 offen lds
mfz 124,76,108
wl 6
mfz 128,80,96
tra 64,8,16384
tra 66,8,18432
mfz 132,80,100
mfz 136,80,104
mfz 140,80,108
wl 6
mfz 144,84,96
tra 68,9,16384
tra 70,9,18432
mfz 148,84,100
s_add_u32 m0, s29, 107520
s_nop 0
buffer_load_dwordx4 v7, s[52:55], s34 offen lds
mfz 152,84,104
mfz 156,84,108
wl 6
mfz 160,88,96
tra 72,10,16384
tra 74,10,18432
mfz 164,88,100
mfz 168,88,104
mfz 172,88,108
sad 34,26,3145728
s_add_u32 m0, s29, 114688
s_nop 0
buffer_load_dwordx4 v6, s[56:59], s34 offen lds
wl 6
mfz 176,92,96
tra 76,11,16384
tra 78,11,18432
mfz 180,92,100
mfz 184,92,104
mfz 188,92,108
wl 6
mfz 192,64,96
tra 80,8,4096
tra 82,8,6144
mfz 196,64,100
mfz 200,64,104
s_add_u32 m0, s29, 115712
s_nop 0
buffer_load_dwordx4 v7, s[56:59], s34 offen lds
mfz 204,64,108
wl 6
mfz 208,68,96
tra 84,9,4096
tra 86,9,6144
mfz 212,68,100
mfz 216,68,104
mfz 220,68,108
wl 6
mfz 224,72,96
tra 88,10,4096
tra 90,10,6144
mfz 228,72,100
sad 33,28,8192
buffer_load_dwordx4 a[224:227], v20, s[16:19], s33 offen sc1
mfz 232,72,104
mfz 236,72,108
wl 6
mfz 240,76,96
tra 92,11,4096
tra 94,11,6144
mfz 244,76,100
mfz 248,76,104
mfz 252,76,108
sad 33,28,28672
buffer_load_dwordx4 a[228:231], v20, s[16:19], s33 offen sc1
wl 6
mfa 64,80,112
tra 64,8,12288
tra 66,8,14336
mfa 68,80,116
mfa 72,80,120
mfa 76,80,124
wl 6
mfa 80,84,112
tra 68,9,12288
tra 70,9,14336
mfa 84,84,116
mfa 88,84,120
sad 33,28,49152
buffer_load_dwordx4 a[232:235], v20, s[16:19], s33 offen sc1
mfa 92,84,124
wl 6
mfa 96,88,112
tra 72,10,12288
tra 74,10,14336
mfa 100,88,116
mfa 104,88,120
mfa 108,88,124
wl 6
mfa 112,92,112
tra 76,11,12288
tra 78,11,14336
mfa 116,92,116
sad 33,28,69632
buffer_load_dwordx4 a[236:239], v20, s[16:19], s33 offen sc1
mfa 120,92,120
mfa 124,92,124
wl 6
mfa 128,64,112
tra 80,8,20480
tra 82,8,22528
mfa 132,64,116
mfa 136,64,120
mfa 140,64,124
sad 33,28,9216
buffer_load_dwordx4 a[240:243], v20, s[16:19], s33 offen sc1
wl 6
mfa 144,68,112
tra 84,9,20480
tra 86,9,22528
mfa 148,68,116
mfa 152,68,120
mfa 156,68,124
wl 6
mfa 160,72,112
tra 88,10,20480
tra 90,10,22528
mfa 164,72,116
mfa 168,72,120
sad 33,28,29696
buffer_load_dwordx4 a[244:247], v20, s[16:19], s33 offen sc1
mfa 172,72,124
wl 6
mfa 176,76,112
tra 92,11,20480
tra 94,11,22528
mfa 180,76,116
mfa 184,76,120
mfa 188,76,124
wl 0
s_barrier
mfa 192,80,112
tra 64,8,24576
tra 66,8,26624
mfa 196,80,116
sad 33,28,50176
buffer_load_dwordx4 a[248:251], v20, s[16:19], s33 offen sc1
mfa 200,80,120
mfa 204,80,124
mfa 208,84,112
tra 68,9,24576
tra 70,9,26624
mfa 212,84,116
mfa 216,84,120
mfa 220,84,124
sad 33,28,70656
buffer_load_dwordx4 a[252:255], v20, s[16:19], s33 offen sc1
mfa 224,88,112
tra 72,10,24576
tra 74,10,26624
mfa 228,88,116
mfa 232,88,120
mfa 236,88,124
mfa 240,92,112
tra 76,11,24576
tra 78,11,26624
mfa 244,92,116
mfa 248,92,120
sad 34,24,3932160
s_add_u32 m0, s29, 0
s_nop 0
buffer_load_dwordx4 v6, s[8:11], s34 offen lds
mfa 252,92,124
wl 6
mfa 64,64,128
tra 80,8,32768
tra 82,8,34816
mfa 68,64,132
mfa 72,64,136
mfa 76,64,140
wl 6
mfa 80,68,128
tra 84,9,32768
tra 86,9,34816
mfa 84,68,132
s_add_u32 m0, s29, 1024
s_nop 0
buffer_load_dwordx4 v7, s[8:11], s34 offen lds
mfa 88,68,136
mfa 92,68,140
wl 6
mfa 96,72,128
tra 88,10,32768
tra 90,10,34816
mfa 100,72,132
mfa 104,72,136
mfa 108,72,140
sad 34,25,3932160
s_add_u32 m0, s29, 8192
s_nop 0
buffer_load_dwordx4 v6, s[52:55], s34 offen lds
wl 6
mfa 112,76,128
tra 92,11,32768
tra 94,11,34816
mfa 116,76,132
mfa 120,76,136
mfa 124,76,140
wl 6
mfa 128,80,128
tra 64,8,40960
tra 66,8,43008
mfa 132,80,132
mfa 136,80,136
s_add_u32 m0, s29, 9216
s_nop 0
buffer_load_dwordx4 v7, s[52:55], s34 offen lds
mfa 140,80,140
wl 6
mfa 144,84,128
tra 68,9,40960
tra 70,9,43008
mfa 148,84,132
mfa 152,84,136
mfa 156,84,140
wl 6
mfa 160,88,128
tra 72,10,40960
tra 74,10,43008
mfa 164,88,132
sad 34,26,3932160
s_add_u32 m0, s29, 16384
s_nop 0
buffer_load_dwordx4 v6, s[56:59], s34 offen lds
mfa 168,88,136
mfa 172,88,140
wl 6
mfa 176,92,128
tra 76,11,40960
tra 78,11,43008
mfa 180,92,132
mfa 184,92,136
mfa 188,92,140
s_add_u32 m0, s29, 17408
s_nop 0
buffer_load_dwordx4 v7, s[56:59], s34 offen lds
wl 6
mfa 192,64,128
tra 80,8,28672
tra 82,8,30720
mfa 196,64,132
mfa 200,64,136
mfa 204,64,140
wl 6
mfa 208,68,128
tra 84,9,28672
tra 86,9,30720
mfa 212,68,132
mfa 216,68,136
sad 33,28,10240
buffer_load_dwordx4 a[96:99], v20, s[16:19], s33 offen sc1
mfa 220,68,140
wl 6
mfa 224,72,128
tra 88,10,28672
tra 90,10,30720
mfa 228,72,132
mfa 232,72,136
mfa 236,72,140
wl 6
mfa 240,76,128
tra 92,11,28672
tra 94,11,30720
mfa 244,76,132
sad 33,28,30720
buffer_load_dwordx4 a[100:103], v20, s[16:19], s33 offen sc1
mfa 248,76,136
mfa 252,76,140
wl 6
mfa 64,80,144
tra 64,8,36864
tra 66,8,38912
mfa 68,80,148
mfa 72,80,152
mfa 76,80,156
sad 33,28,51200
buffer_load_dwordx4 a[104:107], v20, s[16:19], s33 offen sc1
wl 6
mfa 80,84,144
tra 68,9,36864
tra 70,9,38912
mfa 84,84,148
mfa 88,84,152
mfa 92,84,156
wl 6
mfa 96,88,144
tra 72,10,36864
tra 74,10,38912
mfa 100,88,148
mfa 104,88,152
sad 33,28,71680
buffer_load_dwordx4 a[108:111], v20, s[16:19], s33 offen sc1
mfa 108,88,156
wl 6
mfa 112,92,144
tra 76,11,36864
tra 78,11,38912
mfa 116,92,148
mfa 120,92,152
mfa 124,92,156
wl 6
mfa 128,64,144
tra 80,8,45056
tra 82,8,47104
mfa 132,64,148
sad 33,28,11264
buffer_load_dwordx4 a[112:115], v20, s[16:19], s33 offen sc1
mfa 136,64,152
mfa 140,64,156
wl 6
mfa 144,68,144
tra 84,9,45056
tra 86,9,47104
mfa 148,68,148
mfa 152,68,152
mfa 156,68,156
sad 33,28,31744
buffer_load_dwordx4 a[116:119], v20, s[16:19], s33 offen sc1
wl 6
mfa 160,72,144
tra 88,10,45056
tra 90,10,47104
mfa 164,72,148
mfa 168,72,152
mfa 172,72,156
wl 6
mfa 176,76,144
tra 92,11,45056
tra 94,11,47104
mfa 180,76,148
mfa 184,76,152
sad 33,28,52224
buffer_load_dwordx4 a[120:123], v20, s[16:19], s33 offen sc1
mfa 188,76,156
s_waitcnt vmcnt(27) lgkmcnt(0)
s_barrier
s_cmp_lt_i32 s70, 0
s_cbranch_scc1 L_pp_156
s_cmp_lg_u32 s4, 1
s_cbranch_scc1 L_pp_156
s_lshl_b32 s83, s70, 7
v_and_b32 v2, 1, v1
v_cmp_eq_u32 vcc, 1, v2
v_mov_b32 v2, s100
v_mov_b32 v3, s101
v_cndmask_b32 v3, v2, v3, vcc
v_and_b32 v2, 31, v1
v_lshlrev_b32 v2, 2, v2
buffer_store_dword v3, v2, s[88:91], s83 offen sc1
L_pp_156:
s_mov_b32 s70, -1
mfa 192,80,144
tra 64,8,49152
tra 66,8,51200
mfa 196,80,148
mfa 200,80,152
mfa 204,80,156
mfa 208,84,144
tra 68,9,49152
tra 70,9,51200
mfa 212,84,148
sad 33,28,72704
buffer_load_dwordx4 a[124:127], v20, s[16:19], s33 offen sc1
mfa 216,84,152
mfa 220,84,156
mfa 224,88,144
tra 72,10,49152
tra 74,10,51200
mfa 228,88,148
mfa 232,88,152
mfa 236,88,156
sad 34,24,4718592
s_add_u32 m0, s29, 24576
s_nop 0
buffer_load_dwordx4 v6, s[8:11], s34 offen lds
mfa 240,92,144
tra 76,11,49152
tra 78,11,51200
mfa 244,92,148
mfa 248,92,152
mfa 252,92,156
wl 6
mfa 64,64,160
tra 80,8,57344
tra 82,8,59392
mfa 68,64,164
mfa 72,64,168
s_add_u32 m0, s29, 25600
s_nop 0
buffer_load_dwordx4 v7, s[8:11], s34 offen lds
mfa 76,64,172
wl 6
mfa 80,68,160
tra 84,9,57344
tra 86,9,59392
mfa 84,68,164
mfa 88,68,168
mfa 92,68,172
wl 6
mfa 96,72,160
tra 88,10,57344
tra 90,10,59392
mfa 100,72,164
sad 34,25,4718592
s_add_u32 m0, s29, 32768
s_nop 0
buffer_load_dwordx4 v6, s[52:55], s34 offen lds
mfa 104,72,168
mfa 108,72,172
wl 6
mfa 112,76,160
tra 92,11,57344
tra 94,11,59392
mfa 116,76,164
mfa 120,76,168
mfa 124,76,172
s_add_u32 m0, s29, 33792
s_nop 0
buffer_load_dwordx4 v7, s[52:55], s34 offen lds
wl 6
mfa 128,80,160
tra 64,12,16384
tra 66,12,18432
mfa 132,80,164
mfa 136,80,168
mfa 140,80,172
wl 6
mfa 144,84,160
tra 68,13,16384
tra 70,13,18432
mfa 148,84,164
mfa 152,84,168
sad 34,26,4718592
s_add_u32 m0, s29, 40960
s_nop 0
buffer_load_dwordx4 v6, s[56:59], s34 offen lds
mfa 156,84,172
wl 6
mfa 160,88,160
tra 72,14,16384
tra 74,14,18432
mfa 164,88,164
mfa 168,88,168
mfa 172,88,172
wl 6
mfa 176,92,160
tra 76,15,16384
tra 78,15,18432
mfa 180,92,164
s_add_u32 m0, s29, 41984
s_nop 0
buffer_load_dwordx4 v7, s[56:59], s34 offen lds
mfa 184,92,168
mfa 188,92,172
wl 6
mfa 192,64,160
tra 80,8,53248
tra 82,8,55296
mfa 196,64,164
mfa 200,64,168
mfa 204,64,172
sad 33,28,12288
buffer_load_dwordx4 a[128:131], v20, s[16:19], s33 offen sc1
wl 6
mfa 208,68,160
tra 84,9,53248
tra 86,9,55296
mfa 212,68,164
mfa 216,68,168
mfa 220,68,172
wl 6
mfa 224,72,160
tra 88,10,53248
tra 90,10,55296
mfa 228,72,164
mfa 232,72,168
sad 33,28,32768
buffer_load_dwordx4 a[132:135], v20, s[16:19], s33 offen sc1
mfa 236,72,172
wl 6
mfa 240,76,160
tra 92,11,53248
tra 94,11,55296
mfa 244,76,164
mfa 248,76,168
mfa 252,76,172
wl 6
mfa 64,80,176
tra 64,8,61440
tra 66,8,63488
mfa 68,80,180
sad 33,28,53248
buffer_load_dwordx4 a[136:139], v20, s[16:19], s33 offen sc1
mfa 72,80,184
mfa 76,80,188
wl 6
mfa 80,84,176
tra 68,9,61440
tra 70,9,63488
mfa 84,84,180
mfa 88,84,184
mfa 92,84,188
sad 33,28,73728
buffer_load_dwordx4 a[140:143], v20, s[16:19], s33 offen sc1
wl 6
mfa 96,88,176
tra 72,10,61440
tra 74,10,63488
mfa 100,88,180
mfa 104,88,184
mfa 108,88,188
wl 6
mfa 112,92,176
tra 76,11,61440
tra 78,11,63488
mfa 116,92,180
mfa 120,92,184
sad 33,28,13312
buffer_load_dwordx4 a[144:147], v20, s[16:19], s33 offen sc1
mfa 124,92,188
wl 6
mfa 128,64,176
tra 80,12,20480
tra 82,12,22528
mfa 132,64,180
mfa 136,64,184
mfa 140,64,188
wl 6
mfa 144,68,176
tra 84,13,20480
tra 86,13,22528
mfa 148,68,180
sad 33,28,33792
buffer_load_dwordx4 a[148:151], v20, s[16:19], s33 offen sc1
mfa 152,68,184
mfa 156,68,188
wl 6
mfa 160,72,176
tra 88,14,20480
tra 90,14,22528
mfa 164,72,180
mfa 168,72,184
mfa 172,72,188
sad 33,28,54272
buffer_load_dwordx4 a[152:155], v20, s[16:19], s33 offen sc1
wl 6
mfa 176,76,176
tra 92,15,20480
tra 94,15,22528
mfa 180,76,180
mfa 184,76,184
mfa 188,76,188
wl 0
s_barrier
s_sub_u32 s83, s2, 128
s_lshr_b32 s83, s83, 3
s_mul_i32 s83, s83, 0
sad 83,83,36
s_cmp_eq_u32 s68, 1
s_cselect_b32 s83, 0, s83
s_cmp_ge_u32 s2, 144
s_cbranch_scc1 L_xd_157
s_cmp_lt_u32 s78, s83
s_cbranch_scc1 L_xd_157
v_mov_b32 v18, 0x7fff
s_mov_b32 s77, 7
s_branch L_xe_158
L_xd_157:
s_cmp_lg_u32 s4, 0
s_cbranch_scc1 L_ti_159
s_lshl_b32 s83, s76, 2
v_mov_b32 v18, 1
v_mov_b32 v2, 0
s_mov_b64 exec, 1
buffer_atomic_add v18, v2, s[84:87], s83 offen sc0 sc1
s_mov_b64 exec, -1
L_ti_159:
L_xe_158:
mfa 192,80,176
tra 64,12,24576
tra 66,12,26624
mfa 196,80,180
mfa 200,80,184
sad 33,28,74752
buffer_load_dwordx4 a[156:159], v20, s[16:19], s33 offen sc1
mfa 204,80,188
mfa 208,84,176
tra 68,13,24576
tra 70,13,26624
mfa 212,84,180
mfa 216,84,184
mfa 220,84,188
mfa 224,88,176
tra 72,14,24576
tra 74,14,26624
mfa 228,88,180
sad 34,24,5505024
s_add_u32 m0, s29, 49152
s_nop 0
buffer_load_dwordx4 v6, s[8:11], s34 offen lds
mfa 232,88,184
mfa 236,88,188
mfa 240,92,176
tra 76,15,24576
tra 78,15,26624
mfa 244,92,180
mfa 248,92,184
mfa 252,92,188
s_add_u32 m0, s29, 50176
s_nop 0
buffer_load_dwordx4 v7, s[8:11], s34 offen lds
wl 6
mfa 64,64,192
tra 80,12,32768
tra 82,12,34816
mfa 68,64,196
mfa 72,64,200
mfa 76,64,204
wl 6
mfa 80,68,192
tra 84,13,32768
tra 86,13,34816
mfa 84,68,196
mfa 88,68,200
sad 34,25,5505024
s_add_u32 m0, s29, 57344
s_nop 0
buffer_load_dwordx4 v6, s[52:55], s34 offen lds
mfa 92,68,204
wl 6
mfa 96,72,192
tra 88,14,32768
tra 90,14,34816
mfa 100,72,196
mfa 104,72,200
mfa 108,72,204
wl 6
mfa 112,76,192
tra 92,15,32768
tra 94,15,34816
mfa 116,76,196
s_add_u32 m0, s29, 58368
s_nop 0
buffer_load_dwordx4 v7, s[52:55], s34 offen lds
mfa 120,76,200
mfa 124,76,204
wl 6
mfa 128,80,192
tra 64,12,40960
tra 66,12,43008
mfa 132,80,196
mfa 136,80,200
mfa 140,80,204
sad 34,26,5505024
s_add_u32 m0, s29, 65536
s_nop 0
buffer_load_dwordx4 v6, s[56:59], s34 offen lds
wl 6
mfa 144,84,192
tra 68,13,40960
tra 70,13,43008
mfa 148,84,196
mfa 152,84,200
mfa 156,84,204
wl 6
mfa 160,88,192
tra 72,14,40960
tra 74,14,43008
mfa 164,88,196
mfa 168,88,200
s_add_u32 m0, s29, 66560
s_nop 0
buffer_load_dwordx4 v7, s[56:59], s34 offen lds
mfa 172,88,204
wl 6
mfa 176,92,192
tra 76,15,40960
tra 78,15,43008
mfa 180,92,196
mfa 184,92,200
mfa 188,92,204
wl 6
mfa 192,64,192
tra 80,12,28672
tra 82,12,30720
mfa 196,64,196
sad 33,28,14336
buffer_load_dwordx4 a[160:163], v20, s[16:19], s33 offen sc1
mfa 200,64,200
mfa 204,64,204
wl 6
mfa 208,68,192
tra 84,13,28672
tra 86,13,30720
mfa 212,68,196
mfa 216,68,200
mfa 220,68,204
sad 33,28,34816
buffer_load_dwordx4 a[164:167], v20, s[16:19], s33 offen sc1
wl 6
mfa 224,72,192
tra 88,14,28672
tra 90,14,30720
mfa 228,72,196
mfa 232,72,200
mfa 236,72,204
wl 6
mfa 240,76,192
tra 92,15,28672
tra 94,15,30720
mfa 244,76,196
mfa 248,76,200
sad 33,28,55296
buffer_load_dwordx4 a[168:171], v20, s[16:19], s33 offen sc1
mfa 252,76,204
wl 6
mfa 64,80,208
tra 64,12,36864
tra 66,12,38912
mfa 68,80,212
mfa 72,80,216
mfa 76,80,220
wl 6
mfa 80,84,208
tra 68,13,36864
tra 70,13,38912
mfa 84,84,212
sad 33,28,75776
buffer_load_dwordx4 a[172:175], v20, s[16:19], s33 offen sc1
mfa 88,84,216
mfa 92,84,220
wl 6
mfa 96,88,208
tra 72,14,36864
tra 74,14,38912
mfa 100,88,212
mfa 104,88,216
mfa 108,88,220
sad 33,28,15360
buffer_load_dwordx4 a[176:179], v20, s[16:19], s33 offen sc1
wl 6
mfa 112,92,208
tra 76,15,36864
tra 78,15,38912
mfa 116,92,212
mfa 120,92,216
mfa 124,92,220
wl 6
mfa 128,64,208
tra 80,12,45056
tra 82,12,47104
mfa 132,64,212
mfa 136,64,216
sad 33,28,35840
buffer_load_dwordx4 a[180:183], v20, s[16:19], s33 offen sc1
mfa 140,64,220
wl 6
mfa 144,68,208
tra 84,13,45056
tra 86,13,47104
mfa 148,68,212
mfa 152,68,216
mfa 156,68,220
wl 6
mfa 160,72,208
tra 88,14,45056
tra 90,14,47104
mfa 164,72,212
sad 33,28,56320
buffer_load_dwordx4 a[184:187], v20, s[16:19], s33 offen sc1
mfa 168,72,216
mfa 172,72,220
wl 6
mfa 176,76,208
tra 92,15,45056
tra 94,15,47104
mfa 180,76,212
mfa 184,76,216
mfa 188,76,220
sad 33,28,76800
buffer_load_dwordx4 a[188:191], v20, s[16:19], s33 offen sc1
s_waitcnt vmcnt(50) lgkmcnt(0)
s_barrier
mfa 192,80,208
tra 64,12,49152
tra 66,12,51200
mfa 196,80,212
mfa 200,80,216
mfa 204,80,220
mfa 208,84,208
tra 68,13,49152
tra 70,13,51200
mfa 212,84,212
mfa 216,84,216
sad 34,24,6291456
s_add_u32 m0, s29, 122880
s_nop 0
buffer_load_dwordx4 v6, s[8:11], s34 offen lds
mfa 220,84,220
mfa 224,88,208
tra 72,14,49152
tra 74,14,51200
mfa 228,88,212
mfa 232,88,216
mfa 236,88,220
mfa 240,92,208
tra 76,15,49152
tra 78,15,51200
mfa 244,92,212
s_add_u32 m0, s29, 123904
s_nop 0
buffer_load_dwordx4 v7, s[8:11], s34 offen lds
mfa 248,92,216
mfa 252,92,220
wv 48
wl 6
mfa 64,64,224
tra 80,12,57344
tra 82,12,59392
mfa 68,64,228
mfa 72,64,232
mfa 76,64,236
sad 34,25,6291456
s_add_u32 m0, s29, 131072
s_nop 0
buffer_load_dwordx4 v6, s[52:55], s34 offen lds
wl 6
mfa 80,68,224
tra 84,13,57344
tra 86,13,59392
mfa 84,68,228
mfa 88,68,232
mfa 92,68,236
wl 6
mfa 96,72,224
tra 88,14,57344
tra 90,14,59392
mfa 100,72,228
mfa 104,72,232
s_add_u32 m0, s29, 132096
s_nop 0
buffer_load_dwordx4 v7, s[52:55], s34 offen lds
mfa 108,72,236
wl 6
mfa 112,76,224
tra 92,15,57344
tra 94,15,59392
mfa 116,76,228
mfa 120,76,232
mfa 124,76,236
wl 6
mfa 128,80,224
tra 64,24,16384
tra 66,24,18432
mfa 132,80,228
sad 34,26,6291456
s_add_u32 m0, s29, 139264
s_nop 0
buffer_load_dwordx4 v6, s[56:59], s34 offen lds
mfa 136,80,232
mfa 140,80,236
wl 6
mfa 144,84,224
tra 68,25,16384
tra 70,25,18432
mfa 148,84,228
mfa 152,84,232
mfa 156,84,236
s_add_u32 m0, s29, 140288
s_nop 0
buffer_load_dwordx4 v7, s[56:59], s34 offen lds
wl 6
mfa 160,88,224
tra 72,26,16384
tra 74,26,18432
mfa 164,88,228
mfa 168,88,232
mfa 172,88,236
wl 6
mfa 176,92,224
tra 76,27,16384
tra 78,27,18432
mfa 180,92,228
mfa 184,92,232
sad 33,28,16384
buffer_load_dwordx4 a[0:3], v20, s[16:19], s33 offen sc1
mfa 188,92,236
wl 6
mfa 192,64,224
tra 80,12,53248
tra 82,12,55296
mfa 196,64,228
mfa 200,64,232
mfa 204,64,236
wl 6
mfa 208,68,224
tra 84,13,53248
tra 86,13,55296
mfa 212,68,228
sad 33,28,36864
buffer_load_dwordx4 a[4:7], v20, s[16:19], s33 offen sc1
mfa 216,68,232
mfa 220,68,236
wl 6
mfa 224,72,224
tra 88,14,53248
tra 90,14,55296
mfa 228,72,228
mfa 232,72,232
mfa 236,72,236
sad 33,28,57344
buffer_load_dwordx4 a[8:11], v20, s[16:19], s33 offen sc1
wl 6
mfa 240,76,224
tra 92,15,53248
tra 94,15,55296
mfa 244,76,228
mfa 248,76,232
mfa 252,76,236
wv 51
wl 6
mfa 64,80,240
tra 64,12,61440
tra 66,12,63488
mfa 68,80,244
mfa 72,80,248
sad 33,28,77824
buffer_load_dwordx4 a[12:15], v20, s[16:19], s33 offen sc1
mfa 76,80,252
wl 6
mfa 80,84,240
tra 68,13,61440
tra 70,13,63488
mfa 84,84,244
mfa 88,84,248
mfa 92,84,252
wl 6
mfa 96,88,240
tra 72,14,61440
tra 74,14,63488
mfa 100,88,244
sad 33,28,17408
buffer_load_dwordx4 a[16:19], v20, s[16:19], s33 offen sc1
mfa 104,88,248
mfa 108,88,252
wl 6
mfa 112,92,240
tra 76,15,61440
tra 78,15,63488
mfa 116,92,244
mfa 120,92,248
mfa 124,92,252
sad 33,28,37888
buffer_load_dwordx4 a[20:23], v20, s[16:19], s33 offen sc1
wl 6
mfa 128,64,240
tra 80,24,20480
tra 82,24,22528
mfa 132,64,244
mfa 136,64,248
mfa 140,64,252
wl 6
mfa 144,68,240
tra 84,25,20480
tra 86,25,22528
mfa 148,68,244
mfa 152,68,248
sad 33,28,58368
buffer_load_dwordx4 a[24:27], v20, s[16:19], s33 offen sc1
mfa 156,68,252
wl 6
mfa 160,72,240
tra 88,26,20480
tra 90,26,22528
mfa 164,72,244
mfa 168,72,248
mfa 172,72,252
wl 6
mfa 176,76,240
tra 92,27,20480
tra 94,27,22528
mfa 180,76,244
sad 33,28,78848
buffer_load_dwordx4 a[28:31], v20, s[16:19], s33 offen sc1
mfa 184,76,248
mfa 188,76,252
v_mov_b32 v19, 155648
s_cmp_lg_u32 s4, 0
s_cbranch_scc1 L_ps_160
wv 29
s_mov_b64 exec, 1
ds_write_b32 v19, v18
s_mov_b64 exec, -1
wl 0
L_ps_160:
s_waitcnt vmcnt(50) lgkmcnt(0)
s_barrier
ds_read_b32 v18, v19
mfa 192,80,240
tra 64,8,0
tra 66,8,2048
mfa 196,80,244
mfa 200,80,248
mfa 204,80,252
sad 34,24,7077888
s_add_u32 m0, s29, 98304
s_nop 0
buffer_load_dwordx4 v6, s[8:11], s34 offen lds
mfa 208,84,240
tra 68,9,0
tra 70,9,2048
mfa 212,84,244
mfa 216,84,248
mfa 220,84,252
mfa 224,88,240
tra 72,10,0
tra 74,10,2048
mfa 228,88,244
mfa 232,88,248
s_add_u32 m0, s29, 99328
s_nop 0
buffer_load_dwordx4 v7, s[8:11], s34 offen lds
mfa 236,88,252
mfa 240,92,240
tra 76,11,0
tra 78,11,2048
mfa 244,92,244
mfa 248,92,248
mfa 252,92,252
wv 48
wl 6
mfa 64,64,96
tra 80,8,8192
tra 82,8,10240
mfa 68,64,100
sad 34,25,7077888
s_add_u32 m0, s29, 106496
s_nop 0
buffer_load_dwordx4 v6, s[52:55], s34 offen lds
mfa 72,64,104
mfa 76,64,108
wl 6
mfa 80,68,96
tra 84,9,8192
tra 86,9,10240
mfa 84,68,100
mfa 88,68,104
mfa 92,68,108
s_add_u32 m0, s29, 107520
s_nop 0
buffer_load_dwordx4 v7, s[52:55], s34 offen lds
wl 6
mfa 96,72,96
tra 88,10,8192
tra 90,10,10240
mfa 100,72,100
mfa 104,72,104
mfa 108,72,108
wl 6
mfa 112,76,96
tra 92,11,8192
tra 94,11,10240
mfa 116,76,100
mfa 120,76,104
sad 34,26,7077888
s_add_u32 m0, s29, 114688
s_nop 0
buffer_load_dwordx4 v6, s[56:59], s34 offen lds
mfa 124,76,108
wl 6
mfa 128,80,96
tra 64,8,16384
tra 66,8,18432
mfa 132,80,100
mfa 136,80,104
mfa 140,80,108
wl 6
mfa 144,84,96
tra 68,9,16384
tra 70,9,18432
mfa 148,84,100
s_add_u32 m0, s29, 115712
s_nop 0
buffer_load_dwordx4 v7, s[56:59], s34 offen lds
mfa 152,84,104
mfa 156,84,108
wl 6
mfa 160,88,96
tra 72,10,16384
tra 74,10,18432
mfa 164,88,100
mfa 168,88,104
mfa 172,88,108
sad 33,28,18432
buffer_load_dwordx4 a[224:227], v20, s[16:19], s33 offen sc1
wl 6
mfa 176,92,96
tra 76,11,16384
tra 78,11,18432
mfa 180,92,100
mfa 184,92,104
mfa 188,92,108
wl 6
mfa 192,64,96
tra 80,8,4096
tra 82,8,6144
mfa 196,64,100
mfa 200,64,104
sad 33,28,38912
buffer_load_dwordx4 a[228:231], v20, s[16:19], s33 offen sc1
mfa 204,64,108
wl 6
mfa 208,68,96
tra 84,9,4096
tra 86,9,6144
mfa 212,68,100
mfa 216,68,104
mfa 220,68,108
wl 6
mfa 224,72,96
tra 88,10,4096
tra 90,10,6144
mfa 228,72,100
sad 33,28,59392
buffer_load_dwordx4 a[232:235], v20, s[16:19], s33 offen sc1
mfa 232,72,104
mfa 236,72,108
wl 6
mfa 240,76,96
tra 92,11,4096
tra 94,11,6144
mfa 244,76,100
mfa 248,76,104
mfa 252,76,108
sad 33,28,79872
buffer_load_dwordx4 a[236:239], v20, s[16:19], s33 offen sc1
wv 52
wl 6
mfa 64,80,112
tra 64,8,12288
tra 66,8,14336
mfa 68,80,116
mfa 72,80,120
mfa 76,80,124
wl 6
mfa 80,84,112
tra 68,9,12288
tra 70,9,14336
mfa 84,84,116
mfa 88,84,120
sad 33,28,19456
buffer_load_dwordx4 a[240:243], v20, s[16:19], s33 offen sc1
mfa 92,84,124
wl 6
mfa 96,88,112
tra 72,10,12288
tra 74,10,14336
mfa 100,88,116
mfa 104,88,120
mfa 108,88,124
wl 6
mfa 112,92,112
tra 76,11,12288
tra 78,11,14336
mfa 116,92,116
sad 33,28,39936
buffer_load_dwordx4 a[244:247], v20, s[16:19], s33 offen sc1
mfa 120,92,120
mfa 124,92,124
wl 6
mfa 128,64,112
tra 80,8,20480
tra 82,8,22528
mfa 132,64,116
mfa 136,64,120
mfa 140,64,124
sad 33,28,60416
buffer_load_dwordx4 a[248:251], v20, s[16:19], s33 offen sc1
wl 6
mfa 144,68,112
tra 84,9,20480
tra 86,9,22528
mfa 148,68,116
mfa 152,68,120
mfa 156,68,124
wl 6
mfa 160,72,112
tra 88,10,20480
tra 90,10,22528
mfa 164,72,116
mfa 168,72,120
sad 33,28,80896
buffer_load_dwordx4 a[252:255], v20, s[16:19], s33 offen sc1
mfa 172,72,124
wl 6
mfa 176,76,112
tra 92,11,20480
tra 94,11,22528
mfa 180,76,116
mfa 184,76,120
mfa 188,76,124
s_waitcnt vmcnt(50) lgkmcnt(0)
s_barrier
v_readfirstlane_b32 s78, v18
s_mov_b32 s69, 1
s_getpc_b64 s[50:51]
L_c_161:
s_add_u32 s50, s50, L_sched-L_c_161
s_addc_u32 s51, s51, -1
s_swappc_b64 s[74:75], s[50:51]
mfa 192,80,112
tra 64,8,24576
tra 66,8,26624
mfa 196,80,116
s_mul_i32 s34, s60, 0
s_add_u32 s34, s34, s24
s_add_u32 m0, s29, 0
s_nop 0
buffer_load_dwordx4 v6, s[8:11], s34 offen lds
mfa 200,80,120
mfa 204,80,124
mfa 208,84,112
tra 68,9,24576
tra 70,9,26624
mfa 212,84,116
mfa 216,84,120
mfa 220,84,124
s_add_u32 m0, s29, 1024
s_nop 0
buffer_load_dwordx4 v7, s[8:11], s34 offen lds
mfa 224,88,112
tra 72,10,24576
tra 74,10,26624
mfa 228,88,116
mfa 232,88,120
mfa 236,88,124
mfa 240,92,112
tra 76,11,24576
tra 78,11,26624
mfa 244,92,116
mfa 248,92,120
s_mul_i32 s34, s60, 0
s_add_u32 s34, s34, s25
s_add_u32 m0, s29, 8192
s_nop 0
buffer_load_dwordx4 v6, s[52:55], s34 offen lds
mfa 252,92,124
wv 49
wl 6
mfa 64,64,128
tra 80,8,32768
tra 82,8,34816
mfa 68,64,132
mfa 72,64,136
mfa 76,64,140
wl 6
mfa 80,68,128
tra 84,9,32768
tra 86,9,34816
mfa 84,68,132
s_add_u32 m0, s29, 9216
s_nop 0
buffer_load_dwordx4 v7, s[52:55], s34 offen lds
mfa 88,68,136
mfa 92,68,140
wl 6
mfa 96,72,128
tra 88,10,32768
tra 90,10,34816
mfa 100,72,132
mfa 104,72,136
mfa 108,72,140
s_mul_i32 s34, s60, 0
s_add_u32 s34, s34, s26
s_add_u32 m0, s29, 16384
s_nop 0
buffer_load_dwordx4 v6, s[56:59], s34 offen lds
wl 6
mfa 112,76,128
tra 92,11,32768
tra 94,11,34816
mfa 116,76,132
mfa 120,76,136
mfa 124,76,140
wl 6
mfa 128,80,128
tra 64,8,40960
tra 66,8,43008
mfa 132,80,132
mfa 136,80,136
s_add_u32 m0, s29, 17408
s_nop 0
buffer_load_dwordx4 v7, s[56:59], s34 offen lds
mfa 140,80,140
wl 6
mfa 144,84,128
tra 68,9,40960
tra 70,9,43008
mfa 148,84,132
mfa 152,84,136
mfa 156,84,140
wl 6
mfa 160,88,128
tra 72,10,40960
tra 74,10,43008
mfa 164,88,132
sad 33,28,0
buffer_load_dwordx4 a[96:99], v20, s[16:19], s33 offen sc1
mfa 168,88,136
mfa 172,88,140
wl 6
mfa 176,92,128
tra 76,11,40960
tra 78,11,43008
mfa 180,92,132
mfa 184,92,136
mfa 188,92,140
sad 33,28,20480
buffer_load_dwordx4 a[100:103], v20, s[16:19], s33 offen sc1
wl 6
mfa 192,64,128
tra 80,8,28672
tra 82,8,30720
mfa 196,64,132
mfa 200,64,136
mfa 204,64,140
wl 6
mfa 208,68,128
tra 84,9,28672
tra 86,9,30720
mfa 212,68,132
mfa 216,68,136
sad 33,28,40960
buffer_load_dwordx4 a[104:107], v20, s[16:19], s33 offen sc1
mfa 220,68,140
wl 6
mfa 224,72,128
tra 88,10,28672
tra 90,10,30720
mfa 228,72,132
mfa 232,72,136
mfa 236,72,140
wl 6
mfa 240,76,128
tra 92,11,28672
tra 94,11,30720
mfa 244,76,132
sad 33,28,61440
buffer_load_dwordx4 a[108:111], v20, s[16:19], s33 offen sc1
mfa 248,76,136
mfa 252,76,140
wv 52
wl 6
mfa 64,80,144
tra 64,8,36864
tra 66,8,38912
mfa 68,80,148
mfa 72,80,152
mfa 76,80,156
sad 33,28,1024
buffer_load_dwordx4 a[112:115], v20, s[16:19], s33 offen sc1
wl 6
mfa 80,84,144
tra 68,9,36864
tra 70,9,38912
mfa 84,84,148
mfa 88,84,152
mfa 92,84,156
wl 6
mfa 96,88,144
tra 72,10,36864
tra 74,10,38912
mfa 100,88,148
mfa 104,88,152
sad 33,28,21504
buffer_load_dwordx4 a[116:119], v20, s[16:19], s33 offen sc1
mfa 108,88,156
wl 6
mfa 112,92,144
tra 76,11,36864
tra 78,11,38912
mfa 116,92,148
mfa 120,92,152
mfa 124,92,156
wl 6
mfa 128,64,144
tra 80,8,45056
tra 82,8,47104
mfa 132,64,148
sad 33,28,41984
buffer_load_dwordx4 a[120:123], v20, s[16:19], s33 offen sc1
mfa 136,64,152
mfa 140,64,156
wl 6
mfa 144,68,144
tra 84,9,45056
tra 86,9,47104
mfa 148,68,148
mfa 152,68,152
mfa 156,68,156
sad 33,28,62464
buffer_load_dwordx4 a[124:127], v20, s[16:19], s33 offen sc1
wl 6
mfa 160,72,144
tra 88,10,45056
tra 90,10,47104
mfa 164,72,148
mfa 168,72,152
mfa 172,72,156
wl 6
mfa 176,76,144
tra 92,11,45056
tra 94,11,47104
mfa 180,76,148
mfa 184,76,152
mfa 188,76,156
s_waitcnt vmcnt(50) lgkmcnt(0)
s_barrier
mfa 192,80,144
tra 64,8,49152
tra 66,8,51200
mfa 196,80,148
s_mul_i32 s34, s60, 1
s_add_u32 s34, s34, s24
s_add_u32 m0, s29, 24576
s_nop 0
buffer_load_dwordx4 v6, s[8:11], s34 offen lds
mfa 200,80,152
mfa 204,80,156
mfa 208,84,144
tra 68,9,49152
tra 70,9,51200
mfa 212,84,148
mfa 216,84,152
mfa 220,84,156
s_add_u32 m0, s29, 25600
s_nop 0
buffer_load_dwordx4 v7, s[8:11], s34 offen lds
mfa 224,88,144
tra 72,10,49152
tra 74,10,51200
mfa 228,88,148
mfa 232,88,152
mfa 236,88,156
mfa 240,92,144
tra 76,11,49152
tra 78,11,51200
mfa 244,92,148
mfa 248,92,152
s_mul_i32 s34, s60, 1
s_add_u32 s34, s34, s25
s_add_u32 m0, s29, 32768
s_nop 0
buffer_load_dwordx4 v6, s[52:55], s34 offen lds
mfa 252,92,156
wv 49
wl 6
mfa 64,64,160
tra 80,8,57344
tra 82,8,59392
mfa 68,64,164
mfa 72,64,168
mfa 76,64,172
wl 6
mfa 80,68,160
tra 84,9,57344
tra 86,9,59392
mfa 84,68,164
s_add_u32 m0, s29, 33792
s_nop 0
buffer_load_dwordx4 v7, s[52:55], s34 offen lds
mfa 88,68,168
mfa 92,68,172
wl 6
mfa 96,72,160
tra 88,10,57344
tra 90,10,59392
mfa 100,72,164
mfa 104,72,168
mfa 108,72,172
s_mul_i32 s34, s60, 1
s_add_u32 s34, s34, s26
s_add_u32 m0, s29, 40960
s_nop 0
buffer_load_dwordx4 v6, s[56:59], s34 offen lds
wl 6
mfa 112,76,160
tra 92,11,57344
tra 94,11,59392
mfa 116,76,164
mfa 120,76,168
mfa 124,76,172
wl 6
mfa 128,80,160
tra 64,12,16384
tra 66,12,18432
mfa 132,80,164
mfa 136,80,168
s_add_u32 m0, s29, 41984
s_nop 0
buffer_load_dwordx4 v7, s[56:59], s34 offen lds
mfa 140,80,172
wl 6
mfa 144,84,160
tra 68,13,16384
tra 70,13,18432
mfa 148,84,164
mfa 152,84,168
mfa 156,84,172
wl 6
mfa 160,88,160
tra 72,14,16384
tra 74,14,18432
mfa 164,88,164
sad 33,28,2048
buffer_load_dwordx4 a[128:131], v20, s[16:19], s33 offen sc1
mfa 168,88,168
mfa 172,88,172
wl 6
mfa 176,92,160
tra 76,15,16384
tra 78,15,18432
mfa 180,92,164
mfa 184,92,168
mfa 188,92,172
sad 33,28,22528
buffer_load_dwordx4 a[132:135], v20, s[16:19], s33 offen sc1
wl 6
mfa 192,64,160
tra 80,8,53248
tra 82,8,55296
mfa 196,64,164
mfa 200,64,168
mfa 204,64,172
wl 6
mfa 208,68,160
tra 84,9,53248
tra 86,9,55296
mfa 212,68,164
mfa 216,68,168
sad 33,28,43008
buffer_load_dwordx4 a[136:139], v20, s[16:19], s33 offen sc1
mfa 220,68,172
wl 6
mfa 224,72,160
tra 88,10,53248
tra 90,10,55296
mfa 228,72,164
mfa 232,72,168
mfa 236,72,172
wl 6
mfa 240,76,160
tra 92,11,53248
tra 94,11,55296
mfa 244,76,164
sad 33,28,63488
buffer_load_dwordx4 a[140:143], v20, s[16:19], s33 offen sc1
mfa 248,76,168
mfa 252,76,172
wv 52
wl 6
mfa 64,80,176
tra 64,8,61440
tra 66,8,63488
mfa 68,80,180
mfa 72,80,184
mfa 76,80,188
sad 33,28,3072
buffer_load_dwordx4 a[144:147], v20, s[16:19], s33 offen sc1
wl 6
mfa 80,84,176
tra 68,9,61440
tra 70,9,63488
mfa 84,84,180
mfa 88,84,184
mfa 92,84,188
wl 6
mfa 96,88,176
tra 72,10,61440
tra 74,10,63488
mfa 100,88,180
mfa 104,88,184
sad 33,28,23552
buffer_load_dwordx4 a[148:151], v20, s[16:19], s33 offen sc1
mfa 108,88,188
wl 6
mfa 112,92,176
tra 76,11,61440
tra 78,11,63488
mfa 116,92,180
mfa 120,92,184
mfa 124,92,188
wl 6
mfa 128,64,176
tra 80,12,20480
tra 82,12,22528
mfa 132,64,180
sad 33,28,44032
buffer_load_dwordx4 a[152:155], v20, s[16:19], s33 offen sc1
mfa 136,64,184
mfa 140,64,188
wl 6
mfa 144,68,176
tra 84,13,20480
tra 86,13,22528
mfa 148,68,180
mfa 152,68,184
mfa 156,68,188
sad 33,28,64512
buffer_load_dwordx4 a[156:159], v20, s[16:19], s33 offen sc1
wl 6
mfa 160,72,176
tra 88,14,20480
tra 90,14,22528
mfa 164,72,180
mfa 168,72,184
mfa 172,72,188
wl 6
mfa 176,76,176
tra 92,15,20480
tra 94,15,22528
mfa 180,76,180
mfa 184,76,184
mfa 188,76,188
s_waitcnt vmcnt(36) lgkmcnt(0)
s_barrier
mfa 192,80,176
tra 64,24,24576
tra 66,24,26624
mfa 196,80,180
s_mul_i32 s34, s60, 2
s_add_u32 s34, s34, s24
s_add_u32 m0, s29, 49152
s_nop 0
buffer_load_dwordx4 v6, s[8:11], s34 offen lds
mfa 200,80,184
mfa 204,80,188
mfa 208,84,176
tra 68,25,24576
tra 70,25,26624
mfa 212,84,180
mfa 216,84,184
mfa 220,84,188
s_add_u32 m0, s29, 50176
s_nop 0
buffer_load_dwordx4 v7, s[8:11], s34 offen lds
mfa 224,88,176
tra 72,26,24576
tra 74,26,26624
mfa 228,88,180
mfa 232,88,184
mfa 236,88,188
mfa 240,92,176
tra 76,24,28672
tra 78,24,30720
mfa 244,92,180
mfa 248,92,184
s_mul_i32 s34, s60, 2
s_add_u32 s34, s34, s25
s_add_u32 m0, s29, 57344
s_nop 0
buffer_load_dwordx4 v6, s[52:55], s34 offen lds
mfa 252,92,188
wl 6
mfa 64,64,0
tra 80,25,28672
tra 82,25,30720
mfa 68,64,4
s_add_u32 m0, s29, 58368
s_nop 0
buffer_load_dwordx4 v7, s[52:55], s34 offen lds
mfa 72,64,8
mfa 76,64,12
s_mul_i32 s34, s60, 2
s_add_u32 s34, s34, s26
s_add_u32 m0, s29, 65536
s_nop 0
buffer_load_dwordx4 v6, s[56:59], s34 offen lds
wl 6
mfa 80,68,0
tra 84,26,28672
tra 86,26,30720
mfa 84,68,4
mfa 88,68,8
s_add_u32 m0, s29, 66560
s_nop 0
buffer_load_dwordx4 v7, s[56:59], s34 offen lds
mfa 92,68,12
wl 6
mfa 96,72,0
tra 88,12,49152
tra 90,12,51200
mfa 100,72,4
sad 33,28,4096
buffer_load_dwordx4 a[160:163], v20, s[16:19], s33 offen sc1
mfa 104,72,8
mfa 108,72,12
sad 33,28,24576
buffer_load_dwordx4 a[164:167], v20, s[16:19], s33 offen sc1
wl 6
mfa 64,76,16
tra 92,13,49152
tra 94,13,51200
mfa 68,76,20
mfa 72,76,24
sad 33,28,45056
buffer_load_dwordx4 a[168:171], v20, s[16:19], s33 offen sc1
mfa 76,76,28
wl 6
mfa 80,80,16
tra 64,14,49152
tra 66,14,51200
mfa 84,80,20
sad 33,28,65536
buffer_load_dwordx4 a[172:175], v20, s[16:19], s33 offen sc1
mfa 88,80,24
mfa 92,80,28
sad 33,28,5120
buffer_load_dwordx4 a[176:179], v20, s[16:19], s33 offen sc1
wl 6
mfa 96,84,16
tra 68,12,53248
tra 70,12,55296
mfa 100,84,20
mfa 104,84,24
sad 33,28,25600
buffer_load_dwordx4 a[180:183], v20, s[16:19], s33 offen sc1
mfa 108,84,28
wv 44
wl 6
mfa 64,88,224
tra 72,13,53248
tra 74,13,55296
mfa 68,88,228
sad 33,28,46080
buffer_load_dwordx4 a[184:187], v20, s[16:19], s33 offen sc1
mfa 72,88,232
mfa 76,88,236
sad 33,28,66560
buffer_load_dwordx4 a[188:191], v20, s[16:19], s33 offen sc1
wl 6
mfa 80,92,224
tra 76,14,53248
tra 78,14,55296
mfa 84,92,228
mfa 88,92,232
mfa 92,92,236
wl 6
mfa 96,64,224
tra 80,27,24576
tra 82,27,26624
mfa 100,64,228
mfa 104,64,232
mfa 108,64,236
wv 42
wl 6
mfa 64,68,240
tra 84,24,32768
tra 86,24,34816
mfa 68,68,244
mfa 72,68,248
mfa 76,68,252
wl 6
mfa 80,72,240
tra 88,25,32768
tra 90,25,34816
mfa 84,72,244
mfa 88,72,248
mfa 92,72,252
wl 6
mfa 96,76,240
tra 92,27,28672
tra 94,27,30720
mfa 100,76,244
mfa 104,76,248
mfa 108,76,252
wl 6
mfa 112,80,0
tra 64,24,36864
tra 66,24,38912
mfa 116,80,4
mfa 120,80,8
mfa 124,80,12
wl 6
mfa 128,84,0
tra 68,25,36864
tra 70,25,38912
mfa 132,84,4
mfa 136,84,8
mfa 140,84,12
wl 6
mfa 144,88,0
tra 72,15,49152
tra 74,15,51200
mfa 148,88,4
cvp 32,64,65
cvp 33,66,67
mfa 152,88,8
cvp 34,80,81
cvp 35,82,83
mfa 156,88,12
cvp 36,96,97
cvp 37,98,99
wl 6
mfa 112,92,16
tra 76,12,57344
tra 78,12,59392
mfa 116,92,20
sad 32,61,0
buffer_store_dwordx4 v[32:35], v20, s[20:23], s32 offen sc1
mfa 120,92,24
mfa 124,92,28
sad 32,61,0
buffer_store_dwordx2 v[36:37], v21, s[20:23], s32 offen offset:1024 sc1
wl 6
mfa 128,64,16
tra 80,13,57344
tra 82,13,59392
mfa 132,64,20
cvp 40,68,69
cvp 41,70,71
mfa 136,64,24
cvp 42,84,85
cvp 43,86,87
mfa 140,64,28
cvp 44,100,101
cvp 45,102,103
wl 6
mfa 144,68,16
tra 84,15,53248
tra 86,15,55296
mfa 148,68,20
sad 32,62,0
buffer_store_dwordx4 v[40:43], v20, s[20:23], s32 offen sc1
mfa 152,68,24
mfa 156,68,28
sad 32,62,0
buffer_store_dwordx2 v[44:45], v21, s[20:23], s32 offen offset:1024 sc1
wl 6
mfa 112,72,224
tra 88,12,61440
tra 90,12,63488
mfa 116,72,228
cvp 48,72,73
cvp 49,74,75
mfa 120,72,232
cvp 50,88,89
cvp 51,90,91
mfa 124,72,236
cvp 52,104,105
cvp 53,106,107
wl 6
mfa 128,76,224
tra 92,13,61440
tra 94,13,63488
mfa 132,76,228
sad 32,63,0
buffer_store_dwordx4 v[48:51], v20, s[20:23], s32 offen sc1
mfa 136,76,232
mfa 140,76,236
sad 32,63,0
buffer_store_dwordx2 v[52:53], v21, s[20:23], s32 offen offset:1024 sc1
wl 0
s_barrier
mfa 144,80,224
tra 64,26,32768
tra 66,26,34816
mfa 148,80,228
cvp 56,76,77
cvp 57,78,79
mfa 152,80,232
cvp 58,92,93
cvp 59,94,95
mfa 156,80,236
cvp 60,108,109
cvp 61,110,111
mfa 112,84,240
tra 68,27,32768
tra 70,27,34816
mfa 116,84,244
sad 32,64,0
buffer_store_dwordx4 v[56:59], v20, s[20:23], s32 offen sc1
mfa 120,84,248
mfa 124,84,252
sad 32,64,0
buffer_store_dwordx2 v[60:61], v21, s[20:23], s32 offen offset:1024 sc1
mfa 128,88,240
tra 72,24,40960
tra 74,24,43008
mfa 132,88,244
mfa 136,88,248
s_mul_i32 s34, s60, 3
s_add_u32 s34, s34, s24
s_add_u32 m0, s29, 73728
s_nop 0
buffer_load_dwordx4 v6, s[8:11], s34 offen lds
mfa 140,88,252
mfa 144,92,240
tra 76,26,36864
tra 78,26,38912
mfa 148,92,244
s_add_u32 m0, s29, 74752
s_nop 0
buffer_load_dwordx4 v7, s[8:11], s34 offen lds
mfa 152,92,248
mfa 156,92,252
s_mul_i32 s34, s60, 3
s_add_u32 s34, s34, s25
s_add_u32 m0, s29, 81920
s_nop 0
buffer_load_dwordx4 v6, s[52:55], s34 offen lds
wl 6
mfa 160,64,0
tra 80,27,36864
tra 82,27,38912
mfa 164,64,4
mfa 168,64,8
s_add_u32 m0, s29, 82944
s_nop 0
buffer_load_dwordx4 v7, s[52:55], s34 offen lds
mfa 172,64,12
wl 6
mfa 176,68,0
tra 84,24,45056
tra 86,24,47104
mfa 180,68,4
s_mul_i32 s34, s60, 3
s_add_u32 s34, s34, s26
s_add_u32 m0, s29, 90112
s_nop 0
buffer_load_dwordx4 v6, s[56:59], s34 offen lds
mfa 184,68,8
mfa 188,68,12
s_add_u32 m0, s29, 91136
s_nop 0
buffer_load_dwordx4 v7, s[56:59], s34 offen lds
wl 6
mfa 192,72,0
tra 88,14,57344
tra 90,14,59392
mfa 196,72,4
mfa 200,72,8
sad 33,28,6144
buffer_load_dwordx4 a[192:195], v20, s[16:19], s33 offen sc1
mfa 204,72,12
wl 6
mfa 160,76,16
tra 92,15,57344
tra 94,15,59392
mfa 164,76,20
sad 33,28,26624
buffer_load_dwordx4 a[196:199], v20, s[16:19], s33 offen sc1
mfa 168,76,24
mfa 172,76,28
sad 33,28,47104
buffer_load_dwordx4 a[200:203], v20, s[16:19], s33 offen sc1
wl 6
mfa 176,80,16
tra 64,24,16384
tra 66,24,18432
mfa 180,80,20
mfa 184,80,24
sad 33,28,67584
buffer_load_dwordx4 a[204:207], v20, s[16:19], s33 offen sc1
mfa 188,80,28
wl 6
mfa 192,84,16
tra 68,14,61440
tra 70,14,63488
mfa 196,84,20
sad 33,28,7168
buffer_load_dwordx4 a[208:211], v20, s[16:19], s33 offen sc1
mfa 200,84,24
mfa 204,84,28
sad 33,28,27648
buffer_load_dwordx4 a[212:215], v20, s[16:19], s33 offen sc1
wl 6
mfa 160,88,224
tra 72,15,61440
tra 74,15,63488
mfa 164,88,228
mfa 168,88,232
sad 33,28,48128
buffer_load_dwordx4 a[216:219], v20, s[16:19], s33 offen sc1
mfa 172,88,236
wl 6
mfa 176,92,224
tra 76,24,20480
tra 78,24,22528
mfa 180,92,228
sad 33,28,68608
buffer_load_dwordx4 a[220:223], v20, s[16:19], s33 offen sc1
mfa 184,92,232
cvp 32,112,113
cvp 33,114,115
mfa 188,92,236
cvp 34,128,129
cvp 35,130,131
wl 6
mfa 192,64,224
tra 80,25,40960
tra 82,25,43008
mfa 196,64,228
cvp 36,144,145
cvp 37,146,147
mfa 200,64,232
sad 32,61,3072
buffer_store_dwordx4 v[32:35], v20, s[20:23], s32 offen sc1
mfa 204,64,236
wl 6
mfa 160,68,240
tra 84,26,40960
tra 86,26,43008
mfa 164,68,244
sad 32,61,3072
buffer_store_dwordx2 v[36:37], v21, s[20:23], s32 offen offset:1024 sc1
mfa 168,68,248
cvp 40,116,117
cvp 41,118,119
mfa 172,68,252
cvp 42,132,133
cvp 43,134,135
wl 6
mfa 176,72,240
tra 88,27,40960
tra 90,27,43008
mfa 180,72,244
cvp 44,148,149
cvp 45,150,151
mfa 184,72,248
sad 32,62,3072
buffer_store_dwordx4 v[40:43], v20, s[20:23], s32 offen sc1
mfa 188,72,252
wl 6
mfa 192,76,240
tra 92,25,45056
tra 94,25,47104
mfa 196,76,244
sad 32,62,3072
buffer_store_dwordx2 v[44:45], v21, s[20:23], s32 offen offset:1024 sc1
mfa 200,76,248
cvp 48,120,121
cvp 49,122,123
mfa 204,76,252
cvp 50,136,137
cvp 51,138,139
wl 6
mfa 208,80,0
tra 64,26,45056
tra 66,26,47104
mfa 212,80,4
cvp 52,152,153
cvp 53,154,155
mfa 216,80,8
sad 32,63,3072
buffer_store_dwordx4 v[48:51], v20, s[20:23], s32 offen sc1
mfa 220,80,12
wl 6
mfa 224,84,0
tra 68,27,45056
tra 70,27,47104
mfa 228,84,4
sad 32,63,3072
buffer_store_dwordx2 v[52:53], v21, s[20:23], s32 offen offset:1024 sc1
mfa 232,84,8
cvp 56,124,125
cvp 57,126,127
mfa 236,84,12
cvp 58,140,141
cvp 59,142,143
wl 6
mfa 240,88,0
tra 72,25,16384
tra 74,25,18432
mfa 244,88,4
cvp 60,156,157
cvp 61,158,159
mfa 248,88,8
sad 32,64,3072
buffer_store_dwordx4 v[56:59], v20, s[20:23], s32 offen sc1
mfa 252,88,12
wl 6
mfa 208,92,16
tra 76,26,16384
tra 78,26,18432
mfa 212,92,20
sad 32,64,3072
buffer_store_dwordx2 v[60:61], v21, s[20:23], s32 offen offset:1024 sc1
mfa 216,92,24
cvp 32,160,161
cvp 33,162,163
mfa 220,92,28
cvp 34,176,177
cvp 35,178,179
wl 6
mfa 224,64,16
tra 80,27,16384
tra 82,27,18432
mfa 228,64,20
cvp 36,192,193
cvp 37,194,195
mfa 232,64,24
sad 32,61,6144
buffer_store_dwordx4 v[32:35], v20, s[20:23], s32 offen sc1
mfa 236,64,28
wl 6
mfa 240,68,16
tra 84,25,20480
tra 86,25,22528
mfa 244,68,20
sad 32,61,6144
buffer_store_dwordx2 v[36:37], v21, s[20:23], s32 offen offset:1024 sc1
mfa 248,68,24
cvp 40,164,165
cvp 41,166,167
mfa 252,68,28
cvp 42,180,181
cvp 43,182,183
wl 6
mfa 208,72,224
tra 88,26,20480
tra 90,26,22528
mfa 212,72,228
cvp 44,196,197
cvp 45,198,199
mfa 216,72,232
sad 32,62,6144
buffer_store_dwordx4 v[40:43], v20, s[20:23], s32 offen sc1
mfa 220,72,236
wl 6
mfa 224,76,224
tra 92,27,20480
tra 94,27,22528
mfa 228,76,228
sad 32,62,6144
buffer_store_dwordx2 v[44:45], v21, s[20:23], s32 offen offset:1024 sc1
mfa 232,76,232
cvp 48,168,169
cvp 49,170,171
mfa 236,76,236
cvp 50,184,185
cvp 51,186,187
wl 6
mfa 240,80,224
cvp 52,200,201
cvp 53,202,203
mfa 244,80,228
sad 32,63,6144
buffer_store_dwordx4 v[48:51], v20, s[20:23], s32 offen sc1
mfa 248,80,232
mfa 252,80,236
sad 32,63,6144
buffer_store_dwordx2 v[52:53], v21, s[20:23], s32 offen offset:1024 sc1
wl 4
mfa 208,84,240
cvp 56,172,173
cvp 57,174,175
mfa 212,84,244
cvp 58,188,189
cvp 59,190,191
mfa 216,84,248
cvp 60,204,205
cvp 61,206,207
mfa 220,84,252
sad 32,64,6144
buffer_store_dwordx4 v[56:59], v20, s[20:23], s32 offen sc1
wl 2
mfa 224,88,240
mfa 228,88,244
sad 32,64,6144
buffer_store_dwordx2 v[60:61], v21, s[20:23], s32 offen offset:1024 sc1
mfa 232,88,248
mfa 236,88,252
wl 0
mfa 240,92,240
mfa 244,92,244
mfa 248,92,248
mfa 252,92,252
wv 60
wv 52
s_nop 7
cvp 32,208,209
cvp 33,210,211
cvp 34,224,225
cvp 35,226,227
cvp 36,240,241
cvp 37,242,243
sad 32,61,9216
buffer_store_dwordx4 v[32:35], v20, s[20:23], s32 offen sc1
sad 32,61,9216
buffer_store_dwordx2 v[36:37], v21, s[20:23], s32 offen offset:1024 sc1
cvp 40,212,213
cvp 41,214,215
cvp 42,228,229
cvp 43,230,231
cvp 44,244,245
cvp 45,246,247
sad 32,62,9216
buffer_store_dwordx4 v[40:43], v20, s[20:23], s32 offen sc1
sad 32,62,9216
buffer_store_dwordx2 v[44:45], v21, s[20:23], s32 offen offset:1024 sc1
cvp 48,216,217
cvp 49,218,219
cvp 50,232,233
cvp 51,234,235
cvp 52,248,249
cvp 53,250,251
sad 32,63,9216
buffer_store_dwordx4 v[48:51], v20, s[20:23], s32 offen sc1
sad 32,63,9216
buffer_store_dwordx2 v[52:53], v21, s[20:23], s32 offen offset:1024 sc1
cvp 56,220,221
cvp 57,222,223
cvp 58,236,237
cvp 59,238,239
cvp 60,252,253
cvp 61,254,255
sad 32,64,9216
buffer_store_dwordx4 v[56:59], v20, s[20:23], s32 offen sc1
sad 32,64,9216
buffer_store_dwordx2 v[60:61], v21, s[20:23], s32 offen offset:1024 sc1
s_getpc_b64 s[50:51]
L_h_162:
s_add_u32 s50, s50, L_wk_done-L_h_162
s_addc_u32 s51, s51, -1
s_setpc_b64 s[50:51]
.p2align 6
L_main_b1:
sad 20,36,16777216
s_addc_u32 s21, s37, 0
s_and_b32 s21, s21, 0xffff
s_mov_b32 s22, 6291456
s_mov_b32 s23, 0x00020000
s_mul_hi_u32 s46, s3, 178956971
s_mul_i32 s45, s46, 24
s_sub_u32 s45, s3, s45
s_lshr_b32 s46, s46, 0
s_lshl_b32 s46, s46, 2
s_add_u32 s46, s46, s4
s_mul_i32 s46, s46, 4
s_barrier
tra 64,8,0
tra 66,8,2048
tra 68,9,0
tra 70,9,2048
tra 72,10,0
tra 74,10,2048
tra 76,11,0
tra 78,11,2048
wl 6
mfz 64,64,96
tra 80,8,8192
tra 82,8,10240
mfz 68,64,100
sad 34,24,786432
s_add_u32 m0, s29, 98304
s_nop 0
buffer_load_dwordx4 v6, s[8:11], s34 offen lds
mfz 72,64,104
mfz 76,64,108
wl 6
mfz 80,68,96
tra 84,9,8192
tra 86,9,10240
mfz 84,68,100
s_add_u32 m0, s29, 99328
s_nop 0
buffer_load_dwordx4 v7, s[8:11], s34 offen lds
mfz 88,68,104
mfz 92,68,108
wl 6
mfz 96,72,96
tra 88,10,8192
tra 90,10,10240
mfz 100,72,100
sad 34,25,786432
s_add_u32 m0, s29, 106496
s_nop 0
buffer_load_dwordx4 v6, s[52:55], s34 offen lds
mfz 104,72,104
mfz 108,72,108
wl 6
mfz 112,76,96
tra 92,11,8192
tra 94,11,10240
mfz 116,76,100
s_add_u32 m0, s29, 107520
s_nop 0
buffer_load_dwordx4 v7, s[52:55], s34 offen lds
mfz 120,76,104
mfz 124,76,108
wl 6
mfz 128,80,96
tra 64,8,4096
tra 66,8,6144
mfz 132,80,100
sad 33,28,8192
buffer_load_dwordx4 a[224:227], v20, s[16:19], s33 offen sc1
mfz 136,80,104
mfz 140,80,108
wl 6
mfz 144,84,96
tra 68,9,4096
tra 70,9,6144
mfz 148,84,100
sad 33,28,28672
buffer_load_dwordx4 a[228:231], v20, s[16:19], s33 offen sc1
mfz 152,84,104
mfz 156,84,108
wl 6
mfz 160,88,96
tra 72,10,4096
tra 74,10,6144
mfz 164,88,100
sad 33,28,49152
buffer_load_dwordx4 a[232:235], v20, s[16:19], s33 offen sc1
mfz 168,88,104
mfz 172,88,108
wl 6
mfz 176,92,96
tra 76,11,4096
tra 78,11,6144
mfz 180,92,100
sad 33,28,69632
buffer_load_dwordx4 a[236:239], v20, s[16:19], s33 offen sc1
mfz 184,92,104
mfz 188,92,108
wl 6
mfa 64,64,112
tra 80,8,12288
tra 82,8,14336
mfa 68,64,116
sad 33,28,9216
buffer_load_dwordx4 a[240:243], v20, s[16:19], s33 offen sc1
mfa 72,64,120
mfa 76,64,124
wl 6
mfa 80,68,112
tra 84,9,12288
tra 86,9,14336
mfa 84,68,116
sad 33,28,29696
buffer_load_dwordx4 a[244:247], v20, s[16:19], s33 offen sc1
mfa 88,68,120
mfa 92,68,124
wl 6
mfa 96,72,112
tra 88,10,12288
tra 90,10,14336
mfa 100,72,116
sad 33,28,50176
buffer_load_dwordx4 a[248:251], v20, s[16:19], s33 offen sc1
mfa 104,72,120
mfa 108,72,124
wl 6
mfa 112,76,112
tra 92,11,12288
tra 94,11,14336
mfa 116,76,116
sad 33,28,70656
buffer_load_dwordx4 a[252:255], v20, s[16:19], s33 offen sc1
mfa 120,76,120
mfa 124,76,124
wl 0
s_barrier
mfa 128,80,112
tra 64,8,24576
tra 66,8,26624
mfa 132,80,116
sad 34,24,983040
s_add_u32 m0, s29, 0
s_nop 0
buffer_load_dwordx4 v6, s[8:11], s34 offen lds
mfa 136,80,120
mfa 140,80,124
mfa 144,84,112
tra 68,9,24576
tra 70,9,26624
mfa 148,84,116
s_add_u32 m0, s29, 1024
s_nop 0
buffer_load_dwordx4 v7, s[8:11], s34 offen lds
mfa 152,84,120
mfa 156,84,124
mfa 160,88,112
tra 72,10,24576
tra 74,10,26624
mfa 164,88,116
sad 34,25,983040
s_add_u32 m0, s29, 8192
s_nop 0
buffer_load_dwordx4 v6, s[52:55], s34 offen lds
mfa 168,88,120
mfa 172,88,124
mfa 176,92,112
tra 76,11,24576
tra 78,11,26624
mfa 180,92,116
s_add_u32 m0, s29, 9216
s_nop 0
buffer_load_dwordx4 v7, s[52:55], s34 offen lds
mfa 184,92,120
mfa 188,92,124
wl 6
mfa 64,64,128
tra 80,8,32768
tra 82,8,34816
mfa 68,64,132
sad 33,28,10240
buffer_load_dwordx4 a[96:99], v20, s[16:19], s33 offen sc1
mfa 72,64,136
mfa 76,64,140
wl 6
mfa 80,68,128
tra 84,9,32768
tra 86,9,34816
mfa 84,68,132
sad 33,28,30720
buffer_load_dwordx4 a[100:103], v20, s[16:19], s33 offen sc1
mfa 88,68,136
mfa 92,68,140
wl 6
mfa 96,72,128
tra 88,10,32768
tra 90,10,34816
mfa 100,72,132
sad 33,28,51200
buffer_load_dwordx4 a[104:107], v20, s[16:19], s33 offen sc1
mfa 104,72,136
mfa 108,72,140
wl 6
mfa 112,76,128
tra 92,11,32768
tra 94,11,34816
mfa 116,76,132
sad 33,28,71680
buffer_load_dwordx4 a[108:111], v20, s[16:19], s33 offen sc1
mfa 120,76,136
mfa 124,76,140
wl 6
mfa 128,80,128
tra 64,8,28672
tra 66,8,30720
mfa 132,80,132
sad 33,28,11264
buffer_load_dwordx4 a[112:115], v20, s[16:19], s33 offen sc1
mfa 136,80,136
mfa 140,80,140
wl 6
mfa 144,84,128
tra 68,9,28672
tra 70,9,30720
mfa 148,84,132
sad 33,28,31744
buffer_load_dwordx4 a[116:119], v20, s[16:19], s33 offen sc1
mfa 152,84,136
mfa 156,84,140
wl 6
mfa 160,88,128
tra 72,10,28672
tra 74,10,30720
mfa 164,88,132
sad 33,28,52224
buffer_load_dwordx4 a[120:123], v20, s[16:19], s33 offen sc1
mfa 168,88,136
mfa 172,88,140
wl 6
mfa 176,92,128
tra 76,11,28672
tra 78,11,30720
mfa 180,92,132
sad 33,28,72704
buffer_load_dwordx4 a[124:127], v20, s[16:19], s33 offen sc1
mfa 184,92,136
mfa 188,92,140
wl 6
mfa 64,64,144
tra 80,8,36864
tra 82,8,38912
mfa 68,64,148
mfa 72,64,152
mfa 76,64,156
wl 6
mfa 80,68,144
tra 84,9,36864
tra 86,9,38912
mfa 84,68,148
mfa 88,68,152
mfa 92,68,156
wl 6
mfa 96,72,144
tra 88,10,36864
tra 90,10,38912
mfa 100,72,148
mfa 104,72,152
mfa 108,72,156
wl 6
mfa 112,76,144
tra 92,11,36864
tra 94,11,38912
mfa 116,76,148
mfa 120,76,152
mfa 124,76,156
s_waitcnt vmcnt(24) lgkmcnt(0)
s_barrier
s_cmp_lt_i32 s70, 0
s_cbranch_scc1 L_pp_163
s_cmp_lg_u32 s4, 1
s_cbranch_scc1 L_pp_163
s_lshl_b32 s83, s70, 7
v_and_b32 v2, 1, v1
v_cmp_eq_u32 vcc, 1, v2
v_mov_b32 v2, s100
v_mov_b32 v3, s101
v_cndmask_b32 v3, v2, v3, vcc
v_and_b32 v2, 31, v1
v_lshlrev_b32 v2, 2, v2
buffer_store_dword v3, v2, s[88:91], s83 offen sc1
L_pp_163:
s_mov_b32 s70, -1
mfa 128,80,144
tra 64,8,49152
tra 66,8,51200
mfa 132,80,148
sad 34,24,1179648
s_add_u32 m0, s29, 24576
s_nop 0
buffer_load_dwordx4 v6, s[8:11], s34 offen lds
mfa 136,80,152
mfa 140,80,156
mfa 144,84,144
tra 68,9,49152
tra 70,9,51200
mfa 148,84,148
s_add_u32 m0, s29, 25600
s_nop 0
buffer_load_dwordx4 v7, s[8:11], s34 offen lds
mfa 152,84,152
mfa 156,84,156
mfa 160,88,144
tra 72,10,49152
tra 74,10,51200
mfa 164,88,148
sad 34,25,1179648
s_add_u32 m0, s29, 32768
s_nop 0
buffer_load_dwordx4 v6, s[52:55], s34 offen lds
mfa 168,88,152
mfa 172,88,156
mfa 176,92,144
tra 76,11,49152
tra 78,11,51200
mfa 180,92,148
s_add_u32 m0, s29, 33792
s_nop 0
buffer_load_dwordx4 v7, s[52:55], s34 offen lds
mfa 184,92,152
mfa 188,92,156
wl 6
mfa 64,64,160
tra 80,8,57344
tra 82,8,59392
mfa 68,64,164
sad 33,28,12288
buffer_load_dwordx4 a[128:131], v20, s[16:19], s33 offen sc1
mfa 72,64,168
mfa 76,64,172
wl 6
mfa 80,68,160
tra 84,9,57344
tra 86,9,59392
mfa 84,68,164
sad 33,28,32768
buffer_load_dwordx4 a[132:135], v20, s[16:19], s33 offen sc1
mfa 88,68,168
mfa 92,68,172
wl 6
mfa 96,72,160
tra 88,10,57344
tra 90,10,59392
mfa 100,72,164
sad 33,28,53248
buffer_load_dwordx4 a[136:139], v20, s[16:19], s33 offen sc1
mfa 104,72,168
mfa 108,72,172
wl 6
mfa 112,76,160
tra 92,11,57344
tra 94,11,59392
mfa 116,76,164
sad 33,28,73728
buffer_load_dwordx4 a[140:143], v20, s[16:19], s33 offen sc1
mfa 120,76,168
mfa 124,76,172
wl 6
mfa 128,80,160
tra 64,8,53248
tra 66,8,55296
mfa 132,80,164
sad 33,28,13312
buffer_load_dwordx4 a[144:147], v20, s[16:19], s33 offen sc1
mfa 136,80,168
mfa 140,80,172
wl 6
mfa 144,84,160
tra 68,9,53248
tra 70,9,55296
mfa 148,84,164
sad 33,28,33792
buffer_load_dwordx4 a[148:151], v20, s[16:19], s33 offen sc1
mfa 152,84,168
mfa 156,84,172
wl 6
mfa 160,88,160
tra 72,10,53248
tra 74,10,55296
mfa 164,88,164
sad 33,28,54272
buffer_load_dwordx4 a[152:155], v20, s[16:19], s33 offen sc1
mfa 168,88,168
mfa 172,88,172
wl 6
mfa 176,92,160
tra 76,11,53248
tra 78,11,55296
mfa 180,92,164
sad 33,28,74752
buffer_load_dwordx4 a[156:159], v20, s[16:19], s33 offen sc1
mfa 184,92,168
mfa 188,92,172
wl 6
mfa 64,64,176
tra 80,8,61440
tra 82,8,63488
mfa 68,64,180
mfa 72,64,184
mfa 76,64,188
wl 6
mfa 80,68,176
tra 84,9,61440
tra 86,9,63488
mfa 84,68,180
mfa 88,68,184
mfa 92,68,188
wl 6
mfa 96,72,176
tra 88,10,61440
tra 90,10,63488
mfa 100,72,180
mfa 104,72,184
mfa 108,72,188
wl 6
mfa 112,76,176
tra 92,11,61440
tra 94,11,63488
mfa 116,76,180
mfa 120,76,184
mfa 124,76,188
wl 0
s_barrier
s_sub_u32 s83, s2, 128
s_lshr_b32 s83, s83, 3
s_mul_i32 s83, s83, 0
sad 83,83,36
s_cmp_eq_u32 s68, 1
s_cselect_b32 s83, 0, s83
s_cmp_ge_u32 s2, 144
s_cbranch_scc1 L_xd_164
s_cmp_lt_u32 s78, s83
s_cbranch_scc1 L_xd_164
v_mov_b32 v18, 0x7fff
s_mov_b32 s77, 7
s_branch L_xe_165
L_xd_164:
s_cmp_lg_u32 s4, 0
s_cbranch_scc1 L_ti_166
s_lshl_b32 s83, s76, 2
v_mov_b32 v18, 1
v_mov_b32 v2, 0
s_mov_b64 exec, 1
buffer_atomic_add v18, v2, s[84:87], s83 offen sc0 sc1
s_mov_b64 exec, -1
L_ti_166:
L_xe_165:
mfa 128,80,176
tra 64,12,24576
tra 66,12,26624
mfa 132,80,180
sad 34,24,1376256
s_add_u32 m0, s29, 49152
s_nop 0
buffer_load_dwordx4 v6, s[8:11], s34 offen lds
mfa 136,80,184
mfa 140,80,188
mfa 144,84,176
tra 68,13,24576
tra 70,13,26624
mfa 148,84,180
s_add_u32 m0, s29, 50176
s_nop 0
buffer_load_dwordx4 v7, s[8:11], s34 offen lds
mfa 152,84,184
mfa 156,84,188
mfa 160,88,176
tra 72,14,24576
tra 74,14,26624
mfa 164,88,180
sad 34,25,1376256
s_add_u32 m0, s29, 57344
s_nop 0
buffer_load_dwordx4 v6, s[52:55], s34 offen lds
mfa 168,88,184
mfa 172,88,188
mfa 176,92,176
tra 76,15,24576
tra 78,15,26624
mfa 180,92,180
s_add_u32 m0, s29, 58368
s_nop 0
buffer_load_dwordx4 v7, s[52:55], s34 offen lds
mfa 184,92,184
mfa 188,92,188
wl 6
mfa 64,64,192
tra 80,12,32768
tra 82,12,34816
mfa 68,64,196
sad 33,28,14336
buffer_load_dwordx4 a[160:163], v20, s[16:19], s33 offen sc1
mfa 72,64,200
mfa 76,64,204
wl 6
mfa 80,68,192
tra 84,13,32768
tra 86,13,34816
mfa 84,68,196
sad 33,28,34816
buffer_load_dwordx4 a[164:167], v20, s[16:19], s33 offen sc1
mfa 88,68,200
mfa 92,68,204
wl 6
mfa 96,72,192
tra 88,14,32768
tra 90,14,34816
mfa 100,72,196
sad 33,28,55296
buffer_load_dwordx4 a[168:171], v20, s[16:19], s33 offen sc1
mfa 104,72,200
mfa 108,72,204
wl 6
mfa 112,76,192
tra 92,15,32768
tra 94,15,34816
mfa 116,76,196
sad 33,28,75776
buffer_load_dwordx4 a[172:175], v20, s[16:19], s33 offen sc1
mfa 120,76,200
mfa 124,76,204
wl 6
mfa 128,80,192
tra 64,12,28672
tra 66,12,30720
mfa 132,80,196
sad 33,28,15360
buffer_load_dwordx4 a[176:179], v20, s[16:19], s33 offen sc1
mfa 136,80,200
mfa 140,80,204
wl 6
mfa 144,84,192
tra 68,13,28672
tra 70,13,30720
mfa 148,84,196
sad 33,28,35840
buffer_load_dwordx4 a[180:183], v20, s[16:19], s33 offen sc1
mfa 152,84,200
mfa 156,84,204
wl 6
mfa 160,88,192
tra 72,14,28672
tra 74,14,30720
mfa 164,88,196
sad 33,28,56320
buffer_load_dwordx4 a[184:187], v20, s[16:19], s33 offen sc1
mfa 168,88,200
mfa 172,88,204
wl 6
mfa 176,92,192
tra 76,15,28672
tra 78,15,30720
mfa 180,92,196
sad 33,28,76800
buffer_load_dwordx4 a[188:191], v20, s[16:19], s33 offen sc1
mfa 184,92,200
mfa 188,92,204
wl 6
mfa 64,64,208
tra 80,12,36864
tra 82,12,38912
mfa 68,64,212
mfa 72,64,216
mfa 76,64,220
wl 6
mfa 80,68,208
tra 84,13,36864
tra 86,13,38912
mfa 84,68,212
mfa 88,68,216
mfa 92,68,220
wl 6
mfa 96,72,208
tra 88,14,36864
tra 90,14,38912
mfa 100,72,212
mfa 104,72,216
mfa 108,72,220
wl 6
mfa 112,76,208
tra 92,15,36864
tra 94,15,38912
mfa 116,76,212
mfa 120,76,216
mfa 124,76,220
s_waitcnt vmcnt(44) lgkmcnt(0)
s_barrier
mfa 128,80,208
tra 64,12,49152
tra 66,12,51200
mfa 132,80,212
sad 34,24,1572864
s_add_u32 m0, s29, 73728
s_nop 0
buffer_load_dwordx4 v6, s[8:11], s34 offen lds
mfa 136,80,216
mfa 140,80,220
mfa 144,84,208
tra 68,13,49152
tra 70,13,51200
mfa 148,84,212
s_add_u32 m0, s29, 74752
s_nop 0
buffer_load_dwordx4 v7, s[8:11], s34 offen lds
mfa 152,84,216
mfa 156,84,220
mfa 160,88,208
tra 72,14,49152
tra 74,14,51200
mfa 164,88,212
sad 34,25,1572864
s_add_u32 m0, s29, 81920
s_nop 0
buffer_load_dwordx4 v6, s[52:55], s34 offen lds
mfa 168,88,216
mfa 172,88,220
mfa 176,92,208
tra 76,15,49152
tra 78,15,51200
mfa 180,92,212
s_add_u32 m0, s29, 82944
s_nop 0
buffer_load_dwordx4 v7, s[52:55], s34 offen lds
mfa 184,92,216
mfa 188,92,220
wv 44
wl 6
mfa 64,64,224
tra 80,12,57344
tra 82,12,59392
mfa 68,64,228
sad 33,28,16384
buffer_load_dwordx4 a[192:195], v20, s[16:19], s33 offen sc1
mfa 72,64,232
mfa 76,64,236
wl 6
mfa 80,68,224
tra 84,13,57344
tra 86,13,59392
mfa 84,68,228
sad 33,28,36864
buffer_load_dwordx4 a[196:199], v20, s[16:19], s33 offen sc1
mfa 88,68,232
mfa 92,68,236
wl 6
mfa 96,72,224
tra 88,14,57344
tra 90,14,59392
mfa 100,72,228
sad 33,28,57344
buffer_load_dwordx4 a[200:203], v20, s[16:19], s33 offen sc1
mfa 104,72,232
mfa 108,72,236
wl 6
mfa 112,76,224
tra 92,15,57344
tra 94,15,59392
mfa 116,76,228
sad 33,28,77824
buffer_load_dwordx4 a[204:207], v20, s[16:19], s33 offen sc1
mfa 120,76,232
mfa 124,76,236
wl 6
mfa 128,80,224
tra 64,12,53248
tra 66,12,55296
mfa 132,80,228
sad 33,28,17408
buffer_load_dwordx4 a[208:211], v20, s[16:19], s33 offen sc1
mfa 136,80,232
mfa 140,80,236
wl 6
mfa 144,84,224
tra 68,13,53248
tra 70,13,55296
mfa 148,84,228
sad 33,28,37888
buffer_load_dwordx4 a[212:215], v20, s[16:19], s33 offen sc1
mfa 152,84,232
mfa 156,84,236
wl 6
mfa 160,88,224
tra 72,14,53248
tra 74,14,55296
mfa 164,88,228
sad 33,28,58368
buffer_load_dwordx4 a[216:219], v20, s[16:19], s33 offen sc1
mfa 168,88,232
mfa 172,88,236
wl 6
mfa 176,92,224
tra 76,15,53248
tra 78,15,55296
mfa 180,92,228
sad 33,28,78848
buffer_load_dwordx4 a[220:223], v20, s[16:19], s33 offen sc1
mfa 184,92,232
mfa 188,92,236
wv 48
wl 6
mfa 64,64,240
tra 80,12,61440
tra 82,12,63488
mfa 68,64,244
mfa 72,64,248
mfa 76,64,252
wl 6
mfa 80,68,240
tra 84,13,61440
tra 86,13,63488
mfa 84,68,244
mfa 88,68,248
mfa 92,68,252
wl 6
mfa 96,72,240
tra 88,14,61440
tra 90,14,63488
mfa 100,72,244
mfa 104,72,248
mfa 108,72,252
wl 6
mfa 112,76,240
tra 92,15,61440
tra 94,15,63488
mfa 116,76,244
mfa 120,76,248
mfa 124,76,252
v_mov_b32 v19, 155648
s_cmp_lg_u32 s4, 0
s_cbranch_scc1 L_ps_167
wv 24
s_mov_b64 exec, 1
ds_write_b32 v19, v18
s_mov_b64 exec, -1
wl 0
L_ps_167:
s_waitcnt vmcnt(44) lgkmcnt(0)
s_barrier
ds_read_b32 v18, v19
mfa 128,80,240
tra 64,8,0
tra 66,8,2048
mfa 132,80,244
sad 34,24,1769472
s_add_u32 m0, s29, 98304
s_nop 0
buffer_load_dwordx4 v6, s[8:11], s34 offen lds
mfa 136,80,248
mfa 140,80,252
mfa 144,84,240
tra 68,9,0
tra 70,9,2048
mfa 148,84,244
s_add_u32 m0, s29, 99328
s_nop 0
buffer_load_dwordx4 v7, s[8:11], s34 offen lds
mfa 152,84,248
mfa 156,84,252
mfa 160,88,240
tra 72,10,0
tra 74,10,2048
mfa 164,88,244
sad 34,25,1769472
s_add_u32 m0, s29, 106496
s_nop 0
buffer_load_dwordx4 v6, s[52:55], s34 offen lds
mfa 168,88,248
mfa 172,88,252
mfa 176,92,240
tra 76,11,0
tra 78,11,2048
mfa 180,92,244
s_add_u32 m0, s29, 107520
s_nop 0
buffer_load_dwordx4 v7, s[52:55], s34 offen lds
mfa 184,92,248
mfa 188,92,252
wv 44
wl 6
mfa 64,64,96
tra 80,8,8192
tra 82,8,10240
mfa 68,64,100
sad 33,28,18432
buffer_load_dwordx4 a[224:227], v20, s[16:19], s33 offen sc1
mfa 72,64,104
mfa 76,64,108
wl 6
mfa 80,68,96
tra 84,9,8192
tra 86,9,10240
mfa 84,68,100
sad 33,28,38912
buffer_load_dwordx4 a[228:231], v20, s[16:19], s33 offen sc1
mfa 88,68,104
mfa 92,68,108
wl 6
mfa 96,72,96
tra 88,10,8192
tra 90,10,10240
mfa 100,72,100
sad 33,28,59392
buffer_load_dwordx4 a[232:235], v20, s[16:19], s33 offen sc1
mfa 104,72,104
mfa 108,72,108
wl 6
mfa 112,76,96
tra 92,11,8192
tra 94,11,10240
mfa 116,76,100
sad 33,28,79872
buffer_load_dwordx4 a[236:239], v20, s[16:19], s33 offen sc1
mfa 120,76,104
mfa 124,76,108
wl 6
mfa 128,80,96
tra 64,8,4096
tra 66,8,6144
mfa 132,80,100
sad 33,28,19456
buffer_load_dwordx4 a[240:243], v20, s[16:19], s33 offen sc1
mfa 136,80,104
mfa 140,80,108
wl 6
mfa 144,84,96
tra 68,9,4096
tra 70,9,6144
mfa 148,84,100
sad 33,28,39936
buffer_load_dwordx4 a[244:247], v20, s[16:19], s33 offen sc1
mfa 152,84,104
mfa 156,84,108
wl 6
mfa 160,88,96
tra 72,10,4096
tra 74,10,6144
mfa 164,88,100
sad 33,28,60416
buffer_load_dwordx4 a[248:251], v20, s[16:19], s33 offen sc1
mfa 168,88,104
mfa 172,88,108
wl 6
mfa 176,92,96
tra 76,11,4096
tra 78,11,6144
mfa 180,92,100
sad 33,28,80896
buffer_load_dwordx4 a[252:255], v20, s[16:19], s33 offen sc1
mfa 184,92,104
mfa 188,92,108
wv 48
wl 6
mfa 64,64,112
tra 80,8,12288
tra 82,8,14336
mfa 68,64,116
mfa 72,64,120
mfa 76,64,124
wl 6
mfa 80,68,112
tra 84,9,12288
tra 86,9,14336
mfa 84,68,116
mfa 88,68,120
mfa 92,68,124
wl 6
mfa 96,72,112
tra 88,10,12288
tra 90,10,14336
mfa 100,72,116
mfa 104,72,120
mfa 108,72,124
wl 6
mfa 112,76,112
tra 92,11,12288
tra 94,11,14336
mfa 116,76,116
mfa 120,76,120
mfa 124,76,124
s_waitcnt vmcnt(44) lgkmcnt(0)
s_barrier
v_readfirstlane_b32 s78, v18
s_mov_b32 s69, 1
s_getpc_b64 s[50:51]
L_c_168:
s_add_u32 s50, s50, L_sched-L_c_168
s_addc_u32 s51, s51, -1
s_swappc_b64 s[74:75], s[50:51]
mfa 128,80,112
tra 64,8,24576
tra 66,8,26624
mfa 132,80,116
s_mul_i32 s34, s60, 0
s_add_u32 s34, s34, s24
s_add_u32 m0, s29, 0
s_nop 0
buffer_load_dwordx4 v6, s[8:11], s34 offen lds
mfa 136,80,120
mfa 140,80,124
mfa 144,84,112
tra 68,9,24576
tra 70,9,26624
mfa 148,84,116
s_add_u32 m0, s29, 1024
s_nop 0
buffer_load_dwordx4 v7, s[8:11], s34 offen lds
mfa 152,84,120
mfa 156,84,124
mfa 160,88,112
tra 72,10,24576
tra 74,10,26624
mfa 164,88,116
s_mul_i32 s34, s60, 0
s_add_u32 s34, s34, s25
s_add_u32 m0, s29, 8192
s_nop 0
buffer_load_dwordx4 v6, s[52:55], s34 offen lds
mfa 168,88,120
mfa 172,88,124
mfa 176,92,112
tra 76,11,24576
tra 78,11,26624
mfa 180,92,116
s_add_u32 m0, s29, 9216
s_nop 0
buffer_load_dwordx4 v7, s[52:55], s34 offen lds
mfa 184,92,120
mfa 188,92,124
wv 44
wl 6
mfa 64,64,128
tra 80,8,32768
tra 82,8,34816
mfa 68,64,132
s_mul_i32 s34, s60, 0
s_add_u32 s34, s34, s26
s_add_u32 m0, s29, 16384
s_nop 0
buffer_load_dwordx4 v6, s[56:59], s34 offen lds
mfa 72,64,136
mfa 76,64,140
wl 6
mfa 80,68,128
tra 84,9,32768
tra 86,9,34816
mfa 84,68,132
s_add_u32 m0, s29, 17408
s_nop 0
buffer_load_dwordx4 v7, s[56:59], s34 offen lds
mfa 88,68,136
mfa 92,68,140
wl 6
mfa 96,72,128
tra 88,10,32768
tra 90,10,34816
mfa 100,72,132
sad 33,28,0
buffer_load_dwordx4 a[96:99], v20, s[16:19], s33 offen sc1
mfa 104,72,136
mfa 108,72,140
wl 6
mfa 112,76,128
tra 92,11,32768
tra 94,11,34816
mfa 116,76,132
sad 33,28,20480
buffer_load_dwordx4 a[100:103], v20, s[16:19], s33 offen sc1
mfa 120,76,136
mfa 124,76,140
wl 6
mfa 128,80,128
tra 64,8,28672
tra 66,8,30720
mfa 132,80,132
sad 33,28,40960
buffer_load_dwordx4 a[104:107], v20, s[16:19], s33 offen sc1
mfa 136,80,136
mfa 140,80,140
wl 6
mfa 144,84,128
tra 68,9,28672
tra 70,9,30720
mfa 148,84,132
sad 33,28,61440
buffer_load_dwordx4 a[108:111], v20, s[16:19], s33 offen sc1
mfa 152,84,136
mfa 156,84,140
wl 6
mfa 160,88,128
tra 72,10,28672
tra 74,10,30720
mfa 164,88,132
sad 33,28,1024
buffer_load_dwordx4 a[112:115], v20, s[16:19], s33 offen sc1
mfa 168,88,136
mfa 172,88,140
wl 6
mfa 176,92,128
tra 76,11,28672
tra 78,11,30720
mfa 180,92,132
sad 33,28,21504
buffer_load_dwordx4 a[116:119], v20, s[16:19], s33 offen sc1
mfa 184,92,136
mfa 188,92,140
wv 48
wl 6
mfa 64,64,144
tra 80,8,36864
tra 82,8,38912
mfa 68,64,148
sad 33,28,41984
buffer_load_dwordx4 a[120:123], v20, s[16:19], s33 offen sc1
mfa 72,64,152
mfa 76,64,156
wl 6
mfa 80,68,144
tra 84,9,36864
tra 86,9,38912
mfa 84,68,148
sad 33,28,62464
buffer_load_dwordx4 a[124:127], v20, s[16:19], s33 offen sc1
mfa 88,68,152
mfa 92,68,156
wl 6
mfa 96,72,144
tra 88,10,36864
tra 90,10,38912
mfa 100,72,148
mfa 104,72,152
mfa 108,72,156
wl 6
mfa 112,76,144
tra 92,11,36864
tra 94,11,38912
mfa 116,76,148
mfa 120,76,152
mfa 124,76,156
s_waitcnt vmcnt(46) lgkmcnt(0)
s_barrier
mfa 128,80,144
tra 64,8,49152
tra 66,8,51200
mfa 132,80,148
s_mul_i32 s34, s60, 1
s_add_u32 s34, s34, s24
s_add_u32 m0, s29, 24576
s_nop 0
buffer_load_dwordx4 v6, s[8:11], s34 offen lds
mfa 136,80,152
mfa 140,80,156
mfa 144,84,144
tra 68,9,49152
tra 70,9,51200
mfa 148,84,148
s_add_u32 m0, s29, 25600
s_nop 0
buffer_load_dwordx4 v7, s[8:11], s34 offen lds
mfa 152,84,152
mfa 156,84,156
mfa 160,88,144
tra 72,10,49152
tra 74,10,51200
mfa 164,88,148
s_mul_i32 s34, s60, 1
s_add_u32 s34, s34, s25
s_add_u32 m0, s29, 32768
s_nop 0
buffer_load_dwordx4 v6, s[52:55], s34 offen lds
mfa 168,88,152
mfa 172,88,156
mfa 176,92,144
tra 76,11,49152
tra 78,11,51200
mfa 180,92,148
s_add_u32 m0, s29, 33792
s_nop 0
buffer_load_dwordx4 v7, s[52:55], s34 offen lds
mfa 184,92,152
mfa 188,92,156
wv 46
wl 6
mfa 64,64,160
tra 80,8,57344
tra 82,8,59392
mfa 68,64,164
s_mul_i32 s34, s60, 1
s_add_u32 s34, s34, s26
s_add_u32 m0, s29, 40960
s_nop 0
buffer_load_dwordx4 v6, s[56:59], s34 offen lds
mfa 72,64,168
mfa 76,64,172
wl 6
mfa 80,68,160
tra 84,9,57344
tra 86,9,59392
mfa 84,68,164
s_add_u32 m0, s29, 41984
s_nop 0
buffer_load_dwordx4 v7, s[56:59], s34 offen lds
mfa 88,68,168
mfa 92,68,172
wl 6
mfa 96,72,160
tra 88,10,57344
tra 90,10,59392
mfa 100,72,164
sad 33,28,2048
buffer_load_dwordx4 a[128:131], v20, s[16:19], s33 offen sc1
mfa 104,72,168
mfa 108,72,172
wl 6
mfa 112,76,160
tra 92,11,57344
tra 94,11,59392
mfa 116,76,164
sad 33,28,22528
buffer_load_dwordx4 a[132:135], v20, s[16:19], s33 offen sc1
mfa 120,76,168
mfa 124,76,172
wl 6
mfa 128,80,160
tra 64,8,53248
tra 66,8,55296
mfa 132,80,164
sad 33,28,43008
buffer_load_dwordx4 a[136:139], v20, s[16:19], s33 offen sc1
mfa 136,80,168
mfa 140,80,172
wl 6
mfa 144,84,160
tra 68,9,53248
tra 70,9,55296
mfa 148,84,164
sad 33,28,63488
buffer_load_dwordx4 a[140:143], v20, s[16:19], s33 offen sc1
mfa 152,84,168
mfa 156,84,172
wl 6
mfa 160,88,160
tra 72,10,53248
tra 74,10,55296
mfa 164,88,164
sad 33,28,3072
buffer_load_dwordx4 a[144:147], v20, s[16:19], s33 offen sc1
mfa 168,88,168
mfa 172,88,172
wl 6
mfa 176,92,160
tra 76,11,53248
tra 78,11,55296
mfa 180,92,164
sad 33,28,23552
buffer_load_dwordx4 a[148:151], v20, s[16:19], s33 offen sc1
mfa 184,92,168
mfa 188,92,172
wv 50
wl 6
mfa 64,64,176
tra 80,8,61440
tra 82,8,63488
mfa 68,64,180
sad 33,28,44032
buffer_load_dwordx4 a[152:155], v20, s[16:19], s33 offen sc1
mfa 72,64,184
mfa 76,64,188
wl 6
mfa 80,68,176
tra 84,9,61440
tra 86,9,63488
mfa 84,68,180
sad 33,28,64512
buffer_load_dwordx4 a[156:159], v20, s[16:19], s33 offen sc1
mfa 88,68,184
mfa 92,68,188
wl 6
mfa 96,72,176
tra 88,10,61440
tra 90,10,63488
mfa 100,72,180
mfa 104,72,184
mfa 108,72,188
wl 6
mfa 112,76,176
tra 92,11,61440
tra 94,11,63488
mfa 116,76,180
mfa 120,76,184
mfa 124,76,188
s_waitcnt vmcnt(48) lgkmcnt(0)
s_barrier
mfa 128,80,176
tra 64,12,24576
tra 66,12,26624
mfa 132,80,180
s_mul_i32 s34, s60, 2
s_add_u32 s34, s34, s24
s_add_u32 m0, s29, 49152
s_nop 0
buffer_load_dwordx4 v6, s[8:11], s34 offen lds
mfa 136,80,184
mfa 140,80,188
mfa 144,84,176
tra 68,13,24576
tra 70,13,26624
mfa 148,84,180
s_add_u32 m0, s29, 50176
s_nop 0
buffer_load_dwordx4 v7, s[8:11], s34 offen lds
mfa 152,84,184
mfa 156,84,188
mfa 160,88,176
tra 72,14,24576
tra 74,14,26624
mfa 164,88,180
s_mul_i32 s34, s60, 2
s_add_u32 s34, s34, s25
s_add_u32 m0, s29, 57344
s_nop 0
buffer_load_dwordx4 v6, s[52:55], s34 offen lds
mfa 168,88,184
mfa 172,88,188
mfa 176,92,176
tra 76,15,24576
tra 78,15,26624
mfa 180,92,180
s_add_u32 m0, s29, 58368
s_nop 0
buffer_load_dwordx4 v7, s[52:55], s34 offen lds
mfa 184,92,184
mfa 188,92,188
wv 48
wl 6
mfa 64,64,192
tra 80,12,32768
tra 82,12,34816
mfa 68,64,196
s_mul_i32 s34, s60, 2
s_add_u32 s34, s34, s26
s_add_u32 m0, s29, 65536
s_nop 0
buffer_load_dwordx4 v6, s[56:59], s34 offen lds
mfa 72,64,200
mfa 76,64,204
wl 6
mfa 80,68,192
tra 84,13,32768
tra 86,13,34816
mfa 84,68,196
s_add_u32 m0, s29, 66560
s_nop 0
buffer_load_dwordx4 v7, s[56:59], s34 offen lds
mfa 88,68,200
mfa 92,68,204
wl 6
mfa 96,72,192
tra 88,14,32768
tra 90,14,34816
mfa 100,72,196
sad 33,28,4096
buffer_load_dwordx4 a[160:163], v20, s[16:19], s33 offen sc1
mfa 104,72,200
mfa 108,72,204
wl 6
mfa 112,76,192
tra 92,15,32768
tra 94,15,34816
mfa 116,76,196
sad 33,28,24576
buffer_load_dwordx4 a[164:167], v20, s[16:19], s33 offen sc1
mfa 120,76,200
mfa 124,76,204
wl 6
mfa 128,80,192
tra 64,12,28672
tra 66,12,30720
mfa 132,80,196
sad 33,28,45056
buffer_load_dwordx4 a[168:171], v20, s[16:19], s33 offen sc1
mfa 136,80,200
mfa 140,80,204
wl 6
mfa 144,84,192
tra 68,13,28672
tra 70,13,30720
mfa 148,84,196
sad 33,28,65536
buffer_load_dwordx4 a[172:175], v20, s[16:19], s33 offen sc1
mfa 152,84,200
mfa 156,84,204
wl 6
mfa 160,88,192
tra 72,14,28672
tra 74,14,30720
mfa 164,88,196
sad 33,28,5120
buffer_load_dwordx4 a[176:179], v20, s[16:19], s33 offen sc1
mfa 168,88,200
mfa 172,88,204
wl 6
mfa 176,92,192
tra 76,15,28672
tra 78,15,30720
mfa 180,92,196
sad 33,28,25600
buffer_load_dwordx4 a[180:183], v20, s[16:19], s33 offen sc1
mfa 184,92,200
mfa 188,92,204
wv 52
wl 6
mfa 64,64,208
tra 80,12,36864
tra 82,12,38912
mfa 68,64,212
sad 33,28,46080
buffer_load_dwordx4 a[184:187], v20, s[16:19], s33 offen sc1
mfa 72,64,216
mfa 76,64,220
wl 6
mfa 80,68,208
tra 84,13,36864
tra 86,13,38912
mfa 84,68,212
sad 33,28,66560
buffer_load_dwordx4 a[188:191], v20, s[16:19], s33 offen sc1
mfa 88,68,216
mfa 92,68,220
wl 6
mfa 96,72,208
tra 88,14,36864
tra 90,14,38912
mfa 100,72,212
mfa 104,72,216
mfa 108,72,220
wl 6
mfa 112,76,208
tra 92,15,36864
tra 94,15,38912
mfa 116,76,212
mfa 120,76,216
mfa 124,76,220
s_waitcnt vmcnt(50) lgkmcnt(0)
s_barrier
mfa 128,80,208
tra 64,12,49152
tra 66,12,51200
mfa 132,80,212
s_mul_i32 s34, s60, 3
s_add_u32 s34, s34, s24
s_add_u32 m0, s29, 73728
s_nop 0
buffer_load_dwordx4 v6, s[8:11], s34 offen lds
mfa 136,80,216
mfa 140,80,220
mfa 144,84,208
tra 68,13,49152
tra 70,13,51200
mfa 148,84,212
s_add_u32 m0, s29, 74752
s_nop 0
buffer_load_dwordx4 v7, s[8:11], s34 offen lds
mfa 152,84,216
mfa 156,84,220
mfa 160,88,208
tra 72,14,49152
tra 74,14,51200
mfa 164,88,212
s_mul_i32 s34, s60, 3
s_add_u32 s34, s34, s25
s_add_u32 m0, s29, 81920
s_nop 0
buffer_load_dwordx4 v6, s[52:55], s34 offen lds
mfa 168,88,216
mfa 172,88,220
mfa 176,92,208
tra 76,15,49152
tra 78,15,51200
mfa 180,92,212
s_add_u32 m0, s29, 82944
s_nop 0
buffer_load_dwordx4 v7, s[52:55], s34 offen lds
mfa 184,92,216
mfa 188,92,220
wv 50
wl 6
mfa 64,64,224
tra 80,12,57344
tra 82,12,59392
mfa 68,64,228
s_mul_i32 s34, s60, 3
s_add_u32 s34, s34, s26
s_add_u32 m0, s29, 90112
s_nop 0
buffer_load_dwordx4 v6, s[56:59], s34 offen lds
mfa 72,64,232
mfa 76,64,236
wl 6
mfa 80,68,224
tra 84,13,57344
tra 86,13,59392
mfa 84,68,228
s_add_u32 m0, s29, 91136
s_nop 0
buffer_load_dwordx4 v7, s[56:59], s34 offen lds
mfa 88,68,232
mfa 92,68,236
wl 6
mfa 96,72,224
tra 88,14,57344
tra 90,14,59392
mfa 100,72,228
sad 33,28,6144
buffer_load_dwordx4 a[192:195], v20, s[16:19], s33 offen sc1
mfa 104,72,232
mfa 108,72,236
wl 6
mfa 112,76,224
tra 92,15,57344
tra 94,15,59392
mfa 116,76,228
sad 33,28,26624
buffer_load_dwordx4 a[196:199], v20, s[16:19], s33 offen sc1
mfa 120,76,232
mfa 124,76,236
wl 6
mfa 128,80,224
tra 64,12,53248
tra 66,12,55296
mfa 132,80,228
sad 33,28,47104
buffer_load_dwordx4 a[200:203], v20, s[16:19], s33 offen sc1
mfa 136,80,232
mfa 140,80,236
wl 6
mfa 144,84,224
tra 68,13,53248
tra 70,13,55296
mfa 148,84,228
sad 33,28,67584
buffer_load_dwordx4 a[204:207], v20, s[16:19], s33 offen sc1
mfa 152,84,232
mfa 156,84,236
wl 6
mfa 160,88,224
tra 72,14,53248
tra 74,14,55296
mfa 164,88,228
sad 33,28,7168
buffer_load_dwordx4 a[208:211], v20, s[16:19], s33 offen sc1
mfa 168,88,232
mfa 172,88,236
wl 6
mfa 176,92,224
tra 76,15,53248
tra 78,15,55296
mfa 180,92,228
sad 33,28,27648
buffer_load_dwordx4 a[212:215], v20, s[16:19], s33 offen sc1
mfa 184,92,232
mfa 188,92,236
wv 54
wl 6
mfa 64,64,240
tra 80,12,61440
tra 82,12,63488
mfa 68,64,244
sad 33,28,48128
buffer_load_dwordx4 a[216:219], v20, s[16:19], s33 offen sc1
mfa 72,64,248
mfa 76,64,252
wl 6
mfa 80,68,240
tra 84,13,61440
tra 86,13,63488
mfa 84,68,244
sad 33,28,68608
buffer_load_dwordx4 a[220:223], v20, s[16:19], s33 offen sc1
mfa 88,68,248
mfa 92,68,252
wl 6
mfa 96,72,240
tra 88,14,61440
tra 90,14,63488
mfa 100,72,244
mfa 104,72,248
mfa 108,72,252
wl 6
mfa 112,76,240
tra 92,15,61440
tra 94,15,63488
mfa 116,76,244
mfa 120,76,248
mfa 124,76,252
wl 6
mfa 128,80,240
mfa 132,80,244
mfa 136,80,248
mfa 140,80,252
wl 4
mfa 144,84,240
mfa 148,84,244
mfa 152,84,248
mfa 156,84,252
wl 2
mfa 160,88,240
mfa 164,88,244
mfa 168,88,248
mfa 172,88,252
wl 0
mfa 176,92,240
mfa 180,92,244
mfa 184,92,248
mfa 188,92,252
wv 36
wv 28
s_mul_i32 s47, s46, 49152
s_lshl_b32 s32, s45, 11
s_add_u32 s47, s47, s32
s_nop 7
cvp 36,64,65
cvp 37,128,129
v_lshlrev_b32 v38, 16, v36
v_lshlrev_b32 v39, 16, v37
v_and_b32 v36, 0xffff0000, v36
v_and_b32 v37, 0xffff0000, v37
v_mul_f32 v38, v38, v39
v_mul_f32 v36, v36, v37
cvp 32,38,36
cvp 36,66,67
cvp 37,130,131
v_lshlrev_b32 v38, 16, v36
v_lshlrev_b32 v39, 16, v37
v_and_b32 v36, 0xffff0000, v36
v_and_b32 v37, 0xffff0000, v37
v_mul_f32 v38, v38, v39
v_mul_f32 v36, v36, v37
cvp 33,38,36
cvp 36,80,81
cvp 37,144,145
v_lshlrev_b32 v38, 16, v36
v_lshlrev_b32 v39, 16, v37
v_and_b32 v36, 0xffff0000, v36
v_and_b32 v37, 0xffff0000, v37
v_mul_f32 v38, v38, v39
v_mul_f32 v36, v36, v37
cvp 34,38,36
cvp 36,82,83
cvp 37,146,147
v_lshlrev_b32 v38, 16, v36
v_lshlrev_b32 v39, 16, v37
v_and_b32 v36, 0xffff0000, v36
v_and_b32 v37, 0xffff0000, v37
v_mul_f32 v38, v38, v39
v_mul_f32 v36, v36, v37
cvp 35,38,36
sad 32,47,0
buffer_store_dwordx4 v[32:35], v20, s[20:23], s32 offen sc1
cvp 44,96,97
cvp 45,160,161
v_lshlrev_b32 v46, 16, v44
v_lshlrev_b32 v47, 16, v45
v_and_b32 v44, 0xffff0000, v44
v_and_b32 v45, 0xffff0000, v45
v_mul_f32 v46, v46, v47
v_mul_f32 v44, v44, v45
cvp 40,46,44
cvp 44,98,99
cvp 45,162,163
v_lshlrev_b32 v46, 16, v44
v_lshlrev_b32 v47, 16, v45
v_and_b32 v44, 0xffff0000, v44
v_and_b32 v45, 0xffff0000, v45
v_mul_f32 v46, v46, v47
v_mul_f32 v44, v44, v45
cvp 41,46,44
cvp 44,112,113
cvp 45,176,177
v_lshlrev_b32 v46, 16, v44
v_lshlrev_b32 v47, 16, v45
v_and_b32 v44, 0xffff0000, v44
v_and_b32 v45, 0xffff0000, v45
v_mul_f32 v46, v46, v47
v_mul_f32 v44, v44, v45
cvp 42,46,44
cvp 44,114,115
cvp 45,178,179
v_lshlrev_b32 v46, 16, v44
v_lshlrev_b32 v47, 16, v45
v_and_b32 v44, 0xffff0000, v44
v_and_b32 v45, 0xffff0000, v45
v_mul_f32 v46, v46, v47
v_mul_f32 v44, v44, v45
cvp 43,46,44
sad 32,47,1024
buffer_store_dwordx4 v[40:43], v20, s[20:23], s32 offen sc1
cvp 52,68,69
cvp 53,132,133
v_lshlrev_b32 v54, 16, v52
v_lshlrev_b32 v55, 16, v53
v_and_b32 v52, 0xffff0000, v52
v_and_b32 v53, 0xffff0000, v53
v_mul_f32 v54, v54, v55
v_mul_f32 v52, v52, v53
cvp 48,54,52
cvp 52,70,71
cvp 53,134,135
v_lshlrev_b32 v54, 16, v52
v_lshlrev_b32 v55, 16, v53
v_and_b32 v52, 0xffff0000, v52
v_and_b32 v53, 0xffff0000, v53
v_mul_f32 v54, v54, v55
v_mul_f32 v52, v52, v53
cvp 49,54,52
cvp 52,84,85
cvp 53,148,149
v_lshlrev_b32 v54, 16, v52
v_lshlrev_b32 v55, 16, v53
v_and_b32 v52, 0xffff0000, v52
v_and_b32 v53, 0xffff0000, v53
v_mul_f32 v54, v54, v55
v_mul_f32 v52, v52, v53
cvp 50,54,52
cvp 52,86,87
cvp 53,150,151
v_lshlrev_b32 v54, 16, v52
v_lshlrev_b32 v55, 16, v53
v_and_b32 v52, 0xffff0000, v52
v_and_b32 v53, 0xffff0000, v53
v_mul_f32 v54, v54, v55
v_mul_f32 v52, v52, v53
cvp 51,54,52
sad 32,47,49152
buffer_store_dwordx4 v[48:51], v20, s[20:23], s32 offen sc1
cvp 60,100,101
cvp 61,164,165
v_lshlrev_b32 v62, 16, v60
v_lshlrev_b32 v63, 16, v61
v_and_b32 v60, 0xffff0000, v60
v_and_b32 v61, 0xffff0000, v61
v_mul_f32 v62, v62, v63
v_mul_f32 v60, v60, v61
cvp 56,62,60
cvp 60,102,103
cvp 61,166,167
v_lshlrev_b32 v62, 16, v60
v_lshlrev_b32 v63, 16, v61
v_and_b32 v60, 0xffff0000, v60
v_and_b32 v61, 0xffff0000, v61
v_mul_f32 v62, v62, v63
v_mul_f32 v60, v60, v61
cvp 57,62,60
cvp 60,116,117
cvp 61,180,181
v_lshlrev_b32 v62, 16, v60
v_lshlrev_b32 v63, 16, v61
v_and_b32 v60, 0xffff0000, v60
v_and_b32 v61, 0xffff0000, v61
v_mul_f32 v62, v62, v63
v_mul_f32 v60, v60, v61
cvp 58,62,60
cvp 60,118,119
cvp 61,182,183
v_lshlrev_b32 v62, 16, v60
v_lshlrev_b32 v63, 16, v61
v_and_b32 v60, 0xffff0000, v60
v_and_b32 v61, 0xffff0000, v61
v_mul_f32 v62, v62, v63
v_mul_f32 v60, v60, v61
cvp 59,62,60
sad 32,47,50176
buffer_store_dwordx4 v[56:59], v20, s[20:23], s32 offen sc1
cvp 36,72,73
cvp 37,136,137
v_lshlrev_b32 v38, 16, v36
v_lshlrev_b32 v39, 16, v37
v_and_b32 v36, 0xffff0000, v36
v_and_b32 v37, 0xffff0000, v37
v_mul_f32 v38, v38, v39
v_mul_f32 v36, v36, v37
cvp 32,38,36
cvp 36,74,75
cvp 37,138,139
v_lshlrev_b32 v38, 16, v36
v_lshlrev_b32 v39, 16, v37
v_and_b32 v36, 0xffff0000, v36
v_and_b32 v37, 0xffff0000, v37
v_mul_f32 v38, v38, v39
v_mul_f32 v36, v36, v37
cvp 33,38,36
cvp 36,88,89
cvp 37,152,153
v_lshlrev_b32 v38, 16, v36
v_lshlrev_b32 v39, 16, v37
v_and_b32 v36, 0xffff0000, v36
v_and_b32 v37, 0xffff0000, v37
v_mul_f32 v38, v38, v39
v_mul_f32 v36, v36, v37
cvp 34,38,36
cvp 36,90,91
cvp 37,154,155
v_lshlrev_b32 v38, 16, v36
v_lshlrev_b32 v39, 16, v37
v_and_b32 v36, 0xffff0000, v36
v_and_b32 v37, 0xffff0000, v37
v_mul_f32 v38, v38, v39
v_mul_f32 v36, v36, v37
cvp 35,38,36
sad 32,47,98304
buffer_store_dwordx4 v[32:35], v20, s[20:23], s32 offen sc1
cvp 44,104,105
cvp 45,168,169
v_lshlrev_b32 v46, 16, v44
v_lshlrev_b32 v47, 16, v45
v_and_b32 v44, 0xffff0000, v44
v_and_b32 v45, 0xffff0000, v45
v_mul_f32 v46, v46, v47
v_mul_f32 v44, v44, v45
cvp 40,46,44
cvp 44,106,107
cvp 45,170,171
v_lshlrev_b32 v46, 16, v44
v_lshlrev_b32 v47, 16, v45
v_and_b32 v44, 0xffff0000, v44
v_and_b32 v45, 0xffff0000, v45
v_mul_f32 v46, v46, v47
v_mul_f32 v44, v44, v45
cvp 41,46,44
cvp 44,120,121
cvp 45,184,185
v_lshlrev_b32 v46, 16, v44
v_lshlrev_b32 v47, 16, v45
v_and_b32 v44, 0xffff0000, v44
v_and_b32 v45, 0xffff0000, v45
v_mul_f32 v46, v46, v47
v_mul_f32 v44, v44, v45
cvp 42,46,44
cvp 44,122,123
cvp 45,186,187
v_lshlrev_b32 v46, 16, v44
v_lshlrev_b32 v47, 16, v45
v_and_b32 v44, 0xffff0000, v44
v_and_b32 v45, 0xffff0000, v45
v_mul_f32 v46, v46, v47
v_mul_f32 v44, v44, v45
cvp 43,46,44
sad 32,47,99328
buffer_store_dwordx4 v[40:43], v20, s[20:23], s32 offen sc1
cvp 52,76,77
cvp 53,140,141
v_lshlrev_b32 v54, 16, v52
v_lshlrev_b32 v55, 16, v53
v_and_b32 v52, 0xffff0000, v52
v_and_b32 v53, 0xffff0000, v53
v_mul_f32 v54, v54, v55
v_mul_f32 v52, v52, v53
cvp 48,54,52
cvp 52,78,79
cvp 53,142,143
v_lshlrev_b32 v54, 16, v52
v_lshlrev_b32 v55, 16, v53
v_and_b32 v52, 0xffff0000, v52
v_and_b32 v53, 0xffff0000, v53
v_mul_f32 v54, v54, v55
v_mul_f32 v52, v52, v53
cvp 49,54,52
cvp 52,92,93
cvp 53,156,157
v_lshlrev_b32 v54, 16, v52
v_lshlrev_b32 v55, 16, v53
v_and_b32 v52, 0xffff0000, v52
v_and_b32 v53, 0xffff0000, v53
v_mul_f32 v54, v54, v55
v_mul_f32 v52, v52, v53
cvp 50,54,52
cvp 52,94,95
cvp 53,158,159
v_lshlrev_b32 v54, 16, v52
v_lshlrev_b32 v55, 16, v53
v_and_b32 v52, 0xffff0000, v52
v_and_b32 v53, 0xffff0000, v53
v_mul_f32 v54, v54, v55
v_mul_f32 v52, v52, v53
cvp 51,54,52
sad 32,47,147456
buffer_store_dwordx4 v[48:51], v20, s[20:23], s32 offen sc1
cvp 60,108,109
cvp 61,172,173
v_lshlrev_b32 v62, 16, v60
v_lshlrev_b32 v63, 16, v61
v_and_b32 v60, 0xffff0000, v60
v_and_b32 v61, 0xffff0000, v61
v_mul_f32 v62, v62, v63
v_mul_f32 v60, v60, v61
cvp 56,62,60
cvp 60,110,111
cvp 61,174,175
v_lshlrev_b32 v62, 16, v60
v_lshlrev_b32 v63, 16, v61
v_and_b32 v60, 0xffff0000, v60
v_and_b32 v61, 0xffff0000, v61
v_mul_f32 v62, v62, v63
v_mul_f32 v60, v60, v61
cvp 57,62,60
cvp 60,124,125
cvp 61,188,189
v_lshlrev_b32 v62, 16, v60
v_lshlrev_b32 v63, 16, v61
v_and_b32 v60, 0xffff0000, v60
v_and_b32 v61, 0xffff0000, v61
v_mul_f32 v62, v62, v63
v_mul_f32 v60, v60, v61
cvp 58,62,60
cvp 60,126,127
cvp 61,190,191
v_lshlrev_b32 v62, 16, v60
v_lshlrev_b32 v63, 16, v61
v_and_b32 v60, 0xffff0000, v60
v_and_b32 v61, 0xffff0000, v61
v_mul_f32 v62, v62, v63
v_mul_f32 v60, v60, v61
cvp 59,62,60
sad 32,47,148480
buffer_store_dwordx4 v[56:59], v20, s[20:23], s32 offen sc1
s_getpc_b64 s[50:51]
L_h_169:
s_add_u32 s50, s50, L_wk_done-L_h_169
s_addc_u32 s51, s51, -1
s_setpc_b64 s[50:51]
.p2align 6
L_main_b2:
s_lshl_b32 s82, s71, 7
sad 82,82,736
s_lshl_b32 s83, s82, 7
v_min_u32 v3, 23, v1
v_mul_u32_u24 v3, 128, v3
s_mov_b32 s33, 0
L_fw_170:
buffer_load_dwordx2 v[4:5], v3, s[88:91], s83 offen sc1
wv 0
v_xor_b32 v4, s100, v4
v_xor_b32 v5, s101, v5
v_or_b32 v4, v4, v5
v_cmp_ne_u32 vcc, 0, v4
sad 33,33,1
s_cbranch_vccz L_fwd_171
s_sleep 4
s_cmp_lt_u32 s33, 400000
s_cbranch_scc1 L_fw_170
L_fwd_171:
sad 16,36,16777216
s_addc_u32 s17, s37, 0
s_and_b32 s17, s17, 0xffff
s_mov_b32 s18, 6291456
s_mov_b32 s19, 0x00020000
sad 20,36,12582912
s_addc_u32 s21, s37, 0
s_and_b32 s21, s21, 0xffff
s_mov_b32 s22, 2621440
s_mov_b32 s23, 0x00020000
s_mul_hi_u32 s46, s3, 858993460
s_mul_i32 s45, s46, 5
s_sub_u32 s45, s3, s45
s_lshl_b32 s45, s45, 8
s_lshr_b32 s46, s46, 0
s_lshl_b32 s46, s46, 2
s_add_u32 s46, s46, s4
s_mul_i32 s46, s46, 4
sad 33,28,0
buffer_load_dwordx4 a[96:99], v20, s[16:19], s33 offen sc1
sad 33,28,49152
buffer_load_dwordx4 a[100:103], v20, s[16:19], s33 offen sc1
sad 33,28,98304
buffer_load_dwordx4 a[104:107], v20, s[16:19], s33 offen sc1
sad 33,28,147456
buffer_load_dwordx4 a[108:111], v20, s[16:19], s33 offen sc1
sad 33,28,1024
buffer_load_dwordx4 a[112:115], v20, s[16:19], s33 offen sc1
sad 33,28,50176
buffer_load_dwordx4 a[116:119], v20, s[16:19], s33 offen sc1
sad 33,28,99328
buffer_load_dwordx4 a[120:123], v20, s[16:19], s33 offen sc1
sad 33,28,148480
buffer_load_dwordx4 a[124:127], v20, s[16:19], s33 offen sc1
s_barrier
tra 64,8,0
tra 66,8,2048
tra 68,9,0
tra 70,9,2048
tra 72,10,0
tra 74,10,2048
tra 76,11,0
tra 78,11,2048
wv 4
wl 6
mfz 64,64,96
tra 80,8,8192
tra 82,8,10240
mfz 68,64,100
sad 33,28,2048
buffer_load_dwordx4 a[128:131], v20, s[16:19], s33 offen sc1
mfz 72,64,104
mfz 76,64,108
sad 33,28,51200
buffer_load_dwordx4 a[132:135], v20, s[16:19], s33 offen sc1
wl 6
mfz 80,68,96
tra 84,9,8192
tra 86,9,10240
mfz 84,68,100
mfz 88,68,104
sad 33,28,100352
buffer_load_dwordx4 a[136:139], v20, s[16:19], s33 offen sc1
mfz 92,68,108
wl 6
mfz 96,72,96
tra 88,10,8192
tra 90,10,10240
mfz 100,72,100
sad 33,28,149504
buffer_load_dwordx4 a[140:143], v20, s[16:19], s33 offen sc1
mfz 104,72,104
mfz 108,72,108
sad 33,28,3072
buffer_load_dwordx4 a[144:147], v20, s[16:19], s33 offen sc1
wl 6
mfz 112,76,96
tra 92,11,8192
tra 94,11,10240
mfz 116,76,100
mfz 120,76,104
sad 33,28,52224
buffer_load_dwordx4 a[148:151], v20, s[16:19], s33 offen sc1
mfz 124,76,108
wl 6
mfz 128,80,96
tra 64,8,4096
tra 66,8,6144
mfz 132,80,100
sad 33,28,101376
buffer_load_dwordx4 a[152:155], v20, s[16:19], s33 offen sc1
mfz 136,80,104
mfz 140,80,108
sad 33,28,150528
buffer_load_dwordx4 a[156:159], v20, s[16:19], s33 offen sc1
wl 6
mfz 144,84,96
tra 68,9,4096
tra 70,9,6144
mfz 148,84,100
mfz 152,84,104
sad 33,28,4096
buffer_load_dwordx4 a[160:163], v20, s[16:19], s33 offen sc1
mfz 156,84,108
wl 6
mfz 160,88,96
tra 72,10,4096
tra 74,10,6144
mfz 164,88,100
sad 33,28,53248
buffer_load_dwordx4 a[164:167], v20, s[16:19], s33 offen sc1
mfz 168,88,104
mfz 172,88,108
sad 33,28,102400
buffer_load_dwordx4 a[168:171], v20, s[16:19], s33 offen sc1
wl 6
mfz 176,92,96
tra 76,11,4096
tra 78,11,6144
mfz 180,92,100
mfz 184,92,104
sad 33,28,151552
buffer_load_dwordx4 a[172:175], v20, s[16:19], s33 offen sc1
mfz 188,92,108
wv 12
wl 6
mfa 64,64,112
tra 80,8,12288
tra 82,8,14336
mfa 68,64,116
sad 33,28,5120
buffer_load_dwordx4 a[176:179], v20, s[16:19], s33 offen sc1
mfa 72,64,120
mfa 76,64,124
sad 33,28,54272
buffer_load_dwordx4 a[180:183], v20, s[16:19], s33 offen sc1
wl 6
mfa 80,68,112
tra 84,9,12288
tra 86,9,14336
mfa 84,68,116
mfa 88,68,120
sad 33,28,103424
buffer_load_dwordx4 a[184:187], v20, s[16:19], s33 offen sc1
mfa 92,68,124
wl 6
mfa 96,72,112
tra 88,10,12288
tra 90,10,14336
mfa 100,72,116
sad 33,28,152576
buffer_load_dwordx4 a[188:191], v20, s[16:19], s33 offen sc1
mfa 104,72,120
mfa 108,72,124
sad 33,28,6144
buffer_load_dwordx4 a[192:195], v20, s[16:19], s33 offen sc1
wl 6
mfa 112,76,112
tra 92,11,12288
tra 94,11,14336
mfa 116,76,116
mfa 120,76,120
sad 33,28,55296
buffer_load_dwordx4 a[196:199], v20, s[16:19], s33 offen sc1
mfa 124,76,124
wl 0
s_barrier
mfa 128,80,112
tra 64,8,24576
tra 66,8,26624
mfa 132,80,116
sad 33,28,104448
buffer_load_dwordx4 a[200:203], v20, s[16:19], s33 offen sc1
mfa 136,80,120
mfa 140,80,124
sad 33,28,153600
buffer_load_dwordx4 a[204:207], v20, s[16:19], s33 offen sc1
mfa 144,84,112
tra 68,9,24576
tra 70,9,26624
mfa 148,84,116
mfa 152,84,120
sad 33,28,7168
buffer_load_dwordx4 a[208:211], v20, s[16:19], s33 offen sc1
mfa 156,84,124
mfa 160,88,112
tra 72,10,24576
tra 74,10,26624
mfa 164,88,116
sad 33,28,56320
buffer_load_dwordx4 a[212:215], v20, s[16:19], s33 offen sc1
mfa 168,88,120
mfa 172,88,124
sad 33,28,105472
buffer_load_dwordx4 a[216:219], v20, s[16:19], s33 offen sc1
mfa 176,92,112
tra 76,11,24576
tra 78,11,26624
mfa 180,92,116
mfa 184,92,120
sad 33,28,154624
buffer_load_dwordx4 a[220:223], v20, s[16:19], s33 offen sc1
mfa 188,92,124
wv 20
wl 6
mfa 64,64,128
tra 80,8,32768
tra 82,8,34816
mfa 68,64,132
sad 34,24,327680
s_add_u32 m0, s29, 98304
s_nop 0
buffer_load_dwordx4 v6, s[8:11], s34 offen lds
mfa 72,64,136
mfa 76,64,140
s_add_u32 m0, s29, 99328
s_nop 0
buffer_load_dwordx4 v7, s[8:11], s34 offen lds
wl 6
mfa 80,68,128
tra 84,9,32768
tra 86,9,34816
mfa 84,68,132
mfa 88,68,136
sad 34,25,327680
s_add_u32 m0, s29, 106496
s_nop 0
buffer_load_dwordx4 v6, s[52:55], s34 offen lds
mfa 92,68,140
wl 6
mfa 96,72,128
tra 88,10,32768
tra 90,10,34816
mfa 100,72,132
s_add_u32 m0, s29, 107520
s_nop 0
buffer_load_dwordx4 v7, s[52:55], s34 offen lds
mfa 104,72,136
mfa 108,72,140
sad 33,28,8192
buffer_load_dwordx4 a[224:227], v20, s[16:19], s33 offen sc1
wl 6
mfa 112,76,128
tra 92,11,32768
tra 94,11,34816
mfa 116,76,132
mfa 120,76,136
sad 33,28,57344
buffer_load_dwordx4 a[228:231], v20, s[16:19], s33 offen sc1
mfa 124,76,140
wl 6
mfa 128,80,128
tra 64,8,28672
tra 66,8,30720
mfa 132,80,132
sad 33,28,106496
buffer_load_dwordx4 a[232:235], v20, s[16:19], s33 offen sc1
mfa 136,80,136
mfa 140,80,140
sad 33,28,155648
buffer_load_dwordx4 a[236:239], v20, s[16:19], s33 offen sc1
wl 6
mfa 144,84,128
tra 68,9,28672
tra 70,9,30720
mfa 148,84,132
mfa 152,84,136
sad 33,28,9216
buffer_load_dwordx4 a[240:243], v20, s[16:19], s33 offen sc1
mfa 156,84,140
wl 6
mfa 160,88,128
tra 72,10,28672
tra 74,10,30720
mfa 164,88,132
sad 33,28,58368
buffer_load_dwordx4 a[244:247], v20, s[16:19], s33 offen sc1
mfa 168,88,136
mfa 172,88,140
sad 33,28,107520
buffer_load_dwordx4 a[248:251], v20, s[16:19], s33 offen sc1
wl 6
mfa 176,92,128
tra 76,11,28672
tra 78,11,30720
mfa 180,92,132
mfa 184,92,136
sad 33,28,156672
buffer_load_dwordx4 a[252:255], v20, s[16:19], s33 offen sc1
mfa 188,92,140
wv 28
wl 6
mfa 64,64,144
tra 80,8,36864
tra 82,8,38912
mfa 68,64,148
sad 34,24,409600
s_add_u32 m0, s29, 0
s_nop 0
buffer_load_dwordx4 v6, s[8:11], s34 offen lds
mfa 72,64,152
mfa 76,64,156
s_add_u32 m0, s29, 1024
s_nop 0
buffer_load_dwordx4 v7, s[8:11], s34 offen lds
wl 6
mfa 80,68,144
tra 84,9,36864
tra 86,9,38912
mfa 84,68,148
mfa 88,68,152
sad 34,25,409600
s_add_u32 m0, s29, 8192
s_nop 0
buffer_load_dwordx4 v6, s[52:55], s34 offen lds
mfa 92,68,156
wl 6
mfa 96,72,144
tra 88,10,36864
tra 90,10,38912
mfa 100,72,148
s_add_u32 m0, s29, 9216
s_nop 0
buffer_load_dwordx4 v7, s[52:55], s34 offen lds
mfa 104,72,152
mfa 108,72,156
sad 33,28,10240
buffer_load_dwordx4 a[96:99], v20, s[16:19], s33 offen sc1
wl 6
mfa 112,76,144
tra 92,11,36864
tra 94,11,38912
mfa 116,76,148
mfa 120,76,152
sad 33,28,59392
buffer_load_dwordx4 a[100:103], v20, s[16:19], s33 offen sc1
mfa 124,76,156
wl 0
s_barrier
s_cmp_lt_i32 s70, 0
s_cbranch_scc1 L_pp_172
s_cmp_lg_u32 s4, 1
s_cbranch_scc1 L_pp_172
s_lshl_b32 s83, s70, 7
v_and_b32 v2, 1, v1
v_cmp_eq_u32 vcc, 1, v2
v_mov_b32 v2, s100
v_mov_b32 v3, s101
v_cndmask_b32 v3, v2, v3, vcc
v_and_b32 v2, 31, v1
v_lshlrev_b32 v2, 2, v2
buffer_store_dword v3, v2, s[88:91], s83 offen sc1
L_pp_172:
s_mov_b32 s70, -1
mfa 128,80,144
tra 64,8,49152
tra 66,8,51200
mfa 132,80,148
sad 33,28,108544
buffer_load_dwordx4 a[104:107], v20, s[16:19], s33 offen sc1
mfa 136,80,152
mfa 140,80,156
sad 33,28,157696
buffer_load_dwordx4 a[108:111], v20, s[16:19], s33 offen sc1
mfa 144,84,144
tra 68,9,49152
tra 70,9,51200
mfa 148,84,148
mfa 152,84,152
sad 33,28,11264
buffer_load_dwordx4 a[112:115], v20, s[16:19], s33 offen sc1
mfa 156,84,156
mfa 160,88,144
tra 72,10,49152
tra 74,10,51200
mfa 164,88,148
sad 33,28,60416
buffer_load_dwordx4 a[116:119], v20, s[16:19], s33 offen sc1
mfa 168,88,152
mfa 172,88,156
sad 33,28,109568
buffer_load_dwordx4 a[120:123], v20, s[16:19], s33 offen sc1
mfa 176,92,144
tra 76,11,49152
tra 78,11,51200
mfa 180,92,148
mfa 184,92,152
sad 33,28,158720
buffer_load_dwordx4 a[124:127], v20, s[16:19], s33 offen sc1
mfa 188,92,156
wv 36
wl 6
mfa 64,64,160
tra 80,8,57344
tra 82,8,59392
mfa 68,64,164
mfa 72,64,168
sad 34,24,491520
s_add_u32 m0, s29, 24576
s_nop 0
buffer_load_dwordx4 v6, s[8:11], s34 offen lds
mfa 76,64,172
wl 6
mfa 80,68,160
tra 84,9,57344
tra 86,9,59392
mfa 84,68,164
mfa 88,68,168
s_add_u32 m0, s29, 25600
s_nop 0
buffer_load_dwordx4 v7, s[8:11], s34 offen lds
mfa 92,68,172
wl 6
mfa 96,72,160
tra 88,10,57344
tra 90,10,59392
mfa 100,72,164
mfa 104,72,168
sad 34,25,491520
s_add_u32 m0, s29, 32768
s_nop 0
buffer_load_dwordx4 v6, s[52:55], s34 offen lds
mfa 108,72,172
wl 6
mfa 112,76,160
tra 92,11,57344
tra 94,11,59392
mfa 116,76,164
mfa 120,76,168
s_add_u32 m0, s29, 33792
s_nop 0
buffer_load_dwordx4 v7, s[52:55], s34 offen lds
mfa 124,76,172
wl 6
mfa 128,80,160
tra 64,8,53248
tra 66,8,55296
mfa 132,80,164
mfa 136,80,168
sad 33,28,12288
buffer_load_dwordx4 a[128:131], v20, s[16:19], s33 offen sc1
mfa 140,80,172
wl 6
mfa 144,84,160
tra 68,9,53248
tra 70,9,55296
mfa 148,84,164
mfa 152,84,168
sad 33,28,61440
buffer_load_dwordx4 a[132:135], v20, s[16:19], s33 offen sc1
mfa 156,84,172
wl 6
mfa 160,88,160
tra 72,10,53248
tra 74,10,55296
mfa 164,88,164
mfa 168,88,168
sad 33,28,110592
buffer_load_dwordx4 a[136:139], v20, s[16:19], s33 offen sc1
mfa 172,88,172
wl 6
mfa 176,92,160
tra 76,11,53248
tra 78,11,55296
mfa 180,92,164
mfa 184,92,168
sad 33,28,159744
buffer_load_dwordx4 a[140:143], v20, s[16:19], s33 offen sc1
mfa 188,92,172
wv 40
wl 6
mfa 64,64,176
tra 80,8,61440
tra 82,8,63488
mfa 68,64,180
mfa 72,64,184
sad 33,28,13312
buffer_load_dwordx4 a[144:147], v20, s[16:19], s33 offen sc1
mfa 76,64,188
wl 6
mfa 80,68,176
tra 84,9,61440
tra 86,9,63488
mfa 84,68,180
mfa 88,68,184
sad 33,28,62464
buffer_load_dwordx4 a[148:151], v20, s[16:19], s33 offen sc1
mfa 92,68,188
wl 6
mfa 96,72,176
tra 88,10,61440
tra 90,10,63488
mfa 100,72,180
mfa 104,72,184
sad 33,28,111616
buffer_load_dwordx4 a[152:155], v20, s[16:19], s33 offen sc1
mfa 108,72,188
wl 6
mfa 112,76,176
tra 92,11,61440
tra 94,11,63488
mfa 116,76,180
mfa 120,76,184
sad 33,28,160768
buffer_load_dwordx4 a[156:159], v20, s[16:19], s33 offen sc1
mfa 124,76,188
wl 0
s_barrier
mfa 128,80,176
tra 64,12,24576
tra 66,12,26624
mfa 132,80,180
mfa 136,80,184
sad 34,24,573440
s_add_u32 m0, s29, 49152
s_nop 0
buffer_load_dwordx4 v6, s[8:11], s34 offen lds
mfa 140,80,188
mfa 144,84,176
tra 68,13,24576
tra 70,13,26624
mfa 148,84,180
mfa 152,84,184
s_add_u32 m0, s29, 50176
s_nop 0
buffer_load_dwordx4 v7, s[8:11], s34 offen lds
mfa 156,84,188
mfa 160,88,176
tra 72,14,24576
tra 74,14,26624
mfa 164,88,180
mfa 168,88,184
sad 34,25,573440
s_add_u32 m0, s29, 57344
s_nop 0
buffer_load_dwordx4 v6, s[52:55], s34 offen lds
mfa 172,88,188
mfa 176,92,176
tra 76,15,24576
tra 78,15,26624
mfa 180,92,180
mfa 184,92,184
s_add_u32 m0, s29, 58368
s_nop 0
buffer_load_dwordx4 v7, s[52:55], s34 offen lds
mfa 188,92,188
wv 44
wl 6
mfa 64,64,192
tra 80,12,32768
tra 82,12,34816
mfa 68,64,196
mfa 72,64,200
sad 33,28,14336
buffer_load_dwordx4 a[160:163], v20, s[16:19], s33 offen sc1
mfa 76,64,204
wl 6
mfa 80,68,192
tra 84,13,32768
tra 86,13,34816
mfa 84,68,196
mfa 88,68,200
sad 33,28,63488
buffer_load_dwordx4 a[164:167], v20, s[16:19], s33 offen sc1
mfa 92,68,204
wl 6
mfa 96,72,192
tra 88,14,32768
tra 90,14,34816
mfa 100,72,196
mfa 104,72,200
sad 33,28,112640
buffer_load_dwordx4 a[168:171], v20, s[16:19], s33 offen sc1
mfa 108,72,204
wl 6
mfa 112,76,192
tra 92,15,32768
tra 94,15,34816
mfa 116,76,196
mfa 120,76,200
sad 33,28,161792
buffer_load_dwordx4 a[172:175], v20, s[16:19], s33 offen sc1
mfa 124,76,204
wl 6
mfa 128,80,192
tra 64,12,28672
tra 66,12,30720
mfa 132,80,196
mfa 136,80,200
sad 33,28,15360
buffer_load_dwordx4 a[176:179], v20, s[16:19], s33 offen sc1
mfa 140,80,204
wl 6
mfa 144,84,192
tra 68,13,28672
tra 70,13,30720
mfa 148,84,196
mfa 152,84,200
sad 33,28,64512
buffer_load_dwordx4 a[180:183], v20, s[16:19], s33 offen sc1
mfa 156,84,204
wl 6
mfa 160,88,192
tra 72,14,28672
tra 74,14,30720
mfa 164,88,196
mfa 168,88,200
sad 33,28,113664
buffer_load_dwordx4 a[184:187], v20, s[16:19], s33 offen sc1
mfa 172,88,204
wl 6
mfa 176,92,192
tra 76,15,28672
tra 78,15,30720
mfa 180,92,196
mfa 184,92,200
sad 33,28,162816
buffer_load_dwordx4 a[188:191], v20, s[16:19], s33 offen sc1
mfa 188,92,204
wv 48
wl 6
mfa 64,64,208
tra 80,12,36864
tra 82,12,38912
mfa 68,64,212
mfa 72,64,216
mfa 76,64,220
wl 6
mfa 80,68,208
tra 84,13,36864
tra 86,13,38912
mfa 84,68,212
mfa 88,68,216
mfa 92,68,220
wl 6
mfa 96,72,208
tra 88,14,36864
tra 90,14,38912
mfa 100,72,212
mfa 104,72,216
mfa 108,72,220
wl 6
mfa 112,76,208
tra 92,15,36864
tra 94,15,38912
mfa 116,76,212
mfa 120,76,216
mfa 124,76,220
s_waitcnt vmcnt(44) lgkmcnt(0)
s_barrier
mfa 128,80,208
tra 64,12,49152
tra 66,12,51200
mfa 132,80,212
sad 34,24,655360
s_add_u32 m0, s29, 73728
s_nop 0
buffer_load_dwordx4 v6, s[8:11], s34 offen lds
mfa 136,80,216
mfa 140,80,220
mfa 144,84,208
tra 68,13,49152
tra 70,13,51200
mfa 148,84,212
s_add_u32 m0, s29, 74752
s_nop 0
buffer_load_dwordx4 v7, s[8:11], s34 offen lds
mfa 152,84,216
mfa 156,84,220
mfa 160,88,208
tra 72,14,49152
tra 74,14,51200
mfa 164,88,212
sad 34,25,655360
s_add_u32 m0, s29, 81920
s_nop 0
buffer_load_dwordx4 v6, s[52:55], s34 offen lds
mfa 168,88,216
mfa 172,88,220
mfa 176,92,208
tra 76,15,49152
tra 78,15,51200
mfa 180,92,212
s_add_u32 m0, s29, 82944
s_nop 0
buffer_load_dwordx4 v7, s[52:55], s34 offen lds
mfa 184,92,216
mfa 188,92,220
wv 44
wl 6
mfa 64,64,224
tra 80,12,57344
tra 82,12,59392
mfa 68,64,228
sad 33,28,16384
buffer_load_dwordx4 a[192:195], v20, s[16:19], s33 offen sc1
mfa 72,64,232
mfa 76,64,236
wl 6
mfa 80,68,224
tra 84,13,57344
tra 86,13,59392
mfa 84,68,228
sad 33,28,65536
buffer_load_dwordx4 a[196:199], v20, s[16:19], s33 offen sc1
mfa 88,68,232
mfa 92,68,236
wl 6
mfa 96,72,224
tra 88,14,57344
tra 90,14,59392
mfa 100,72,228
sad 33,28,114688
buffer_load_dwordx4 a[200:203], v20, s[16:19], s33 offen sc1
mfa 104,72,232
mfa 108,72,236
wl 6
mfa 112,76,224
tra 92,15,57344
tra 94,15,59392
mfa 116,76,228
sad 33,28,163840
buffer_load_dwordx4 a[204:207], v20, s[16:19], s33 offen sc1
mfa 120,76,232
mfa 124,76,236
wl 6
mfa 128,80,224
tra 64,12,53248
tra 66,12,55296
mfa 132,80,228
sad 33,28,17408
buffer_load_dwordx4 a[208:211], v20, s[16:19], s33 offen sc1
mfa 136,80,232
mfa 140,80,236
wl 6
mfa 144,84,224
tra 68,13,53248
tra 70,13,55296
mfa 148,84,228
sad 33,28,66560
buffer_load_dwordx4 a[212:215], v20, s[16:19], s33 offen sc1
mfa 152,84,232
mfa 156,84,236
wl 6
mfa 160,88,224
tra 72,14,53248
tra 74,14,55296
mfa 164,88,228
sad 33,28,115712
buffer_load_dwordx4 a[216:219], v20, s[16:19], s33 offen sc1
mfa 168,88,232
mfa 172,88,236
wl 6
mfa 176,92,224
tra 76,15,53248
tra 78,15,55296
mfa 180,92,228
sad 33,28,164864
buffer_load_dwordx4 a[220:223], v20, s[16:19], s33 offen sc1
mfa 184,92,232
mfa 188,92,236
wv 48
wl 6
mfa 64,64,240
tra 80,12,61440
tra 82,12,63488
mfa 68,64,244
mfa 72,64,248
mfa 76,64,252
wl 6
mfa 80,68,240
tra 84,13,61440
tra 86,13,63488
mfa 84,68,244
mfa 88,68,248
mfa 92,68,252
wl 6
mfa 96,72,240
tra 88,14,61440
tra 90,14,63488
mfa 100,72,244
mfa 104,72,248
mfa 108,72,252
wl 6
mfa 112,76,240
tra 92,15,61440
tra 94,15,63488
mfa 116,76,244
mfa 120,76,248
mfa 124,76,252
s_waitcnt vmcnt(44) lgkmcnt(0)
s_barrier
mfa 128,80,240
tra 64,8,0
tra 66,8,2048
mfa 132,80,244
sad 34,24,737280
s_add_u32 m0, s29, 98304
s_nop 0
buffer_load_dwordx4 v6, s[8:11], s34 offen lds
mfa 136,80,248
mfa 140,80,252
mfa 144,84,240
tra 68,9,0
tra 70,9,2048
mfa 148,84,244
s_add_u32 m0, s29, 99328
s_nop 0
buffer_load_dwordx4 v7, s[8:11], s34 offen lds
mfa 152,84,248
mfa 156,84,252
mfa 160,88,240
tra 72,10,0
tra 74,10,2048
mfa 164,88,244
sad 34,25,737280
s_add_u32 m0, s29, 106496
s_nop 0
buffer_load_dwordx4 v6, s[52:55], s34 offen lds
mfa 168,88,248
mfa 172,88,252
mfa 176,92,240
tra 76,11,0
tra 78,11,2048
mfa 180,92,244
s_add_u32 m0, s29, 107520
s_nop 0
buffer_load_dwordx4 v7, s[52:55], s34 offen lds
mfa 184,92,248
mfa 188,92,252
wv 44
wl 6
mfa 64,64,96
tra 80,8,8192
tra 82,8,10240
mfa 68,64,100
sad 33,28,18432
buffer_load_dwordx4 a[224:227], v20, s[16:19], s33 offen sc1
mfa 72,64,104
mfa 76,64,108
wl 6
mfa 80,68,96
tra 84,9,8192
tra 86,9,10240
mfa 84,68,100
sad 33,28,67584
buffer_load_dwordx4 a[228:231], v20, s[16:19], s33 offen sc1
mfa 88,68,104
mfa 92,68,108
wl 6
mfa 96,72,96
tra 88,10,8192
tra 90,10,10240
mfa 100,72,100
sad 33,28,116736
buffer_load_dwordx4 a[232:235], v20, s[16:19], s33 offen sc1
mfa 104,72,104
mfa 108,72,108
wl 6
mfa 112,76,96
tra 92,11,8192
tra 94,11,10240
mfa 116,76,100
sad 33,28,165888
buffer_load_dwordx4 a[236:239], v20, s[16:19], s33 offen sc1
mfa 120,76,104
mfa 124,76,108
wl 6
mfa 128,80,96
tra 64,8,4096
tra 66,8,6144
mfa 132,80,100
sad 33,28,19456
buffer_load_dwordx4 a[240:243], v20, s[16:19], s33 offen sc1
mfa 136,80,104
mfa 140,80,108
wl 6
mfa 144,84,96
tra 68,9,4096
tra 70,9,6144
mfa 148,84,100
sad 33,28,68608
buffer_load_dwordx4 a[244:247], v20, s[16:19], s33 offen sc1
mfa 152,84,104
mfa 156,84,108
wl 6
mfa 160,88,96
tra 72,10,4096
tra 74,10,6144
mfa 164,88,100
sad 33,28,117760
buffer_load_dwordx4 a[248:251], v20, s[16:19], s33 offen sc1
mfa 168,88,104
mfa 172,88,108
wl 6
mfa 176,92,96
tra 76,11,4096
tra 78,11,6144
mfa 180,92,100
sad 33,28,166912
buffer_load_dwordx4 a[252:255], v20, s[16:19], s33 offen sc1
mfa 184,92,104
mfa 188,92,108
wv 48
wl 6
mfa 64,64,112
tra 80,8,12288
tra 82,8,14336
mfa 68,64,116
mfa 72,64,120
mfa 76,64,124
wl 6
mfa 80,68,112
tra 84,9,12288
tra 86,9,14336
mfa 84,68,116
mfa 88,68,120
mfa 92,68,124
wl 6
mfa 96,72,112
tra 88,10,12288
tra 90,10,14336
mfa 100,72,116
mfa 104,72,120
mfa 108,72,124
wl 6
mfa 112,76,112
tra 92,11,12288
tra 94,11,14336
mfa 116,76,116
mfa 120,76,120
mfa 124,76,124
s_waitcnt vmcnt(44) lgkmcnt(0)
s_barrier
mfa 128,80,112
tra 64,8,24576
tra 66,8,26624
mfa 132,80,116
sad 34,24,819200
s_add_u32 m0, s29, 0
s_nop 0
buffer_load_dwordx4 v6, s[8:11], s34 offen lds
mfa 136,80,120
mfa 140,80,124
mfa 144,84,112
tra 68,9,24576
tra 70,9,26624
mfa 148,84,116
s_add_u32 m0, s29, 1024
s_nop 0
buffer_load_dwordx4 v7, s[8:11], s34 offen lds
mfa 152,84,120
mfa 156,84,124
mfa 160,88,112
tra 72,10,24576
tra 74,10,26624
mfa 164,88,116
sad 34,25,819200
s_add_u32 m0, s29, 8192
s_nop 0
buffer_load_dwordx4 v6, s[52:55], s34 offen lds
mfa 168,88,120
mfa 172,88,124
mfa 176,92,112
tra 76,11,24576
tra 78,11,26624
mfa 180,92,116
s_add_u32 m0, s29, 9216
s_nop 0
buffer_load_dwordx4 v7, s[52:55], s34 offen lds
mfa 184,92,120
mfa 188,92,124
wv 44
wl 6
mfa 64,64,128
tra 80,8,32768
tra 82,8,34816
mfa 68,64,132
sad 33,28,20480
buffer_load_dwordx4 a[96:99], v20, s[16:19], s33 offen sc1
mfa 72,64,136
mfa 76,64,140
wl 6
mfa 80,68,128
tra 84,9,32768
tra 86,9,34816
mfa 84,68,132
sad 33,28,69632
buffer_load_dwordx4 a[100:103], v20, s[16:19], s33 offen sc1
mfa 88,68,136
mfa 92,68,140
wl 6
mfa 96,72,128
tra 88,10,32768
tra 90,10,34816
mfa 100,72,132
sad 33,28,118784
buffer_load_dwordx4 a[104:107], v20, s[16:19], s33 offen sc1
mfa 104,72,136
mfa 108,72,140
wl 6
mfa 112,76,128
tra 92,11,32768
tra 94,11,34816
mfa 116,76,132
sad 33,28,167936
buffer_load_dwordx4 a[108:111], v20, s[16:19], s33 offen sc1
mfa 120,76,136
mfa 124,76,140
wl 6
mfa 128,80,128
tra 64,8,28672
tra 66,8,30720
mfa 132,80,132
sad 33,28,21504
buffer_load_dwordx4 a[112:115], v20, s[16:19], s33 offen sc1
mfa 136,80,136
mfa 140,80,140
wl 6
mfa 144,84,128
tra 68,9,28672
tra 70,9,30720
mfa 148,84,132
sad 33,28,70656
buffer_load_dwordx4 a[116:119], v20, s[16:19], s33 offen sc1
mfa 152,84,136
mfa 156,84,140
wl 6
mfa 160,88,128
tra 72,10,28672
tra 74,10,30720
mfa 164,88,132
sad 33,28,119808
buffer_load_dwordx4 a[120:123], v20, s[16:19], s33 offen sc1
mfa 168,88,136
mfa 172,88,140
wl 6
mfa 176,92,128
tra 76,11,28672
tra 78,11,30720
mfa 180,92,132
sad 33,28,168960
buffer_load_dwordx4 a[124:127], v20, s[16:19], s33 offen sc1
mfa 184,92,136
mfa 188,92,140
wv 48
wl 6
mfa 64,64,144
tra 80,8,36864
tra 82,8,38912
mfa 68,64,148
mfa 72,64,152
mfa 76,64,156
wl 6
mfa 80,68,144
tra 84,9,36864
tra 86,9,38912
mfa 84,68,148
mfa 88,68,152
mfa 92,68,156
wl 6
mfa 96,72,144
tra 88,10,36864
tra 90,10,38912
mfa 100,72,148
mfa 104,72,152
mfa 108,72,156
wl 6
mfa 112,76,144
tra 92,11,36864
tra 94,11,38912
mfa 116,76,148
mfa 120,76,152
mfa 124,76,156
s_waitcnt vmcnt(44) lgkmcnt(0)
s_barrier
mfa 128,80,144
tra 64,8,49152
tra 66,8,51200
mfa 132,80,148
sad 34,24,901120
s_add_u32 m0, s29, 24576
s_nop 0
buffer_load_dwordx4 v6, s[8:11], s34 offen lds
mfa 136,80,152
mfa 140,80,156
mfa 144,84,144
tra 68,9,49152
tra 70,9,51200
mfa 148,84,148
s_add_u32 m0, s29, 25600
s_nop 0
buffer_load_dwordx4 v7, s[8:11], s34 offen lds
mfa 152,84,152
mfa 156,84,156
mfa 160,88,144
tra 72,10,49152
tra 74,10,51200
mfa 164,88,148
sad 34,25,901120
s_add_u32 m0, s29, 32768
s_nop 0
buffer_load_dwordx4 v6, s[52:55], s34 offen lds
mfa 168,88,152
mfa 172,88,156
mfa 176,92,144
tra 76,11,49152
tra 78,11,51200
mfa 180,92,148
s_add_u32 m0, s29, 33792
s_nop 0
buffer_load_dwordx4 v7, s[52:55], s34 offen lds
mfa 184,92,152
mfa 188,92,156
wv 44
wl 6
mfa 64,64,160
tra 80,8,57344
tra 82,8,59392
mfa 68,64,164
sad 33,28,22528
buffer_load_dwordx4 a[128:131], v20, s[16:19], s33 offen sc1
mfa 72,64,168
mfa 76,64,172
wl 6
mfa 80,68,160
tra 84,9,57344
tra 86,9,59392
mfa 84,68,164
sad 33,28,71680
buffer_load_dwordx4 a[132:135], v20, s[16:19], s33 offen sc1
mfa 88,68,168
mfa 92,68,172
wl 6
mfa 96,72,160
tra 88,10,57344
tra 90,10,59392
mfa 100,72,164
sad 33,28,120832
buffer_load_dwordx4 a[136:139], v20, s[16:19], s33 offen sc1
mfa 104,72,168
mfa 108,72,172
wl 6
mfa 112,76,160
tra 92,11,57344
tra 94,11,59392
mfa 116,76,164
sad 33,28,169984
buffer_load_dwordx4 a[140:143], v20, s[16:19], s33 offen sc1
mfa 120,76,168
mfa 124,76,172
wl 6
mfa 128,80,160
tra 64,8,53248
tra 66,8,55296
mfa 132,80,164
sad 33,28,23552
buffer_load_dwordx4 a[144:147], v20, s[16:19], s33 offen sc1
mfa 136,80,168
mfa 140,80,172
wl 6
mfa 144,84,160
tra 68,9,53248
tra 70,9,55296
mfa 148,84,164
sad 33,28,72704
buffer_load_dwordx4 a[148:151], v20, s[16:19], s33 offen sc1
mfa 152,84,168
mfa 156,84,172
wl 6
mfa 160,88,160
tra 72,10,53248
tra 74,10,55296
mfa 164,88,164
sad 33,28,121856
buffer_load_dwordx4 a[152:155], v20, s[16:19], s33 offen sc1
mfa 168,88,168
mfa 172,88,172
wl 6
mfa 176,92,160
tra 76,11,53248
tra 78,11,55296
mfa 180,92,164
sad 33,28,171008
buffer_load_dwordx4 a[156:159], v20, s[16:19], s33 offen sc1
mfa 184,92,168
mfa 188,92,172
wv 48
wl 6
mfa 64,64,176
tra 80,8,61440
tra 82,8,63488
mfa 68,64,180
mfa 72,64,184
mfa 76,64,188
wl 6
mfa 80,68,176
tra 84,9,61440
tra 86,9,63488
mfa 84,68,180
mfa 88,68,184
mfa 92,68,188
wl 6
mfa 96,72,176
tra 88,10,61440
tra 90,10,63488
mfa 100,72,180
mfa 104,72,184
mfa 108,72,188
wl 6
mfa 112,76,176
tra 92,11,61440
tra 94,11,63488
mfa 116,76,180
mfa 120,76,184
mfa 124,76,188
s_waitcnt vmcnt(44) lgkmcnt(0)
s_barrier
mfa 128,80,176
tra 64,12,24576
tra 66,12,26624
mfa 132,80,180
sad 34,24,983040
s_add_u32 m0, s29, 49152
s_nop 0
buffer_load_dwordx4 v6, s[8:11], s34 offen lds
mfa 136,80,184
mfa 140,80,188
mfa 144,84,176
tra 68,13,24576
tra 70,13,26624
mfa 148,84,180
s_add_u32 m0, s29, 50176
s_nop 0
buffer_load_dwordx4 v7, s[8:11], s34 offen lds
mfa 152,84,184
mfa 156,84,188
mfa 160,88,176
tra 72,14,24576
tra 74,14,26624
mfa 164,88,180
sad 34,25,983040
s_add_u32 m0, s29, 57344
s_nop 0
buffer_load_dwordx4 v6, s[52:55], s34 offen lds
mfa 168,88,184
mfa 172,88,188
mfa 176,92,176
tra 76,15,24576
tra 78,15,26624
mfa 180,92,180
s_add_u32 m0, s29, 58368
s_nop 0
buffer_load_dwordx4 v7, s[52:55], s34 offen lds
mfa 184,92,184
mfa 188,92,188
wv 44
wl 6
mfa 64,64,192
tra 80,12,32768
tra 82,12,34816
mfa 68,64,196
sad 33,28,24576
buffer_load_dwordx4 a[160:163], v20, s[16:19], s33 offen sc1
mfa 72,64,200
mfa 76,64,204
wl 6
mfa 80,68,192
tra 84,13,32768
tra 86,13,34816
mfa 84,68,196
sad 33,28,73728
buffer_load_dwordx4 a[164:167], v20, s[16:19], s33 offen sc1
mfa 88,68,200
mfa 92,68,204
wl 6
mfa 96,72,192
tra 88,14,32768
tra 90,14,34816
mfa 100,72,196
sad 33,28,122880
buffer_load_dwordx4 a[168:171], v20, s[16:19], s33 offen sc1
mfa 104,72,200
mfa 108,72,204
wl 6
mfa 112,76,192
tra 92,15,32768
tra 94,15,34816
mfa 116,76,196
sad 33,28,172032
buffer_load_dwordx4 a[172:175], v20, s[16:19], s33 offen sc1
mfa 120,76,200
mfa 124,76,204
wl 6
mfa 128,80,192
tra 64,12,28672
tra 66,12,30720
mfa 132,80,196
sad 33,28,25600
buffer_load_dwordx4 a[176:179], v20, s[16:19], s33 offen sc1
mfa 136,80,200
mfa 140,80,204
wl 6
mfa 144,84,192
tra 68,13,28672
tra 70,13,30720
mfa 148,84,196
sad 33,28,74752
buffer_load_dwordx4 a[180:183], v20, s[16:19], s33 offen sc1
mfa 152,84,200
mfa 156,84,204
wl 6
mfa 160,88,192
tra 72,14,28672
tra 74,14,30720
mfa 164,88,196
sad 33,28,123904
buffer_load_dwordx4 a[184:187], v20, s[16:19], s33 offen sc1
mfa 168,88,200
mfa 172,88,204
wl 6
mfa 176,92,192
tra 76,15,28672
tra 78,15,30720
mfa 180,92,196
sad 33,28,173056
buffer_load_dwordx4 a[188:191], v20, s[16:19], s33 offen sc1
mfa 184,92,200
mfa 188,92,204
wv 48
wl 6
mfa 64,64,208
tra 80,12,36864
tra 82,12,38912
mfa 68,64,212
mfa 72,64,216
mfa 76,64,220
wl 6
mfa 80,68,208
tra 84,13,36864
tra 86,13,38912
mfa 84,68,212
mfa 88,68,216
mfa 92,68,220
wl 6
mfa 96,72,208
tra 88,14,36864
tra 90,14,38912
mfa 100,72,212
mfa 104,72,216
mfa 108,72,220
wl 6
mfa 112,76,208
tra 92,15,36864
tra 94,15,38912
mfa 116,76,212
mfa 120,76,216
mfa 124,76,220
s_waitcnt vmcnt(44) lgkmcnt(0)
s_barrier
mfa 128,80,208
tra 64,12,49152
tra 66,12,51200
mfa 132,80,212
sad 34,24,1064960
s_add_u32 m0, s29, 73728
s_nop 0
buffer_load_dwordx4 v6, s[8:11], s34 offen lds
mfa 136,80,216
mfa 140,80,220
mfa 144,84,208
tra 68,13,49152
tra 70,13,51200
mfa 148,84,212
s_add_u32 m0, s29, 74752
s_nop 0
buffer_load_dwordx4 v7, s[8:11], s34 offen lds
mfa 152,84,216
mfa 156,84,220
mfa 160,88,208
tra 72,14,49152
tra 74,14,51200
mfa 164,88,212
sad 34,25,1064960
s_add_u32 m0, s29, 81920
s_nop 0
buffer_load_dwordx4 v6, s[52:55], s34 offen lds
mfa 168,88,216
mfa 172,88,220
mfa 176,92,208
tra 76,15,49152
tra 78,15,51200
mfa 180,92,212
s_add_u32 m0, s29, 82944
s_nop 0
buffer_load_dwordx4 v7, s[52:55], s34 offen lds
mfa 184,92,216
mfa 188,92,220
wv 44
wl 6
mfa 64,64,224
tra 80,12,57344
tra 82,12,59392
mfa 68,64,228
sad 33,28,26624
buffer_load_dwordx4 a[192:195], v20, s[16:19], s33 offen sc1
mfa 72,64,232
mfa 76,64,236
wl 6
mfa 80,68,224
tra 84,13,57344
tra 86,13,59392
mfa 84,68,228
sad 33,28,75776
buffer_load_dwordx4 a[196:199], v20, s[16:19], s33 offen sc1
mfa 88,68,232
mfa 92,68,236
wl 6
mfa 96,72,224
tra 88,14,57344
tra 90,14,59392
mfa 100,72,228
sad 33,28,124928
buffer_load_dwordx4 a[200:203], v20, s[16:19], s33 offen sc1
mfa 104,72,232
mfa 108,72,236
wl 6
mfa 112,76,224
tra 92,15,57344
tra 94,15,59392
mfa 116,76,228
sad 33,28,174080
buffer_load_dwordx4 a[204:207], v20, s[16:19], s33 offen sc1
mfa 120,76,232
mfa 124,76,236
wl 6
mfa 128,80,224
tra 64,12,53248
tra 66,12,55296
mfa 132,80,228
sad 33,28,27648
buffer_load_dwordx4 a[208:211], v20, s[16:19], s33 offen sc1
mfa 136,80,232
mfa 140,80,236
wl 6
mfa 144,84,224
tra 68,13,53248
tra 70,13,55296
mfa 148,84,228
sad 33,28,76800
buffer_load_dwordx4 a[212:215], v20, s[16:19], s33 offen sc1
mfa 152,84,232
mfa 156,84,236
wl 6
mfa 160,88,224
tra 72,14,53248
tra 74,14,55296
mfa 164,88,228
sad 33,28,125952
buffer_load_dwordx4 a[216:219], v20, s[16:19], s33 offen sc1
mfa 168,88,232
mfa 172,88,236
wl 6
mfa 176,92,224
tra 76,15,53248
tra 78,15,55296
mfa 180,92,228
sad 33,28,175104
buffer_load_dwordx4 a[220:223], v20, s[16:19], s33 offen sc1
mfa 184,92,232
mfa 188,92,236
wv 48
wl 6
mfa 64,64,240
tra 80,12,61440
tra 82,12,63488
mfa 68,64,244
mfa 72,64,248
mfa 76,64,252
wl 6
mfa 80,68,240
tra 84,13,61440
tra 86,13,63488
mfa 84,68,244
mfa 88,68,248
mfa 92,68,252
wl 6
mfa 96,72,240
tra 88,14,61440
tra 90,14,63488
mfa 100,72,244
mfa 104,72,248
mfa 108,72,252
wl 6
mfa 112,76,240
tra 92,15,61440
tra 94,15,63488
mfa 116,76,244
mfa 120,76,248
mfa 124,76,252
s_waitcnt vmcnt(44) lgkmcnt(0)
s_barrier
mfa 128,80,240
tra 64,8,0
tra 66,8,2048
mfa 132,80,244
sad 34,24,1146880
s_add_u32 m0, s29, 98304
s_nop 0
buffer_load_dwordx4 v6, s[8:11], s34 offen lds
mfa 136,80,248
mfa 140,80,252
mfa 144,84,240
tra 68,9,0
tra 70,9,2048
mfa 148,84,244
s_add_u32 m0, s29, 99328
s_nop 0
buffer_load_dwordx4 v7, s[8:11], s34 offen lds
mfa 152,84,248
mfa 156,84,252
mfa 160,88,240
tra 72,10,0
tra 74,10,2048
mfa 164,88,244
sad 34,25,1146880
s_add_u32 m0, s29, 106496
s_nop 0
buffer_load_dwordx4 v6, s[52:55], s34 offen lds
mfa 168,88,248
mfa 172,88,252
mfa 176,92,240
tra 76,11,0
tra 78,11,2048
mfa 180,92,244
s_add_u32 m0, s29, 107520
s_nop 0
buffer_load_dwordx4 v7, s[52:55], s34 offen lds
mfa 184,92,248
mfa 188,92,252
wv 44
wl 6
mfa 64,64,96
tra 80,8,8192
tra 82,8,10240
mfa 68,64,100
sad 33,28,28672
buffer_load_dwordx4 a[224:227], v20, s[16:19], s33 offen sc1
mfa 72,64,104
mfa 76,64,108
wl 6
mfa 80,68,96
tra 84,9,8192
tra 86,9,10240
mfa 84,68,100
sad 33,28,77824
buffer_load_dwordx4 a[228:231], v20, s[16:19], s33 offen sc1
mfa 88,68,104
mfa 92,68,108
wl 6
mfa 96,72,96
tra 88,10,8192
tra 90,10,10240
mfa 100,72,100
sad 33,28,126976
buffer_load_dwordx4 a[232:235], v20, s[16:19], s33 offen sc1
mfa 104,72,104
mfa 108,72,108
wl 6
mfa 112,76,96
tra 92,11,8192
tra 94,11,10240
mfa 116,76,100
sad 33,28,176128
buffer_load_dwordx4 a[236:239], v20, s[16:19], s33 offen sc1
mfa 120,76,104
mfa 124,76,108
wl 6
mfa 128,80,96
tra 64,8,4096
tra 66,8,6144
mfa 132,80,100
sad 33,28,29696
buffer_load_dwordx4 a[240:243], v20, s[16:19], s33 offen sc1
mfa 136,80,104
mfa 140,80,108
wl 6
mfa 144,84,96
tra 68,9,4096
tra 70,9,6144
mfa 148,84,100
sad 33,28,78848
buffer_load_dwordx4 a[244:247], v20, s[16:19], s33 offen sc1
mfa 152,84,104
mfa 156,84,108
wl 6
mfa 160,88,96
tra 72,10,4096
tra 74,10,6144
mfa 164,88,100
sad 33,28,128000
buffer_load_dwordx4 a[248:251], v20, s[16:19], s33 offen sc1
mfa 168,88,104
mfa 172,88,108
wl 6
mfa 176,92,96
tra 76,11,4096
tra 78,11,6144
mfa 180,92,100
sad 33,28,177152
buffer_load_dwordx4 a[252:255], v20, s[16:19], s33 offen sc1
mfa 184,92,104
mfa 188,92,108
wv 48
wl 6
mfa 64,64,112
tra 80,8,12288
tra 82,8,14336
mfa 68,64,116
mfa 72,64,120
mfa 76,64,124
wl 6
mfa 80,68,112
tra 84,9,12288
tra 86,9,14336
mfa 84,68,116
mfa 88,68,120
mfa 92,68,124
wl 6
mfa 96,72,112
tra 88,10,12288
tra 90,10,14336
mfa 100,72,116
mfa 104,72,120
mfa 108,72,124
wl 6
mfa 112,76,112
tra 92,11,12288
tra 94,11,14336
mfa 116,76,116
mfa 120,76,120
mfa 124,76,124
s_waitcnt vmcnt(44) lgkmcnt(0)
s_barrier
mfa 128,80,112
tra 64,8,24576
tra 66,8,26624
mfa 132,80,116
sad 34,24,1228800
s_add_u32 m0, s29, 0
s_nop 0
buffer_load_dwordx4 v6, s[8:11], s34 offen lds
mfa 136,80,120
mfa 140,80,124
mfa 144,84,112
tra 68,9,24576
tra 70,9,26624
mfa 148,84,116
s_add_u32 m0, s29, 1024
s_nop 0
buffer_load_dwordx4 v7, s[8:11], s34 offen lds
mfa 152,84,120
mfa 156,84,124
mfa 160,88,112
tra 72,10,24576
tra 74,10,26624
mfa 164,88,116
sad 34,25,1228800
s_add_u32 m0, s29, 8192
s_nop 0
buffer_load_dwordx4 v6, s[52:55], s34 offen lds
mfa 168,88,120
mfa 172,88,124
mfa 176,92,112
tra 76,11,24576
tra 78,11,26624
mfa 180,92,116
s_add_u32 m0, s29, 9216
s_nop 0
buffer_load_dwordx4 v7, s[52:55], s34 offen lds
mfa 184,92,120
mfa 188,92,124
wv 44
wl 6
mfa 64,64,128
tra 80,8,32768
tra 82,8,34816
mfa 68,64,132
sad 33,28,30720
buffer_load_dwordx4 a[96:99], v20, s[16:19], s33 offen sc1
mfa 72,64,136
mfa 76,64,140
wl 6
mfa 80,68,128
tra 84,9,32768
tra 86,9,34816
mfa 84,68,132
sad 33,28,79872
buffer_load_dwordx4 a[100:103], v20, s[16:19], s33 offen sc1
mfa 88,68,136
mfa 92,68,140
wl 6
mfa 96,72,128
tra 88,10,32768
tra 90,10,34816
mfa 100,72,132
sad 33,28,129024
buffer_load_dwordx4 a[104:107], v20, s[16:19], s33 offen sc1
mfa 104,72,136
mfa 108,72,140
wl 6
mfa 112,76,128
tra 92,11,32768
tra 94,11,34816
mfa 116,76,132
sad 33,28,178176
buffer_load_dwordx4 a[108:111], v20, s[16:19], s33 offen sc1
mfa 120,76,136
mfa 124,76,140
wl 6
mfa 128,80,128
tra 64,8,28672
tra 66,8,30720
mfa 132,80,132
sad 33,28,31744
buffer_load_dwordx4 a[112:115], v20, s[16:19], s33 offen sc1
mfa 136,80,136
mfa 140,80,140
wl 6
mfa 144,84,128
tra 68,9,28672
tra 70,9,30720
mfa 148,84,132
sad 33,28,80896
buffer_load_dwordx4 a[116:119], v20, s[16:19], s33 offen sc1
mfa 152,84,136
mfa 156,84,140
wl 6
mfa 160,88,128
tra 72,10,28672
tra 74,10,30720
mfa 164,88,132
sad 33,28,130048
buffer_load_dwordx4 a[120:123], v20, s[16:19], s33 offen sc1
mfa 168,88,136
mfa 172,88,140
wl 6
mfa 176,92,128
tra 76,11,28672
tra 78,11,30720
mfa 180,92,132
sad 33,28,179200
buffer_load_dwordx4 a[124:127], v20, s[16:19], s33 offen sc1
mfa 184,92,136
mfa 188,92,140
wv 48
wl 6
mfa 64,64,144
tra 80,8,36864
tra 82,8,38912
mfa 68,64,148
mfa 72,64,152
mfa 76,64,156
wl 6
mfa 80,68,144
tra 84,9,36864
tra 86,9,38912
mfa 84,68,148
mfa 88,68,152
mfa 92,68,156
wl 6
mfa 96,72,144
tra 88,10,36864
tra 90,10,38912
mfa 100,72,148
mfa 104,72,152
mfa 108,72,156
wl 6
mfa 112,76,144
tra 92,11,36864
tra 94,11,38912
mfa 116,76,148
mfa 120,76,152
mfa 124,76,156
s_waitcnt vmcnt(44) lgkmcnt(0)
s_barrier
mfa 128,80,144
tra 64,8,49152
tra 66,8,51200
mfa 132,80,148
sad 34,24,1310720
s_add_u32 m0, s29, 24576
s_nop 0
buffer_load_dwordx4 v6, s[8:11], s34 offen lds
mfa 136,80,152
mfa 140,80,156
mfa 144,84,144
tra 68,9,49152
tra 70,9,51200
mfa 148,84,148
s_add_u32 m0, s29, 25600
s_nop 0
buffer_load_dwordx4 v7, s[8:11], s34 offen lds
mfa 152,84,152
mfa 156,84,156
mfa 160,88,144
tra 72,10,49152
tra 74,10,51200
mfa 164,88,148
sad 34,25,1310720
s_add_u32 m0, s29, 32768
s_nop 0
buffer_load_dwordx4 v6, s[52:55], s34 offen lds
mfa 168,88,152
mfa 172,88,156
mfa 176,92,144
tra 76,11,49152
tra 78,11,51200
mfa 180,92,148
s_add_u32 m0, s29, 33792
s_nop 0
buffer_load_dwordx4 v7, s[52:55], s34 offen lds
mfa 184,92,152
mfa 188,92,156
wv 44
wl 6
mfa 64,64,160
tra 80,8,57344
tra 82,8,59392
mfa 68,64,164
sad 33,28,32768
buffer_load_dwordx4 a[128:131], v20, s[16:19], s33 offen sc1
mfa 72,64,168
mfa 76,64,172
wl 6
mfa 80,68,160
tra 84,9,57344
tra 86,9,59392
mfa 84,68,164
sad 33,28,81920
buffer_load_dwordx4 a[132:135], v20, s[16:19], s33 offen sc1
mfa 88,68,168
mfa 92,68,172
wl 6
mfa 96,72,160
tra 88,10,57344
tra 90,10,59392
mfa 100,72,164
sad 33,28,131072
buffer_load_dwordx4 a[136:139], v20, s[16:19], s33 offen sc1
mfa 104,72,168
mfa 108,72,172
wl 6
mfa 112,76,160
tra 92,11,57344
tra 94,11,59392
mfa 116,76,164
sad 33,28,180224
buffer_load_dwordx4 a[140:143], v20, s[16:19], s33 offen sc1
mfa 120,76,168
mfa 124,76,172
wl 6
mfa 128,80,160
tra 64,8,53248
tra 66,8,55296
mfa 132,80,164
sad 33,28,33792
buffer_load_dwordx4 a[144:147], v20, s[16:19], s33 offen sc1
mfa 136,80,168
mfa 140,80,172
wl 6
mfa 144,84,160
tra 68,9,53248
tra 70,9,55296
mfa 148,84,164
sad 33,28,82944
buffer_load_dwordx4 a[148:151], v20, s[16:19], s33 offen sc1
mfa 152,84,168
mfa 156,84,172
wl 6
mfa 160,88,160
tra 72,10,53248
tra 74,10,55296
mfa 164,88,164
sad 33,28,132096
buffer_load_dwordx4 a[152:155], v20, s[16:19], s33 offen sc1
mfa 168,88,168
mfa 172,88,172
wl 6
mfa 176,92,160
tra 76,11,53248
tra 78,11,55296
mfa 180,92,164
sad 33,28,181248
buffer_load_dwordx4 a[156:159], v20, s[16:19], s33 offen sc1
mfa 184,92,168
mfa 188,92,172
wv 48
wl 6
mfa 64,64,176
tra 80,8,61440
tra 82,8,63488
mfa 68,64,180
mfa 72,64,184
mfa 76,64,188
wl 6
mfa 80,68,176
tra 84,9,61440
tra 86,9,63488
mfa 84,68,180
mfa 88,68,184
mfa 92,68,188
wl 6
mfa 96,72,176
tra 88,10,61440
tra 90,10,63488
mfa 100,72,180
mfa 104,72,184
mfa 108,72,188
wl 6
mfa 112,76,176
tra 92,11,61440
tra 94,11,63488
mfa 116,76,180
mfa 120,76,184
mfa 124,76,188
s_waitcnt vmcnt(44) lgkmcnt(0)
s_barrier
mfa 128,80,176
tra 64,12,24576
tra 66,12,26624
mfa 132,80,180
sad 34,24,1392640
s_add_u32 m0, s29, 49152
s_nop 0
buffer_load_dwordx4 v6, s[8:11], s34 offen lds
mfa 136,80,184
mfa 140,80,188
mfa 144,84,176
tra 68,13,24576
tra 70,13,26624
mfa 148,84,180
s_add_u32 m0, s29, 50176
s_nop 0
buffer_load_dwordx4 v7, s[8:11], s34 offen lds
mfa 152,84,184
mfa 156,84,188
mfa 160,88,176
tra 72,14,24576
tra 74,14,26624
mfa 164,88,180
sad 34,25,1392640
s_add_u32 m0, s29, 57344
s_nop 0
buffer_load_dwordx4 v6, s[52:55], s34 offen lds
mfa 168,88,184
mfa 172,88,188
mfa 176,92,176
tra 76,15,24576
tra 78,15,26624
mfa 180,92,180
s_add_u32 m0, s29, 58368
s_nop 0
buffer_load_dwordx4 v7, s[52:55], s34 offen lds
mfa 184,92,184
mfa 188,92,188
wv 44
wl 6
mfa 64,64,192
tra 80,12,32768
tra 82,12,34816
mfa 68,64,196
sad 33,28,34816
buffer_load_dwordx4 a[160:163], v20, s[16:19], s33 offen sc1
mfa 72,64,200
mfa 76,64,204
wl 6
mfa 80,68,192
tra 84,13,32768
tra 86,13,34816
mfa 84,68,196
sad 33,28,83968
buffer_load_dwordx4 a[164:167], v20, s[16:19], s33 offen sc1
mfa 88,68,200
mfa 92,68,204
wl 6
mfa 96,72,192
tra 88,14,32768
tra 90,14,34816
mfa 100,72,196
sad 33,28,133120
buffer_load_dwordx4 a[168:171], v20, s[16:19], s33 offen sc1
mfa 104,72,200
mfa 108,72,204
wl 6
mfa 112,76,192
tra 92,15,32768
tra 94,15,34816
mfa 116,76,196
sad 33,28,182272
buffer_load_dwordx4 a[172:175], v20, s[16:19], s33 offen sc1
mfa 120,76,200
mfa 124,76,204
wl 6
mfa 128,80,192
tra 64,12,28672
tra 66,12,30720
mfa 132,80,196
sad 33,28,35840
buffer_load_dwordx4 a[176:179], v20, s[16:19], s33 offen sc1
mfa 136,80,200
mfa 140,80,204
wl 6
mfa 144,84,192
tra 68,13,28672
tra 70,13,30720
mfa 148,84,196
sad 33,28,84992
buffer_load_dwordx4 a[180:183], v20, s[16:19], s33 offen sc1
mfa 152,84,200
mfa 156,84,204
wl 6
mfa 160,88,192
tra 72,14,28672
tra 74,14,30720
mfa 164,88,196
sad 33,28,134144
buffer_load_dwordx4 a[184:187], v20, s[16:19], s33 offen sc1
mfa 168,88,200
mfa 172,88,204
wl 6
mfa 176,92,192
tra 76,15,28672
tra 78,15,30720
mfa 180,92,196
sad 33,28,183296
buffer_load_dwordx4 a[188:191], v20, s[16:19], s33 offen sc1
mfa 184,92,200
mfa 188,92,204
wv 48
wl 6
mfa 64,64,208
tra 80,12,36864
tra 82,12,38912
mfa 68,64,212
mfa 72,64,216
mfa 76,64,220
wl 6
mfa 80,68,208
tra 84,13,36864
tra 86,13,38912
mfa 84,68,212
mfa 88,68,216
mfa 92,68,220
wl 6
mfa 96,72,208
tra 88,14,36864
tra 90,14,38912
mfa 100,72,212
mfa 104,72,216
mfa 108,72,220
wl 6
mfa 112,76,208
tra 92,15,36864
tra 94,15,38912
mfa 116,76,212
mfa 120,76,216
mfa 124,76,220
s_waitcnt vmcnt(44) lgkmcnt(0)
s_barrier
mfa 128,80,208
tra 64,12,49152
tra 66,12,51200
mfa 132,80,212
sad 34,24,1474560
s_add_u32 m0, s29, 73728
s_nop 0
buffer_load_dwordx4 v6, s[8:11], s34 offen lds
mfa 136,80,216
mfa 140,80,220
mfa 144,84,208
tra 68,13,49152
tra 70,13,51200
mfa 148,84,212
s_add_u32 m0, s29, 74752
s_nop 0
buffer_load_dwordx4 v7, s[8:11], s34 offen lds
mfa 152,84,216
mfa 156,84,220
mfa 160,88,208
tra 72,14,49152
tra 74,14,51200
mfa 164,88,212
sad 34,25,1474560
s_add_u32 m0, s29, 81920
s_nop 0
buffer_load_dwordx4 v6, s[52:55], s34 offen lds
mfa 168,88,216
mfa 172,88,220
mfa 176,92,208
tra 76,15,49152
tra 78,15,51200
mfa 180,92,212
s_add_u32 m0, s29, 82944
s_nop 0
buffer_load_dwordx4 v7, s[52:55], s34 offen lds
mfa 184,92,216
mfa 188,92,220
wv 44
wl 6
mfa 64,64,224
tra 80,12,57344
tra 82,12,59392
mfa 68,64,228
sad 33,28,36864
buffer_load_dwordx4 a[192:195], v20, s[16:19], s33 offen sc1
mfa 72,64,232
mfa 76,64,236
wl 6
mfa 80,68,224
tra 84,13,57344
tra 86,13,59392
mfa 84,68,228
sad 33,28,86016
buffer_load_dwordx4 a[196:199], v20, s[16:19], s33 offen sc1
mfa 88,68,232
mfa 92,68,236
wl 6
mfa 96,72,224
tra 88,14,57344
tra 90,14,59392
mfa 100,72,228
sad 33,28,135168
buffer_load_dwordx4 a[200:203], v20, s[16:19], s33 offen sc1
mfa 104,72,232
mfa 108,72,236
wl 6
mfa 112,76,224
tra 92,15,57344
tra 94,15,59392
mfa 116,76,228
sad 33,28,184320
buffer_load_dwordx4 a[204:207], v20, s[16:19], s33 offen sc1
mfa 120,76,232
mfa 124,76,236
wl 6
mfa 128,80,224
tra 64,12,53248
tra 66,12,55296
mfa 132,80,228
sad 33,28,37888
buffer_load_dwordx4 a[208:211], v20, s[16:19], s33 offen sc1
mfa 136,80,232
mfa 140,80,236
wl 6
mfa 144,84,224
tra 68,13,53248
tra 70,13,55296
mfa 148,84,228
sad 33,28,87040
buffer_load_dwordx4 a[212:215], v20, s[16:19], s33 offen sc1
mfa 152,84,232
mfa 156,84,236
wl 6
mfa 160,88,224
tra 72,14,53248
tra 74,14,55296
mfa 164,88,228
sad 33,28,136192
buffer_load_dwordx4 a[216:219], v20, s[16:19], s33 offen sc1
mfa 168,88,232
mfa 172,88,236
wl 6
mfa 176,92,224
tra 76,15,53248
tra 78,15,55296
mfa 180,92,228
sad 33,28,185344
buffer_load_dwordx4 a[220:223], v20, s[16:19], s33 offen sc1
mfa 184,92,232
mfa 188,92,236
wv 48
wl 6
mfa 64,64,240
tra 80,12,61440
tra 82,12,63488
mfa 68,64,244
mfa 72,64,248
mfa 76,64,252
wl 6
mfa 80,68,240
tra 84,13,61440
tra 86,13,63488
mfa 84,68,244
mfa 88,68,248
mfa 92,68,252
wl 6
mfa 96,72,240
tra 88,14,61440
tra 90,14,63488
mfa 100,72,244
mfa 104,72,248
mfa 108,72,252
wl 6
mfa 112,76,240
tra 92,15,61440
tra 94,15,63488
mfa 116,76,244
mfa 120,76,248
mfa 124,76,252
s_waitcnt vmcnt(44) lgkmcnt(0)
s_barrier
mfa 128,80,240
tra 64,8,0
tra 66,8,2048
mfa 132,80,244
sad 34,24,1556480
s_add_u32 m0, s29, 98304
s_nop 0
buffer_load_dwordx4 v6, s[8:11], s34 offen lds
mfa 136,80,248
mfa 140,80,252
mfa 144,84,240
tra 68,9,0
tra 70,9,2048
mfa 148,84,244
s_add_u32 m0, s29, 99328
s_nop 0
buffer_load_dwordx4 v7, s[8:11], s34 offen lds
mfa 152,84,248
mfa 156,84,252
mfa 160,88,240
tra 72,10,0
tra 74,10,2048
mfa 164,88,244
sad 34,25,1556480
s_add_u32 m0, s29, 106496
s_nop 0
buffer_load_dwordx4 v6, s[52:55], s34 offen lds
mfa 168,88,248
mfa 172,88,252
mfa 176,92,240
tra 76,11,0
tra 78,11,2048
mfa 180,92,244
s_add_u32 m0, s29, 107520
s_nop 0
buffer_load_dwordx4 v7, s[52:55], s34 offen lds
mfa 184,92,248
mfa 188,92,252
wv 44
wl 6
mfa 64,64,96
tra 80,8,8192
tra 82,8,10240
mfa 68,64,100
sad 33,28,38912
buffer_load_dwordx4 a[224:227], v20, s[16:19], s33 offen sc1
mfa 72,64,104
mfa 76,64,108
wl 6
mfa 80,68,96
tra 84,9,8192
tra 86,9,10240
mfa 84,68,100
sad 33,28,88064
buffer_load_dwordx4 a[228:231], v20, s[16:19], s33 offen sc1
mfa 88,68,104
mfa 92,68,108
wl 6
mfa 96,72,96
tra 88,10,8192
tra 90,10,10240
mfa 100,72,100
sad 33,28,137216
buffer_load_dwordx4 a[232:235], v20, s[16:19], s33 offen sc1
mfa 104,72,104
mfa 108,72,108
wl 6
mfa 112,76,96
tra 92,11,8192
tra 94,11,10240
mfa 116,76,100
sad 33,28,186368
buffer_load_dwordx4 a[236:239], v20, s[16:19], s33 offen sc1
mfa 120,76,104
mfa 124,76,108
wl 6
mfa 128,80,96
tra 64,8,4096
tra 66,8,6144
mfa 132,80,100
sad 33,28,39936
buffer_load_dwordx4 a[240:243], v20, s[16:19], s33 offen sc1
mfa 136,80,104
mfa 140,80,108
wl 6
mfa 144,84,96
tra 68,9,4096
tra 70,9,6144
mfa 148,84,100
sad 33,28,89088
buffer_load_dwordx4 a[244:247], v20, s[16:19], s33 offen sc1
mfa 152,84,104
mfa 156,84,108
wl 6
mfa 160,88,96
tra 72,10,4096
tra 74,10,6144
mfa 164,88,100
sad 33,28,138240
buffer_load_dwordx4 a[248:251], v20, s[16:19], s33 offen sc1
mfa 168,88,104
mfa 172,88,108
wl 6
mfa 176,92,96
tra 76,11,4096
tra 78,11,6144
mfa 180,92,100
sad 33,28,187392
buffer_load_dwordx4 a[252:255], v20, s[16:19], s33 offen sc1
mfa 184,92,104
mfa 188,92,108
wv 48
wl 6
mfa 64,64,112
tra 80,8,12288
tra 82,8,14336
mfa 68,64,116
mfa 72,64,120
mfa 76,64,124
wl 6
mfa 80,68,112
tra 84,9,12288
tra 86,9,14336
mfa 84,68,116
mfa 88,68,120
mfa 92,68,124
wl 6
mfa 96,72,112
tra 88,10,12288
tra 90,10,14336
mfa 100,72,116
mfa 104,72,120
mfa 108,72,124
wl 6
mfa 112,76,112
tra 92,11,12288
tra 94,11,14336
mfa 116,76,116
mfa 120,76,120
mfa 124,76,124
s_waitcnt vmcnt(44) lgkmcnt(0)
s_barrier
mfa 128,80,112
tra 64,8,24576
tra 66,8,26624
mfa 132,80,116
sad 34,24,1638400
s_add_u32 m0, s29, 0
s_nop 0
buffer_load_dwordx4 v6, s[8:11], s34 offen lds
mfa 136,80,120
mfa 140,80,124
mfa 144,84,112
tra 68,9,24576
tra 70,9,26624
mfa 148,84,116
s_add_u32 m0, s29, 1024
s_nop 0
buffer_load_dwordx4 v7, s[8:11], s34 offen lds
mfa 152,84,120
mfa 156,84,124
mfa 160,88,112
tra 72,10,24576
tra 74,10,26624
mfa 164,88,116
sad 34,25,1638400
s_add_u32 m0, s29, 8192
s_nop 0
buffer_load_dwordx4 v6, s[52:55], s34 offen lds
mfa 168,88,120
mfa 172,88,124
mfa 176,92,112
tra 76,11,24576
tra 78,11,26624
mfa 180,92,116
s_add_u32 m0, s29, 9216
s_nop 0
buffer_load_dwordx4 v7, s[52:55], s34 offen lds
mfa 184,92,120
mfa 188,92,124
wv 44
wl 6
mfa 64,64,128
tra 80,8,32768
tra 82,8,34816
mfa 68,64,132
sad 33,28,40960
buffer_load_dwordx4 a[96:99], v20, s[16:19], s33 offen sc1
mfa 72,64,136
mfa 76,64,140
wl 6
mfa 80,68,128
tra 84,9,32768
tra 86,9,34816
mfa 84,68,132
sad 33,28,90112
buffer_load_dwordx4 a[100:103], v20, s[16:19], s33 offen sc1
mfa 88,68,136
mfa 92,68,140
wl 6
mfa 96,72,128
tra 88,10,32768
tra 90,10,34816
mfa 100,72,132
sad 33,28,139264
buffer_load_dwordx4 a[104:107], v20, s[16:19], s33 offen sc1
mfa 104,72,136
mfa 108,72,140
wl 6
mfa 112,76,128
tra 92,11,32768
tra 94,11,34816
mfa 116,76,132
sad 33,28,188416
buffer_load_dwordx4 a[108:111], v20, s[16:19], s33 offen sc1
mfa 120,76,136
mfa 124,76,140
wl 6
mfa 128,80,128
tra 64,8,28672
tra 66,8,30720
mfa 132,80,132
sad 33,28,41984
buffer_load_dwordx4 a[112:115], v20, s[16:19], s33 offen sc1
mfa 136,80,136
mfa 140,80,140
wl 6
mfa 144,84,128
tra 68,9,28672
tra 70,9,30720
mfa 148,84,132
sad 33,28,91136
buffer_load_dwordx4 a[116:119], v20, s[16:19], s33 offen sc1
mfa 152,84,136
mfa 156,84,140
wl 6
mfa 160,88,128
tra 72,10,28672
tra 74,10,30720
mfa 164,88,132
sad 33,28,140288
buffer_load_dwordx4 a[120:123], v20, s[16:19], s33 offen sc1
mfa 168,88,136
mfa 172,88,140
wl 6
mfa 176,92,128
tra 76,11,28672
tra 78,11,30720
mfa 180,92,132
sad 33,28,189440
buffer_load_dwordx4 a[124:127], v20, s[16:19], s33 offen sc1
mfa 184,92,136
mfa 188,92,140
wv 48
wl 6
mfa 64,64,144
tra 80,8,36864
tra 82,8,38912
mfa 68,64,148
mfa 72,64,152
mfa 76,64,156
wl 6
mfa 80,68,144
tra 84,9,36864
tra 86,9,38912
mfa 84,68,148
mfa 88,68,152
mfa 92,68,156
wl 6
mfa 96,72,144
tra 88,10,36864
tra 90,10,38912
mfa 100,72,148
mfa 104,72,152
mfa 108,72,156
wl 6
mfa 112,76,144
tra 92,11,36864
tra 94,11,38912
mfa 116,76,148
mfa 120,76,152
mfa 124,76,156
s_waitcnt vmcnt(44) lgkmcnt(0)
s_barrier
s_sub_u32 s83, s2, 128
s_lshr_b32 s83, s83, 3
s_mul_i32 s83, s83, 0
sad 83,83,36
s_cmp_eq_u32 s68, 1
s_cselect_b32 s83, 0, s83
s_cmp_ge_u32 s2, 144
s_cbranch_scc1 L_xd_173
s_cmp_lt_u32 s78, s83
s_cbranch_scc1 L_xd_173
v_mov_b32 v18, 0x7fff
s_mov_b32 s77, 7
s_branch L_xe_174
L_xd_173:
s_cmp_lg_u32 s4, 0
s_cbranch_scc1 L_ti_175
s_lshl_b32 s83, s76, 2
v_mov_b32 v18, 1
v_mov_b32 v2, 0
s_mov_b64 exec, 1
buffer_atomic_add v18, v2, s[84:87], s83 offen sc0 sc1
s_mov_b64 exec, -1
L_ti_175:
L_xe_174:
mfa 128,80,144
tra 64,8,49152
tra 66,8,51200
mfa 132,80,148
sad 34,24,1720320
s_add_u32 m0, s29, 24576
s_nop 0
buffer_load_dwordx4 v6, s[8:11], s34 offen lds
mfa 136,80,152
mfa 140,80,156
mfa 144,84,144
tra 68,9,49152
tra 70,9,51200
mfa 148,84,148
s_add_u32 m0, s29, 25600
s_nop 0
buffer_load_dwordx4 v7, s[8:11], s34 offen lds
mfa 152,84,152
mfa 156,84,156
mfa 160,88,144
tra 72,10,49152
tra 74,10,51200
mfa 164,88,148
sad 34,25,1720320
s_add_u32 m0, s29, 32768
s_nop 0
buffer_load_dwordx4 v6, s[52:55], s34 offen lds
mfa 168,88,152
mfa 172,88,156
mfa 176,92,144
tra 76,11,49152
tra 78,11,51200
mfa 180,92,148
s_add_u32 m0, s29, 33792
s_nop 0
buffer_load_dwordx4 v7, s[52:55], s34 offen lds
mfa 184,92,152
mfa 188,92,156
wv 44
wl 6
mfa 64,64,160
tra 80,8,57344
tra 82,8,59392
mfa 68,64,164
sad 33,28,43008
buffer_load_dwordx4 a[128:131], v20, s[16:19], s33 offen sc1
mfa 72,64,168
mfa 76,64,172
wl 6
mfa 80,68,160
tra 84,9,57344
tra 86,9,59392
mfa 84,68,164
sad 33,28,92160
buffer_load_dwordx4 a[132:135], v20, s[16:19], s33 offen sc1
mfa 88,68,168
mfa 92,68,172
wl 6
mfa 96,72,160
tra 88,10,57344
tra 90,10,59392
mfa 100,72,164
sad 33,28,141312
buffer_load_dwordx4 a[136:139], v20, s[16:19], s33 offen sc1
mfa 104,72,168
mfa 108,72,172
wl 6
mfa 112,76,160
tra 92,11,57344
tra 94,11,59392
mfa 116,76,164
sad 33,28,190464
buffer_load_dwordx4 a[140:143], v20, s[16:19], s33 offen sc1
mfa 120,76,168
mfa 124,76,172
wl 6
mfa 128,80,160
tra 64,8,53248
tra 66,8,55296
mfa 132,80,164
sad 33,28,44032
buffer_load_dwordx4 a[144:147], v20, s[16:19], s33 offen sc1
mfa 136,80,168
mfa 140,80,172
wl 6
mfa 144,84,160
tra 68,9,53248
tra 70,9,55296
mfa 148,84,164
sad 33,28,93184
buffer_load_dwordx4 a[148:151], v20, s[16:19], s33 offen sc1
mfa 152,84,168
mfa 156,84,172
wl 6
mfa 160,88,160
tra 72,10,53248
tra 74,10,55296
mfa 164,88,164
sad 33,28,142336
buffer_load_dwordx4 a[152:155], v20, s[16:19], s33 offen sc1
mfa 168,88,168
mfa 172,88,172
wl 6
mfa 176,92,160
tra 76,11,53248
tra 78,11,55296
mfa 180,92,164
sad 33,28,191488
buffer_load_dwordx4 a[156:159], v20, s[16:19], s33 offen sc1
mfa 184,92,168
mfa 188,92,172
wv 48
wl 6
mfa 64,64,176
tra 80,8,61440
tra 82,8,63488
mfa 68,64,180
mfa 72,64,184
mfa 76,64,188
wl 6
mfa 80,68,176
tra 84,9,61440
tra 86,9,63488
mfa 84,68,180
mfa 88,68,184
mfa 92,68,188
wl 6
mfa 96,72,176
tra 88,10,61440
tra 90,10,63488
mfa 100,72,180
mfa 104,72,184
mfa 108,72,188
wl 6
mfa 112,76,176
tra 92,11,61440
tra 94,11,63488
mfa 116,76,180
mfa 120,76,184
mfa 124,76,188
s_waitcnt vmcnt(44) lgkmcnt(0)
s_barrier
mfa 128,80,176
tra 64,12,24576
tra 66,12,26624
mfa 132,80,180
sad 34,24,1802240
s_add_u32 m0, s29, 49152
s_nop 0
buffer_load_dwordx4 v6, s[8:11], s34 offen lds
mfa 136,80,184
mfa 140,80,188
mfa 144,84,176
tra 68,13,24576
tra 70,13,26624
mfa 148,84,180
s_add_u32 m0, s29, 50176
s_nop 0
buffer_load_dwordx4 v7, s[8:11], s34 offen lds
mfa 152,84,184
mfa 156,84,188
mfa 160,88,176
tra 72,14,24576
tra 74,14,26624
mfa 164,88,180
sad 34,25,1802240
s_add_u32 m0, s29, 57344
s_nop 0
buffer_load_dwordx4 v6, s[52:55], s34 offen lds
mfa 168,88,184
mfa 172,88,188
mfa 176,92,176
tra 76,15,24576
tra 78,15,26624
mfa 180,92,180
s_add_u32 m0, s29, 58368
s_nop 0
buffer_load_dwordx4 v7, s[52:55], s34 offen lds
mfa 184,92,184
mfa 188,92,188
wv 44
wl 6
mfa 64,64,192
tra 80,12,32768
tra 82,12,34816
mfa 68,64,196
sad 33,28,45056
buffer_load_dwordx4 a[160:163], v20, s[16:19], s33 offen sc1
mfa 72,64,200
mfa 76,64,204
wl 6
mfa 80,68,192
tra 84,13,32768
tra 86,13,34816
mfa 84,68,196
sad 33,28,94208
buffer_load_dwordx4 a[164:167], v20, s[16:19], s33 offen sc1
mfa 88,68,200
mfa 92,68,204
wl 6
mfa 96,72,192
tra 88,14,32768
tra 90,14,34816
mfa 100,72,196
sad 33,28,143360
buffer_load_dwordx4 a[168:171], v20, s[16:19], s33 offen sc1
mfa 104,72,200
mfa 108,72,204
wl 6
mfa 112,76,192
tra 92,15,32768
tra 94,15,34816
mfa 116,76,196
sad 33,28,192512
buffer_load_dwordx4 a[172:175], v20, s[16:19], s33 offen sc1
mfa 120,76,200
mfa 124,76,204
wl 6
mfa 128,80,192
tra 64,12,28672
tra 66,12,30720
mfa 132,80,196
sad 33,28,46080
buffer_load_dwordx4 a[176:179], v20, s[16:19], s33 offen sc1
mfa 136,80,200
mfa 140,80,204
wl 6
mfa 144,84,192
tra 68,13,28672
tra 70,13,30720
mfa 148,84,196
sad 33,28,95232
buffer_load_dwordx4 a[180:183], v20, s[16:19], s33 offen sc1
mfa 152,84,200
mfa 156,84,204
wl 6
mfa 160,88,192
tra 72,14,28672
tra 74,14,30720
mfa 164,88,196
sad 33,28,144384
buffer_load_dwordx4 a[184:187], v20, s[16:19], s33 offen sc1
mfa 168,88,200
mfa 172,88,204
wl 6
mfa 176,92,192
tra 76,15,28672
tra 78,15,30720
mfa 180,92,196
sad 33,28,193536
buffer_load_dwordx4 a[188:191], v20, s[16:19], s33 offen sc1
mfa 184,92,200
mfa 188,92,204
wv 48
wl 6
mfa 64,64,208
tra 80,12,36864
tra 82,12,38912
mfa 68,64,212
mfa 72,64,216
mfa 76,64,220
wl 6
mfa 80,68,208
tra 84,13,36864
tra 86,13,38912
mfa 84,68,212
mfa 88,68,216
mfa 92,68,220
wl 6
mfa 96,72,208
tra 88,14,36864
tra 90,14,38912
mfa 100,72,212
mfa 104,72,216
mfa 108,72,220
wl 6
mfa 112,76,208
tra 92,15,36864
tra 94,15,38912
mfa 116,76,212
mfa 120,76,216
mfa 124,76,220
v_mov_b32 v19, 155648
s_cmp_lg_u32 s4, 0
s_cbranch_scc1 L_ps_176
wv 24
s_mov_b64 exec, 1
ds_write_b32 v19, v18
s_mov_b64 exec, -1
wl 0
L_ps_176:
s_waitcnt vmcnt(44) lgkmcnt(0)
s_barrier
ds_read_b32 v18, v19
mfa 128,80,208
tra 64,12,49152
tra 66,12,51200
mfa 132,80,212
sad 34,24,1884160
s_add_u32 m0, s29, 73728
s_nop 0
buffer_load_dwordx4 v6, s[8:11], s34 offen lds
mfa 136,80,216
mfa 140,80,220
mfa 144,84,208
tra 68,13,49152
tra 70,13,51200
mfa 148,84,212
s_add_u32 m0, s29, 74752
s_nop 0
buffer_load_dwordx4 v7, s[8:11], s34 offen lds
mfa 152,84,216
mfa 156,84,220
mfa 160,88,208
tra 72,14,49152
tra 74,14,51200
mfa 164,88,212
sad 34,25,1884160
s_add_u32 m0, s29, 81920
s_nop 0
buffer_load_dwordx4 v6, s[52:55], s34 offen lds
mfa 168,88,216
mfa 172,88,220
mfa 176,92,208
tra 76,15,49152
tra 78,15,51200
mfa 180,92,212
s_add_u32 m0, s29, 82944
s_nop 0
buffer_load_dwordx4 v7, s[52:55], s34 offen lds
mfa 184,92,216
mfa 188,92,220
wv 44
wl 6
mfa 64,64,224
tra 80,12,57344
tra 82,12,59392
mfa 68,64,228
sad 33,28,47104
buffer_load_dwordx4 a[192:195], v20, s[16:19], s33 offen sc1
mfa 72,64,232
mfa 76,64,236
wl 6
mfa 80,68,224
tra 84,13,57344
tra 86,13,59392
mfa 84,68,228
sad 33,28,96256
buffer_load_dwordx4 a[196:199], v20, s[16:19], s33 offen sc1
mfa 88,68,232
mfa 92,68,236
wl 6
mfa 96,72,224
tra 88,14,57344
tra 90,14,59392
mfa 100,72,228
sad 33,28,145408
buffer_load_dwordx4 a[200:203], v20, s[16:19], s33 offen sc1
mfa 104,72,232
mfa 108,72,236
wl 6
mfa 112,76,224
tra 92,15,57344
tra 94,15,59392
mfa 116,76,228
sad 33,28,194560
buffer_load_dwordx4 a[204:207], v20, s[16:19], s33 offen sc1
mfa 120,76,232
mfa 124,76,236
wl 6
mfa 128,80,224
tra 64,12,53248
tra 66,12,55296
mfa 132,80,228
sad 33,28,48128
buffer_load_dwordx4 a[208:211], v20, s[16:19], s33 offen sc1
mfa 136,80,232
mfa 140,80,236
wl 6
mfa 144,84,224
tra 68,13,53248
tra 70,13,55296
mfa 148,84,228
sad 33,28,97280
buffer_load_dwordx4 a[212:215], v20, s[16:19], s33 offen sc1
mfa 152,84,232
mfa 156,84,236
wl 6
mfa 160,88,224
tra 72,14,53248
tra 74,14,55296
mfa 164,88,228
sad 33,28,146432
buffer_load_dwordx4 a[216:219], v20, s[16:19], s33 offen sc1
mfa 168,88,232
mfa 172,88,236
wl 6
mfa 176,92,224
tra 76,15,53248
tra 78,15,55296
mfa 180,92,228
sad 33,28,195584
buffer_load_dwordx4 a[220:223], v20, s[16:19], s33 offen sc1
mfa 184,92,232
mfa 188,92,236
wv 48
wl 6
mfa 64,64,240
tra 80,12,61440
tra 82,12,63488
mfa 68,64,244
mfa 72,64,248
mfa 76,64,252
wl 6
mfa 80,68,240
tra 84,13,61440
tra 86,13,63488
mfa 84,68,244
mfa 88,68,248
mfa 92,68,252
wl 6
mfa 96,72,240
tra 88,14,61440
tra 90,14,63488
mfa 100,72,244
mfa 104,72,248
mfa 108,72,252
wl 6
mfa 112,76,240
tra 92,15,61440
tra 94,15,63488
mfa 116,76,244
mfa 120,76,248
mfa 124,76,252
s_waitcnt vmcnt(44) lgkmcnt(0)
s_barrier
v_readfirstlane_b32 s78, v18
s_mov_b32 s69, 0
s_getpc_b64 s[50:51]
L_c_177:
s_add_u32 s50, s50, L_sched-L_c_177
s_addc_u32 s51, s51, -1
s_swappc_b64 s[74:75], s[50:51]
mfa 128,80,240
tra 64,8,0
tra 66,8,2048
mfa 132,80,244
mfa 136,80,248
mfa 140,80,252
mfa 144,84,240
tra 68,9,0
tra 70,9,2048
mfa 148,84,244
mfa 152,84,248
mfa 156,84,252
mfa 160,88,240
tra 72,10,0
tra 74,10,2048
mfa 164,88,244
mfa 168,88,248
mfa 172,88,252
mfa 176,92,240
tra 76,11,0
tra 78,11,2048
mfa 180,92,244
mfa 184,92,248
mfa 188,92,252
wv 40
wl 6
mfa 64,64,96
tra 80,8,8192
tra 82,8,10240
mfa 68,64,100
mfa 72,64,104
mfa 76,64,108
wl 6
mfa 80,68,96
tra 84,9,8192
tra 86,9,10240
mfa 84,68,100
mfa 88,68,104
mfa 92,68,108
wl 6
mfa 96,72,96
tra 88,10,8192
tra 90,10,10240
mfa 100,72,100
mfa 104,72,104
mfa 108,72,108
wl 6
mfa 112,76,96
tra 92,11,8192
tra 94,11,10240
mfa 116,76,100
mfa 120,76,104
mfa 124,76,108
wl 6
mfa 128,80,96
tra 64,8,4096
tra 66,8,6144
mfa 132,80,100
mfa 136,80,104
mfa 140,80,108
wl 6
mfa 144,84,96
tra 68,9,4096
tra 70,9,6144
mfa 148,84,100
mfa 152,84,104
mfa 156,84,108
wl 6
mfa 160,88,96
tra 72,10,4096
tra 74,10,6144
mfa 164,88,100
mfa 168,88,104
mfa 172,88,108
wl 6
mfa 176,92,96
tra 76,11,4096
tra 78,11,6144
mfa 180,92,100
mfa 184,92,104
mfa 188,92,108
wv 36
wl 6
mfa 64,64,112
tra 80,8,12288
tra 82,8,14336
mfa 68,64,116
mfa 72,64,120
mfa 76,64,124
wl 6
mfa 80,68,112
tra 84,9,12288
tra 86,9,14336
mfa 84,68,116
mfa 88,68,120
mfa 92,68,124
wl 6
mfa 96,72,112
tra 88,10,12288
tra 90,10,14336
mfa 100,72,116
mfa 104,72,120
mfa 108,72,124
wl 6
mfa 112,76,112
tra 92,11,12288
tra 94,11,14336
mfa 116,76,116
mfa 120,76,120
mfa 124,76,124
s_waitcnt vmcnt(32) lgkmcnt(0)
s_barrier
mfa 128,80,112
tra 64,8,24576
tra 66,8,26624
mfa 132,80,116
mfa 136,80,120
mfa 140,80,124
mfa 144,84,112
tra 68,9,24576
tra 70,9,26624
mfa 148,84,116
mfa 152,84,120
mfa 156,84,124
mfa 160,88,112
tra 72,10,24576
tra 74,10,26624
mfa 164,88,116
mfa 168,88,120
mfa 172,88,124
mfa 176,92,112
tra 76,11,24576
tra 78,11,26624
mfa 180,92,116
mfa 184,92,120
mfa 188,92,124
wv 28
wl 6
mfa 64,64,128
tra 80,8,32768
tra 82,8,34816
mfa 68,64,132
mfa 72,64,136
mfa 76,64,140
wl 6
mfa 80,68,128
tra 84,9,32768
tra 86,9,34816
mfa 84,68,132
mfa 88,68,136
mfa 92,68,140
wl 6
mfa 96,72,128
tra 88,10,32768
tra 90,10,34816
mfa 100,72,132
mfa 104,72,136
mfa 108,72,140
wl 6
mfa 112,76,128
tra 92,11,32768
tra 94,11,34816
mfa 116,76,132
mfa 120,76,136
mfa 124,76,140
wl 6
mfa 128,80,128
tra 64,8,28672
tra 66,8,30720
mfa 132,80,132
mfa 136,80,136
mfa 140,80,140
wl 6
mfa 144,84,128
tra 68,9,28672
tra 70,9,30720
mfa 148,84,132
mfa 152,84,136
mfa 156,84,140
wl 6
mfa 160,88,128
tra 72,10,28672
tra 74,10,30720
mfa 164,88,132
mfa 168,88,136
mfa 172,88,140
wl 6
mfa 176,92,128
tra 76,11,28672
tra 78,11,30720
mfa 180,92,132
mfa 184,92,136
mfa 188,92,140
wv 24
wl 6
mfa 64,64,144
tra 80,8,36864
tra 82,8,38912
mfa 68,64,148
mfa 72,64,152
mfa 76,64,156
wl 6
mfa 80,68,144
tra 84,9,36864
tra 86,9,38912
mfa 84,68,148
mfa 88,68,152
mfa 92,68,156
wl 6
mfa 96,72,144
tra 88,10,36864
tra 90,10,38912
mfa 100,72,148
mfa 104,72,152
mfa 108,72,156
wl 6
mfa 112,76,144
tra 92,11,36864
tra 94,11,38912
mfa 116,76,148
mfa 120,76,152
mfa 124,76,156
s_waitcnt vmcnt(20) lgkmcnt(0)
s_barrier
mfa 128,80,144
tra 64,8,49152
tra 66,8,51200
mfa 132,80,148
mfa 136,80,152
mfa 140,80,156
mfa 144,84,144
tra 68,9,49152
tra 70,9,51200
mfa 148,84,148
mfa 152,84,152
mfa 156,84,156
mfa 160,88,144
tra 72,10,49152
tra 74,10,51200
mfa 164,88,148
mfa 168,88,152
mfa 172,88,156
mfa 176,92,144
tra 76,11,49152
tra 78,11,51200
mfa 180,92,148
mfa 184,92,152
mfa 188,92,156
wv 16
wl 6
mfa 64,64,160
tra 80,8,57344
tra 82,8,59392
mfa 68,64,164
mfa 72,64,168
mfa 76,64,172
wl 6
mfa 80,68,160
tra 84,9,57344
tra 86,9,59392
mfa 84,68,164
mfa 88,68,168
mfa 92,68,172
wl 6
mfa 96,72,160
tra 88,10,57344
tra 90,10,59392
mfa 100,72,164
mfa 104,72,168
mfa 108,72,172
wl 6
mfa 112,76,160
tra 92,11,57344
tra 94,11,59392
mfa 116,76,164
mfa 120,76,168
mfa 124,76,172
wl 6
mfa 128,80,160
tra 64,8,53248
tra 66,8,55296
mfa 132,80,164
mfa 136,80,168
mfa 140,80,172
wl 6
mfa 144,84,160
tra 68,9,53248
tra 70,9,55296
mfa 148,84,164
mfa 152,84,168
mfa 156,84,172
wl 6
mfa 160,88,160
tra 72,10,53248
tra 74,10,55296
mfa 164,88,164
mfa 168,88,168
mfa 172,88,172
wl 6
mfa 176,92,160
tra 76,11,53248
tra 78,11,55296
mfa 180,92,164
mfa 184,92,168
mfa 188,92,172
wv 12
wl 6
mfa 64,64,176
tra 80,8,61440
tra 82,8,63488
mfa 68,64,180
mfa 72,64,184
mfa 76,64,188
wl 6
mfa 80,68,176
tra 84,9,61440
tra 86,9,63488
mfa 84,68,180
mfa 88,68,184
mfa 92,68,188
wl 6
mfa 96,72,176
tra 88,10,61440
tra 90,10,63488
mfa 100,72,180
mfa 104,72,184
mfa 108,72,188
wl 6
mfa 112,76,176
tra 92,11,61440
tra 94,11,63488
mfa 116,76,180
mfa 120,76,184
mfa 124,76,188
s_waitcnt vmcnt(8) lgkmcnt(0)
s_barrier
mfa 128,80,176
tra 64,12,24576
tra 66,12,26624
mfa 132,80,180
mfa 136,80,184
mfa 140,80,188
mfa 144,84,176
tra 68,13,24576
tra 70,13,26624
mfa 148,84,180
mfa 152,84,184
mfa 156,84,188
mfa 160,88,176
tra 72,14,24576
tra 74,14,26624
mfa 164,88,180
mfa 168,88,184
mfa 172,88,188
mfa 176,92,176
tra 76,15,24576
tra 78,15,26624
mfa 180,92,180
mfa 184,92,184
mfa 188,92,188
wv 4
wl 6
mfa 64,64,192
tra 80,12,32768
tra 82,12,34816
mfa 68,64,196
mfa 72,64,200
mfa 76,64,204
wl 6
mfa 80,68,192
tra 84,13,32768
tra 86,13,34816
mfa 84,68,196
mfa 88,68,200
mfa 92,68,204
wl 6
mfa 96,72,192
tra 88,14,32768
tra 90,14,34816
mfa 100,72,196
mfa 104,72,200
mfa 108,72,204
wl 6
mfa 112,76,192
tra 92,15,32768
tra 94,15,34816
mfa 116,76,196
mfa 120,76,200
mfa 124,76,204
wl 6
mfa 128,80,192
tra 64,12,28672
tra 66,12,30720
mfa 132,80,196
mfa 136,80,200
mfa 140,80,204
wl 6
mfa 144,84,192
tra 68,13,28672
tra 70,13,30720
mfa 148,84,196
mfa 152,84,200
mfa 156,84,204
wl 6
mfa 160,88,192
tra 72,14,28672
tra 74,14,30720
mfa 164,88,196
mfa 168,88,200
mfa 172,88,204
wl 6
mfa 176,92,192
tra 76,15,28672
tra 78,15,30720
mfa 180,92,196
mfa 184,92,200
mfa 188,92,204
wv 0
wl 6
mfa 64,64,208
tra 80,12,36864
tra 82,12,38912
mfa 68,64,212
mfa 72,64,216
mfa 76,64,220
wl 6
mfa 80,68,208
tra 84,13,36864
tra 86,13,38912
mfa 84,68,212
mfa 88,68,216
mfa 92,68,220
wl 6
mfa 96,72,208
tra 88,14,36864
tra 90,14,38912
mfa 100,72,212
mfa 104,72,216
mfa 108,72,220
wl 6
mfa 112,76,208
tra 92,15,36864
tra 94,15,38912
mfa 116,76,212
mfa 120,76,216
mfa 124,76,220
wl 6
mfa 128,80,208
mfa 132,80,212
mfa 136,80,216
mfa 140,80,220
wl 4
mfa 144,84,208
mfa 148,84,212
mfa 152,84,216
mfa 156,84,220
wl 2
mfa 160,88,208
mfa 164,88,212
mfa 168,88,216
mfa 172,88,220
wl 0
mfa 176,92,208
mfa 180,92,212
mfa 184,92,216
mfa 188,92,220
v_and_b32 v2, 15, v1
v_mul_u32_u24 v21, 1280, v2
v_lshrrev_b32 v2, 4, v1
v_lshl_add_u32 v21, v2, 3, v21
s_mul_i32 s47, s46, 20480
s_add_u32 s47, s47, s45
s_mov_b32 s48, 0xbfb8aa3b
s_nop 7
sad 32,47,0
cvp 32,64,65
cvp 33,66,67
v_lshlrev_b32 v34, 16, v32
v_and_b32 v35, 0xffff0000, v32
v_lshlrev_b32 v36, 16, v33
v_and_b32 v37, 0xffff0000, v33
v_mul_f32 v38, s48, v34
v_mul_f32 v39, s48, v35
v_mul_f32 v40, s48, v36
v_mul_f32 v41, s48, v37
v_exp_f32 v38, v38
v_exp_f32 v39, v39
v_exp_f32 v40, v40
v_exp_f32 v41, v41
v_add_f32 v38, 1.0, v38
v_add_f32 v39, 1.0, v39
v_add_f32 v40, 1.0, v40
v_add_f32 v41, 1.0, v41
v_rcp_f32 v38, v38
v_rcp_f32 v39, v39
v_rcp_f32 v40, v40
v_rcp_f32 v41, v41
v_mul_f32 v34, v34, v38
v_mul_f32 v35, v35, v39
v_mul_f32 v36, v36, v40
v_mul_f32 v37, v37, v41
cvp 32,34,35
cvp 33,36,37
buffer_store_dwordx2 v[32:33], v21, s[20:23], s32 offen offset:0 sc1
cvp 42,80,81
cvp 43,82,83
v_lshlrev_b32 v44, 16, v42
v_and_b32 v45, 0xffff0000, v42
v_lshlrev_b32 v46, 16, v43
v_and_b32 v47, 0xffff0000, v43
v_mul_f32 v48, s48, v44
v_mul_f32 v49, s48, v45
v_mul_f32 v50, s48, v46
v_mul_f32 v51, s48, v47
v_exp_f32 v48, v48
v_exp_f32 v49, v49
v_exp_f32 v50, v50
v_exp_f32 v51, v51
v_add_f32 v48, 1.0, v48
v_add_f32 v49, 1.0, v49
v_add_f32 v50, 1.0, v50
v_add_f32 v51, 1.0, v51
v_rcp_f32 v48, v48
v_rcp_f32 v49, v49
v_rcp_f32 v50, v50
v_rcp_f32 v51, v51
v_mul_f32 v44, v44, v48
v_mul_f32 v45, v45, v49
v_mul_f32 v46, v46, v50
v_mul_f32 v47, v47, v51
cvp 42,44,45
cvp 43,46,47
buffer_store_dwordx2 v[42:43], v21, s[20:23], s32 offen offset:32 sc1
cvp 52,96,97
cvp 53,98,99
v_lshlrev_b32 v54, 16, v52
v_and_b32 v55, 0xffff0000, v52
v_lshlrev_b32 v56, 16, v53
v_and_b32 v57, 0xffff0000, v53
v_mul_f32 v58, s48, v54
v_mul_f32 v59, s48, v55
v_mul_f32 v60, s48, v56
v_mul_f32 v61, s48, v57
v_exp_f32 v58, v58
v_exp_f32 v59, v59
v_exp_f32 v60, v60
v_exp_f32 v61, v61
v_add_f32 v58, 1.0, v58
v_add_f32 v59, 1.0, v59
v_add_f32 v60, 1.0, v60
v_add_f32 v61, 1.0, v61
v_rcp_f32 v58, v58
v_rcp_f32 v59, v59
v_rcp_f32 v60, v60
v_rcp_f32 v61, v61
v_mul_f32 v54, v54, v58
v_mul_f32 v55, v55, v59
v_mul_f32 v56, v56, v60
v_mul_f32 v57, v57, v61
cvp 52,54,55
cvp 53,56,57
buffer_store_dwordx2 v[52:53], v21, s[20:23], s32 offen offset:64 sc1
cvp 32,112,113
cvp 33,114,115
v_lshlrev_b32 v34, 16, v32
v_and_b32 v35, 0xffff0000, v32
v_lshlrev_b32 v36, 16, v33
v_and_b32 v37, 0xffff0000, v33
v_mul_f32 v38, s48, v34
v_mul_f32 v39, s48, v35
v_mul_f32 v40, s48, v36
v_mul_f32 v41, s48, v37
v_exp_f32 v38, v38
v_exp_f32 v39, v39
v_exp_f32 v40, v40
v_exp_f32 v41, v41
v_add_f32 v38, 1.0, v38
v_add_f32 v39, 1.0, v39
v_add_f32 v40, 1.0, v40
v_add_f32 v41, 1.0, v41
v_rcp_f32 v38, v38
v_rcp_f32 v39, v39
v_rcp_f32 v40, v40
v_rcp_f32 v41, v41
v_mul_f32 v34, v34, v38
v_mul_f32 v35, v35, v39
v_mul_f32 v36, v36, v40
v_mul_f32 v37, v37, v41
cvp 32,34,35
cvp 33,36,37
buffer_store_dwordx2 v[32:33], v21, s[20:23], s32 offen offset:96 sc1
cvp 42,128,129
cvp 43,130,131
v_lshlrev_b32 v44, 16, v42
v_and_b32 v45, 0xffff0000, v42
v_lshlrev_b32 v46, 16, v43
v_and_b32 v47, 0xffff0000, v43
v_mul_f32 v48, s48, v44
v_mul_f32 v49, s48, v45
v_mul_f32 v50, s48, v46
v_mul_f32 v51, s48, v47
v_exp_f32 v48, v48
v_exp_f32 v49, v49
v_exp_f32 v50, v50
v_exp_f32 v51, v51
v_add_f32 v48, 1.0, v48
v_add_f32 v49, 1.0, v49
v_add_f32 v50, 1.0, v50
v_add_f32 v51, 1.0, v51
v_rcp_f32 v48, v48
v_rcp_f32 v49, v49
v_rcp_f32 v50, v50
v_rcp_f32 v51, v51
v_mul_f32 v44, v44, v48
v_mul_f32 v45, v45, v49
v_mul_f32 v46, v46, v50
v_mul_f32 v47, v47, v51
cvp 42,44,45
cvp 43,46,47
buffer_store_dwordx2 v[42:43], v21, s[20:23], s32 offen offset:128 sc1
cvp 52,144,145
cvp 53,146,147
v_lshlrev_b32 v54, 16, v52
v_and_b32 v55, 0xffff0000, v52
v_lshlrev_b32 v56, 16, v53
v_and_b32 v57, 0xffff0000, v53
v_mul_f32 v58, s48, v54
v_mul_f32 v59, s48, v55
v_mul_f32 v60, s48, v56
v_mul_f32 v61, s48, v57
v_exp_f32 v58, v58
v_exp_f32 v59, v59
v_exp_f32 v60, v60
v_exp_f32 v61, v61
v_add_f32 v58, 1.0, v58
v_add_f32 v59, 1.0, v59
v_add_f32 v60, 1.0, v60
v_add_f32 v61, 1.0, v61
v_rcp_f32 v58, v58
v_rcp_f32 v59, v59
v_rcp_f32 v60, v60
v_rcp_f32 v61, v61
v_mul_f32 v54, v54, v58
v_mul_f32 v55, v55, v59
v_mul_f32 v56, v56, v60
v_mul_f32 v57, v57, v61
cvp 52,54,55
cvp 53,56,57
buffer_store_dwordx2 v[52:53], v21, s[20:23], s32 offen offset:160 sc1
cvp 32,160,161
cvp 33,162,163
v_lshlrev_b32 v34, 16, v32
v_and_b32 v35, 0xffff0000, v32
v_lshlrev_b32 v36, 16, v33
v_and_b32 v37, 0xffff0000, v33
v_mul_f32 v38, s48, v34
v_mul_f32 v39, s48, v35
v_mul_f32 v40, s48, v36
v_mul_f32 v41, s48, v37
v_exp_f32 v38, v38
v_exp_f32 v39, v39
v_exp_f32 v40, v40
v_exp_f32 v41, v41
v_add_f32 v38, 1.0, v38
v_add_f32 v39, 1.0, v39
v_add_f32 v40, 1.0, v40
v_add_f32 v41, 1.0, v41
v_rcp_f32 v38, v38
v_rcp_f32 v39, v39
v_rcp_f32 v40, v40
v_rcp_f32 v41, v41
v_mul_f32 v34, v34, v38
v_mul_f32 v35, v35, v39
v_mul_f32 v36, v36, v40
v_mul_f32 v37, v37, v41
cvp 32,34,35
cvp 33,36,37
buffer_store_dwordx2 v[32:33], v21, s[20:23], s32 offen offset:192 sc1
cvp 42,176,177
cvp 43,178,179
v_lshlrev_b32 v44, 16, v42
v_and_b32 v45, 0xffff0000, v42
v_lshlrev_b32 v46, 16, v43
v_and_b32 v47, 0xffff0000, v43
v_mul_f32 v48, s48, v44
v_mul_f32 v49, s48, v45
v_mul_f32 v50, s48, v46
v_mul_f32 v51, s48, v47
v_exp_f32 v48, v48
v_exp_f32 v49, v49
v_exp_f32 v50, v50
v_exp_f32 v51, v51
v_add_f32 v48, 1.0, v48
v_add_f32 v49, 1.0, v49
v_add_f32 v50, 1.0, v50
v_add_f32 v51, 1.0, v51
v_rcp_f32 v48, v48
v_rcp_f32 v49, v49
v_rcp_f32 v50, v50
v_rcp_f32 v51, v51
v_mul_f32 v44, v44, v48
v_mul_f32 v45, v45, v49
v_mul_f32 v46, v46, v50
v_mul_f32 v47, v47, v51
cvp 42,44,45
cvp 43,46,47
buffer_store_dwordx2 v[42:43], v21, s[20:23], s32 offen offset:224 sc1
sad 32,47,20480
cvp 52,68,69
cvp 53,70,71
v_lshlrev_b32 v54, 16, v52
v_and_b32 v55, 0xffff0000, v52
v_lshlrev_b32 v56, 16, v53
v_and_b32 v57, 0xffff0000, v53
v_mul_f32 v58, s48, v54
v_mul_f32 v59, s48, v55
v_mul_f32 v60, s48, v56
v_mul_f32 v61, s48, v57
v_exp_f32 v58, v58
v_exp_f32 v59, v59
v_exp_f32 v60, v60
v_exp_f32 v61, v61
v_add_f32 v58, 1.0, v58
v_add_f32 v59, 1.0, v59
v_add_f32 v60, 1.0, v60
v_add_f32 v61, 1.0, v61
v_rcp_f32 v58, v58
v_rcp_f32 v59, v59
v_rcp_f32 v60, v60
v_rcp_f32 v61, v61
v_mul_f32 v54, v54, v58
v_mul_f32 v55, v55, v59
v_mul_f32 v56, v56, v60
v_mul_f32 v57, v57, v61
cvp 52,54,55
cvp 53,56,57
buffer_store_dwordx2 v[52:53], v21, s[20:23], s32 offen offset:0 sc1
cvp 32,84,85
cvp 33,86,87
v_lshlrev_b32 v34, 16, v32
v_and_b32 v35, 0xffff0000, v32
v_lshlrev_b32 v36, 16, v33
v_and_b32 v37, 0xffff0000, v33
v_mul_f32 v38, s48, v34
v_mul_f32 v39, s48, v35
v_mul_f32 v40, s48, v36
v_mul_f32 v41, s48, v37
v_exp_f32 v38, v38
v_exp_f32 v39, v39
v_exp_f32 v40, v40
v_exp_f32 v41, v41
v_add_f32 v38, 1.0, v38
v_add_f32 v39, 1.0, v39
v_add_f32 v40, 1.0, v40
v_add_f32 v41, 1.0, v41
v_rcp_f32 v38, v38
v_rcp_f32 v39, v39
v_rcp_f32 v40, v40
v_rcp_f32 v41, v41
v_mul_f32 v34, v34, v38
v_mul_f32 v35, v35, v39
v_mul_f32 v36, v36, v40
v_mul_f32 v37, v37, v41
cvp 32,34,35
cvp 33,36,37
buffer_store_dwordx2 v[32:33], v21, s[20:23], s32 offen offset:32 sc1
cvp 42,100,101
cvp 43,102,103
v_lshlrev_b32 v44, 16, v42
v_and_b32 v45, 0xffff0000, v42
v_lshlrev_b32 v46, 16, v43
v_and_b32 v47, 0xffff0000, v43
v_mul_f32 v48, s48, v44
v_mul_f32 v49, s48, v45
v_mul_f32 v50, s48, v46
v_mul_f32 v51, s48, v47
v_exp_f32 v48, v48
v_exp_f32 v49, v49
v_exp_f32 v50, v50
v_exp_f32 v51, v51
v_add_f32 v48, 1.0, v48
v_add_f32 v49, 1.0, v49
v_add_f32 v50, 1.0, v50
v_add_f32 v51, 1.0, v51
v_rcp_f32 v48, v48
v_rcp_f32 v49, v49
v_rcp_f32 v50, v50
v_rcp_f32 v51, v51
v_mul_f32 v44, v44, v48
v_mul_f32 v45, v45, v49
v_mul_f32 v46, v46, v50
v_mul_f32 v47, v47, v51
cvp 42,44,45
cvp 43,46,47
buffer_store_dwordx2 v[42:43], v21, s[20:23], s32 offen offset:64 sc1
cvp 52,116,117
cvp 53,118,119
v_lshlrev_b32 v54, 16, v52
v_and_b32 v55, 0xffff0000, v52
v_lshlrev_b32 v56, 16, v53
v_and_b32 v57, 0xffff0000, v53
v_mul_f32 v58, s48, v54
v_mul_f32 v59, s48, v55
v_mul_f32 v60, s48, v56
v_mul_f32 v61, s48, v57
v_exp_f32 v58, v58
v_exp_f32 v59, v59
v_exp_f32 v60, v60
v_exp_f32 v61, v61
v_add_f32 v58, 1.0, v58
v_add_f32 v59, 1.0, v59
v_add_f32 v60, 1.0, v60
v_add_f32 v61, 1.0, v61
v_rcp_f32 v58, v58
v_rcp_f32 v59, v59
v_rcp_f32 v60, v60
v_rcp_f32 v61, v61
v_mul_f32 v54, v54, v58
v_mul_f32 v55, v55, v59
v_mul_f32 v56, v56, v60
v_mul_f32 v57, v57, v61
cvp 52,54,55
cvp 53,56,57
buffer_store_dwordx2 v[52:53], v21, s[20:23], s32 offen offset:96 sc1
cvp 32,132,133
cvp 33,134,135
v_lshlrev_b32 v34, 16, v32
v_and_b32 v35, 0xffff0000, v32
v_lshlrev_b32 v36, 16, v33
v_and_b32 v37, 0xffff0000, v33
v_mul_f32 v38, s48, v34
v_mul_f32 v39, s48, v35
v_mul_f32 v40, s48, v36
v_mul_f32 v41, s48, v37
v_exp_f32 v38, v38
v_exp_f32 v39, v39
v_exp_f32 v40, v40
v_exp_f32 v41, v41
v_add_f32 v38, 1.0, v38
v_add_f32 v39, 1.0, v39
v_add_f32 v40, 1.0, v40
v_add_f32 v41, 1.0, v41
v_rcp_f32 v38, v38
v_rcp_f32 v39, v39
v_rcp_f32 v40, v40
v_rcp_f32 v41, v41
v_mul_f32 v34, v34, v38
v_mul_f32 v35, v35, v39
v_mul_f32 v36, v36, v40
v_mul_f32 v37, v37, v41
cvp 32,34,35
cvp 33,36,37
buffer_store_dwordx2 v[32:33], v21, s[20:23], s32 offen offset:128 sc1
cvp 42,148,149
cvp 43,150,151
v_lshlrev_b32 v44, 16, v42
v_and_b32 v45, 0xffff0000, v42
v_lshlrev_b32 v46, 16, v43
v_and_b32 v47, 0xffff0000, v43
v_mul_f32 v48, s48, v44
v_mul_f32 v49, s48, v45
v_mul_f32 v50, s48, v46
v_mul_f32 v51, s48, v47
v_exp_f32 v48, v48
v_exp_f32 v49, v49
v_exp_f32 v50, v50
v_exp_f32 v51, v51
v_add_f32 v48, 1.0, v48
v_add_f32 v49, 1.0, v49
v_add_f32 v50, 1.0, v50
v_add_f32 v51, 1.0, v51
v_rcp_f32 v48, v48
v_rcp_f32 v49, v49
v_rcp_f32 v50, v50
v_rcp_f32 v51, v51
v_mul_f32 v44, v44, v48
v_mul_f32 v45, v45, v49
v_mul_f32 v46, v46, v50
v_mul_f32 v47, v47, v51
cvp 42,44,45
cvp 43,46,47
buffer_store_dwordx2 v[42:43], v21, s[20:23], s32 offen offset:160 sc1
cvp 52,164,165
cvp 53,166,167
v_lshlrev_b32 v54, 16, v52
v_and_b32 v55, 0xffff0000, v52
v_lshlrev_b32 v56, 16, v53
v_and_b32 v57, 0xffff0000, v53
v_mul_f32 v58, s48, v54
v_mul_f32 v59, s48, v55
v_mul_f32 v60, s48, v56
v_mul_f32 v61, s48, v57
v_exp_f32 v58, v58
v_exp_f32 v59, v59
v_exp_f32 v60, v60
v_exp_f32 v61, v61
v_add_f32 v58, 1.0, v58
v_add_f32 v59, 1.0, v59
v_add_f32 v60, 1.0, v60
v_add_f32 v61, 1.0, v61
v_rcp_f32 v58, v58
v_rcp_f32 v59, v59
v_rcp_f32 v60, v60
v_rcp_f32 v61, v61
v_mul_f32 v54, v54, v58
v_mul_f32 v55, v55, v59
v_mul_f32 v56, v56, v60
v_mul_f32 v57, v57, v61
cvp 52,54,55
cvp 53,56,57
buffer_store_dwordx2 v[52:53], v21, s[20:23], s32 offen offset:192 sc1
cvp 32,180,181
cvp 33,182,183
v_lshlrev_b32 v34, 16, v32
v_and_b32 v35, 0xffff0000, v32
v_lshlrev_b32 v36, 16, v33
v_and_b32 v37, 0xffff0000, v33
v_mul_f32 v38, s48, v34
v_mul_f32 v39, s48, v35
v_mul_f32 v40, s48, v36
v_mul_f32 v41, s48, v37
v_exp_f32 v38, v38
v_exp_f32 v39, v39
v_exp_f32 v40, v40
v_exp_f32 v41, v41
v_add_f32 v38, 1.0, v38
v_add_f32 v39, 1.0, v39
v_add_f32 v40, 1.0, v40
v_add_f32 v41, 1.0, v41
v_rcp_f32 v38, v38
v_rcp_f32 v39, v39
v_rcp_f32 v40, v40
v_rcp_f32 v41, v41
v_mul_f32 v34, v34, v38
v_mul_f32 v35, v35, v39
v_mul_f32 v36, v36, v40
v_mul_f32 v37, v37, v41
cvp 32,34,35
cvp 33,36,37
buffer_store_dwordx2 v[32:33], v21, s[20:23], s32 offen offset:224 sc1
sad 32,47,40960
cvp 42,72,73
cvp 43,74,75
v_lshlrev_b32 v44, 16, v42
v_and_b32 v45, 0xffff0000, v42
v_lshlrev_b32 v46, 16, v43
v_and_b32 v47, 0xffff0000, v43
v_mul_f32 v48, s48, v44
v_mul_f32 v49, s48, v45
v_mul_f32 v50, s48, v46
v_mul_f32 v51, s48, v47
v_exp_f32 v48, v48
v_exp_f32 v49, v49
v_exp_f32 v50, v50
v_exp_f32 v51, v51
v_add_f32 v48, 1.0, v48
v_add_f32 v49, 1.0, v49
v_add_f32 v50, 1.0, v50
v_add_f32 v51, 1.0, v51
v_rcp_f32 v48, v48
v_rcp_f32 v49, v49
v_rcp_f32 v50, v50
v_rcp_f32 v51, v51
v_mul_f32 v44, v44, v48
v_mul_f32 v45, v45, v49
v_mul_f32 v46, v46, v50
v_mul_f32 v47, v47, v51
cvp 42,44,45
cvp 43,46,47
buffer_store_dwordx2 v[42:43], v21, s[20:23], s32 offen offset:0 sc1
cvp 52,88,89
cvp 53,90,91
v_lshlrev_b32 v54, 16, v52
v_and_b32 v55, 0xffff0000, v52
v_lshlrev_b32 v56, 16, v53
v_and_b32 v57, 0xffff0000, v53
v_mul_f32 v58, s48, v54
v_mul_f32 v59, s48, v55
v_mul_f32 v60, s48, v56
v_mul_f32 v61, s48, v57
v_exp_f32 v58, v58
v_exp_f32 v59, v59
v_exp_f32 v60, v60
v_exp_f32 v61, v61
v_add_f32 v58, 1.0, v58
v_add_f32 v59, 1.0, v59
v_add_f32 v60, 1.0, v60
v_add_f32 v61, 1.0, v61
v_rcp_f32 v58, v58
v_rcp_f32 v59, v59
v_rcp_f32 v60, v60
v_rcp_f32 v61, v61
v_mul_f32 v54, v54, v58
v_mul_f32 v55, v55, v59
v_mul_f32 v56, v56, v60
v_mul_f32 v57, v57, v61
cvp 52,54,55
cvp 53,56,57
buffer_store_dwordx2 v[52:53], v21, s[20:23], s32 offen offset:32 sc1
cvp 32,104,105
cvp 33,106,107
v_lshlrev_b32 v34, 16, v32
v_and_b32 v35, 0xffff0000, v32
v_lshlrev_b32 v36, 16, v33
v_and_b32 v37, 0xffff0000, v33
v_mul_f32 v38, s48, v34
v_mul_f32 v39, s48, v35
v_mul_f32 v40, s48, v36
v_mul_f32 v41, s48, v37
v_exp_f32 v38, v38
v_exp_f32 v39, v39
v_exp_f32 v40, v40
v_exp_f32 v41, v41
v_add_f32 v38, 1.0, v38
v_add_f32 v39, 1.0, v39
v_add_f32 v40, 1.0, v40
v_add_f32 v41, 1.0, v41
v_rcp_f32 v38, v38
v_rcp_f32 v39, v39
v_rcp_f32 v40, v40
v_rcp_f32 v41, v41
v_mul_f32 v34, v34, v38
v_mul_f32 v35, v35, v39
v_mul_f32 v36, v36, v40
v_mul_f32 v37, v37, v41
cvp 32,34,35
cvp 33,36,37
buffer_store_dwordx2 v[32:33], v21, s[20:23], s32 offen offset:64 sc1
cvp 42,120,121
cvp 43,122,123
v_lshlrev_b32 v44, 16, v42
v_and_b32 v45, 0xffff0000, v42
v_lshlrev_b32 v46, 16, v43
v_and_b32 v47, 0xffff0000, v43
v_mul_f32 v48, s48, v44
v_mul_f32 v49, s48, v45
v_mul_f32 v50, s48, v46
v_mul_f32 v51, s48, v47
v_exp_f32 v48, v48
v_exp_f32 v49, v49
v_exp_f32 v50, v50
v_exp_f32 v51, v51
v_add_f32 v48, 1.0, v48
v_add_f32 v49, 1.0, v49
v_add_f32 v50, 1.0, v50
v_add_f32 v51, 1.0, v51
v_rcp_f32 v48, v48
v_rcp_f32 v49, v49
v_rcp_f32 v50, v50
v_rcp_f32 v51, v51
v_mul_f32 v44, v44, v48
v_mul_f32 v45, v45, v49
v_mul_f32 v46, v46, v50
v_mul_f32 v47, v47, v51
cvp 42,44,45
cvp 43,46,47
buffer_store_dwordx2 v[42:43], v21, s[20:23], s32 offen offset:96 sc1
cvp 52,136,137
cvp 53,138,139
v_lshlrev_b32 v54, 16, v52
v_and_b32 v55, 0xffff0000, v52
v_lshlrev_b32 v56, 16, v53
v_and_b32 v57, 0xffff0000, v53
v_mul_f32 v58, s48, v54
v_mul_f32 v59, s48, v55
v_mul_f32 v60, s48, v56
v_mul_f32 v61, s48, v57
v_exp_f32 v58, v58
v_exp_f32 v59, v59
v_exp_f32 v60, v60
v_exp_f32 v61, v61
v_add_f32 v58, 1.0, v58
v_add_f32 v59, 1.0, v59
v_add_f32 v60, 1.0, v60
v_add_f32 v61, 1.0, v61
v_rcp_f32 v58, v58
v_rcp_f32 v59, v59
v_rcp_f32 v60, v60
v_rcp_f32 v61, v61
v_mul_f32 v54, v54, v58
v_mul_f32 v55, v55, v59
v_mul_f32 v56, v56, v60
v_mul_f32 v57, v57, v61
cvp 52,54,55
cvp 53,56,57
buffer_store_dwordx2 v[52:53], v21, s[20:23], s32 offen offset:128 sc1
cvp 32,152,153
cvp 33,154,155
v_lshlrev_b32 v34, 16, v32
v_and_b32 v35, 0xffff0000, v32
v_lshlrev_b32 v36, 16, v33
v_and_b32 v37, 0xffff0000, v33
v_mul_f32 v38, s48, v34
v_mul_f32 v39, s48, v35
v_mul_f32 v40, s48, v36
v_mul_f32 v41, s48, v37
v_exp_f32 v38, v38
v_exp_f32 v39, v39
v_exp_f32 v40, v40
v_exp_f32 v41, v41
v_add_f32 v38, 1.0, v38
v_add_f32 v39, 1.0, v39
v_add_f32 v40, 1.0, v40
v_add_f32 v41, 1.0, v41
v_rcp_f32 v38, v38
v_rcp_f32 v39, v39
v_rcp_f32 v40, v40
v_rcp_f32 v41, v41
v_mul_f32 v34, v34, v38
v_mul_f32 v35, v35, v39
v_mul_f32 v36, v36, v40
v_mul_f32 v37, v37, v41
cvp 32,34,35
cvp 33,36,37
buffer_store_dwordx2 v[32:33], v21, s[20:23], s32 offen offset:160 sc1
cvp 42,168,169
cvp 43,170,171
v_lshlrev_b32 v44, 16, v42
v_and_b32 v45, 0xffff0000, v42
v_lshlrev_b32 v46, 16, v43
v_and_b32 v47, 0xffff0000, v43
v_mul_f32 v48, s48, v44
v_mul_f32 v49, s48, v45
v_mul_f32 v50, s48, v46
v_mul_f32 v51, s48, v47
v_exp_f32 v48, v48
v_exp_f32 v49, v49
v_exp_f32 v50, v50
v_exp_f32 v51, v51
v_add_f32 v48, 1.0, v48
v_add_f32 v49, 1.0, v49
v_add_f32 v50, 1.0, v50
v_add_f32 v51, 1.0, v51
v_rcp_f32 v48, v48
v_rcp_f32 v49, v49
v_rcp_f32 v50, v50
v_rcp_f32 v51, v51
v_mul_f32 v44, v44, v48
v_mul_f32 v45, v45, v49
v_mul_f32 v46, v46, v50
v_mul_f32 v47, v47, v51
cvp 42,44,45
cvp 43,46,47
buffer_store_dwordx2 v[42:43], v21, s[20:23], s32 offen offset:192 sc1
cvp 52,184,185
cvp 53,186,187
v_lshlrev_b32 v54, 16, v52
v_and_b32 v55, 0xffff0000, v52
v_lshlrev_b32 v56, 16, v53
v_and_b32 v57, 0xffff0000, v53
v_mul_f32 v58, s48, v54
v_mul_f32 v59, s48, v55
v_mul_f32 v60, s48, v56
v_mul_f32 v61, s48, v57
v_exp_f32 v58, v58
v_exp_f32 v59, v59
v_exp_f32 v60, v60
v_exp_f32 v61, v61
v_add_f32 v58, 1.0, v58
v_add_f32 v59, 1.0, v59
v_add_f32 v60, 1.0, v60
v_add_f32 v61, 1.0, v61
v_rcp_f32 v58, v58
v_rcp_f32 v59, v59
v_rcp_f32 v60, v60
v_rcp_f32 v61, v61
v_mul_f32 v54, v54, v58
v_mul_f32 v55, v55, v59
v_mul_f32 v56, v56, v60
v_mul_f32 v57, v57, v61
cvp 52,54,55
cvp 53,56,57
buffer_store_dwordx2 v[52:53], v21, s[20:23], s32 offen offset:224 sc1
sad 32,47,61440
cvp 32,76,77
cvp 33,78,79
v_lshlrev_b32 v34, 16, v32
v_and_b32 v35, 0xffff0000, v32
v_lshlrev_b32 v36, 16, v33
v_and_b32 v37, 0xffff0000, v33
v_mul_f32 v38, s48, v34
v_mul_f32 v39, s48, v35
v_mul_f32 v40, s48, v36
v_mul_f32 v41, s48, v37
v_exp_f32 v38, v38
v_exp_f32 v39, v39
v_exp_f32 v40, v40
v_exp_f32 v41, v41
v_add_f32 v38, 1.0, v38
v_add_f32 v39, 1.0, v39
v_add_f32 v40, 1.0, v40
v_add_f32 v41, 1.0, v41
v_rcp_f32 v38, v38
v_rcp_f32 v39, v39
v_rcp_f32 v40, v40
v_rcp_f32 v41, v41
v_mul_f32 v34, v34, v38
v_mul_f32 v35, v35, v39
v_mul_f32 v36, v36, v40
v_mul_f32 v37, v37, v41
cvp 32,34,35
cvp 33,36,37
buffer_store_dwordx2 v[32:33], v21, s[20:23], s32 offen offset:0 sc1
cvp 42,92,93
cvp 43,94,95
v_lshlrev_b32 v44, 16, v42
v_and_b32 v45, 0xffff0000, v42
v_lshlrev_b32 v46, 16, v43
v_and_b32 v47, 0xffff0000, v43
v_mul_f32 v48, s48, v44
v_mul_f32 v49, s48, v45
v_mul_f32 v50, s48, v46
v_mul_f32 v51, s48, v47
v_exp_f32 v48, v48
v_exp_f32 v49, v49
v_exp_f32 v50, v50
v_exp_f32 v51, v51
v_add_f32 v48, 1.0, v48
v_add_f32 v49, 1.0, v49
v_add_f32 v50, 1.0, v50
v_add_f32 v51, 1.0, v51
v_rcp_f32 v48, v48
v_rcp_f32 v49, v49
v_rcp_f32 v50, v50
v_rcp_f32 v51, v51
v_mul_f32 v44, v44, v48
v_mul_f32 v45, v45, v49
v_mul_f32 v46, v46, v50
v_mul_f32 v47, v47, v51
cvp 42,44,45
cvp 43,46,47
buffer_store_dwordx2 v[42:43], v21, s[20:23], s32 offen offset:32 sc1
cvp 52,108,109
cvp 53,110,111
v_lshlrev_b32 v54, 16, v52
v_and_b32 v55, 0xffff0000, v52
v_lshlrev_b32 v56, 16, v53
v_and_b32 v57, 0xffff0000, v53
v_mul_f32 v58, s48, v54
v_mul_f32 v59, s48, v55
v_mul_f32 v60, s48, v56
v_mul_f32 v61, s48, v57
v_exp_f32 v58, v58
v_exp_f32 v59, v59
v_exp_f32 v60, v60
v_exp_f32 v61, v61
v_add_f32 v58, 1.0, v58
v_add_f32 v59, 1.0, v59
v_add_f32 v60, 1.0, v60
v_add_f32 v61, 1.0, v61
v_rcp_f32 v58, v58
v_rcp_f32 v59, v59
v_rcp_f32 v60, v60
v_rcp_f32 v61, v61
v_mul_f32 v54, v54, v58
v_mul_f32 v55, v55, v59
v_mul_f32 v56, v56, v60
v_mul_f32 v57, v57, v61
cvp 52,54,55
cvp 53,56,57
buffer_store_dwordx2 v[52:53], v21, s[20:23], s32 offen offset:64 sc1
cvp 32,124,125
cvp 33,126,127
v_lshlrev_b32 v34, 16, v32
v_and_b32 v35, 0xffff0000, v32
v_lshlrev_b32 v36, 16, v33
v_and_b32 v37, 0xffff0000, v33
v_mul_f32 v38, s48, v34
v_mul_f32 v39, s48, v35
v_mul_f32 v40, s48, v36
v_mul_f32 v41, s48, v37
v_exp_f32 v38, v38
v_exp_f32 v39, v39
v_exp_f32 v40, v40
v_exp_f32 v41, v41
v_add_f32 v38, 1.0, v38
v_add_f32 v39, 1.0, v39
v_add_f32 v40, 1.0, v40
v_add_f32 v41, 1.0, v41
v_rcp_f32 v38, v38
v_rcp_f32 v39, v39
v_rcp_f32 v40, v40
v_rcp_f32 v41, v41
v_mul_f32 v34, v34, v38
v_mul_f32 v35, v35, v39
v_mul_f32 v36, v36, v40
v_mul_f32 v37, v37, v41
cvp 32,34,35
cvp 33,36,37
buffer_store_dwordx2 v[32:33], v21, s[20:23], s32 offen offset:96 sc1
cvp 42,140,141
cvp 43,142,143
v_lshlrev_b32 v44, 16, v42
v_and_b32 v45, 0xffff0000, v42
v_lshlrev_b32 v46, 16, v43
v_and_b32 v47, 0xffff0000, v43
v_mul_f32 v48, s48, v44
v_mul_f32 v49, s48, v45
v_mul_f32 v50, s48, v46
v_mul_f32 v51, s48, v47
v_exp_f32 v48, v48
v_exp_f32 v49, v49
v_exp_f32 v50, v50
v_exp_f32 v51, v51
v_add_f32 v48, 1.0, v48
v_add_f32 v49, 1.0, v49
v_add_f32 v50, 1.0, v50
v_add_f32 v51, 1.0, v51
v_rcp_f32 v48, v48
v_rcp_f32 v49, v49
v_rcp_f32 v50, v50
v_rcp_f32 v51, v51
v_mul_f32 v44, v44, v48
v_mul_f32 v45, v45, v49
v_mul_f32 v46, v46, v50
v_mul_f32 v47, v47, v51
cvp 42,44,45
cvp 43,46,47
buffer_store_dwordx2 v[42:43], v21, s[20:23], s32 offen offset:128 sc1
cvp 52,156,157
cvp 53,158,159
v_lshlrev_b32 v54, 16, v52
v_and_b32 v55, 0xffff0000, v52
v_lshlrev_b32 v56, 16, v53
v_and_b32 v57, 0xffff0000, v53
v_mul_f32 v58, s48, v54
v_mul_f32 v59, s48, v55
v_mul_f32 v60, s48, v56
v_mul_f32 v61, s48, v57
v_exp_f32 v58, v58
v_exp_f32 v59, v59
v_exp_f32 v60, v60
v_exp_f32 v61, v61
v_add_f32 v58, 1.0, v58
v_add_f32 v59, 1.0, v59
v_add_f32 v60, 1.0, v60
v_add_f32 v61, 1.0, v61
v_rcp_f32 v58, v58
v_rcp_f32 v59, v59
v_rcp_f32 v60, v60
v_rcp_f32 v61, v61
v_mul_f32 v54, v54, v58
v_mul_f32 v55, v55, v59
v_mul_f32 v56, v56, v60
v_mul_f32 v57, v57, v61
cvp 52,54,55
cvp 53,56,57
buffer_store_dwordx2 v[52:53], v21, s[20:23], s32 offen offset:160 sc1
cvp 32,172,173
cvp 33,174,175
v_lshlrev_b32 v34, 16, v32
v_and_b32 v35, 0xffff0000, v32
v_lshlrev_b32 v36, 16, v33
v_and_b32 v37, 0xffff0000, v33
v_mul_f32 v38, s48, v34
v_mul_f32 v39, s48, v35
v_mul_f32 v40, s48, v36
v_mul_f32 v41, s48, v37
v_exp_f32 v38, v38
v_exp_f32 v39, v39
v_exp_f32 v40, v40
v_exp_f32 v41, v41
v_add_f32 v38, 1.0, v38
v_add_f32 v39, 1.0, v39
v_add_f32 v40, 1.0, v40
v_add_f32 v41, 1.0, v41
v_rcp_f32 v38, v38
v_rcp_f32 v39, v39
v_rcp_f32 v40, v40
v_rcp_f32 v41, v41
v_mul_f32 v34, v34, v38
v_mul_f32 v35, v35, v39
v_mul_f32 v36, v36, v40
v_mul_f32 v37, v37, v41
cvp 32,34,35
cvp 33,36,37
buffer_store_dwordx2 v[32:33], v21, s[20:23], s32 offen offset:192 sc1
cvp 42,188,189
cvp 43,190,191
v_lshlrev_b32 v44, 16, v42
v_and_b32 v45, 0xffff0000, v42
v_lshlrev_b32 v46, 16, v43
v_and_b32 v47, 0xffff0000, v43
v_mul_f32 v48, s48, v44
v_mul_f32 v49, s48, v45
v_mul_f32 v50, s48, v46
v_mul_f32 v51, s48, v47
v_exp_f32 v48, v48
v_exp_f32 v49, v49
v_exp_f32 v50, v50
v_exp_f32 v51, v51
v_add_f32 v48, 1.0, v48
v_add_f32 v49, 1.0, v49
v_add_f32 v50, 1.0, v50
v_add_f32 v51, 1.0, v51
v_rcp_f32 v48, v48
v_rcp_f32 v49, v49
v_rcp_f32 v50, v50
v_rcp_f32 v51, v51
v_mul_f32 v44, v44, v48
v_mul_f32 v45, v45, v49
v_mul_f32 v46, v46, v50
v_mul_f32 v47, v47, v51
cvp 42,44,45
cvp 43,46,47
buffer_store_dwordx2 v[42:43], v21, s[20:23], s32 offen offset:224 sc1
s_getpc_b64 s[50:51]
L_h_178:
s_add_u32 s50, s50, L_wk_done-L_h_178
s_addc_u32 s51, s51, -1
s_setpc_b64 s[50:51]
.p2align 6
L_main_vz2:
s_mov_b32 s18, 2621440
sad 20,36,134217728
s_addc_u32 s21, s37, 0
s_and_b32 s21, s21, 0xffff
s_mov_b32 s22, 83886080
s_mov_b32 s23, 0x00020000
s_and_b32 s45, s3, 31
s_mul_i32 s27, s45, 245760
s_lshr_b32 s46, s3, 5
s_lshl_b32 s46, s46, 2
s_add_u32 s46, s46, s4
s_mul_i32 s46, s46, 2
v_bfe_u32 v2, v1, 3, 1
v_lshlrev_b32 v21, 14, v2
v_lshrrev_b32 v2, 4, v1
v_lshl_add_u32 v21, v2, 10, v21
v_and_b32 v2, 7, v1
v_lshl_add_u32 v21, v2, 4, v21
s_lshr_b32 s47, s46, 1
s_mul_i32 s47, s47, 1310720
s_lshr_b32 s32, s45, 3
s_lshl_b32 s32, s32, 12
s_add_u32 s47, s47, s32
s_and_b32 s32, s45, 3
s_lshl_b32 s32, s32, 8
s_add_u32 s47, s47, s32
s_bfe_u32 s32, s45, 0x10002
s_lshl_b32 s32, s32, 7
s_add_u32 s47, s47, s32
sad 33,28,0
buffer_load_dwordx4 a[96:99], v20, s[16:19], s33 offen sc1
sad 33,28,20480
buffer_load_dwordx4 a[100:103], v20, s[16:19], s33 offen sc1
sad 33,28,1024
buffer_load_dwordx4 a[104:107], v20, s[16:19], s33 offen sc1
sad 33,28,21504
buffer_load_dwordx4 a[108:111], v20, s[16:19], s33 offen sc1
s_barrier
tra 64,8,0
tra 66,8,2048
tra 68,9,0
tra 70,9,2048
tra 72,10,0
tra 74,10,2048
tra 76,11,0
tra 78,11,2048
wv 2
wl 6
mfz 64,64,96
tra 80,8,8192
tra 82,8,10240
mfz 68,64,100
sad 33,28,2048
buffer_load_dwordx4 a[128:131], v20, s[16:19], s33 offen sc1
wl 6
mfz 72,68,96
tra 84,9,8192
tra 86,9,10240
mfz 76,68,100
sad 33,28,22528
buffer_load_dwordx4 a[132:135], v20, s[16:19], s33 offen sc1
wl 6
mfz 80,72,96
tra 88,10,8192
tra 90,10,10240
mfz 84,72,100
sad 33,28,3072
buffer_load_dwordx4 a[136:139], v20, s[16:19], s33 offen sc1
wl 6
mfz 88,76,96
tra 92,11,8192
tra 94,11,10240
mfz 92,76,100
sad 33,28,23552
buffer_load_dwordx4 a[140:143], v20, s[16:19], s33 offen sc1
wl 6
mfz 96,80,96
tra 64,8,16384
tra 66,8,18432
mfz 100,80,100
sad 33,28,4096
buffer_load_dwordx4 a[160:163], v20, s[16:19], s33 offen sc1
wl 6
mfz 104,84,96
tra 68,9,16384
tra 70,9,18432
mfz 108,84,100
sad 33,28,24576
buffer_load_dwordx4 a[164:167], v20, s[16:19], s33 offen sc1
wl 6
mfz 112,88,96
tra 72,10,16384
tra 74,10,18432
mfz 116,88,100
sad 33,28,5120
buffer_load_dwordx4 a[168:171], v20, s[16:19], s33 offen sc1
wl 6
mfz 120,92,96
tra 76,11,16384
tra 78,11,18432
mfz 124,92,100
sad 33,28,25600
buffer_load_dwordx4 a[172:175], v20, s[16:19], s33 offen sc1
wl 6
mfz 128,64,96
tra 80,8,4096
tra 82,8,6144
mfz 132,64,100
sad 33,28,6144
buffer_load_dwordx4 a[192:195], v20, s[16:19], s33 offen sc1
wl 6
mfz 136,68,96
tra 84,9,4096
tra 86,9,6144
mfz 140,68,100
sad 33,28,26624
buffer_load_dwordx4 a[196:199], v20, s[16:19], s33 offen sc1
wl 6
mfz 144,72,96
tra 88,10,4096
tra 90,10,6144
mfz 148,72,100
sad 33,28,7168
buffer_load_dwordx4 a[200:203], v20, s[16:19], s33 offen sc1
wl 6
mfz 152,76,96
tra 92,11,4096
tra 94,11,6144
mfz 156,76,100
sad 33,28,27648
buffer_load_dwordx4 a[204:207], v20, s[16:19], s33 offen sc1
wv 12
wl 6
mfa 64,80,104
tra 64,8,12288
tra 66,8,14336
mfa 68,80,108
sad 34,24,3145728
s_add_u32 m0, s29, 98304
s_nop 0
buffer_load_dwordx4 v6, s[8:11], s34 offen lds
wl 6
mfa 72,84,104
tra 68,9,12288
tra 70,9,14336
mfa 76,84,108
s_add_u32 m0, s29, 99328
s_nop 0
buffer_load_dwordx4 v7, s[8:11], s34 offen lds
wl 6
mfa 80,88,104
tra 72,10,12288
tra 74,10,14336
mfa 84,88,108
sad 34,25,3145728
s_add_u32 m0, s29, 106496
s_nop 0
buffer_load_dwordx4 v6, s[52:55], s34 offen lds
wl 6
mfa 88,92,104
tra 76,11,12288
tra 78,11,14336
mfa 92,92,108
s_add_u32 m0, s29, 107520
s_nop 0
buffer_load_dwordx4 v7, s[52:55], s34 offen lds
wl 6
mfa 96,64,104
tra 80,8,20480
tra 82,8,22528
mfa 100,64,108
sad 34,26,3145728
s_add_u32 m0, s29, 114688
s_nop 0
buffer_load_dwordx4 v6, s[56:59], s34 offen lds
wl 6
mfa 104,68,104
tra 84,9,20480
tra 86,9,22528
mfa 108,68,108
s_add_u32 m0, s29, 115712
s_nop 0
buffer_load_dwordx4 v7, s[56:59], s34 offen lds
wl 6
mfa 112,72,104
tra 88,10,20480
tra 90,10,22528
mfa 116,72,108
sad 33,28,8192
buffer_load_dwordx4 a[224:227], v20, s[16:19], s33 offen sc1
wl 6
mfa 120,76,104
tra 92,11,20480
tra 94,11,22528
mfa 124,76,108
sad 33,28,28672
buffer_load_dwordx4 a[228:231], v20, s[16:19], s33 offen sc1
wl 0
s_barrier
mfa 128,80,104
tra 64,8,24576
tra 66,8,26624
mfa 132,80,108
sad 33,28,9216
buffer_load_dwordx4 a[232:235], v20, s[16:19], s33 offen sc1
mfa 136,84,104
tra 68,9,24576
tra 70,9,26624
mfa 140,84,108
sad 33,28,29696
buffer_load_dwordx4 a[236:239], v20, s[16:19], s33 offen sc1
mfa 144,88,104
tra 72,10,24576
tra 74,10,26624
mfa 148,88,108
sad 34,24,3932160
s_add_u32 m0, s29, 0
s_nop 0
buffer_load_dwordx4 v6, s[8:11], s34 offen lds
mfa 152,92,104
tra 76,11,24576
tra 78,11,26624
mfa 156,92,108
s_add_u32 m0, s29, 1024
s_nop 0
buffer_load_dwordx4 v7, s[8:11], s34 offen lds
wv 22
wl 6
mfa 64,64,128
tra 80,8,32768
tra 82,8,34816
mfa 68,64,132
sad 34,25,3932160
s_add_u32 m0, s29, 8192
s_nop 0
buffer_load_dwordx4 v6, s[52:55], s34 offen lds
wl 6
mfa 72,68,128
tra 84,9,32768
tra 86,9,34816
mfa 76,68,132
s_add_u32 m0, s29, 9216
s_nop 0
buffer_load_dwordx4 v7, s[52:55], s34 offen lds
wl 6
mfa 80,72,128
tra 88,10,32768
tra 90,10,34816
mfa 84,72,132
sad 34,26,3932160
s_add_u32 m0, s29, 16384
s_nop 0
buffer_load_dwordx4 v6, s[56:59], s34 offen lds
wl 6
mfa 88,76,128
tra 92,11,32768
tra 94,11,34816
mfa 92,76,132
s_add_u32 m0, s29, 17408
s_nop 0
buffer_load_dwordx4 v7, s[56:59], s34 offen lds
wl 6
mfa 96,80,128
tra 64,8,40960
tra 66,8,43008
mfa 100,80,132
sad 33,28,10240
buffer_load_dwordx4 a[96:99], v20, s[16:19], s33 offen sc1
wl 6
mfa 104,84,128
tra 68,9,40960
tra 70,9,43008
mfa 108,84,132
sad 33,28,30720
buffer_load_dwordx4 a[100:103], v20, s[16:19], s33 offen sc1
wl 6
mfa 112,88,128
tra 72,10,40960
tra 74,10,43008
mfa 116,88,132
sad 33,28,11264
buffer_load_dwordx4 a[104:107], v20, s[16:19], s33 offen sc1
wl 6
mfa 120,92,128
tra 76,11,40960
tra 78,11,43008
mfa 124,92,132
sad 33,28,31744
buffer_load_dwordx4 a[108:111], v20, s[16:19], s33 offen sc1
wl 6
mfa 128,64,128
tra 80,8,28672
tra 82,8,30720
mfa 132,64,132
wl 6
mfa 136,68,128
tra 84,9,28672
tra 86,9,30720
mfa 140,68,132
wl 6
mfa 144,72,128
tra 88,10,28672
tra 90,10,30720
mfa 148,72,132
wl 6
mfa 152,76,128
tra 92,11,28672
tra 94,11,30720
mfa 156,76,132
wv 28
wl 6
mfa 64,80,136
tra 64,8,36864
tra 66,8,38912
mfa 68,80,140
wl 6
mfa 72,84,136
tra 68,9,36864
tra 70,9,38912
mfa 76,84,140
wl 6
mfa 80,88,136
tra 72,10,36864
tra 74,10,38912
mfa 84,88,140
wl 6
mfa 88,92,136
tra 76,11,36864
tra 78,11,38912
mfa 92,92,140
wl 6
mfa 96,64,136
tra 80,8,45056
tra 82,8,47104
mfa 100,64,140
wl 6
mfa 104,68,136
tra 84,9,45056
tra 86,9,47104
mfa 108,68,140
wl 6
mfa 112,72,136
tra 88,10,45056
tra 90,10,47104
mfa 116,72,140
wl 6
mfa 120,76,136
tra 92,11,45056
tra 94,11,47104
mfa 124,76,140
wl 0
s_barrier
s_cmp_lt_i32 s70, 0
s_cbranch_scc1 L_pp_179
s_cmp_lg_u32 s4, 1
s_cbranch_scc1 L_pp_179
s_lshl_b32 s83, s70, 7
v_and_b32 v2, 1, v1
v_cmp_eq_u32 vcc, 1, v2
v_mov_b32 v2, s100
v_mov_b32 v3, s101
v_cndmask_b32 v3, v2, v3, vcc
v_and_b32 v2, 31, v1
v_lshlrev_b32 v2, 2, v2
buffer_store_dword v3, v2, s[88:91], s83 offen sc1
L_pp_179:
s_mov_b32 s70, -1
mfa 128,80,136
tra 64,8,49152
tra 66,8,51200
mfa 132,80,140
sad 34,24,4718592
s_add_u32 m0, s29, 24576
s_nop 0
buffer_load_dwordx4 v6, s[8:11], s34 offen lds
mfa 136,84,136
tra 68,9,49152
tra 70,9,51200
mfa 140,84,140
s_add_u32 m0, s29, 25600
s_nop 0
buffer_load_dwordx4 v7, s[8:11], s34 offen lds
mfa 144,88,136
tra 72,10,49152
tra 74,10,51200
mfa 148,88,140
sad 34,25,4718592
s_add_u32 m0, s29, 32768
s_nop 0
buffer_load_dwordx4 v6, s[52:55], s34 offen lds
mfa 152,92,136
tra 76,11,49152
tra 78,11,51200
mfa 156,92,140
s_add_u32 m0, s29, 33792
s_nop 0
buffer_load_dwordx4 v7, s[52:55], s34 offen lds
wv 30
wl 6
mfa 64,64,160
tra 80,8,57344
tra 82,8,59392
mfa 68,64,164
sad 34,26,4718592
s_add_u32 m0, s29, 40960
s_nop 0
buffer_load_dwordx4 v6, s[56:59], s34 offen lds
wl 6
mfa 72,68,160
tra 84,9,57344
tra 86,9,59392
mfa 76,68,164
s_add_u32 m0, s29, 41984
s_nop 0
buffer_load_dwordx4 v7, s[56:59], s34 offen lds
wl 6
mfa 80,72,160
tra 88,10,57344
tra 90,10,59392
mfa 84,72,164
sad 33,28,12288
buffer_load_dwordx4 a[128:131], v20, s[16:19], s33 offen sc1
wl 6
mfa 88,76,160
tra 92,11,57344
tra 94,11,59392
mfa 92,76,164
sad 33,28,32768
buffer_load_dwordx4 a[132:135], v20, s[16:19], s33 offen sc1
wl 6
mfa 96,80,160
tra 64,12,16384
tra 66,12,18432
mfa 100,80,164
sad 33,28,13312
buffer_load_dwordx4 a[136:139], v20, s[16:19], s33 offen sc1
wl 6
mfa 104,84,160
tra 68,13,16384
tra 70,13,18432
mfa 108,84,164
sad 33,28,33792
buffer_load_dwordx4 a[140:143], v20, s[16:19], s33 offen sc1
wl 6
mfa 112,88,160
tra 72,14,16384
tra 74,14,18432
mfa 116,88,164
wl 6
mfa 120,92,160
tra 76,15,16384
tra 78,15,18432
mfa 124,92,164
wl 6
mfa 128,64,160
tra 80,8,53248
tra 82,8,55296
mfa 132,64,164
wl 6
mfa 136,68,160
tra 84,9,53248
tra 86,9,55296
mfa 140,68,164
wl 6
mfa 144,72,160
tra 88,10,53248
tra 90,10,55296
mfa 148,72,164
wl 6
mfa 152,76,160
tra 92,11,53248
tra 94,11,55296
mfa 156,76,164
wv 34
wl 6
mfa 64,80,168
tra 64,8,61440
tra 66,8,63488
mfa 68,80,172
wl 6
mfa 72,84,168
tra 68,9,61440
tra 70,9,63488
mfa 76,84,172
wl 6
mfa 80,88,168
tra 72,10,61440
tra 74,10,63488
mfa 84,88,172
wl 6
mfa 88,92,168
tra 76,11,61440
tra 78,11,63488
mfa 92,92,172
wl 6
mfa 96,64,168
tra 80,12,20480
tra 82,12,22528
mfa 100,64,172
wl 6
mfa 104,68,168
tra 84,13,20480
tra 86,13,22528
mfa 108,68,172
wl 6
mfa 112,72,168
tra 88,14,20480
tra 90,14,22528
mfa 116,72,172
wl 6
mfa 120,76,168
tra 92,15,20480
tra 94,15,22528
mfa 124,76,172
wl 0
s_barrier
mfa 128,80,168
tra 64,12,24576
tra 66,12,26624
mfa 132,80,172
sad 34,24,5505024
s_add_u32 m0, s29, 49152
s_nop 0
buffer_load_dwordx4 v6, s[8:11], s34 offen lds
mfa 136,84,168
tra 68,13,24576
tra 70,13,26624
mfa 140,84,172
s_add_u32 m0, s29, 50176
s_nop 0
buffer_load_dwordx4 v7, s[8:11], s34 offen lds
mfa 144,88,168
tra 72,14,24576
tra 74,14,26624
mfa 148,88,172
sad 34,25,5505024
s_add_u32 m0, s29, 57344
s_nop 0
buffer_load_dwordx4 v6, s[52:55], s34 offen lds
mfa 152,92,168
tra 76,15,24576
tra 78,15,26624
mfa 156,92,172
s_add_u32 m0, s29, 58368
s_nop 0
buffer_load_dwordx4 v7, s[52:55], s34 offen lds
wv 36
wl 6
mfa 64,64,192
tra 80,12,32768
tra 82,12,34816
mfa 68,64,196
sad 34,26,5505024
s_add_u32 m0, s29, 65536
s_nop 0
buffer_load_dwordx4 v6, s[56:59], s34 offen lds
wl 6
mfa 72,68,192
tra 84,13,32768
tra 86,13,34816
mfa 76,68,196
s_add_u32 m0, s29, 66560
s_nop 0
buffer_load_dwordx4 v7, s[56:59], s34 offen lds
wl 6
mfa 80,72,192
tra 88,14,32768
tra 90,14,34816
mfa 84,72,196
sad 33,28,14336
buffer_load_dwordx4 a[160:163], v20, s[16:19], s33 offen sc1
wl 6
mfa 88,76,192
tra 92,15,32768
tra 94,15,34816
mfa 92,76,196
sad 33,28,34816
buffer_load_dwordx4 a[164:167], v20, s[16:19], s33 offen sc1
wl 6
mfa 96,80,192
tra 64,12,40960
tra 66,12,43008
mfa 100,80,196
sad 33,28,15360
buffer_load_dwordx4 a[168:171], v20, s[16:19], s33 offen sc1
wl 6
mfa 104,84,192
tra 68,13,40960
tra 70,13,43008
mfa 108,84,196
sad 33,28,35840
buffer_load_dwordx4 a[172:175], v20, s[16:19], s33 offen sc1
wl 6
mfa 112,88,192
tra 72,14,40960
tra 74,14,43008
mfa 116,88,196
wl 6
mfa 120,92,192
tra 76,15,40960
tra 78,15,43008
mfa 124,92,196
wl 6
mfa 128,64,192
tra 80,12,28672
tra 82,12,30720
mfa 132,64,196
wl 6
mfa 136,68,192
tra 84,13,28672
tra 86,13,30720
mfa 140,68,196
wl 6
mfa 144,72,192
tra 88,14,28672
tra 90,14,30720
mfa 148,72,196
wl 6
mfa 152,76,192
tra 92,15,28672
tra 94,15,30720
mfa 156,76,196
wv 40
wl 6
mfa 64,80,200
tra 64,12,36864
tra 66,12,38912
mfa 68,80,204
wl 6
mfa 72,84,200
tra 68,13,36864
tra 70,13,38912
mfa 76,84,204
wl 6
mfa 80,88,200
tra 72,14,36864
tra 74,14,38912
mfa 84,88,204
wl 6
mfa 88,92,200
tra 76,15,36864
tra 78,15,38912
mfa 92,92,204
wl 6
mfa 96,64,200
tra 80,12,45056
tra 82,12,47104
mfa 100,64,204
wl 6
mfa 104,68,200
tra 84,13,45056
tra 86,13,47104
mfa 108,68,204
wl 6
mfa 112,72,200
tra 88,14,45056
tra 90,14,47104
mfa 116,72,204
wl 6
mfa 120,76,200
tra 92,15,45056
tra 94,15,47104
mfa 124,76,204
s_waitcnt vmcnt(34) lgkmcnt(0)
s_barrier
mfa 128,80,200
tra 64,12,49152
tra 66,12,51200
mfa 132,80,204
sad 34,24,6291456
s_add_u32 m0, s29, 73728
s_nop 0
buffer_load_dwordx4 v6, s[8:11], s34 offen lds
mfa 136,84,200
tra 68,13,49152
tra 70,13,51200
mfa 140,84,204
s_add_u32 m0, s29, 74752
s_nop 0
buffer_load_dwordx4 v7, s[8:11], s34 offen lds
mfa 144,88,200
tra 72,14,49152
tra 74,14,51200
mfa 148,88,204
sad 34,25,6291456
s_add_u32 m0, s29, 81920
s_nop 0
buffer_load_dwordx4 v6, s[52:55], s34 offen lds
mfa 152,92,200
tra 76,15,49152
tra 78,15,51200
mfa 156,92,204
s_add_u32 m0, s29, 82944
s_nop 0
buffer_load_dwordx4 v7, s[52:55], s34 offen lds
wv 36
wl 6
mfa 64,64,224
tra 80,12,57344
tra 82,12,59392
mfa 68,64,228
sad 34,26,6291456
s_add_u32 m0, s29, 90112
s_nop 0
buffer_load_dwordx4 v6, s[56:59], s34 offen lds
wl 6
mfa 72,68,224
tra 84,13,57344
tra 86,13,59392
mfa 76,68,228
s_add_u32 m0, s29, 91136
s_nop 0
buffer_load_dwordx4 v7, s[56:59], s34 offen lds
wl 6
mfa 80,72,224
tra 88,14,57344
tra 90,14,59392
mfa 84,72,228
sad 33,28,16384
buffer_load_dwordx4 a[192:195], v20, s[16:19], s33 offen sc1
wl 6
mfa 88,76,224
tra 92,15,57344
tra 94,15,59392
mfa 92,76,228
sad 33,28,36864
buffer_load_dwordx4 a[196:199], v20, s[16:19], s33 offen sc1
wl 6
mfa 96,80,224
tra 64,24,16384
tra 66,24,18432
mfa 100,80,228
sad 33,28,17408
buffer_load_dwordx4 a[200:203], v20, s[16:19], s33 offen sc1
wl 6
mfa 104,84,224
tra 68,25,16384
tra 70,25,18432
mfa 108,84,228
sad 33,28,37888
buffer_load_dwordx4 a[204:207], v20, s[16:19], s33 offen sc1
wl 6
mfa 112,88,224
tra 72,26,16384
tra 74,26,18432
mfa 116,88,228
wl 6
mfa 120,92,224
tra 76,27,16384
tra 78,27,18432
mfa 124,92,228
wl 6
mfa 128,64,224
tra 80,12,53248
tra 82,12,55296
mfa 132,64,228
wl 6
mfa 136,68,224
tra 84,13,53248
tra 86,13,55296
mfa 140,68,228
wl 6
mfa 144,72,224
tra 88,14,53248
tra 90,14,55296
mfa 148,72,228
wl 6
mfa 152,76,224
tra 92,15,53248
tra 94,15,55296
mfa 156,76,228
wv 40
wl 6
mfa 64,80,232
tra 64,12,61440
tra 66,12,63488
mfa 68,80,236
wl 6
mfa 72,84,232
tra 68,13,61440
tra 70,13,63488
mfa 76,84,236
wl 6
mfa 80,88,232
tra 72,14,61440
tra 74,14,63488
mfa 84,88,236
wl 6
mfa 88,92,232
tra 76,15,61440
tra 78,15,63488
mfa 92,92,236
wl 6
mfa 96,64,232
tra 80,24,20480
tra 82,24,22528
mfa 100,64,236
wl 6
mfa 104,68,232
tra 84,25,20480
tra 86,25,22528
mfa 108,68,236
wl 6
mfa 112,72,232
tra 88,26,20480
tra 90,26,22528
mfa 116,72,236
wl 6
mfa 120,76,232
tra 92,27,20480
tra 94,27,22528
mfa 124,76,236
s_waitcnt vmcnt(34) lgkmcnt(0)
s_barrier
mfa 128,80,232
tra 64,8,0
tra 66,8,2048
mfa 132,80,236
sad 34,24,7077888
s_add_u32 m0, s29, 98304
s_nop 0
buffer_load_dwordx4 v6, s[8:11], s34 offen lds
mfa 136,84,232
tra 68,9,0
tra 70,9,2048
mfa 140,84,236
s_add_u32 m0, s29, 99328
s_nop 0
buffer_load_dwordx4 v7, s[8:11], s34 offen lds
mfa 144,88,232
tra 72,10,0
tra 74,10,2048
mfa 148,88,236
sad 34,25,7077888
s_add_u32 m0, s29, 106496
s_nop 0
buffer_load_dwordx4 v6, s[52:55], s34 offen lds
mfa 152,92,232
tra 76,11,0
tra 78,11,2048
mfa 156,92,236
s_add_u32 m0, s29, 107520
s_nop 0
buffer_load_dwordx4 v7, s[52:55], s34 offen lds
wv 36
wl 6
mfa 64,64,96
tra 80,8,8192
tra 82,8,10240
mfa 68,64,100
sad 34,26,7077888
s_add_u32 m0, s29, 114688
s_nop 0
buffer_load_dwordx4 v6, s[56:59], s34 offen lds
wl 6
mfa 72,68,96
tra 84,9,8192
tra 86,9,10240
mfa 76,68,100
s_add_u32 m0, s29, 115712
s_nop 0
buffer_load_dwordx4 v7, s[56:59], s34 offen lds
wl 6
mfa 80,72,96
tra 88,10,8192
tra 90,10,10240
mfa 84,72,100
sad 33,28,18432
buffer_load_dwordx4 a[224:227], v20, s[16:19], s33 offen sc1
wl 6
mfa 88,76,96
tra 92,11,8192
tra 94,11,10240
mfa 92,76,100
sad 33,28,38912
buffer_load_dwordx4 a[228:231], v20, s[16:19], s33 offen sc1
wl 6
mfa 96,80,96
tra 64,8,16384
tra 66,8,18432
mfa 100,80,100
sad 33,28,19456
buffer_load_dwordx4 a[232:235], v20, s[16:19], s33 offen sc1
wl 6
mfa 104,84,96
tra 68,9,16384
tra 70,9,18432
mfa 108,84,100
sad 33,28,39936
buffer_load_dwordx4 a[236:239], v20, s[16:19], s33 offen sc1
wl 6
mfa 112,88,96
tra 72,10,16384
tra 74,10,18432
mfa 116,88,100
wl 6
mfa 120,92,96
tra 76,11,16384
tra 78,11,18432
mfa 124,92,100
wl 6
mfa 128,64,96
tra 80,8,4096
tra 82,8,6144
mfa 132,64,100
wl 6
mfa 136,68,96
tra 84,9,4096
tra 86,9,6144
mfa 140,68,100
wl 6
mfa 144,72,96
tra 88,10,4096
tra 90,10,6144
mfa 148,72,100
wl 6
mfa 152,76,96
tra 92,11,4096
tra 94,11,6144
mfa 156,76,100
wv 40
wl 6
mfa 64,80,104
tra 64,8,12288
tra 66,8,14336
mfa 68,80,108
wl 6
mfa 72,84,104
tra 68,9,12288
tra 70,9,14336
mfa 76,84,108
wl 6
mfa 80,88,104
tra 72,10,12288
tra 74,10,14336
mfa 84,88,108
wl 6
mfa 88,92,104
tra 76,11,12288
tra 78,11,14336
mfa 92,92,108
wl 6
mfa 96,64,104
tra 80,8,20480
tra 82,8,22528
mfa 100,64,108
wl 6
mfa 104,68,104
tra 84,9,20480
tra 86,9,22528
mfa 108,68,108
wl 6
mfa 112,72,104
tra 88,10,20480
tra 90,10,22528
mfa 116,72,108
wl 6
mfa 120,76,104
tra 92,11,20480
tra 94,11,22528
mfa 124,76,108
s_waitcnt vmcnt(34) lgkmcnt(0)
s_barrier
mfa 128,80,104
tra 64,8,24576
tra 66,8,26624
mfa 132,80,108
sad 34,27,0
s_add_u32 m0, s29, 0
s_nop 0
buffer_load_dwordx4 v30, s[12:15], s34 offen lds
mfa 136,84,104
tra 68,9,24576
tra 70,9,26624
mfa 140,84,108
s_add_u32 m0, s29, 1024
s_nop 0
buffer_load_dwordx4 v31, s[12:15], s34 offen lds
mfa 144,88,104
tra 72,10,24576
tra 74,10,26624
mfa 148,88,108
sad 34,27,81920
s_add_u32 m0, s29, 8192
s_nop 0
buffer_load_dwordx4 v30, s[12:15], s34 offen lds
mfa 152,92,104
tra 76,11,24576
tra 78,11,26624
mfa 156,92,108
s_add_u32 m0, s29, 9216
s_nop 0
buffer_load_dwordx4 v31, s[12:15], s34 offen lds
wv 36
wl 6
mfa 64,64,128
tra 80,8,32768
tra 82,8,34816
mfa 68,64,132
sad 34,27,163840
s_add_u32 m0, s29, 16384
s_nop 0
buffer_load_dwordx4 v30, s[12:15], s34 offen lds
wl 6
mfa 72,68,128
tra 84,9,32768
tra 86,9,34816
mfa 76,68,132
s_add_u32 m0, s29, 17408
s_nop 0
buffer_load_dwordx4 v31, s[12:15], s34 offen lds
wl 6
mfa 80,72,128
tra 88,10,32768
tra 90,10,34816
mfa 84,72,132
wl 6
mfa 88,76,128
tra 92,11,32768
tra 94,11,34816
mfa 92,76,132
wl 6
mfa 96,80,128
tra 64,8,40960
tra 66,8,43008
mfa 100,80,132
wl 6
mfa 104,84,128
tra 68,9,40960
tra 70,9,43008
mfa 108,84,132
wl 6
mfa 112,88,128
tra 72,10,40960
tra 74,10,43008
mfa 116,88,132
wl 6
mfa 120,92,128
tra 76,11,40960
tra 78,11,43008
mfa 124,92,132
wl 6
mfa 128,64,128
tra 80,8,28672
tra 82,8,30720
mfa 132,64,132
wl 6
mfa 136,68,128
tra 84,9,28672
tra 86,9,30720
mfa 140,68,132
wl 6
mfa 144,72,128
tra 88,10,28672
tra 90,10,30720
mfa 148,72,132
wl 6
mfa 152,76,128
tra 92,11,28672
tra 94,11,30720
mfa 156,76,132
wv 36
wl 6
mfa 64,80,136
tra 64,8,36864
tra 66,8,38912
mfa 68,80,140
wl 6
mfa 72,84,136
tra 68,9,36864
tra 70,9,38912
mfa 76,84,140
wl 6
mfa 80,88,136
tra 72,10,36864
tra 74,10,38912
mfa 84,88,140
wl 6
mfa 88,92,136
tra 76,11,36864
tra 78,11,38912
mfa 92,92,140
wl 6
mfa 96,64,136
tra 80,8,45056
tra 82,8,47104
mfa 100,64,140
wl 6
mfa 104,68,136
tra 84,9,45056
tra 86,9,47104
mfa 108,68,140
wl 6
mfa 112,72,136
tra 88,10,45056
tra 90,10,47104
mfa 116,72,140
wl 6
mfa 120,76,136
tra 92,11,45056
tra 94,11,47104
mfa 124,76,140
s_waitcnt vmcnt(30) lgkmcnt(0)
s_barrier
mfa 128,80,136
tra 64,8,49152
tra 66,8,51200
mfa 132,80,140
sad 34,27,128
s_add_u32 m0, s29, 24576
s_nop 0
buffer_load_dwordx4 v30, s[12:15], s34 offen lds
mfa 136,84,136
tra 68,9,49152
tra 70,9,51200
mfa 140,84,140
s_add_u32 m0, s29, 25600
s_nop 0
buffer_load_dwordx4 v31, s[12:15], s34 offen lds
mfa 144,88,136
tra 72,10,49152
tra 74,10,51200
mfa 148,88,140
sad 34,27,82048
s_add_u32 m0, s29, 32768
s_nop 0
buffer_load_dwordx4 v30, s[12:15], s34 offen lds
mfa 152,92,136
tra 76,11,49152
tra 78,11,51200
mfa 156,92,140
s_add_u32 m0, s29, 33792
s_nop 0
buffer_load_dwordx4 v31, s[12:15], s34 offen lds
wv 32
wl 6
mfa 64,64,160
tra 80,8,57344
tra 82,8,59392
mfa 68,64,164
sad 34,27,163968
s_add_u32 m0, s29, 40960
s_nop 0
buffer_load_dwordx4 v30, s[12:15], s34 offen lds
wl 6
mfa 72,68,160
tra 84,9,57344
tra 86,9,59392
mfa 76,68,164
s_add_u32 m0, s29, 41984
s_nop 0
buffer_load_dwordx4 v31, s[12:15], s34 offen lds
wl 6
mfa 80,72,160
tra 88,10,57344
tra 90,10,59392
mfa 84,72,164
wl 6
mfa 88,76,160
tra 92,11,57344
tra 94,11,59392
mfa 92,76,164
wl 6
mfa 96,80,160
tra 64,12,16384
tra 66,12,18432
mfa 100,80,164
wl 6
mfa 104,84,160
tra 68,13,16384
tra 70,13,18432
mfa 108,84,164
wl 6
mfa 112,88,160
tra 72,14,16384
tra 74,14,18432
mfa 116,88,164
wl 6
mfa 120,92,160
tra 76,15,16384
tra 78,15,18432
mfa 124,92,164
wl 6
mfa 128,64,160
tra 80,8,53248
tra 82,8,55296
mfa 132,64,164
wl 6
mfa 136,68,160
tra 84,9,53248
tra 86,9,55296
mfa 140,68,164
wl 6
mfa 144,72,160
tra 88,10,53248
tra 90,10,55296
mfa 148,72,164
wl 6
mfa 152,76,160
tra 92,11,53248
tra 94,11,55296
mfa 156,76,164
wv 32
wl 6
mfa 64,80,168
tra 64,8,61440
tra 66,8,63488
mfa 68,80,172
wl 6
mfa 72,84,168
tra 68,9,61440
tra 70,9,63488
mfa 76,84,172
wl 6
mfa 80,88,168
tra 72,10,61440
tra 74,10,63488
mfa 84,88,172
wl 6
mfa 88,92,168
tra 76,11,61440
tra 78,11,63488
mfa 92,92,172
wl 6
mfa 96,64,168
tra 80,12,20480
tra 82,12,22528
mfa 100,64,172
wl 6
mfa 104,68,168
tra 84,13,20480
tra 86,13,22528
mfa 108,68,172
wl 6
mfa 112,72,168
tra 88,14,20480
tra 90,14,22528
mfa 116,72,172
wl 6
mfa 120,76,168
tra 92,15,20480
tra 94,15,22528
mfa 124,76,172
s_waitcnt vmcnt(26) lgkmcnt(0)
s_barrier
mfa 128,80,168
tra 64,12,24576
tra 66,12,26624
mfa 132,80,172
sad 34,27,256
s_add_u32 m0, s29, 49152
s_nop 0
buffer_load_dwordx4 v30, s[12:15], s34 offen lds
mfa 136,84,168
tra 68,13,24576
tra 70,13,26624
mfa 140,84,172
s_add_u32 m0, s29, 50176
s_nop 0
buffer_load_dwordx4 v31, s[12:15], s34 offen lds
mfa 144,88,168
tra 72,14,24576
tra 74,14,26624
mfa 148,88,172
sad 34,27,82176
s_add_u32 m0, s29, 57344
s_nop 0
buffer_load_dwordx4 v30, s[12:15], s34 offen lds
mfa 152,92,168
tra 76,15,24576
tra 78,15,26624
mfa 156,92,172
s_add_u32 m0, s29, 58368
s_nop 0
buffer_load_dwordx4 v31, s[12:15], s34 offen lds
wv 28
wl 6
mfa 64,64,192
tra 80,12,32768
tra 82,12,34816
mfa 68,64,196
sad 34,27,164096
s_add_u32 m0, s29, 65536
s_nop 0
buffer_load_dwordx4 v30, s[12:15], s34 offen lds
wl 6
mfa 72,68,192
tra 84,13,32768
tra 86,13,34816
mfa 76,68,196
s_add_u32 m0, s29, 66560
s_nop 0
buffer_load_dwordx4 v31, s[12:15], s34 offen lds
wl 6
mfa 80,72,192
tra 88,14,32768
tra 90,14,34816
mfa 84,72,196
wl 6
mfa 88,76,192
tra 92,15,32768
tra 94,15,34816
mfa 92,76,196
wl 6
mfa 96,80,192
tra 64,12,40960
tra 66,12,43008
mfa 100,80,196
wl 6
mfa 104,84,192
tra 68,13,40960
tra 70,13,43008
mfa 108,84,196
wl 6
mfa 112,88,192
tra 72,14,40960
tra 74,14,43008
mfa 116,88,196
wl 6
mfa 120,92,192
tra 76,15,40960
tra 78,15,43008
mfa 124,92,196
wl 6
mfa 128,64,192
tra 80,12,28672
tra 82,12,30720
mfa 132,64,196
wl 6
mfa 136,68,192
tra 84,13,28672
tra 86,13,30720
mfa 140,68,196
wl 6
mfa 144,72,192
tra 88,14,28672
tra 90,14,30720
mfa 148,72,196
wl 6
mfa 152,76,192
tra 92,15,28672
tra 94,15,30720
mfa 156,76,196
wv 28
wl 6
mfa 64,80,200
tra 64,12,36864
tra 66,12,38912
mfa 68,80,204
wl 6
mfa 72,84,200
tra 68,13,36864
tra 70,13,38912
mfa 76,84,204
wl 6
mfa 80,88,200
tra 72,14,36864
tra 74,14,38912
mfa 84,88,204
wl 6
mfa 88,92,200
tra 76,15,36864
tra 78,15,38912
mfa 92,92,204
wl 6
mfa 96,64,200
tra 80,12,45056
tra 82,12,47104
mfa 100,64,204
wl 6
mfa 104,68,200
tra 84,13,45056
tra 86,13,47104
mfa 108,68,204
wl 6
mfa 112,72,200
tra 88,14,45056
tra 90,14,47104
mfa 116,72,204
wl 6
mfa 120,76,200
tra 92,15,45056
tra 94,15,47104
mfa 124,76,204
s_waitcnt vmcnt(22) lgkmcnt(0)
s_barrier
mfa 128,80,200
tra 64,12,49152
tra 66,12,51200
mfa 132,80,204
sad 34,27,384
s_add_u32 m0, s29, 73728
s_nop 0
buffer_load_dwordx4 v30, s[12:15], s34 offen lds
mfa 136,84,200
tra 68,13,49152
tra 70,13,51200
mfa 140,84,204
s_add_u32 m0, s29, 74752
s_nop 0
buffer_load_dwordx4 v31, s[12:15], s34 offen lds
mfa 144,88,200
tra 72,14,49152
tra 74,14,51200
mfa 148,88,204
sad 34,27,82304
s_add_u32 m0, s29, 81920
s_nop 0
buffer_load_dwordx4 v30, s[12:15], s34 offen lds
mfa 152,92,200
tra 76,15,49152
tra 78,15,51200
mfa 156,92,204
s_add_u32 m0, s29, 82944
s_nop 0
buffer_load_dwordx4 v31, s[12:15], s34 offen lds
wv 24
wl 6
mfa 64,64,224
tra 80,12,57344
tra 82,12,59392
mfa 68,64,228
sad 34,27,164224
s_add_u32 m0, s29, 90112
s_nop 0
buffer_load_dwordx4 v30, s[12:15], s34 offen lds
wl 6
mfa 72,68,224
tra 84,13,57344
tra 86,13,59392
mfa 76,68,228
s_add_u32 m0, s29, 91136
s_nop 0
buffer_load_dwordx4 v31, s[12:15], s34 offen lds
wl 6
mfa 80,72,224
tra 88,14,57344
tra 90,14,59392
mfa 84,72,228
wl 6
mfa 88,76,224
tra 92,15,57344
tra 94,15,59392
mfa 92,76,228
wl 6
mfa 96,80,224
tra 64,24,16384
tra 66,24,18432
mfa 100,80,228
wl 6
mfa 104,84,224
tra 68,25,16384
tra 70,25,18432
mfa 108,84,228
wl 6
mfa 112,88,224
tra 72,26,16384
tra 74,26,18432
mfa 116,88,228
wl 6
mfa 120,92,224
tra 76,27,16384
tra 78,27,18432
mfa 124,92,228
wl 6
mfa 128,64,224
tra 80,12,53248
tra 82,12,55296
mfa 132,64,228
wl 6
mfa 136,68,224
tra 84,13,53248
tra 86,13,55296
mfa 140,68,228
wl 6
mfa 144,72,224
tra 88,14,53248
tra 90,14,55296
mfa 148,72,228
wl 6
mfa 152,76,224
tra 92,15,53248
tra 94,15,55296
mfa 156,76,228
wv 24
wl 6
mfa 64,80,232
tra 64,12,61440
tra 66,12,63488
mfa 68,80,236
wl 6
mfa 72,84,232
tra 68,13,61440
tra 70,13,63488
mfa 76,84,236
wl 6
mfa 80,88,232
tra 72,14,61440
tra 74,14,63488
mfa 84,88,236
wl 6
mfa 88,92,232
tra 76,15,61440
tra 78,15,63488
mfa 92,92,236
wl 6
mfa 96,64,232
tra 80,24,20480
tra 82,24,22528
mfa 100,64,236
wl 6
mfa 104,68,232
tra 84,25,20480
tra 86,25,22528
mfa 108,68,236
wl 6
mfa 112,72,232
tra 88,26,20480
tra 90,26,22528
mfa 116,72,236
cvp 64,64,65
cvp 65,66,67
cvp 66,72,73
cvp 67,74,75
wl 6
mfa 120,76,232
tra 92,27,20480
tra 94,27,22528
mfa 124,76,236
cvp 68,68,69
cvp 69,70,71
cvp 70,76,77
cvp 71,78,79
s_waitcnt vmcnt(18) lgkmcnt(0)
s_barrier
mfa 128,80,232
tra 64,8,0
tra 66,8,2048
mfa 132,80,236
cvp 80,80,81
cvp 81,82,83
cvp 82,88,89
cvp 83,90,91
mfa 136,84,232
tra 68,9,0
tra 70,9,2048
mfa 140,84,236
cvp 84,84,85
cvp 85,86,87
cvp 86,92,93
cvp 87,94,95
mfa 144,88,232
tra 72,10,0
tra 74,10,2048
mfa 148,88,236
sad 34,27,512
s_add_u32 m0, s29, 98304
s_nop 0
buffer_load_dwordx4 v30, s[12:15], s34 offen lds
mfa 152,92,232
tra 76,11,0
tra 78,11,2048
mfa 156,92,236
s_add_u32 m0, s29, 99328
s_nop 0
buffer_load_dwordx4 v31, s[12:15], s34 offen lds
sad 34,27,82432
s_add_u32 m0, s29, 106496
s_nop 0
buffer_load_dwordx4 v30, s[12:15], s34 offen lds
s_add_u32 m0, s29, 107520
s_nop 0
buffer_load_dwordx4 v31, s[12:15], s34 offen lds
sad 34,27,164352
s_add_u32 m0, s29, 114688
s_nop 0
buffer_load_dwordx4 v30, s[12:15], s34 offen lds
s_add_u32 m0, s29, 115712
s_nop 0
buffer_load_dwordx4 v31, s[12:15], s34 offen lds
cvp 96,96,97
cvp 97,98,99
cvp 98,104,105
cvp 99,106,107
cvp 100,100,101
cvp 101,102,103
cvp 102,108,109
cvp 103,110,111
cvp 112,112,113
cvp 113,114,115
cvp 114,120,121
cvp 115,122,123
cvp 116,116,117
cvp 117,118,119
cvp 118,124,125
cvp 119,126,127
s_nop 7
cvp 128,128,129
cvp 129,130,131
cvp 130,136,137
cvp 131,138,139
cvp 132,132,133
cvp 133,134,135
cvp 134,140,141
cvp 135,142,143
cvp 144,144,145
cvp 145,146,147
cvp 146,152,153
cvp 147,154,155
cvp 148,148,149
cvp 149,150,151
cvp 150,156,157
cvp 151,158,159
s_nop 1
wl 6
mfw 160,64,64
tra 80,8,4096
tra 82,8,6144
mfw 164,68,64
wl 6
mfw 168,64,68
tra 84,9,4096
tra 86,9,6144
mfw 172,68,68
wl 6
mfw 176,64,72
tra 88,10,4096
tra 90,10,6144
mfw 180,68,72
wl 6
mfw 184,64,76
tra 92,11,4096
tra 94,11,6144
mfw 188,68,76
wl 6
mfv 160,80,80
tra 64,8,8192
tra 66,8,10240
mfv 164,84,80
wl 6
mfv 168,80,84
tra 68,9,8192
tra 70,9,10240
mfv 172,84,84
wl 6
mfv 176,80,88
tra 72,10,8192
tra 74,10,10240
mfv 180,84,88
wl 6
mfv 184,80,92
tra 76,11,8192
tra 78,11,10240
mfv 188,84,92
wl 6
mfv 160,96,64
tra 80,8,12288
tra 82,8,14336
mfv 164,100,64
wl 6
mfv 168,96,68
tra 84,9,12288
tra 86,9,14336
mfv 172,100,68
wl 6
mfv 176,96,72
tra 88,10,12288
tra 90,10,14336
mfv 180,100,72
wl 6
mfv 184,96,76
tra 92,11,12288
tra 94,11,14336
mfv 188,100,76
wl 6
mfv 160,112,80
tra 64,8,16384
tra 66,8,18432
mfv 164,116,80
wl 6
mfv 168,112,84
tra 68,9,16384
tra 70,9,18432
mfv 172,116,84
wl 6
mfv 176,112,88
tra 72,10,16384
tra 74,10,18432
mfv 180,116,88
wl 6
mfv 184,112,92
tra 76,11,16384
tra 78,11,18432
mfv 188,116,92
wl 6
mfv 160,128,64
tra 80,8,20480
tra 82,8,22528
mfv 164,132,64
wl 6
mfv 168,128,68
tra 84,9,20480
tra 86,9,22528
mfv 172,132,68
wl 6
mfv 176,128,72
tra 88,10,20480
tra 90,10,22528
mfv 180,132,72
wl 6
mfv 184,128,76
tra 92,11,20480
tra 94,11,22528
mfv 188,132,76
s_waitcnt vmcnt(18) lgkmcnt(0)
s_barrier
mfv 160,144,80
tra 64,8,24576
tra 66,8,26624
mfv 164,148,80
sad 34,27,640
s_add_u32 m0, s29, 0
s_nop 0
buffer_load_dwordx4 v30, s[12:15], s34 offen lds
mfv 168,144,84
tra 68,9,24576
tra 70,9,26624
mfv 172,148,84
s_add_u32 m0, s29, 1024
s_nop 0
buffer_load_dwordx4 v31, s[12:15], s34 offen lds
mfv 176,144,88
tra 72,10,24576
tra 74,10,26624
mfv 180,148,88
sad 34,27,82560
s_add_u32 m0, s29, 8192
s_nop 0
buffer_load_dwordx4 v30, s[12:15], s34 offen lds
mfv 184,144,92
tra 76,11,24576
tra 78,11,26624
mfv 188,148,92
s_add_u32 m0, s29, 9216
s_nop 0
buffer_load_dwordx4 v31, s[12:15], s34 offen lds
wl 6
mfw 192,64,64
tra 80,8,28672
tra 82,8,30720
mfw 196,68,64
sad 34,27,164480
s_add_u32 m0, s29, 16384
s_nop 0
buffer_load_dwordx4 v30, s[12:15], s34 offen lds
wl 6
mfw 200,64,68
tra 84,9,28672
tra 86,9,30720
mfw 204,68,68
s_add_u32 m0, s29, 17408
s_nop 0
buffer_load_dwordx4 v31, s[12:15], s34 offen lds
wl 6
mfw 208,64,72
tra 88,10,28672
tra 90,10,30720
mfw 212,68,72
wl 6
mfw 216,64,76
tra 92,11,28672
tra 94,11,30720
mfw 220,68,76
wl 6
mfv 192,80,80
tra 64,8,32768
tra 66,8,34816
mfv 196,84,80
wl 6
mfv 200,80,84
tra 68,9,32768
tra 70,9,34816
mfv 204,84,84
cvp 160,160,161
cvp 161,162,163
cvp 162,164,165
cvp 163,166,167
wl 6
mfv 208,80,88
tra 72,10,32768
tra 74,10,34816
mfv 212,84,88
sad 32,47,0
buffer_store_dwordx4 v[160:163], v21, s[20:23], s32 offen sc1
cvp 168,168,169
cvp 169,170,171
wl 6
mfv 216,80,92
tra 76,11,32768
tra 78,11,34816
mfv 220,84,92
cvp 170,172,173
cvp 171,174,175
sad 32,47,32768
buffer_store_dwordx4 v[168:171], v21, s[20:23], s32 offen sc1
wl 6
mfv 192,96,64
tra 80,8,36864
tra 82,8,38912
mfv 196,100,64
cvp 176,176,177
cvp 177,178,179
cvp 178,180,181
cvp 179,182,183
wl 6
mfv 200,96,68
tra 84,9,36864
tra 86,9,38912
mfv 204,100,68
sad 32,47,65536
buffer_store_dwordx4 v[176:179], v21, s[20:23], s32 offen sc1
cvp 184,184,185
cvp 185,186,187
wl 6
mfv 208,96,72
tra 88,10,36864
tra 90,10,38912
mfv 212,100,72
cvp 186,188,189
cvp 187,190,191
sad 32,47,98304
buffer_store_dwordx4 v[184:187], v21, s[20:23], s32 offen sc1
wl 6
mfv 216,96,76
tra 92,11,36864
tra 94,11,38912
mfv 220,100,76
wl 6
mfv 192,112,80
tra 64,8,40960
tra 66,8,43008
mfv 196,116,80
wl 6
mfv 200,112,84
tra 68,9,40960
tra 70,9,43008
mfv 204,116,84
wl 6
mfv 208,112,88
tra 72,10,40960
tra 74,10,43008
mfv 212,116,88
wl 6
mfv 216,112,92
tra 76,11,40960
tra 78,11,43008
mfv 220,116,92
wl 6
mfv 192,128,64
tra 80,8,45056
tra 82,8,47104
mfv 196,132,64
wl 6
mfv 200,128,68
tra 84,9,45056
tra 86,9,47104
mfv 204,132,68
wl 6
mfv 208,128,72
tra 88,10,45056
tra 90,10,47104
mfv 212,132,72
wl 6
mfv 216,128,76
tra 92,11,45056
tra 94,11,47104
mfv 220,132,76
s_waitcnt vmcnt(22) lgkmcnt(0)
s_barrier
mfv 192,144,80
tra 64,8,49152
tra 66,8,51200
mfv 196,148,80
sad 34,27,768
s_add_u32 m0, s29, 24576
s_nop 0
buffer_load_dwordx4 v30, s[12:15], s34 offen lds
mfv 200,144,84
tra 68,9,49152
tra 70,9,51200
mfv 204,148,84
s_add_u32 m0, s29, 25600
s_nop 0
buffer_load_dwordx4 v31, s[12:15], s34 offen lds
mfv 208,144,88
tra 72,10,49152
tra 74,10,51200
mfv 212,148,88
sad 34,27,82688
s_add_u32 m0, s29, 32768
s_nop 0
buffer_load_dwordx4 v30, s[12:15], s34 offen lds
mfv 216,144,92
tra 76,11,49152
tra 78,11,51200
mfv 220,148,92
s_add_u32 m0, s29, 33792
s_nop 0
buffer_load_dwordx4 v31, s[12:15], s34 offen lds
s_nop 1
wl 6
mfw 160,64,64
tra 80,8,53248
tra 82,8,55296
mfw 164,68,64
sad 34,27,164608
s_add_u32 m0, s29, 40960
s_nop 0
buffer_load_dwordx4 v30, s[12:15], s34 offen lds
wl 6
mfw 168,64,68
tra 84,9,53248
tra 86,9,55296
mfw 172,68,68
s_add_u32 m0, s29, 41984
s_nop 0
buffer_load_dwordx4 v31, s[12:15], s34 offen lds
wl 6
mfw 176,64,72
tra 88,10,53248
tra 90,10,55296
mfw 180,68,72
wl 6
mfw 184,64,76
tra 92,11,53248
tra 94,11,55296
mfw 188,68,76
wl 6
mfv 160,80,80
tra 64,8,57344
tra 66,8,59392
mfv 164,84,80
wl 6
mfv 168,80,84
tra 68,9,57344
tra 70,9,59392
mfv 172,84,84
cvp 192,192,193
cvp 193,194,195
cvp 194,196,197
cvp 195,198,199
wl 6
mfv 176,80,88
tra 72,10,57344
tra 74,10,59392
mfv 180,84,88
sad 32,47,131072
buffer_store_dwordx4 v[192:195], v21, s[20:23], s32 offen sc1
cvp 200,200,201
cvp 201,202,203
wl 6
mfv 184,80,92
tra 76,11,57344
tra 78,11,59392
mfv 188,84,92
cvp 202,204,205
cvp 203,206,207
sad 32,47,163840
buffer_store_dwordx4 v[200:203], v21, s[20:23], s32 offen sc1
wl 6
mfv 160,96,64
tra 80,8,61440
tra 82,8,63488
mfv 164,100,64
cvp 208,208,209
cvp 209,210,211
cvp 210,212,213
cvp 211,214,215
wl 6
mfv 168,96,68
tra 84,9,61440
tra 86,9,63488
mfv 172,100,68
sad 32,47,196608
buffer_store_dwordx4 v[208:211], v21, s[20:23], s32 offen sc1
cvp 216,216,217
cvp 217,218,219
wl 6
mfv 176,96,72
tra 88,10,61440
tra 90,10,63488
mfv 180,100,72
cvp 218,220,221
cvp 219,222,223
sad 32,47,229376
buffer_store_dwordx4 v[216:219], v21, s[20:23], s32 offen sc1
wl 6
mfv 184,96,76
tra 92,11,61440
tra 94,11,63488
mfv 188,100,76
wl 6
mfv 160,112,80
tra 64,12,16384
tra 66,12,18432
mfv 164,116,80
wl 6
mfv 168,112,84
tra 68,13,16384
tra 70,13,18432
mfv 172,116,84
wl 6
mfv 176,112,88
tra 72,14,16384
tra 74,14,18432
mfv 180,116,88
wl 6
mfv 184,112,92
tra 76,15,16384
tra 78,15,18432
mfv 188,116,92
wl 6
mfv 160,128,64
tra 80,12,20480
tra 82,12,22528
mfv 164,132,64
wl 6
mfv 168,128,68
tra 84,13,20480
tra 86,13,22528
mfv 172,132,68
wl 6
mfv 176,128,72
tra 88,14,20480
tra 90,14,22528
mfv 180,132,72
wl 6
mfv 184,128,76
tra 92,15,20480
tra 94,15,22528
mfv 188,132,76
s_waitcnt vmcnt(26) lgkmcnt(0)
s_barrier
s_sub_u32 s83, s2, 128
s_lshr_b32 s83, s83, 3
s_mul_i32 s83, s83, 0
sad 83,83,36
s_cmp_eq_u32 s68, 1
s_cselect_b32 s83, 0, s83
s_cmp_ge_u32 s2, 144
s_cbranch_scc1 L_xd_180
s_cmp_lt_u32 s78, s83
s_cbranch_scc1 L_xd_180
v_mov_b32 v18, 0x7fff
s_mov_b32 s77, 7
s_branch L_xe_181
L_xd_180:
s_cmp_lg_u32 s4, 0
s_cbranch_scc1 L_ti_182
s_lshl_b32 s83, s76, 2
v_mov_b32 v18, 1
v_mov_b32 v2, 0
s_mov_b64 exec, 1
buffer_atomic_add v18, v2, s[84:87], s83 offen sc0 sc1
s_mov_b64 exec, -1
L_ti_182:
L_xe_181:
mfv 160,144,80
tra 64,12,24576
tra 66,12,26624
mfv 164,148,80
sad 34,27,896
s_add_u32 m0, s29, 49152
s_nop 0
buffer_load_dwordx4 v30, s[12:15], s34 offen lds
mfv 168,144,84
tra 68,13,24576
tra 70,13,26624
mfv 172,148,84
s_add_u32 m0, s29, 50176
s_nop 0
buffer_load_dwordx4 v31, s[12:15], s34 offen lds
mfv 176,144,88
tra 72,14,24576
tra 74,14,26624
mfv 180,148,88
sad 34,27,82816
s_add_u32 m0, s29, 57344
s_nop 0
buffer_load_dwordx4 v30, s[12:15], s34 offen lds
mfv 184,144,92
tra 76,15,24576
tra 78,15,26624
mfv 188,148,92
s_add_u32 m0, s29, 58368
s_nop 0
buffer_load_dwordx4 v31, s[12:15], s34 offen lds
s_nop 1
wl 6
mfw 192,64,64
tra 80,12,28672
tra 82,12,30720
mfw 196,68,64
sad 34,27,164736
s_add_u32 m0, s29, 65536
s_nop 0
buffer_load_dwordx4 v30, s[12:15], s34 offen lds
wl 6
mfw 200,64,68
tra 84,13,28672
tra 86,13,30720
mfw 204,68,68
s_add_u32 m0, s29, 66560
s_nop 0
buffer_load_dwordx4 v31, s[12:15], s34 offen lds
wl 6
mfw 208,64,72
tra 88,14,28672
tra 90,14,30720
mfw 212,68,72
wl 6
mfw 216,64,76
tra 92,15,28672
tra 94,15,30720
mfw 220,68,76
wl 6
mfv 192,80,80
tra 64,12,32768
tra 66,12,34816
mfv 196,84,80
wl 6
mfv 200,80,84
tra 68,13,32768
tra 70,13,34816
mfv 204,84,84
cvp 160,160,161
cvp 161,162,163
cvp 162,164,165
cvp 163,166,167
wl 6
mfv 208,80,88
tra 72,14,32768
tra 74,14,34816
mfv 212,84,88
sad 32,47,262144
buffer_store_dwordx4 v[160:163], v21, s[20:23], s32 offen sc1
cvp 168,168,169
cvp 169,170,171
wl 6
mfv 216,80,92
tra 76,15,32768
tra 78,15,34816
mfv 220,84,92
cvp 170,172,173
cvp 171,174,175
sad 32,47,294912
buffer_store_dwordx4 v[168:171], v21, s[20:23], s32 offen sc1
wl 6
mfv 192,96,64
tra 80,12,36864
tra 82,12,38912
mfv 196,100,64
cvp 176,176,177
cvp 177,178,179
cvp 178,180,181
cvp 179,182,183
wl 6
mfv 200,96,68
tra 84,13,36864
tra 86,13,38912
mfv 204,100,68
sad 32,47,327680
buffer_store_dwordx4 v[176:179], v21, s[20:23], s32 offen sc1
cvp 184,184,185
cvp 185,186,187
wl 6
mfv 208,96,72
tra 88,14,36864
tra 90,14,38912
mfv 212,100,72
cvp 186,188,189
cvp 187,190,191
sad 32,47,360448
buffer_store_dwordx4 v[184:187], v21, s[20:23], s32 offen sc1
wl 6
mfv 216,96,76
tra 92,15,36864
tra 94,15,38912
mfv 220,100,76
wl 6
mfv 192,112,80
tra 64,12,40960
tra 66,12,43008
mfv 196,116,80
wl 6
mfv 200,112,84
tra 68,13,40960
tra 70,13,43008
mfv 204,116,84
wl 6
mfv 208,112,88
tra 72,14,40960
tra 74,14,43008
mfv 212,116,88
wl 6
mfv 216,112,92
tra 76,15,40960
tra 78,15,43008
mfv 220,116,92
wl 6
mfv 192,128,64
tra 80,12,45056
tra 82,12,47104
mfv 196,132,64
wl 6
mfv 200,128,68
tra 84,13,45056
tra 86,13,47104
mfv 204,132,68
wl 6
mfv 208,128,72
tra 88,14,45056
tra 90,14,47104
mfv 212,132,72
wl 6
mfv 216,128,76
tra 92,15,45056
tra 94,15,47104
mfv 220,132,76
s_waitcnt vmcnt(30) lgkmcnt(0)
s_barrier
mfv 192,144,80
tra 64,12,49152
tra 66,12,51200
mfv 196,148,80
sad 34,27,1024
s_add_u32 m0, s29, 73728
s_nop 0
buffer_load_dwordx4 v30, s[12:15], s34 offen lds
mfv 200,144,84
tra 68,13,49152
tra 70,13,51200
mfv 204,148,84
s_add_u32 m0, s29, 74752
s_nop 0
buffer_load_dwordx4 v31, s[12:15], s34 offen lds
mfv 208,144,88
tra 72,14,49152
tra 74,14,51200
mfv 212,148,88
sad 34,27,82944
s_add_u32 m0, s29, 81920
s_nop 0
buffer_load_dwordx4 v30, s[12:15], s34 offen lds
mfv 216,144,92
tra 76,15,49152
tra 78,15,51200
mfv 220,148,92
s_add_u32 m0, s29, 82944
s_nop 0
buffer_load_dwordx4 v31, s[12:15], s34 offen lds
s_nop 1
wl 6
mfw 160,64,64
tra 80,12,53248
tra 82,12,55296
mfw 164,68,64
sad 34,27,164864
s_add_u32 m0, s29, 90112
s_nop 0
buffer_load_dwordx4 v30, s[12:15], s34 offen lds
wl 6
mfw 168,64,68
tra 84,13,53248
tra 86,13,55296
mfw 172,68,68
s_add_u32 m0, s29, 91136
s_nop 0
buffer_load_dwordx4 v31, s[12:15], s34 offen lds
wl 6
mfw 176,64,72
tra 88,14,53248
tra 90,14,55296
mfw 180,68,72
wl 6
mfw 184,64,76
tra 92,15,53248
tra 94,15,55296
mfw 188,68,76
wl 6
mfv 160,80,80
tra 64,12,57344
tra 66,12,59392
mfv 164,84,80
wl 6
mfv 168,80,84
tra 68,13,57344
tra 70,13,59392
mfv 172,84,84
cvp 192,192,193
cvp 193,194,195
cvp 194,196,197
cvp 195,198,199
wl 6
mfv 176,80,88
tra 72,14,57344
tra 74,14,59392
mfv 180,84,88
sad 32,47,393216
buffer_store_dwordx4 v[192:195], v21, s[20:23], s32 offen sc1
cvp 200,200,201
cvp 201,202,203
wl 6
mfv 184,80,92
tra 76,15,57344
tra 78,15,59392
mfv 188,84,92
cvp 202,204,205
cvp 203,206,207
sad 32,47,425984
buffer_store_dwordx4 v[200:203], v21, s[20:23], s32 offen sc1
wl 6
mfv 160,96,64
tra 80,12,61440
tra 82,12,63488
mfv 164,100,64
cvp 208,208,209
cvp 209,210,211
cvp 210,212,213
cvp 211,214,215
wl 6
mfv 168,96,68
tra 84,13,61440
tra 86,13,63488
mfv 172,100,68
sad 32,47,458752
buffer_store_dwordx4 v[208:211], v21, s[20:23], s32 offen sc1
cvp 216,216,217
cvp 217,218,219
wl 6
mfv 176,96,72
tra 88,14,61440
tra 90,14,63488
mfv 180,100,72
cvp 218,220,221
cvp 219,222,223
sad 32,47,491520
buffer_store_dwordx4 v[216:219], v21, s[20:23], s32 offen sc1
wl 6
mfv 184,96,76
tra 92,15,61440
tra 94,15,63488
mfv 188,100,76
wl 6
mfv 160,112,80
tra 64,24,16384
tra 66,24,18432
mfv 164,116,80
wl 6
mfv 168,112,84
tra 68,25,16384
tra 70,25,18432
mfv 172,116,84
wl 6
mfv 176,112,88
tra 72,26,16384
tra 74,26,18432
mfv 180,116,88
wl 6
mfv 184,112,92
tra 76,27,16384
tra 78,27,18432
mfv 188,116,92
wl 6
mfv 160,128,64
tra 80,24,20480
tra 82,24,22528
mfv 164,132,64
wl 6
mfv 168,128,68
tra 84,25,20480
tra 86,25,22528
mfv 172,132,68
wl 6
mfv 176,128,72
tra 88,26,20480
tra 90,26,22528
mfv 180,132,72
wl 6
mfv 184,128,76
tra 92,27,20480
tra 94,27,22528
mfv 188,132,76
v_mov_b32 v19, 155648
s_cmp_lg_u32 s4, 0
s_cbranch_scc1 L_ps_183
wv 20
s_mov_b64 exec, 1
ds_write_b32 v19, v18
s_mov_b64 exec, -1
wl 0
L_ps_183:
s_waitcnt vmcnt(34) lgkmcnt(0)
s_barrier
ds_read_b32 v18, v19
mfv 160,144,80
tra 64,8,0
tra 66,8,2048
mfv 164,148,80
sad 34,27,1152
s_add_u32 m0, s29, 98304
s_nop 0
buffer_load_dwordx4 v30, s[12:15], s34 offen lds
mfv 168,144,84
tra 68,9,0
tra 70,9,2048
mfv 172,148,84
s_add_u32 m0, s29, 99328
s_nop 0
buffer_load_dwordx4 v31, s[12:15], s34 offen lds
mfv 176,144,88
tra 72,10,0
tra 74,10,2048
mfv 180,148,88
sad 34,27,83072
s_add_u32 m0, s29, 106496
s_nop 0
buffer_load_dwordx4 v30, s[12:15], s34 offen lds
mfv 184,144,92
tra 76,11,0
tra 78,11,2048
mfv 188,148,92
s_add_u32 m0, s29, 107520
s_nop 0
buffer_load_dwordx4 v31, s[12:15], s34 offen lds
s_nop 1
wl 6
mfw 192,64,64
tra 80,8,4096
tra 82,8,6144
mfw 196,68,64
sad 34,27,164992
s_add_u32 m0, s29, 114688
s_nop 0
buffer_load_dwordx4 v30, s[12:15], s34 offen lds
wl 6
mfw 200,64,68
tra 84,9,4096
tra 86,9,6144
mfw 204,68,68
s_add_u32 m0, s29, 115712
s_nop 0
buffer_load_dwordx4 v31, s[12:15], s34 offen lds
wl 6
mfw 208,64,72
tra 88,10,4096
tra 90,10,6144
mfw 212,68,72
wl 6
mfw 216,64,76
tra 92,11,4096
tra 94,11,6144
mfw 220,68,76
wl 6
mfv 192,80,80
tra 64,8,8192
tra 66,8,10240
mfv 196,84,80
wl 6
mfv 200,80,84
tra 68,9,8192
tra 70,9,10240
mfv 204,84,84
cvp 160,160,161
cvp 161,162,163
cvp 162,164,165
cvp 163,166,167
wl 6
mfv 208,80,88
tra 72,10,8192
tra 74,10,10240
mfv 212,84,88
sad 32,47,524288
buffer_store_dwordx4 v[160:163], v21, s[20:23], s32 offen sc1
cvp 168,168,169
cvp 169,170,171
wl 6
mfv 216,80,92
tra 76,11,8192
tra 78,11,10240
mfv 220,84,92
cvp 170,172,173
cvp 171,174,175
sad 32,47,557056
buffer_store_dwordx4 v[168:171], v21, s[20:23], s32 offen sc1
wl 6
mfv 192,96,64
tra 80,8,12288
tra 82,8,14336
mfv 196,100,64
cvp 176,176,177
cvp 177,178,179
cvp 178,180,181
cvp 179,182,183
wl 6
mfv 200,96,68
tra 84,9,12288
tra 86,9,14336
mfv 204,100,68
sad 32,47,589824
buffer_store_dwordx4 v[176:179], v21, s[20:23], s32 offen sc1
cvp 184,184,185
cvp 185,186,187
wl 6
mfv 208,96,72
tra 88,10,12288
tra 90,10,14336
mfv 212,100,72
cvp 186,188,189
cvp 187,190,191
sad 32,47,622592
buffer_store_dwordx4 v[184:187], v21, s[20:23], s32 offen sc1
wl 6
mfv 216,96,76
tra 92,11,12288
tra 94,11,14336
mfv 220,100,76
wl 6
mfv 192,112,80
tra 64,8,16384
tra 66,8,18432
mfv 196,116,80
wl 6
mfv 200,112,84
tra 68,9,16384
tra 70,9,18432
mfv 204,116,84
wl 6
mfv 208,112,88
tra 72,10,16384
tra 74,10,18432
mfv 212,116,88
wl 6
mfv 216,112,92
tra 76,11,16384
tra 78,11,18432
mfv 220,116,92
wl 6
mfv 192,128,64
tra 80,8,20480
tra 82,8,22528
mfv 196,132,64
wl 6
mfv 200,128,68
tra 84,9,20480
tra 86,9,22528
mfv 204,132,68
wl 6
mfv 208,128,72
tra 88,10,20480
tra 90,10,22528
mfv 212,132,72
wl 6
mfv 216,128,76
tra 92,11,20480
tra 94,11,22528
mfv 220,132,76
s_waitcnt vmcnt(34) lgkmcnt(0)
s_barrier
v_readfirstlane_b32 s78, v18
s_mov_b32 s69, 1
s_getpc_b64 s[50:51]
L_c_184:
s_add_u32 s50, s50, L_sched-L_c_184
s_addc_u32 s51, s51, -1
s_swappc_b64 s[74:75], s[50:51]
mfv 192,144,80
tra 64,8,24576
tra 66,8,26624
mfv 196,148,80
s_mul_i32 s34, s60, 0
s_add_u32 s34, s34, s24
s_add_u32 m0, s29, 0
s_nop 0
buffer_load_dwordx4 v6, s[8:11], s34 offen lds
mfv 200,144,84
tra 68,9,24576
tra 70,9,26624
mfv 204,148,84
s_add_u32 m0, s29, 1024
s_nop 0
buffer_load_dwordx4 v7, s[8:11], s34 offen lds
mfv 208,144,88
tra 72,10,24576
tra 74,10,26624
mfv 212,148,88
s_mul_i32 s34, s60, 0
s_add_u32 s34, s34, s25
s_add_u32 m0, s29, 8192
s_nop 0
buffer_load_dwordx4 v6, s[52:55], s34 offen lds
mfv 216,144,92
tra 76,11,24576
tra 78,11,26624
mfv 220,148,92
s_add_u32 m0, s29, 9216
s_nop 0
buffer_load_dwordx4 v7, s[52:55], s34 offen lds
s_nop 1
wl 6
mfw 160,64,64
tra 80,8,28672
tra 82,8,30720
mfw 164,68,64
s_mul_i32 s34, s60, 0
s_add_u32 s34, s34, s26
s_add_u32 m0, s29, 16384
s_nop 0
buffer_load_dwordx4 v6, s[56:59], s34 offen lds
wl 6
mfw 168,64,68
tra 84,9,28672
tra 86,9,30720
mfw 172,68,68
s_add_u32 m0, s29, 17408
s_nop 0
buffer_load_dwordx4 v7, s[56:59], s34 offen lds
wl 6
mfw 176,64,72
tra 88,10,28672
tra 90,10,30720
mfw 180,68,72
sad 33,28,0
buffer_load_dwordx4 a[96:99], v20, s[16:19], s33 offen sc1
wl 6
mfw 184,64,76
tra 92,11,28672
tra 94,11,30720
mfw 188,68,76
sad 33,28,20480
buffer_load_dwordx4 a[100:103], v20, s[16:19], s33 offen sc1
wl 6
mfv 160,80,80
tra 64,8,32768
tra 66,8,34816
mfv 164,84,80
sad 33,28,40960
buffer_load_dwordx4 a[104:107], v20, s[16:19], s33 offen sc1
wl 6
mfv 168,80,84
tra 68,9,32768
tra 70,9,34816
mfv 172,84,84
sad 33,28,61440
buffer_load_dwordx4 a[108:111], v20, s[16:19], s33 offen sc1
wl 6
mfv 176,80,88
tra 72,10,32768
tra 74,10,34816
mfv 180,84,88
sad 33,28,1024
buffer_load_dwordx4 a[112:115], v20, s[16:19], s33 offen sc1
wl 6
mfv 184,80,92
tra 76,11,32768
tra 78,11,34816
mfv 188,84,92
sad 33,28,21504
buffer_load_dwordx4 a[116:119], v20, s[16:19], s33 offen sc1
wl 6
mfv 160,96,64
tra 80,8,36864
tra 82,8,38912
mfv 164,100,64
sad 33,28,41984
buffer_load_dwordx4 a[120:123], v20, s[16:19], s33 offen sc1
wl 6
mfv 168,96,68
tra 84,9,36864
tra 86,9,38912
mfv 172,100,68
sad 33,28,62464
buffer_load_dwordx4 a[124:127], v20, s[16:19], s33 offen sc1
cvp 192,192,193
cvp 193,194,195
wl 6
mfv 176,96,72
tra 88,10,36864
tra 90,10,38912
mfv 180,100,72
cvp 194,196,197
cvp 195,198,199
sad 32,47,655360
buffer_store_dwordx4 v[192:195], v21, s[20:23], s32 offen sc1
wl 6
mfv 184,96,76
tra 92,11,36864
tra 94,11,38912
mfv 188,100,76
cvp 200,200,201
cvp 201,202,203
cvp 202,204,205
cvp 203,206,207
wl 6
mfv 160,112,80
tra 64,8,40960
tra 66,8,43008
mfv 164,116,80
sad 32,47,688128
buffer_store_dwordx4 v[200:203], v21, s[20:23], s32 offen sc1
cvp 208,208,209
cvp 209,210,211
wl 6
mfv 168,112,84
tra 68,9,40960
tra 70,9,43008
mfv 172,116,84
cvp 210,212,213
cvp 211,214,215
sad 32,47,720896
buffer_store_dwordx4 v[208:211], v21, s[20:23], s32 offen sc1
wl 6
mfv 176,112,88
tra 72,10,40960
tra 74,10,43008
mfv 180,116,88
cvp 216,216,217
cvp 217,218,219
cvp 218,220,221
cvp 219,222,223
wl 6
mfv 184,112,92
tra 76,11,40960
tra 78,11,43008
mfv 188,116,92
sad 32,47,753664
buffer_store_dwordx4 v[216:219], v21, s[20:23], s32 offen sc1
wl 6
mfv 160,128,64
tra 80,8,45056
tra 82,8,47104
mfv 164,132,64
wl 6
mfv 168,128,68
tra 84,9,45056
tra 86,9,47104
mfv 172,132,68
wl 6
mfv 176,128,72
tra 88,10,45056
tra 90,10,47104
mfv 180,132,72
wl 6
mfv 184,128,76
tra 92,11,45056
tra 94,11,47104
mfv 188,132,76
s_waitcnt vmcnt(42) lgkmcnt(0)
s_barrier
mfv 160,144,80
tra 64,8,49152
tra 66,8,51200
mfv 164,148,80
s_mul_i32 s34, s60, 1
s_add_u32 s34, s34, s24
s_add_u32 m0, s29, 24576
s_nop 0
buffer_load_dwordx4 v6, s[8:11], s34 offen lds
mfv 168,144,84
tra 68,9,49152
tra 70,9,51200
mfv 172,148,84
s_add_u32 m0, s29, 25600
s_nop 0
buffer_load_dwordx4 v7, s[8:11], s34 offen lds
mfv 176,144,88
tra 72,10,49152
tra 74,10,51200
mfv 180,148,88
s_mul_i32 s34, s60, 1
s_add_u32 s34, s34, s25
s_add_u32 m0, s29, 32768
s_nop 0
buffer_load_dwordx4 v6, s[52:55], s34 offen lds
mfv 184,144,92
tra 76,11,49152
tra 78,11,51200
mfv 188,148,92
s_add_u32 m0, s29, 33792
s_nop 0
buffer_load_dwordx4 v7, s[52:55], s34 offen lds
s_nop 1
wl 6
mfw 192,64,64
tra 80,8,53248
tra 82,8,55296
mfw 196,68,64
s_mul_i32 s34, s60, 1
s_add_u32 s34, s34, s26
s_add_u32 m0, s29, 40960
s_nop 0
buffer_load_dwordx4 v6, s[56:59], s34 offen lds
wl 6
mfw 200,64,68
tra 84,9,53248
tra 86,9,55296
mfw 204,68,68
s_add_u32 m0, s29, 41984
s_nop 0
buffer_load_dwordx4 v7, s[56:59], s34 offen lds
wl 6
mfw 208,64,72
tra 88,10,53248
tra 90,10,55296
mfw 212,68,72
sad 33,28,2048
buffer_load_dwordx4 a[128:131], v20, s[16:19], s33 offen sc1
wl 6
mfw 216,64,76
tra 92,11,53248
tra 94,11,55296
mfw 220,68,76
sad 33,28,22528
buffer_load_dwordx4 a[132:135], v20, s[16:19], s33 offen sc1
wl 6
mfv 192,80,80
tra 64,8,57344
tra 66,8,59392
mfv 196,84,80
sad 33,28,43008
buffer_load_dwordx4 a[136:139], v20, s[16:19], s33 offen sc1
wl 6
mfv 200,80,84
tra 68,9,57344
tra 70,9,59392
mfv 204,84,84
sad 33,28,63488
buffer_load_dwordx4 a[140:143], v20, s[16:19], s33 offen sc1
wl 6
mfv 208,80,88
tra 72,10,57344
tra 74,10,59392
mfv 212,84,88
sad 33,28,3072
buffer_load_dwordx4 a[144:147], v20, s[16:19], s33 offen sc1
wl 6
mfv 216,80,92
tra 76,11,57344
tra 78,11,59392
mfv 220,84,92
sad 33,28,23552
buffer_load_dwordx4 a[148:151], v20, s[16:19], s33 offen sc1
wl 6
mfv 192,96,64
tra 80,8,61440
tra 82,8,63488
mfv 196,100,64
sad 33,28,44032
buffer_load_dwordx4 a[152:155], v20, s[16:19], s33 offen sc1
wl 6
mfv 200,96,68
tra 84,9,61440
tra 86,9,63488
mfv 204,100,68
sad 33,28,64512
buffer_load_dwordx4 a[156:159], v20, s[16:19], s33 offen sc1
cvp 160,160,161
cvp 161,162,163
wl 6
mfv 208,96,72
tra 88,10,61440
tra 90,10,63488
mfv 212,100,72
cvp 162,164,165
cvp 163,166,167
sad 32,47,786432
buffer_store_dwordx4 v[160:163], v21, s[20:23], s32 offen sc1
wl 6
mfv 216,96,76
tra 92,11,61440
tra 94,11,63488
mfv 220,100,76
cvp 168,168,169
cvp 169,170,171
cvp 170,172,173
cvp 171,174,175
wl 6
mfv 192,112,80
tra 64,12,16384
tra 66,12,18432
mfv 196,116,80
sad 32,47,819200
buffer_store_dwordx4 v[168:171], v21, s[20:23], s32 offen sc1
cvp 176,176,177
cvp 177,178,179
wl 6
mfv 200,112,84
tra 68,13,16384
tra 70,13,18432
mfv 204,116,84
cvp 178,180,181
cvp 179,182,183
sad 32,47,851968
buffer_store_dwordx4 v[176:179], v21, s[20:23], s32 offen sc1
wl 6
mfv 208,112,88
tra 72,14,16384
tra 74,14,18432
mfv 212,116,88
cvp 184,184,185
cvp 185,186,187
cvp 186,188,189
cvp 187,190,191
wl 6
mfv 216,112,92
tra 76,15,16384
tra 78,15,18432
mfv 220,116,92
sad 32,47,884736
buffer_store_dwordx4 v[184:187], v21, s[20:23], s32 offen sc1
wl 6
mfv 192,128,64
tra 80,12,20480
tra 82,12,22528
mfv 196,132,64
wl 6
mfv 200,128,68
tra 84,13,20480
tra 86,13,22528
mfv 204,132,68
wl 6
mfv 208,128,72
tra 88,14,20480
tra 90,14,22528
mfv 212,132,72
wl 6
mfv 216,128,76
tra 92,15,20480
tra 94,15,22528
mfv 220,132,76
s_waitcnt vmcnt(50) lgkmcnt(0)
s_barrier
mfv 192,144,80
tra 64,12,24576
tra 66,12,26624
mfv 196,148,80
s_mul_i32 s34, s60, 2
s_add_u32 s34, s34, s24
s_add_u32 m0, s29, 49152
s_nop 0
buffer_load_dwordx4 v6, s[8:11], s34 offen lds
mfv 200,144,84
tra 68,13,24576
tra 70,13,26624
mfv 204,148,84
s_add_u32 m0, s29, 50176
s_nop 0
buffer_load_dwordx4 v7, s[8:11], s34 offen lds
mfv 208,144,88
tra 72,14,24576
tra 74,14,26624
mfv 212,148,88
s_mul_i32 s34, s60, 2
s_add_u32 s34, s34, s25
s_add_u32 m0, s29, 57344
s_nop 0
buffer_load_dwordx4 v6, s[52:55], s34 offen lds
mfv 216,144,92
tra 76,15,24576
tra 78,15,26624
mfv 220,148,92
s_add_u32 m0, s29, 58368
s_nop 0
buffer_load_dwordx4 v7, s[52:55], s34 offen lds
s_nop 1
wl 6
mfw 160,64,64
tra 80,12,28672
tra 82,12,30720
mfw 164,68,64
s_mul_i32 s34, s60, 2
s_add_u32 s34, s34, s26
s_add_u32 m0, s29, 65536
s_nop 0
buffer_load_dwordx4 v6, s[56:59], s34 offen lds
wl 6
mfw 168,64,68
tra 84,13,28672
tra 86,13,30720
mfw 172,68,68
s_add_u32 m0, s29, 66560
s_nop 0
buffer_load_dwordx4 v7, s[56:59], s34 offen lds
wl 6
mfw 176,64,72
tra 88,14,28672
tra 90,14,30720
mfw 180,68,72
sad 33,28,4096
buffer_load_dwordx4 a[160:163], v20, s[16:19], s33 offen sc1
wl 6
mfw 184,64,76
tra 92,15,28672
tra 94,15,30720
mfw 188,68,76
sad 33,28,24576
buffer_load_dwordx4 a[164:167], v20, s[16:19], s33 offen sc1
wl 6
mfv 160,80,80
tra 64,12,32768
tra 66,12,34816
mfv 164,84,80
sad 33,28,45056
buffer_load_dwordx4 a[168:171], v20, s[16:19], s33 offen sc1
wl 6
mfv 168,80,84
tra 68,13,32768
tra 70,13,34816
mfv 172,84,84
sad 33,28,65536
buffer_load_dwordx4 a[172:175], v20, s[16:19], s33 offen sc1
wl 6
mfv 176,80,88
tra 72,14,32768
tra 74,14,34816
mfv 180,84,88
sad 33,28,5120
buffer_load_dwordx4 a[176:179], v20, s[16:19], s33 offen sc1
wl 6
mfv 184,80,92
tra 76,15,32768
tra 78,15,34816
mfv 188,84,92
sad 33,28,25600
buffer_load_dwordx4 a[180:183], v20, s[16:19], s33 offen sc1
wl 6
mfv 160,96,64
tra 80,12,36864
tra 82,12,38912
mfv 164,100,64
sad 33,28,46080
buffer_load_dwordx4 a[184:187], v20, s[16:19], s33 offen sc1
wl 6
mfv 168,96,68
tra 84,13,36864
tra 86,13,38912
mfv 172,100,68
sad 33,28,66560
buffer_load_dwordx4 a[188:191], v20, s[16:19], s33 offen sc1
cvp 192,192,193
cvp 193,194,195
wl 6
mfv 176,96,72
tra 88,14,36864
tra 90,14,38912
mfv 180,100,72
cvp 194,196,197
cvp 195,198,199
sad 32,47,917504
buffer_store_dwordx4 v[192:195], v21, s[20:23], s32 offen sc1
wl 6
mfv 184,96,76
tra 92,15,36864
tra 94,15,38912
mfv 188,100,76
cvp 200,200,201
cvp 201,202,203
cvp 202,204,205
cvp 203,206,207
wl 6
mfv 160,112,80
tra 64,12,40960
tra 66,12,43008
mfv 164,116,80
sad 32,47,950272
buffer_store_dwordx4 v[200:203], v21, s[20:23], s32 offen sc1
cvp 208,208,209
cvp 209,210,211
wl 6
mfv 168,112,84
tra 68,13,40960
tra 70,13,43008
mfv 172,116,84
cvp 210,212,213
cvp 211,214,215
sad 32,47,983040
buffer_store_dwordx4 v[208:211], v21, s[20:23], s32 offen sc1
wl 6
mfv 176,112,88
tra 72,14,40960
tra 74,14,43008
mfv 180,116,88
cvp 216,216,217
cvp 217,218,219
cvp 218,220,221
cvp 219,222,223
wl 6
mfv 184,112,92
tra 76,15,40960
tra 78,15,43008
mfv 188,116,92
sad 32,47,1015808
buffer_store_dwordx4 v[216:219], v21, s[20:23], s32 offen sc1
wl 6
mfv 160,128,64
tra 80,12,45056
tra 82,12,47104
mfv 164,132,64
wl 6
mfv 168,128,68
tra 84,13,45056
tra 86,13,47104
mfv 172,132,68
wl 6
mfv 176,128,72
tra 88,14,45056
tra 90,14,47104
mfv 180,132,72
wl 6
mfv 184,128,76
tra 92,15,45056
tra 94,15,47104
mfv 188,132,76
s_waitcnt vmcnt(58) lgkmcnt(0)
s_barrier
mfv 160,144,80
tra 64,12,49152
tra 66,12,51200
mfv 164,148,80
s_mul_i32 s34, s60, 3
s_add_u32 s34, s34, s24
s_add_u32 m0, s29, 73728
s_nop 0
buffer_load_dwordx4 v6, s[8:11], s34 offen lds
mfv 168,144,84
tra 68,13,49152
tra 70,13,51200
mfv 172,148,84
s_add_u32 m0, s29, 74752
s_nop 0
buffer_load_dwordx4 v7, s[8:11], s34 offen lds
mfv 176,144,88
tra 72,14,49152
tra 74,14,51200
mfv 180,148,88
s_mul_i32 s34, s60, 3
s_add_u32 s34, s34, s25
s_add_u32 m0, s29, 81920
s_nop 0
buffer_load_dwordx4 v6, s[52:55], s34 offen lds
mfv 184,144,92
tra 76,15,49152
tra 78,15,51200
mfv 188,148,92
s_add_u32 m0, s29, 82944
s_nop 0
buffer_load_dwordx4 v7, s[52:55], s34 offen lds
s_nop 1
wl 6
mfw 192,64,64
tra 80,12,53248
tra 82,12,55296
mfw 196,68,64
s_mul_i32 s34, s60, 3
s_add_u32 s34, s34, s26
s_add_u32 m0, s29, 90112
s_nop 0
buffer_load_dwordx4 v6, s[56:59], s34 offen lds
wl 6
mfw 200,64,68
tra 84,13,53248
tra 86,13,55296
mfw 204,68,68
s_add_u32 m0, s29, 91136
s_nop 0
buffer_load_dwordx4 v7, s[56:59], s34 offen lds
wl 6
mfw 208,64,72
tra 88,14,53248
tra 90,14,55296
mfw 212,68,72
sad 33,28,6144
buffer_load_dwordx4 a[192:195], v20, s[16:19], s33 offen sc1
wl 6
mfw 216,64,76
tra 92,15,53248
tra 94,15,55296
mfw 220,68,76
sad 33,28,26624
buffer_load_dwordx4 a[196:199], v20, s[16:19], s33 offen sc1
wl 6
mfv 192,80,80
tra 64,12,57344
tra 66,12,59392
mfv 196,84,80
sad 33,28,47104
buffer_load_dwordx4 a[200:203], v20, s[16:19], s33 offen sc1
wl 6
mfv 200,80,84
tra 68,13,57344
tra 70,13,59392
mfv 204,84,84
sad 33,28,67584
buffer_load_dwordx4 a[204:207], v20, s[16:19], s33 offen sc1
wl 6
mfv 208,80,88
tra 72,14,57344
tra 74,14,59392
mfv 212,84,88
sad 33,28,7168
buffer_load_dwordx4 a[208:211], v20, s[16:19], s33 offen sc1
wl 6
mfv 216,80,92
tra 76,15,57344
tra 78,15,59392
mfv 220,84,92
sad 33,28,27648
buffer_load_dwordx4 a[212:215], v20, s[16:19], s33 offen sc1
wl 6
mfv 192,96,64
tra 80,12,61440
tra 82,12,63488
mfv 196,100,64
sad 33,28,48128
buffer_load_dwordx4 a[216:219], v20, s[16:19], s33 offen sc1
wl 6
mfv 200,96,68
tra 84,13,61440
tra 86,13,63488
mfv 204,100,68
sad 33,28,68608
buffer_load_dwordx4 a[220:223], v20, s[16:19], s33 offen sc1
cvp 160,160,161
cvp 161,162,163
wl 6
mfv 208,96,72
tra 88,14,61440
tra 90,14,63488
mfv 212,100,72
cvp 162,164,165
cvp 163,166,167
sad 32,47,1048576
buffer_store_dwordx4 v[160:163], v21, s[20:23], s32 offen sc1
wl 6
mfv 216,96,76
tra 92,15,61440
tra 94,15,63488
mfv 220,100,76
cvp 168,168,169
cvp 169,170,171
cvp 170,172,173
cvp 171,174,175
wl 6
mfv 192,112,80
tra 64,24,16384
tra 66,24,18432
mfv 196,116,80
sad 32,47,1081344
buffer_store_dwordx4 v[168:171], v21, s[20:23], s32 offen sc1
cvp 176,176,177
cvp 177,178,179
wl 6
mfv 200,112,84
tra 68,25,16384
tra 70,25,18432
mfv 204,116,84
cvp 178,180,181
cvp 179,182,183
sad 32,47,1114112
buffer_store_dwordx4 v[176:179], v21, s[20:23], s32 offen sc1
wl 6
mfv 208,112,88
tra 72,26,16384
tra 74,26,18432
mfv 212,116,88
cvp 184,184,185
cvp 185,186,187
cvp 186,188,189
cvp 187,190,191
wl 6
mfv 216,112,92
tra 76,27,16384
tra 78,27,18432
mfv 220,116,92
sad 32,47,1146880
buffer_store_dwordx4 v[184:187], v21, s[20:23], s32 offen sc1
wl 6
mfv 192,128,64
tra 80,24,20480
tra 82,24,22528
mfv 196,132,64
wl 6
mfv 200,128,68
tra 84,25,20480
tra 86,25,22528
mfv 204,132,68
wl 6
mfv 208,128,72
tra 88,26,20480
tra 90,26,22528
mfv 212,132,72
wl 6
mfv 216,128,76
tra 92,27,20480
tra 94,27,22528
mfv 220,132,76
wl 6
mfv 192,144,80
mfv 196,148,80
wl 4
mfv 200,144,84
mfv 204,148,84
wl 2
mfv 208,144,88
mfv 212,148,88
wl 0
mfv 216,144,92
mfv 220,148,92
s_nop 1
wv 48
wv 40
s_nop 7
cvp 192,192,193
cvp 193,194,195
cvp 194,196,197
cvp 195,198,199
sad 32,47,1179648
buffer_store_dwordx4 v[192:195], v21, s[20:23], s32 offen sc1
cvp 200,200,201
cvp 201,202,203
cvp 202,204,205
cvp 203,206,207
sad 32,47,1212416
buffer_store_dwordx4 v[200:203], v21, s[20:23], s32 offen sc1
cvp 208,208,209
cvp 209,210,211
cvp 210,212,213
cvp 211,214,215
sad 32,47,1245184
buffer_store_dwordx4 v[208:211], v21, s[20:23], s32 offen sc1
cvp 216,216,217
cvp 217,218,219
cvp 218,220,221
cvp 219,222,223
sad 32,47,1277952
buffer_store_dwordx4 v[216:219], v21, s[20:23], s32 offen sc1
s_getpc_b64 s[50:51]
L_h_185:
s_add_u32 s50, s50, L_wk_done-L_h_185
s_addc_u32 s51, s51, -1
s_setpc_b64 s[50:51]
.p2align 6
L_main_qk2:
s_mov_b32 s18, 2621440
s_bitcmp1_b32 s3, 5
s_mov_b32 s44, 100663296
s_cselect_b32 s44, 67108864, s44
s_add_u32 s20, s36, s44
s_addc_u32 s21, s37, 0
s_and_b32 s21, s21, 0xffff
s_mov_b32 s22, 25165824
s_mov_b32 s23, 0x00020000
s_and_b32 s45, s3, 31
s_lshr_b32 s46, s3, 6
s_lshl_b32 s46, s46, 2
s_add_u32 s46, s46, s4
s_mul_i32 s46, s46, 2
v_lshlrev_b32 v21, 3, v1
s_mul_i32 s47, s45, 12288
sad 32,46,0
s_lshr_b32 s33, s32, 1
s_mul_i32 s33, s33, 393216
s_and_b32 s32, s32, 1
s_mul_i32 s32, s32, 1536
s_add_u32 s33, s33, s32
s_add_u32 s61, s33, s47
sad 32,46,1
s_lshr_b32 s33, s32, 1
s_mul_i32 s33, s33, 393216
s_and_b32 s32, s32, 1
s_mul_i32 s32, s32, 1536
s_add_u32 s33, s33, s32
s_add_u32 s62, s33, s47
sad 33,28,0
buffer_load_dwordx4 a[96:99], v20, s[16:19], s33 offen sc1
sad 33,28,20480
buffer_load_dwordx4 a[100:103], v20, s[16:19], s33 offen sc1
sad 33,28,1024
buffer_load_dwordx4 a[104:107], v20, s[16:19], s33 offen sc1
sad 33,28,21504
buffer_load_dwordx4 a[108:111], v20, s[16:19], s33 offen sc1
s_barrier
tra 64,8,0
tra 66,8,2048
tra 68,9,0
tra 70,9,2048
tra 72,10,0
tra 74,10,2048
tra 76,11,0
tra 78,11,2048
wv 2
wl 6
mfz 64,64,96
tra 80,8,8192
tra 82,8,10240
mfz 68,64,100
sad 33,28,2048
buffer_load_dwordx4 a[128:131], v20, s[16:19], s33 offen sc1
wl 6
mfz 72,68,96
tra 84,9,8192
tra 86,9,10240
mfz 76,68,100
sad 33,28,22528
buffer_load_dwordx4 a[132:135], v20, s[16:19], s33 offen sc1
wl 6
mfz 80,72,96
tra 88,10,8192
tra 90,10,10240
mfz 84,72,100
sad 33,28,3072
buffer_load_dwordx4 a[136:139], v20, s[16:19], s33 offen sc1
wl 6
mfz 88,76,96
tra 92,11,8192
tra 94,11,10240
mfz 92,76,100
sad 33,28,23552
buffer_load_dwordx4 a[140:143], v20, s[16:19], s33 offen sc1
wl 6
mfz 96,80,96
tra 64,8,16384
tra 66,8,18432
mfz 100,80,100
sad 33,28,4096
buffer_load_dwordx4 a[160:163], v20, s[16:19], s33 offen sc1
wl 6
mfz 104,84,96
tra 68,9,16384
tra 70,9,18432
mfz 108,84,100
sad 33,28,24576
buffer_load_dwordx4 a[164:167], v20, s[16:19], s33 offen sc1
wl 6
mfz 112,88,96
tra 72,10,16384
tra 74,10,18432
mfz 116,88,100
sad 33,28,5120
buffer_load_dwordx4 a[168:171], v20, s[16:19], s33 offen sc1
wl 6
mfz 120,92,96
tra 76,11,16384
tra 78,11,18432
mfz 124,92,100
sad 33,28,25600
buffer_load_dwordx4 a[172:175], v20, s[16:19], s33 offen sc1
wl 6
mfz 128,64,96
tra 80,8,4096
tra 82,8,6144
mfz 132,64,100
sad 33,28,6144
buffer_load_dwordx4 a[192:195], v20, s[16:19], s33 offen sc1
wl 6
mfz 136,68,96
tra 84,9,4096
tra 86,9,6144
mfz 140,68,100
sad 33,28,26624
buffer_load_dwordx4 a[196:199], v20, s[16:19], s33 offen sc1
wl 6
mfz 144,72,96
tra 88,10,4096
tra 90,10,6144
mfz 148,72,100
sad 33,28,7168
buffer_load_dwordx4 a[200:203], v20, s[16:19], s33 offen sc1
wl 6
mfz 152,76,96
tra 92,11,4096
tra 94,11,6144
mfz 156,76,100
sad 33,28,27648
buffer_load_dwordx4 a[204:207], v20, s[16:19], s33 offen sc1
wv 12
wl 6
mfa 64,80,104
tra 64,8,12288
tra 66,8,14336
mfa 68,80,108
sad 34,24,3145728
s_add_u32 m0, s29, 98304
s_nop 0
buffer_load_dwordx4 v6, s[8:11], s34 offen lds
wl 6
mfa 72,84,104
tra 68,9,12288
tra 70,9,14336
mfa 76,84,108
s_add_u32 m0, s29, 99328
s_nop 0
buffer_load_dwordx4 v7, s[8:11], s34 offen lds
wl 6
mfa 80,88,104
tra 72,10,12288
tra 74,10,14336
mfa 84,88,108
sad 34,25,3145728
s_add_u32 m0, s29, 106496
s_nop 0
buffer_load_dwordx4 v6, s[52:55], s34 offen lds
wl 6
mfa 88,92,104
tra 76,11,12288
tra 78,11,14336
mfa 92,92,108
s_add_u32 m0, s29, 107520
s_nop 0
buffer_load_dwordx4 v7, s[52:55], s34 offen lds
wl 6
mfa 96,64,104
tra 80,8,20480
tra 82,8,22528
mfa 100,64,108
sad 34,26,3145728
s_add_u32 m0, s29, 114688
s_nop 0
buffer_load_dwordx4 v6, s[56:59], s34 offen lds
wl 6
mfa 104,68,104
tra 84,9,20480
tra 86,9,22528
mfa 108,68,108
s_add_u32 m0, s29, 115712
s_nop 0
buffer_load_dwordx4 v7, s[56:59], s34 offen lds
wl 6
mfa 112,72,104
tra 88,10,20480
tra 90,10,22528
mfa 116,72,108
sad 33,28,8192
buffer_load_dwordx4 a[224:227], v20, s[16:19], s33 offen sc1
wl 6
mfa 120,76,104
tra 92,11,20480
tra 94,11,22528
mfa 124,76,108
sad 33,28,28672
buffer_load_dwordx4 a[228:231], v20, s[16:19], s33 offen sc1
wl 0
s_barrier
mfa 128,80,104
tra 64,8,24576
tra 66,8,26624
mfa 132,80,108
sad 33,28,9216
buffer_load_dwordx4 a[232:235], v20, s[16:19], s33 offen sc1
mfa 136,84,104
tra 68,9,24576
tra 70,9,26624
mfa 140,84,108
sad 33,28,29696
buffer_load_dwordx4 a[236:239], v20, s[16:19], s33 offen sc1
mfa 144,88,104
tra 72,10,24576
tra 74,10,26624
mfa 148,88,108
sad 34,24,3932160
s_add_u32 m0, s29, 0
s_nop 0
buffer_load_dwordx4 v6, s[8:11], s34 offen lds
mfa 152,92,104
tra 76,11,24576
tra 78,11,26624
mfa 156,92,108
s_add_u32 m0, s29, 1024
s_nop 0
buffer_load_dwordx4 v7, s[8:11], s34 offen lds
wv 22
wl 6
mfa 64,64,128
tra 80,8,32768
tra 82,8,34816
mfa 68,64,132
sad 34,25,3932160
s_add_u32 m0, s29, 8192
s_nop 0
buffer_load_dwordx4 v6, s[52:55], s34 offen lds
wl 6
mfa 72,68,128
tra 84,9,32768
tra 86,9,34816
mfa 76,68,132
s_add_u32 m0, s29, 9216
s_nop 0
buffer_load_dwordx4 v7, s[52:55], s34 offen lds
wl 6
mfa 80,72,128
tra 88,10,32768
tra 90,10,34816
mfa 84,72,132
sad 34,26,3932160
s_add_u32 m0, s29, 16384
s_nop 0
buffer_load_dwordx4 v6, s[56:59], s34 offen lds
wl 6
mfa 88,76,128
tra 92,11,32768
tra 94,11,34816
mfa 92,76,132
s_add_u32 m0, s29, 17408
s_nop 0
buffer_load_dwordx4 v7, s[56:59], s34 offen lds
wl 6
mfa 96,80,128
tra 64,8,40960
tra 66,8,43008
mfa 100,80,132
sad 33,28,10240
buffer_load_dwordx4 a[96:99], v20, s[16:19], s33 offen sc1
wl 6
mfa 104,84,128
tra 68,9,40960
tra 70,9,43008
mfa 108,84,132
sad 33,28,30720
buffer_load_dwordx4 a[100:103], v20, s[16:19], s33 offen sc1
wl 6
mfa 112,88,128
tra 72,10,40960
tra 74,10,43008
mfa 116,88,132
sad 33,28,11264
buffer_load_dwordx4 a[104:107], v20, s[16:19], s33 offen sc1
wl 6
mfa 120,92,128
tra 76,11,40960
tra 78,11,43008
mfa 124,92,132
sad 33,28,31744
buffer_load_dwordx4 a[108:111], v20, s[16:19], s33 offen sc1
wl 6
mfa 128,64,128
tra 80,8,28672
tra 82,8,30720
mfa 132,64,132
wl 6
mfa 136,68,128
tra 84,9,28672
tra 86,9,30720
mfa 140,68,132
wl 6
mfa 144,72,128
tra 88,10,28672
tra 90,10,30720
mfa 148,72,132
wl 6
mfa 152,76,128
tra 92,11,28672
tra 94,11,30720
mfa 156,76,132
wv 28
wl 6
mfa 64,80,136
tra 64,8,36864
tra 66,8,38912
mfa 68,80,140
wl 6
mfa 72,84,136
tra 68,9,36864
tra 70,9,38912
mfa 76,84,140
wl 6
mfa 80,88,136
tra 72,10,36864
tra 74,10,38912
mfa 84,88,140
wl 6
mfa 88,92,136
tra 76,11,36864
tra 78,11,38912
mfa 92,92,140
wl 6
mfa 96,64,136
tra 80,8,45056
tra 82,8,47104
mfa 100,64,140
wl 6
mfa 104,68,136
tra 84,9,45056
tra 86,9,47104
mfa 108,68,140
wl 6
mfa 112,72,136
tra 88,10,45056
tra 90,10,47104
mfa 116,72,140
wl 6
mfa 120,76,136
tra 92,11,45056
tra 94,11,47104
mfa 124,76,140
wl 0
s_barrier
s_cmp_lt_i32 s70, 0
s_cbranch_scc1 L_pp_186
s_cmp_lg_u32 s4, 1
s_cbranch_scc1 L_pp_186
s_lshl_b32 s83, s70, 7
v_and_b32 v2, 1, v1
v_cmp_eq_u32 vcc, 1, v2
v_mov_b32 v2, s100
v_mov_b32 v3, s101
v_cndmask_b32 v3, v2, v3, vcc
v_and_b32 v2, 31, v1
v_lshlrev_b32 v2, 2, v2
buffer_store_dword v3, v2, s[88:91], s83 offen sc1
L_pp_186:
s_mov_b32 s70, -1
mfa 128,80,136
tra 64,8,49152
tra 66,8,51200
mfa 132,80,140
sad 34,24,4718592
s_add_u32 m0, s29, 24576
s_nop 0
buffer_load_dwordx4 v6, s[8:11], s34 offen lds
mfa 136,84,136
tra 68,9,49152
tra 70,9,51200
mfa 140,84,140
s_add_u32 m0, s29, 25600
s_nop 0
buffer_load_dwordx4 v7, s[8:11], s34 offen lds
mfa 144,88,136
tra 72,10,49152
tra 74,10,51200
mfa 148,88,140
sad 34,25,4718592
s_add_u32 m0, s29, 32768
s_nop 0
buffer_load_dwordx4 v6, s[52:55], s34 offen lds
mfa 152,92,136
tra 76,11,49152
tra 78,11,51200
mfa 156,92,140
s_add_u32 m0, s29, 33792
s_nop 0
buffer_load_dwordx4 v7, s[52:55], s34 offen lds
wv 30
wl 6
mfa 64,64,160
tra 80,8,57344
tra 82,8,59392
mfa 68,64,164
sad 34,26,4718592
s_add_u32 m0, s29, 40960
s_nop 0
buffer_load_dwordx4 v6, s[56:59], s34 offen lds
wl 6
mfa 72,68,160
tra 84,9,57344
tra 86,9,59392
mfa 76,68,164
s_add_u32 m0, s29, 41984
s_nop 0
buffer_load_dwordx4 v7, s[56:59], s34 offen lds
wl 6
mfa 80,72,160
tra 88,10,57344
tra 90,10,59392
mfa 84,72,164
sad 33,28,12288
buffer_load_dwordx4 a[128:131], v20, s[16:19], s33 offen sc1
wl 6
mfa 88,76,160
tra 92,11,57344
tra 94,11,59392
mfa 92,76,164
sad 33,28,32768
buffer_load_dwordx4 a[132:135], v20, s[16:19], s33 offen sc1
wl 6
mfa 96,80,160
tra 64,12,16384
tra 66,12,18432
mfa 100,80,164
sad 33,28,13312
buffer_load_dwordx4 a[136:139], v20, s[16:19], s33 offen sc1
wl 6
mfa 104,84,160
tra 68,13,16384
tra 70,13,18432
mfa 108,84,164
sad 33,28,33792
buffer_load_dwordx4 a[140:143], v20, s[16:19], s33 offen sc1
wl 6
mfa 112,88,160
tra 72,14,16384
tra 74,14,18432
mfa 116,88,164
wl 6
mfa 120,92,160
tra 76,15,16384
tra 78,15,18432
mfa 124,92,164
wl 6
mfa 128,64,160
tra 80,8,53248
tra 82,8,55296
mfa 132,64,164
wl 6
mfa 136,68,160
tra 84,9,53248
tra 86,9,55296
mfa 140,68,164
wl 6
mfa 144,72,160
tra 88,10,53248
tra 90,10,55296
mfa 148,72,164
wl 6
mfa 152,76,160
tra 92,11,53248
tra 94,11,55296
mfa 156,76,164
wv 34
wl 6
mfa 64,80,168
tra 64,8,61440
tra 66,8,63488
mfa 68,80,172
wl 6
mfa 72,84,168
tra 68,9,61440
tra 70,9,63488
mfa 76,84,172
wl 6
mfa 80,88,168
tra 72,10,61440
tra 74,10,63488
mfa 84,88,172
wl 6
mfa 88,92,168
tra 76,11,61440
tra 78,11,63488
mfa 92,92,172
wl 6
mfa 96,64,168
tra 80,12,20480
tra 82,12,22528
mfa 100,64,172
wl 6
mfa 104,68,168
tra 84,13,20480
tra 86,13,22528
mfa 108,68,172
wl 6
mfa 112,72,168
tra 88,14,20480
tra 90,14,22528
mfa 116,72,172
wl 6
mfa 120,76,168
tra 92,15,20480
tra 94,15,22528
mfa 124,76,172
wl 0
s_barrier
s_sub_u32 s83, s2, 128
s_lshr_b32 s83, s83, 3
s_mul_i32 s83, s83, 0
sad 83,83,36
s_cmp_eq_u32 s68, 1
s_cselect_b32 s83, 0, s83
s_cmp_ge_u32 s2, 144
s_cbranch_scc1 L_xd_187
s_cmp_lt_u32 s78, s83
s_cbranch_scc1 L_xd_187
v_mov_b32 v18, 0x7fff
s_mov_b32 s77, 7
s_branch L_xe_188
L_xd_187:
s_cmp_lg_u32 s4, 0
s_cbranch_scc1 L_ti_189
s_lshl_b32 s83, s76, 2
v_mov_b32 v18, 1
v_mov_b32 v2, 0
s_mov_b64 exec, 1
buffer_atomic_add v18, v2, s[84:87], s83 offen sc0 sc1
s_mov_b64 exec, -1
L_ti_189:
L_xe_188:
mfa 128,80,168
tra 64,12,24576
tra 66,12,26624
mfa 132,80,172
sad 34,24,5505024
s_add_u32 m0, s29, 49152
s_nop 0
buffer_load_dwordx4 v6, s[8:11], s34 offen lds
mfa 136,84,168
tra 68,13,24576
tra 70,13,26624
mfa 140,84,172
s_add_u32 m0, s29, 50176
s_nop 0
buffer_load_dwordx4 v7, s[8:11], s34 offen lds
mfa 144,88,168
tra 72,14,24576
tra 74,14,26624
mfa 148,88,172
sad 34,25,5505024
s_add_u32 m0, s29, 57344
s_nop 0
buffer_load_dwordx4 v6, s[52:55], s34 offen lds
mfa 152,92,168
tra 76,15,24576
tra 78,15,26624
mfa 156,92,172
s_add_u32 m0, s29, 58368
s_nop 0
buffer_load_dwordx4 v7, s[52:55], s34 offen lds
wv 36
wl 6
mfa 64,64,192
tra 80,12,32768
tra 82,12,34816
mfa 68,64,196
sad 34,26,5505024
s_add_u32 m0, s29, 65536
s_nop 0
buffer_load_dwordx4 v6, s[56:59], s34 offen lds
wl 6
mfa 72,68,192
tra 84,13,32768
tra 86,13,34816
mfa 76,68,196
s_add_u32 m0, s29, 66560
s_nop 0
buffer_load_dwordx4 v7, s[56:59], s34 offen lds
wl 6
mfa 80,72,192
tra 88,14,32768
tra 90,14,34816
mfa 84,72,196
sad 33,28,14336
buffer_load_dwordx4 a[160:163], v20, s[16:19], s33 offen sc1
wl 6
mfa 88,76,192
tra 92,15,32768
tra 94,15,34816
mfa 92,76,196
sad 33,28,34816
buffer_load_dwordx4 a[164:167], v20, s[16:19], s33 offen sc1
wl 6
mfa 96,80,192
tra 64,12,40960
tra 66,12,43008
mfa 100,80,196
sad 33,28,15360
buffer_load_dwordx4 a[168:171], v20, s[16:19], s33 offen sc1
wl 6
mfa 104,84,192
tra 68,13,40960
tra 70,13,43008
mfa 108,84,196
sad 33,28,35840
buffer_load_dwordx4 a[172:175], v20, s[16:19], s33 offen sc1
wl 6
mfa 112,88,192
tra 72,14,40960
tra 74,14,43008
mfa 116,88,196
wl 6
mfa 120,92,192
tra 76,15,40960
tra 78,15,43008
mfa 124,92,196
wl 6
mfa 128,64,192
tra 80,12,28672
tra 82,12,30720
mfa 132,64,196
wl 6
mfa 136,68,192
tra 84,13,28672
tra 86,13,30720
mfa 140,68,196
wl 6
mfa 144,72,192
tra 88,14,28672
tra 90,14,30720
mfa 148,72,196
wl 6
mfa 152,76,192
tra 92,15,28672
tra 94,15,30720
mfa 156,76,196
wv 40
wl 6
mfa 64,80,200
tra 64,12,36864
tra 66,12,38912
mfa 68,80,204
wl 6
mfa 72,84,200
tra 68,13,36864
tra 70,13,38912
mfa 76,84,204
wl 6
mfa 80,88,200
tra 72,14,36864
tra 74,14,38912
mfa 84,88,204
wl 6
mfa 88,92,200
tra 76,15,36864
tra 78,15,38912
mfa 92,92,204
wl 6
mfa 96,64,200
tra 80,12,45056
tra 82,12,47104
mfa 100,64,204
wl 6
mfa 104,68,200
tra 84,13,45056
tra 86,13,47104
mfa 108,68,204
wl 6
mfa 112,72,200
tra 88,14,45056
tra 90,14,47104
mfa 116,72,204
wl 6
mfa 120,76,200
tra 92,15,45056
tra 94,15,47104
mfa 124,76,204
s_waitcnt vmcnt(34) lgkmcnt(0)
s_barrier
mfa 128,80,200
tra 64,12,49152
tra 66,12,51200
mfa 132,80,204
sad 34,24,6291456
s_add_u32 m0, s29, 73728
s_nop 0
buffer_load_dwordx4 v6, s[8:11], s34 offen lds
mfa 136,84,200
tra 68,13,49152
tra 70,13,51200
mfa 140,84,204
s_add_u32 m0, s29, 74752
s_nop 0
buffer_load_dwordx4 v7, s[8:11], s34 offen lds
mfa 144,88,200
tra 72,14,49152
tra 74,14,51200
mfa 148,88,204
sad 34,25,6291456
s_add_u32 m0, s29, 81920
s_nop 0
buffer_load_dwordx4 v6, s[52:55], s34 offen lds
mfa 152,92,200
tra 76,15,49152
tra 78,15,51200
mfa 156,92,204
s_add_u32 m0, s29, 82944
s_nop 0
buffer_load_dwordx4 v7, s[52:55], s34 offen lds
wv 36
wl 6
mfa 64,64,224
tra 80,12,57344
tra 82,12,59392
mfa 68,64,228
sad 34,26,6291456
s_add_u32 m0, s29, 90112
s_nop 0
buffer_load_dwordx4 v6, s[56:59], s34 offen lds
wl 6
mfa 72,68,224
tra 84,13,57344
tra 86,13,59392
mfa 76,68,228
s_add_u32 m0, s29, 91136
s_nop 0
buffer_load_dwordx4 v7, s[56:59], s34 offen lds
wl 6
mfa 80,72,224
tra 88,14,57344
tra 90,14,59392
mfa 84,72,228
sad 33,28,16384
buffer_load_dwordx4 a[192:195], v20, s[16:19], s33 offen sc1
wl 6
mfa 88,76,224
tra 92,15,57344
tra 94,15,59392
mfa 92,76,228
sad 33,28,36864
buffer_load_dwordx4 a[196:199], v20, s[16:19], s33 offen sc1
wl 6
mfa 96,80,224
tra 64,24,16384
tra 66,24,18432
mfa 100,80,228
sad 33,28,17408
buffer_load_dwordx4 a[200:203], v20, s[16:19], s33 offen sc1
wl 6
mfa 104,84,224
tra 68,25,16384
tra 70,25,18432
mfa 108,84,228
sad 33,28,37888
buffer_load_dwordx4 a[204:207], v20, s[16:19], s33 offen sc1
wl 6
mfa 112,88,224
tra 72,26,16384
tra 74,26,18432
mfa 116,88,228
wl 6
mfa 120,92,224
tra 76,27,16384
tra 78,27,18432
mfa 124,92,228
wl 6
mfa 128,64,224
tra 80,12,53248
tra 82,12,55296
mfa 132,64,228
wl 6
mfa 136,68,224
tra 84,13,53248
tra 86,13,55296
mfa 140,68,228
wl 6
mfa 144,72,224
tra 88,14,53248
tra 90,14,55296
mfa 148,72,228
wl 6
mfa 152,76,224
tra 92,15,53248
tra 94,15,55296
mfa 156,76,228
wv 40
wl 6
mfa 64,80,232
tra 64,12,61440
tra 66,12,63488
mfa 68,80,236
wl 6
mfa 72,84,232
tra 68,13,61440
tra 70,13,63488
mfa 76,84,236
wl 6
mfa 80,88,232
tra 72,14,61440
tra 74,14,63488
mfa 84,88,236
wl 6
mfa 88,92,232
tra 76,15,61440
tra 78,15,63488
mfa 92,92,236
wl 6
mfa 96,64,232
tra 80,24,20480
tra 82,24,22528
mfa 100,64,236
wl 6
mfa 104,68,232
tra 84,25,20480
tra 86,25,22528
mfa 108,68,236
wl 6
mfa 112,72,232
tra 88,26,20480
tra 90,26,22528
mfa 116,72,236
wl 6
mfa 120,76,232
tra 92,27,20480
tra 94,27,22528
mfa 124,76,236
v_mov_b32 v19, 155648
s_cmp_lg_u32 s4, 0
s_cbranch_scc1 L_ps_190
wv 20
s_mov_b64 exec, 1
ds_write_b32 v19, v18
s_mov_b64 exec, -1
wl 0
L_ps_190:
s_waitcnt vmcnt(34) lgkmcnt(0)
s_barrier
ds_read_b32 v18, v19
mfa 128,80,232
tra 64,8,0
tra 66,8,2048
mfa 132,80,236
sad 34,24,7077888
s_add_u32 m0, s29, 98304
s_nop 0
buffer_load_dwordx4 v6, s[8:11], s34 offen lds
mfa 136,84,232
tra 68,9,0
tra 70,9,2048
mfa 140,84,236
s_add_u32 m0, s29, 99328
s_nop 0
buffer_load_dwordx4 v7, s[8:11], s34 offen lds
mfa 144,88,232
tra 72,10,0
tra 74,10,2048
mfa 148,88,236
sad 34,25,7077888
s_add_u32 m0, s29, 106496
s_nop 0
buffer_load_dwordx4 v6, s[52:55], s34 offen lds
mfa 152,92,232
tra 76,11,0
tra 78,11,2048
mfa 156,92,236
s_add_u32 m0, s29, 107520
s_nop 0
buffer_load_dwordx4 v7, s[52:55], s34 offen lds
wv 36
wl 6
mfa 64,64,96
tra 80,8,8192
tra 82,8,10240
mfa 68,64,100
sad 34,26,7077888
s_add_u32 m0, s29, 114688
s_nop 0
buffer_load_dwordx4 v6, s[56:59], s34 offen lds
wl 6
mfa 72,68,96
tra 84,9,8192
tra 86,9,10240
mfa 76,68,100
s_add_u32 m0, s29, 115712
s_nop 0
buffer_load_dwordx4 v7, s[56:59], s34 offen lds
wl 6
mfa 80,72,96
tra 88,10,8192
tra 90,10,10240
mfa 84,72,100
sad 33,28,18432
buffer_load_dwordx4 a[224:227], v20, s[16:19], s33 offen sc1
wl 6
mfa 88,76,96
tra 92,11,8192
tra 94,11,10240
mfa 92,76,100
sad 33,28,38912
buffer_load_dwordx4 a[228:231], v20, s[16:19], s33 offen sc1
wl 6
mfa 96,80,96
tra 64,8,16384
tra 66,8,18432
mfa 100,80,100
sad 33,28,19456
buffer_load_dwordx4 a[232:235], v20, s[16:19], s33 offen sc1
wl 6
mfa 104,84,96
tra 68,9,16384
tra 70,9,18432
mfa 108,84,100
sad 33,28,39936
buffer_load_dwordx4 a[236:239], v20, s[16:19], s33 offen sc1
wl 6
mfa 112,88,96
tra 72,10,16384
tra 74,10,18432
mfa 116,88,100
wl 6
mfa 120,92,96
tra 76,11,16384
tra 78,11,18432
mfa 124,92,100
wl 6
mfa 128,64,96
tra 80,8,4096
tra 82,8,6144
mfa 132,64,100
wl 6
mfa 136,68,96
tra 84,9,4096
tra 86,9,6144
mfa 140,68,100
wl 6
mfa 144,72,96
tra 88,10,4096
tra 90,10,6144
mfa 148,72,100
wl 6
mfa 152,76,96
tra 92,11,4096
tra 94,11,6144
mfa 156,76,100
wv 40
wl 6
mfa 64,80,104
tra 64,8,12288
tra 66,8,14336
mfa 68,80,108
wl 6
mfa 72,84,104
tra 68,9,12288
tra 70,9,14336
mfa 76,84,108
wl 6
mfa 80,88,104
tra 72,10,12288
tra 74,10,14336
mfa 84,88,108
wl 6
mfa 88,92,104
tra 76,11,12288
tra 78,11,14336
mfa 92,92,108
wl 6
mfa 96,64,104
tra 80,8,20480
tra 82,8,22528
mfa 100,64,108
wl 6
mfa 104,68,104
tra 84,9,20480
tra 86,9,22528
mfa 108,68,108
wl 6
mfa 112,72,104
tra 88,10,20480
tra 90,10,22528
mfa 116,72,108
wl 6
mfa 120,76,104
tra 92,11,20480
tra 94,11,22528
mfa 124,76,108
s_waitcnt vmcnt(34) lgkmcnt(0)
s_barrier
v_readfirstlane_b32 s78, v18
s_mov_b32 s69, 1
s_getpc_b64 s[50:51]
L_c_191:
s_add_u32 s50, s50, L_sched-L_c_191
s_addc_u32 s51, s51, -1
s_swappc_b64 s[74:75], s[50:51]
mfa 128,80,104
tra 64,8,24576
tra 66,8,26624
mfa 132,80,108
s_mul_i32 s34, s60, 0
s_add_u32 s34, s34, s24
s_add_u32 m0, s29, 0
s_nop 0
buffer_load_dwordx4 v6, s[8:11], s34 offen lds
mfa 136,84,104
tra 68,9,24576
tra 70,9,26624
mfa 140,84,108
s_add_u32 m0, s29, 1024
s_nop 0
buffer_load_dwordx4 v7, s[8:11], s34 offen lds
mfa 144,88,104
tra 72,10,24576
tra 74,10,26624
mfa 148,88,108
s_mul_i32 s34, s60, 0
s_add_u32 s34, s34, s25
s_add_u32 m0, s29, 8192
s_nop 0
buffer_load_dwordx4 v6, s[52:55], s34 offen lds
mfa 152,92,104
tra 76,11,24576
tra 78,11,26624
mfa 156,92,108
s_add_u32 m0, s29, 9216
s_nop 0
buffer_load_dwordx4 v7, s[52:55], s34 offen lds
wv 36
wl 6
mfa 64,64,128
tra 80,8,32768
tra 82,8,34816
mfa 68,64,132
s_mul_i32 s34, s60, 0
s_add_u32 s34, s34, s26
s_add_u32 m0, s29, 16384
s_nop 0
buffer_load_dwordx4 v6, s[56:59], s34 offen lds
wl 6
mfa 72,68,128
tra 84,9,32768
tra 86,9,34816
mfa 76,68,132
s_add_u32 m0, s29, 17408
s_nop 0
buffer_load_dwordx4 v7, s[56:59], s34 offen lds
wl 6
mfa 80,72,128
tra 88,10,32768
tra 90,10,34816
mfa 84,72,132
sad 33,28,0
buffer_load_dwordx4 a[96:99], v20, s[16:19], s33 offen sc1
wl 6
mfa 88,76,128
tra 92,11,32768
tra 94,11,34816
mfa 92,76,132
sad 33,28,20480
buffer_load_dwordx4 a[100:103], v20, s[16:19], s33 offen sc1
wl 6
mfa 96,80,128
tra 64,8,40960
tra 66,8,43008
mfa 100,80,132
sad 33,28,40960
buffer_load_dwordx4 a[104:107], v20, s[16:19], s33 offen sc1
wl 6
mfa 104,84,128
tra 68,9,40960
tra 70,9,43008
mfa 108,84,132
sad 33,28,61440
buffer_load_dwordx4 a[108:111], v20, s[16:19], s33 offen sc1
wl 6
mfa 112,88,128
tra 72,10,40960
tra 74,10,43008
mfa 116,88,132
sad 33,28,1024
buffer_load_dwordx4 a[112:115], v20, s[16:19], s33 offen sc1
wl 6
mfa 120,92,128
tra 76,11,40960
tra 78,11,43008
mfa 124,92,132
sad 33,28,21504
buffer_load_dwordx4 a[116:119], v20, s[16:19], s33 offen sc1
wl 6
mfa 128,64,128
tra 80,8,28672
tra 82,8,30720
mfa 132,64,132
sad 33,28,41984
buffer_load_dwordx4 a[120:123], v20, s[16:19], s33 offen sc1
wl 6
mfa 136,68,128
tra 84,9,28672
tra 86,9,30720
mfa 140,68,132
sad 33,28,62464
buffer_load_dwordx4 a[124:127], v20, s[16:19], s33 offen sc1
wl 6
mfa 144,72,128
tra 88,10,28672
tra 90,10,30720
mfa 148,72,132
wl 6
mfa 152,76,128
tra 92,11,28672
tra 94,11,30720
mfa 156,76,132
wv 44
wl 6
mfa 64,80,136
tra 64,8,36864
tra 66,8,38912
mfa 68,80,140
wl 6
mfa 72,84,136
tra 68,9,36864
tra 70,9,38912
mfa 76,84,140
wl 6
mfa 80,88,136
tra 72,10,36864
tra 74,10,38912
mfa 84,88,140
wl 6
mfa 88,92,136
tra 76,11,36864
tra 78,11,38912
mfa 92,92,140
wl 6
mfa 96,64,136
tra 80,8,45056
tra 82,8,47104
mfa 100,64,140
wl 6
mfa 104,68,136
tra 84,9,45056
tra 86,9,47104
mfa 108,68,140
wl 6
mfa 112,72,136
tra 88,10,45056
tra 90,10,47104
mfa 116,72,140
wl 6
mfa 120,76,136
tra 92,11,45056
tra 94,11,47104
mfa 124,76,140
s_waitcnt vmcnt(38) lgkmcnt(0)
s_barrier
mfa 128,80,136
tra 64,8,49152
tra 66,8,51200
mfa 132,80,140
s_mul_i32 s34, s60, 1
s_add_u32 s34, s34, s24
s_add_u32 m0, s29, 24576
s_nop 0
buffer_load_dwordx4 v6, s[8:11], s34 offen lds
mfa 136,84,136
tra 68,9,49152
tra 70,9,51200
mfa 140,84,140
s_add_u32 m0, s29, 25600
s_nop 0
buffer_load_dwordx4 v7, s[8:11], s34 offen lds
mfa 144,88,136
tra 72,10,49152
tra 74,10,51200
mfa 148,88,140
s_mul_i32 s34, s60, 1
s_add_u32 s34, s34, s25
s_add_u32 m0, s29, 32768
s_nop 0
buffer_load_dwordx4 v6, s[52:55], s34 offen lds
mfa 152,92,136
tra 76,11,49152
tra 78,11,51200
mfa 156,92,140
s_add_u32 m0, s29, 33792
s_nop 0
buffer_load_dwordx4 v7, s[52:55], s34 offen lds
wv 40
wl 6
mfa 64,64,160
tra 80,8,57344
tra 82,8,59392
mfa 68,64,164
s_mul_i32 s34, s60, 1
s_add_u32 s34, s34, s26
s_add_u32 m0, s29, 40960
s_nop 0
buffer_load_dwordx4 v6, s[56:59], s34 offen lds
wl 6
mfa 72,68,160
tra 84,9,57344
tra 86,9,59392
mfa 76,68,164
s_add_u32 m0, s29, 41984
s_nop 0
buffer_load_dwordx4 v7, s[56:59], s34 offen lds
wl 6
mfa 80,72,160
tra 88,10,57344
tra 90,10,59392
mfa 84,72,164
sad 33,28,2048
buffer_load_dwordx4 a[128:131], v20, s[16:19], s33 offen sc1
wl 6
mfa 88,76,160
tra 92,11,57344
tra 94,11,59392
mfa 92,76,164
sad 33,28,22528
buffer_load_dwordx4 a[132:135], v20, s[16:19], s33 offen sc1
wl 6
mfa 96,80,160
tra 64,12,16384
tra 66,12,18432
mfa 100,80,164
sad 33,28,43008
buffer_load_dwordx4 a[136:139], v20, s[16:19], s33 offen sc1
wl 6
mfa 104,84,160
tra 68,13,16384
tra 70,13,18432
mfa 108,84,164
sad 33,28,63488
buffer_load_dwordx4 a[140:143], v20, s[16:19], s33 offen sc1
wl 6
mfa 112,88,160
tra 72,14,16384
tra 74,14,18432
mfa 116,88,164
sad 33,28,3072
buffer_load_dwordx4 a[144:147], v20, s[16:19], s33 offen sc1
wl 6
mfa 120,92,160
tra 76,15,16384
tra 78,15,18432
mfa 124,92,164
sad 33,28,23552
buffer_load_dwordx4 a[148:151], v20, s[16:19], s33 offen sc1
wl 6
mfa 128,64,160
tra 80,8,53248
tra 82,8,55296
mfa 132,64,164
sad 33,28,44032
buffer_load_dwordx4 a[152:155], v20, s[16:19], s33 offen sc1
wl 6
mfa 136,68,160
tra 84,9,53248
tra 86,9,55296
mfa 140,68,164
sad 33,28,64512
buffer_load_dwordx4 a[156:159], v20, s[16:19], s33 offen sc1
wl 6
mfa 144,72,160
tra 88,10,53248
tra 90,10,55296
mfa 148,72,164
wl 6
mfa 152,76,160
tra 92,11,53248
tra 94,11,55296
mfa 156,76,164
wv 48
wl 6
mfa 64,80,168
tra 64,8,61440
tra 66,8,63488
mfa 68,80,172
wl 6
mfa 72,84,168
tra 68,9,61440
tra 70,9,63488
mfa 76,84,172
wl 6
mfa 80,88,168
tra 72,10,61440
tra 74,10,63488
mfa 84,88,172
wl 6
mfa 88,92,168
tra 76,11,61440
tra 78,11,63488
mfa 92,92,172
wl 6
mfa 96,64,168
tra 80,12,20480
tra 82,12,22528
mfa 100,64,172
wl 6
mfa 104,68,168
tra 84,13,20480
tra 86,13,22528
mfa 108,68,172
wl 6
mfa 112,72,168
tra 88,14,20480
tra 90,14,22528
mfa 116,72,172
wl 6
mfa 120,76,168
tra 92,15,20480
tra 94,15,22528
mfa 124,76,172
s_waitcnt vmcnt(42) lgkmcnt(0)
s_barrier
mfa 128,80,168
tra 64,12,24576
tra 66,12,26624
mfa 132,80,172
s_mul_i32 s34, s60, 2
s_add_u32 s34, s34, s24
s_add_u32 m0, s29, 49152
s_nop 0
buffer_load_dwordx4 v6, s[8:11], s34 offen lds
mfa 136,84,168
tra 68,13,24576
tra 70,13,26624
mfa 140,84,172
s_add_u32 m0, s29, 50176
s_nop 0
buffer_load_dwordx4 v7, s[8:11], s34 offen lds
mfa 144,88,168
tra 72,14,24576
tra 74,14,26624
mfa 148,88,172
s_mul_i32 s34, s60, 2
s_add_u32 s34, s34, s25
s_add_u32 m0, s29, 57344
s_nop 0
buffer_load_dwordx4 v6, s[52:55], s34 offen lds
mfa 152,92,168
tra 76,15,24576
tra 78,15,26624
mfa 156,92,172
s_add_u32 m0, s29, 58368
s_nop 0
buffer_load_dwordx4 v7, s[52:55], s34 offen lds
wv 44
wl 6
mfa 64,64,192
tra 80,12,32768
tra 82,12,34816
mfa 68,64,196
s_mul_i32 s34, s60, 2
s_add_u32 s34, s34, s26
s_add_u32 m0, s29, 65536
s_nop 0
buffer_load_dwordx4 v6, s[56:59], s34 offen lds
wl 6
mfa 72,68,192
tra 84,13,32768
tra 86,13,34816
mfa 76,68,196
s_add_u32 m0, s29, 66560
s_nop 0
buffer_load_dwordx4 v7, s[56:59], s34 offen lds
wl 6
mfa 80,72,192
tra 88,14,32768
tra 90,14,34816
mfa 84,72,196
sad 33,28,4096
buffer_load_dwordx4 a[160:163], v20, s[16:19], s33 offen sc1
wl 6
mfa 88,76,192
tra 92,15,32768
tra 94,15,34816
mfa 92,76,196
sad 33,28,24576
buffer_load_dwordx4 a[164:167], v20, s[16:19], s33 offen sc1
wl 6
mfa 96,80,192
tra 64,12,40960
tra 66,12,43008
mfa 100,80,196
sad 33,28,45056
buffer_load_dwordx4 a[168:171], v20, s[16:19], s33 offen sc1
wl 6
mfa 104,84,192
tra 68,13,40960
tra 70,13,43008
mfa 108,84,196
sad 33,28,65536
buffer_load_dwordx4 a[172:175], v20, s[16:19], s33 offen sc1
wl 6
mfa 112,88,192
tra 72,14,40960
tra 74,14,43008
mfa 116,88,196
sad 33,28,5120
buffer_load_dwordx4 a[176:179], v20, s[16:19], s33 offen sc1
wl 6
mfa 120,92,192
tra 76,15,40960
tra 78,15,43008
mfa 124,92,196
sad 33,28,25600
buffer_load_dwordx4 a[180:183], v20, s[16:19], s33 offen sc1
wl 6
mfa 128,64,192
tra 80,12,28672
tra 82,12,30720
mfa 132,64,196
sad 33,28,46080
buffer_load_dwordx4 a[184:187], v20, s[16:19], s33 offen sc1
wl 6
mfa 136,68,192
tra 84,13,28672
tra 86,13,30720
mfa 140,68,196
sad 33,28,66560
buffer_load_dwordx4 a[188:191], v20, s[16:19], s33 offen sc1
wl 6
mfa 144,72,192
tra 88,14,28672
tra 90,14,30720
mfa 148,72,196
wl 6
mfa 152,76,192
tra 92,15,28672
tra 94,15,30720
mfa 156,76,196
wv 52
wl 6
mfa 64,80,200
tra 64,12,36864
tra 66,12,38912
mfa 68,80,204
wl 6
mfa 72,84,200
tra 68,13,36864
tra 70,13,38912
mfa 76,84,204
wl 6
mfa 80,88,200
tra 72,14,36864
tra 74,14,38912
mfa 84,88,204
wl 6
mfa 88,92,200
tra 76,15,36864
tra 78,15,38912
mfa 92,92,204
wl 6
mfa 96,64,200
tra 80,12,45056
tra 82,12,47104
mfa 100,64,204
wl 6
mfa 104,68,200
tra 84,13,45056
tra 86,13,47104
mfa 108,68,204
wl 6
mfa 112,72,200
tra 88,14,45056
tra 90,14,47104
mfa 116,72,204
wl 6
mfa 120,76,200
tra 92,15,45056
tra 94,15,47104
mfa 124,76,204
s_waitcnt vmcnt(46) lgkmcnt(0)
s_barrier
mfa 128,80,200
tra 64,12,49152
tra 66,12,51200
mfa 132,80,204
s_mul_i32 s34, s60, 3
s_add_u32 s34, s34, s24
s_add_u32 m0, s29, 73728
s_nop 0
buffer_load_dwordx4 v6, s[8:11], s34 offen lds
mfa 136,84,200
tra 68,13,49152
tra 70,13,51200
mfa 140,84,204
s_add_u32 m0, s29, 74752
s_nop 0
buffer_load_dwordx4 v7, s[8:11], s34 offen lds
mfa 144,88,200
tra 72,14,49152
tra 74,14,51200
mfa 148,88,204
s_mul_i32 s34, s60, 3
s_add_u32 s34, s34, s25
s_add_u32 m0, s29, 81920
s_nop 0
buffer_load_dwordx4 v6, s[52:55], s34 offen lds
mfa 152,92,200
tra 76,15,49152
tra 78,15,51200
mfa 156,92,204
s_add_u32 m0, s29, 82944
s_nop 0
buffer_load_dwordx4 v7, s[52:55], s34 offen lds
wv 48
wl 6
mfa 64,64,224
tra 80,12,57344
tra 82,12,59392
mfa 68,64,228
s_mul_i32 s34, s60, 3
s_add_u32 s34, s34, s26
s_add_u32 m0, s29, 90112
s_nop 0
buffer_load_dwordx4 v6, s[56:59], s34 offen lds
wl 6
mfa 72,68,224
tra 84,13,57344
tra 86,13,59392
mfa 76,68,228
s_add_u32 m0, s29, 91136
s_nop 0
buffer_load_dwordx4 v7, s[56:59], s34 offen lds
wl 6
mfa 80,72,224
tra 88,14,57344
tra 90,14,59392
mfa 84,72,228
sad 33,28,6144
buffer_load_dwordx4 a[192:195], v20, s[16:19], s33 offen sc1
wl 6
mfa 88,76,224
tra 92,15,57344
tra 94,15,59392
mfa 92,76,228
sad 33,28,26624
buffer_load_dwordx4 a[196:199], v20, s[16:19], s33 offen sc1
wl 6
mfa 96,80,224
tra 64,24,16384
tra 66,24,18432
mfa 100,80,228
sad 33,28,47104
buffer_load_dwordx4 a[200:203], v20, s[16:19], s33 offen sc1
wl 6
mfa 104,84,224
tra 68,25,16384
tra 70,25,18432
mfa 108,84,228
sad 33,28,67584
buffer_load_dwordx4 a[204:207], v20, s[16:19], s33 offen sc1
wl 6
mfa 112,88,224
tra 72,26,16384
tra 74,26,18432
mfa 116,88,228
sad 33,28,7168
buffer_load_dwordx4 a[208:211], v20, s[16:19], s33 offen sc1
wl 6
mfa 120,92,224
tra 76,27,16384
tra 78,27,18432
mfa 124,92,228
sad 33,28,27648
buffer_load_dwordx4 a[212:215], v20, s[16:19], s33 offen sc1
wl 6
mfa 128,64,224
tra 80,12,53248
tra 82,12,55296
mfa 132,64,228
sad 33,28,48128
buffer_load_dwordx4 a[216:219], v20, s[16:19], s33 offen sc1
wl 6
mfa 136,68,224
tra 84,13,53248
tra 86,13,55296
mfa 140,68,228
sad 33,28,68608
buffer_load_dwordx4 a[220:223], v20, s[16:19], s33 offen sc1
wl 6
mfa 144,72,224
tra 88,14,53248
tra 90,14,55296
mfa 148,72,228
wl 6
mfa 152,76,224
tra 92,15,53248
tra 94,15,55296
mfa 156,76,228
wv 56
wl 6
mfa 64,80,232
tra 64,12,61440
tra 66,12,63488
mfa 68,80,236
wl 6
mfa 72,84,232
tra 68,13,61440
tra 70,13,63488
mfa 76,84,236
wl 6
mfa 80,88,232
tra 72,14,61440
tra 74,14,63488
mfa 84,88,236
wl 6
mfa 88,92,232
tra 76,15,61440
tra 78,15,63488
mfa 92,92,236
wl 6
mfa 96,64,232
tra 80,24,20480
tra 82,24,22528
mfa 100,64,236
wl 6
mfa 104,68,232
tra 84,25,20480
tra 86,25,22528
mfa 108,68,236
wl 6
mfa 112,72,232
tra 88,26,20480
tra 90,26,22528
mfa 116,72,236
wl 6
mfa 120,76,232
tra 92,27,20480
tra 94,27,22528
mfa 124,76,236
wl 6
mfa 128,80,232
mfa 132,80,236
wl 4
mfa 136,84,232
mfa 140,84,236
wl 2
mfa 144,88,232
mfa 148,88,236
wl 0
mfa 152,92,232
mfa 156,92,236
wv 36
wv 28
s_nop 7
cvp 32,64,65
cvp 33,66,67
cvp 34,72,73
cvp 35,74,75
cvp 36,80,81
cvp 37,82,83
sad 32,61,0
buffer_store_dwordx4 v[32:35], v20, s[20:23], s32 offen sc1
sad 32,61,0
buffer_store_dwordx2 v[36:37], v21, s[20:23], s32 offen offset:1024 sc1
cvp 40,68,69
cvp 41,70,71
cvp 42,76,77
cvp 43,78,79
cvp 44,84,85
cvp 45,86,87
sad 32,62,0
buffer_store_dwordx4 v[40:43], v20, s[20:23], s32 offen sc1
sad 32,62,0
buffer_store_dwordx2 v[44:45], v21, s[20:23], s32 offen offset:1024 sc1
cvp 48,88,89
cvp 49,90,91
cvp 50,96,97
cvp 51,98,99
cvp 52,104,105
cvp 53,106,107
sad 32,61,3072
buffer_store_dwordx4 v[48:51], v20, s[20:23], s32 offen sc1
sad 32,61,3072
buffer_store_dwordx2 v[52:53], v21, s[20:23], s32 offen offset:1024 sc1
cvp 56,92,93
cvp 57,94,95
cvp 58,100,101
cvp 59,102,103
cvp 60,108,109
cvp 61,110,111
sad 32,62,3072
buffer_store_dwordx4 v[56:59], v20, s[20:23], s32 offen sc1
sad 32,62,3072
buffer_store_dwordx2 v[60:61], v21, s[20:23], s32 offen offset:1024 sc1
cvp 32,112,113
cvp 33,114,115
cvp 34,120,121
cvp 35,122,123
cvp 36,128,129
cvp 37,130,131
sad 32,61,6144
buffer_store_dwordx4 v[32:35], v20, s[20:23], s32 offen sc1
sad 32,61,6144
buffer_store_dwordx2 v[36:37], v21, s[20:23], s32 offen offset:1024 sc1
cvp 40,116,117
cvp 41,118,119
cvp 42,124,125
cvp 43,126,127
cvp 44,132,133
cvp 45,134,135
sad 32,62,6144
buffer_store_dwordx4 v[40:43], v20, s[20:23], s32 offen sc1
sad 32,62,6144
buffer_store_dwordx2 v[44:45], v21, s[20:23], s32 offen offset:1024 sc1
cvp 48,136,137
cvp 49,138,139
cvp 50,144,145
cvp 51,146,147
cvp 52,152,153
cvp 53,154,155
sad 32,61,9216
buffer_store_dwordx4 v[48:51], v20, s[20:23], s32 offen sc1
sad 32,61,9216
buffer_store_dwordx2 v[52:53], v21, s[20:23], s32 offen offset:1024 sc1
cvp 56,140,141
cvp 57,142,143
cvp 58,148,149
cvp 59,150,151
cvp 60,156,157
cvp 61,158,159
sad 32,62,9216
buffer_store_dwordx4 v[56:59], v20, s[20:23], s32 offen sc1
sad 32,62,9216
buffer_store_dwordx2 v[60:61], v21, s[20:23], s32 offen offset:1024 sc1
s_getpc_b64 s[50:51]
L_h_192:
s_add_u32 s50, s50, L_wk_done-L_h_192
s_addc_u32 s51, s51, -1
s_setpc_b64 s[50:51]
L_wk_x:
s_load_dwordx2 s[36:37], s[0:1], 104
v_lshlrev_b32 v7, 4, v1
s_mov_b32 s42, 400000
wl 0
s_load_dwordx2 s[48:49], s[0:1], 0
s_load_dwordx2 s[50:51], s[0:1], 88
wl 0
sad 12,36,226492416
s_addc_u32 s13, s37, 0
s_and_b32 s13, s13, 0xffff
s_mov_b32 s14, 20971520
s_mov_b32 s15, 0x00020000
sad 16,36,134217728
s_addc_u32 s17, s37, 0
s_and_b32 s17, s17, 0xffff
s_mov_b32 s18, 83886080
s_mov_b32 s19, 0x00020000
sad 20,36,25165824
s_addc_u32 s21, s37, 0
s_and_b32 s21, s21, 0xffff
s_mov_b32 s22, 5242880
s_mov_b32 s23, 0x00020000
s_mov_b32 s24, s48
s_and_b32 s25, s49, 0xffff
s_mov_b32 s26, 2621440
s_mov_b32 s27, 0x00020000
s_mov_b32 s28, s50
s_and_b32 s29, s51, 0xffff
s_mov_b32 s30, 2621440
s_mov_b32 s31, 0x00020000
sad 32,36,12582912
s_addc_u32 s33, s37, 0
s_and_b32 s33, s33, 0xffff
s_mov_b32 s34, 2621440
s_mov_b32 s35, 0x00020000
s_mov_b32 s8, s36
s_and_b32 s9, s37, 0xffff
s_mov_b32 s10, 8388608
s_mov_b32 s11, 0x00020000
sad 68,36,62914560
s_addc_u32 s69, s37, 0
s_and_b32 s69, s69, 0xffff
s_mov_b32 s70, 2621440
s_mov_b32 s71, 0x00020000
v_cmp_gt_u32 s[66:67], 32, v1
v_and_b32 v2, 15, v1
v_lshrrev_b32 v3, 5, v1
v_lshl_add_u32 v2, v3, 4, v2
v_mul_u32_u24 v8, 1280, v2
v_bfe_u32 v3, v1, 4, 1
v_lshl_add_u32 v8, v3, 3, v8
v_and_b32 v9, 15, v1
v_lshlrev_b32 v9, 7, v9
s_lshl_b32 s38, s4, 14
v_add_u32 v10, s38, v7
s_lshl_b32 s38, s4, 12
v_add_u32 v11, s38, v7
s_mov_b32 s81, 26624
v_min_u32 v3, 31, v1
v_mul_u32_u24 v3, 128, v3
s_mov_b32 s82, 0
L_fw_193:
buffer_load_dwordx2 v[4:5], v3, s[88:91], s81 offen sc1
wv 0
v_xor_b32 v4, s100, v4
v_xor_b32 v5, s101, v5
v_or_b32 v4, v4, v5
v_cmp_ne_u32 vcc, 0, v4
sad 82,82,1
s_cbranch_vccz L_fwd_194
s_sleep 4
s_cmp_lt_u32 s82, 400000
s_cbranch_scc1 L_fw_193
L_fwd_194:
s_mov_b32 s76, 8
s_cmp_lg_u32 s4, 0
s_cbranch_scc1 L_ti_195
s_lshl_b32 s83, s76, 2
v_mov_b32 v18, 1
v_mov_b32 v2, 0
s_mov_b64 exec, 1
buffer_atomic_add v18, v2, s[84:87], s83 offen sc0 sc1
s_mov_b64 exec, -1
L_ti_195:
L_x_next:
wv 0
v_mov_b32 v2, 155648
s_cmp_lg_u32 s4, 0
s_cbranch_scc1 L_ts_196
s_mov_b64 exec, 1
ds_write_b32 v2, v18
s_mov_b64 exec, -1
L_ts_196:
wl 0
s_barrier
ds_read_b32 v3, v2
wl 0
v_readfirstlane_b32 s78, v3
s_barrier
s_cmp_lt_u32 s78, 443
s_cbranch_scc1 L_x_go
s_endpgm
L_x_go:
s_cmp_ge_u32 s78, 343
s_cbranch_scc1 L_x_fine
s_cmp_lt_u32 s78, 275
s_cbranch_scc1 L_x_c
s_sub_u32 s78, s78, 48
s_cmp_ge_u32 s78, 275
s_cbranch_scc1 L_x_c
s_sub_u32 s53, s78, 227
s_lshr_b32 s80, s53, 3
s_lshl_b32 s80, s80, 7
sad 80,80,760
s_lshl_b32 s81, s80, 7
v_min_u32 v3, 4, v1
v_mul_u32_u24 v3, 128, v3
s_mov_b32 s82, 0
L_fw_197:
buffer_load_dwordx2 v[4:5], v3, s[88:91], s81 offen sc1
wv 0
v_xor_b32 v4, s100, v4
v_xor_b32 v5, s101, v5
v_or_b32 v4, v4, v5
v_cmp_ne_u32 vcc, 0, v4
sad 82,82,1
s_cbranch_vccz L_fwd_198
s_sleep 4
s_cmp_lt_u32 s82, 400000
s_cbranch_scc1 L_fw_197
L_fwd_198:
s_mul_i32 s80, s53, 5
sad 80,80,1920
s_lshl_b32 s81, s80, 7
v_min_u32 v3, 4, v1
v_mul_u32_u24 v3, 128, v3
s_mov_b32 s82, 0
L_fw_199:
buffer_load_dwordx2 v[4:5], v3, s[88:91], s81 offen sc1
wv 0
v_xor_b32 v4, s100, v4
v_xor_b32 v5, s101, v5
v_or_b32 v4, v4, v5
v_cmp_ne_u32 vcc, 0, v4
sad 82,82,1
s_cbranch_vccz L_fwd_200
s_sleep 4
s_cmp_lt_u32 s82, 400000
s_cbranch_scc1 L_fw_199
L_fwd_200:
s_mul_i32 s38, s53, 40960
s_lshl_b32 s39, s4, 10
s_add_u32 s38, s38, s39
s_mul_i32 s40, s53, 40960
s_lshl_b32 s41, s4, 6
sad 39,38,0
buffer_load_dwordx4 v[24:27], v7, s[68:71], s39 offen sc1
buffer_load_dwordx4 v[28:31], v7, s[32:35], s39 offen sc1
buffer_load_dwordx4 v[32:35], v7, s[24:27], s39 offen
sad 39,38,4096
buffer_load_dwordx4 v[36:39], v7, s[68:71], s39 offen sc1
buffer_load_dwordx4 v[40:43], v7, s[32:35], s39 offen sc1
buffer_load_dwordx4 v[44:47], v7, s[24:27], s39 offen
sad 39,38,8192
buffer_load_dwordx4 v[48:51], v7, s[68:71], s39 offen sc1
buffer_load_dwordx4 v[52:55], v7, s[32:35], s39 offen sc1
buffer_load_dwordx4 v[56:59], v7, s[24:27], s39 offen
sad 39,38,12288
buffer_load_dwordx4 v[60:63], v7, s[68:71], s39 offen sc1
buffer_load_dwordx4 v[64:67], v7, s[32:35], s39 offen sc1
buffer_load_dwordx4 v[68:71], v7, s[24:27], s39 offen
sad 39,38,16384
buffer_load_dwordx4 v[72:75], v7, s[68:71], s39 offen sc1
buffer_load_dwordx4 v[76:79], v7, s[32:35], s39 offen sc1
buffer_load_dwordx4 v[80:83], v7, s[24:27], s39 offen
sad 39,38,20480
buffer_load_dwordx4 v[84:87], v7, s[68:71], s39 offen sc1
buffer_load_dwordx4 v[88:91], v7, s[32:35], s39 offen sc1
buffer_load_dwordx4 v[92:95], v7, s[24:27], s39 offen
sad 39,38,24576
buffer_load_dwordx4 v[96:99], v7, s[68:71], s39 offen sc1
buffer_load_dwordx4 v[100:103], v7, s[32:35], s39 offen sc1
buffer_load_dwordx4 v[104:107], v7, s[24:27], s39 offen
sad 39,38,28672
buffer_load_dwordx4 v[108:111], v7, s[68:71], s39 offen sc1
buffer_load_dwordx4 v[112:115], v7, s[32:35], s39 offen sc1
buffer_load_dwordx4 v[116:119], v7, s[24:27], s39 offen
sad 39,38,32768
buffer_load_dwordx4 v[120:123], v7, s[68:71], s39 offen sc1
buffer_load_dwordx4 v[124:127], v7, s[32:35], s39 offen sc1
buffer_load_dwordx4 v[128:131], v7, s[24:27], s39 offen
sad 39,38,36864
buffer_load_dwordx4 v[132:135], v7, s[68:71], s39 offen sc1
buffer_load_dwordx4 v[136:139], v7, s[32:35], s39 offen sc1
buffer_load_dwordx4 v[140:143], v7, s[24:27], s39 offen
wv 27
v_lshlrev_b32 v160, 16, v24
v_and_b32 v161, 0xffff0000, v24
v_lshlrev_b32 v162, 16, v28
v_and_b32 v163, 0xffff0000, v28
v_mul_f32 v160, v160, v162
v_mul_f32 v161, v161, v163
cvp 160,160,161
v_and_b32 v161, 0xffff0000, v160
v_lshlrev_b32 v160, 16, v160
v_lshlrev_b32 v162, 16, v32
v_and_b32 v163, 0xffff0000, v32
v_add_f32 v160, v160, v162
v_add_f32 v161, v161, v163
cvp 24,160,161
v_lshlrev_b32 v160, 16, v25
v_and_b32 v161, 0xffff0000, v25
v_lshlrev_b32 v162, 16, v29
v_and_b32 v163, 0xffff0000, v29
v_mul_f32 v160, v160, v162
v_mul_f32 v161, v161, v163
cvp 160,160,161
v_and_b32 v161, 0xffff0000, v160
v_lshlrev_b32 v160, 16, v160
v_lshlrev_b32 v162, 16, v33
v_and_b32 v163, 0xffff0000, v33
v_add_f32 v160, v160, v162
v_add_f32 v161, v161, v163
cvp 25,160,161
v_lshlrev_b32 v160, 16, v26
v_and_b32 v161, 0xffff0000, v26
v_lshlrev_b32 v162, 16, v30
v_and_b32 v163, 0xffff0000, v30
v_mul_f32 v160, v160, v162
v_mul_f32 v161, v161, v163
cvp 160,160,161
v_and_b32 v161, 0xffff0000, v160
v_lshlrev_b32 v160, 16, v160
v_lshlrev_b32 v162, 16, v34
v_and_b32 v163, 0xffff0000, v34
v_add_f32 v160, v160, v162
v_add_f32 v161, v161, v163
cvp 26,160,161
v_lshlrev_b32 v160, 16, v27
v_and_b32 v161, 0xffff0000, v27
v_lshlrev_b32 v162, 16, v31
v_and_b32 v163, 0xffff0000, v31
v_mul_f32 v160, v160, v162
v_mul_f32 v161, v161, v163
cvp 160,160,161
v_and_b32 v161, 0xffff0000, v160
v_lshlrev_b32 v160, 16, v160
v_lshlrev_b32 v162, 16, v35
v_and_b32 v163, 0xffff0000, v35
v_add_f32 v160, v160, v162
v_add_f32 v161, v161, v163
cvp 27,160,161
sad 39,38,0
buffer_store_dwordx4 v[24:27], v7, s[28:31], s39 offen
wv 25
v_lshlrev_b32 v160, 16, v36
v_and_b32 v161, 0xffff0000, v36
v_lshlrev_b32 v162, 16, v40
v_and_b32 v163, 0xffff0000, v40
v_mul_f32 v160, v160, v162
v_mul_f32 v161, v161, v163
cvp 160,160,161
v_and_b32 v161, 0xffff0000, v160
v_lshlrev_b32 v160, 16, v160
v_lshlrev_b32 v162, 16, v44
v_and_b32 v163, 0xffff0000, v44
v_add_f32 v160, v160, v162
v_add_f32 v161, v161, v163
cvp 36,160,161
v_lshlrev_b32 v160, 16, v37
v_and_b32 v161, 0xffff0000, v37
v_lshlrev_b32 v162, 16, v41
v_and_b32 v163, 0xffff0000, v41
v_mul_f32 v160, v160, v162
v_mul_f32 v161, v161, v163
cvp 160,160,161
v_and_b32 v161, 0xffff0000, v160
v_lshlrev_b32 v160, 16, v160
v_lshlrev_b32 v162, 16, v45
v_and_b32 v163, 0xffff0000, v45
v_add_f32 v160, v160, v162
v_add_f32 v161, v161, v163
cvp 37,160,161
v_lshlrev_b32 v160, 16, v38
v_and_b32 v161, 0xffff0000, v38
v_lshlrev_b32 v162, 16, v42
v_and_b32 v163, 0xffff0000, v42
v_mul_f32 v160, v160, v162
v_mul_f32 v161, v161, v163
cvp 160,160,161
v_and_b32 v161, 0xffff0000, v160
v_lshlrev_b32 v160, 16, v160
v_lshlrev_b32 v162, 16, v46
v_and_b32 v163, 0xffff0000, v46
v_add_f32 v160, v160, v162
v_add_f32 v161, v161, v163
cvp 38,160,161
v_lshlrev_b32 v160, 16, v39
v_and_b32 v161, 0xffff0000, v39
v_lshlrev_b32 v162, 16, v43
v_and_b32 v163, 0xffff0000, v43
v_mul_f32 v160, v160, v162
v_mul_f32 v161, v161, v163
cvp 160,160,161
v_and_b32 v161, 0xffff0000, v160
v_lshlrev_b32 v160, 16, v160
v_lshlrev_b32 v162, 16, v47
v_and_b32 v163, 0xffff0000, v47
v_add_f32 v160, v160, v162
v_add_f32 v161, v161, v163
cvp 39,160,161
sad 39,38,4096
buffer_store_dwordx4 v[36:39], v7, s[28:31], s39 offen
wv 23
v_lshlrev_b32 v160, 16, v48
v_and_b32 v161, 0xffff0000, v48
v_lshlrev_b32 v162, 16, v52
v_and_b32 v163, 0xffff0000, v52
v_mul_f32 v160, v160, v162
v_mul_f32 v161, v161, v163
cvp 160,160,161
v_and_b32 v161, 0xffff0000, v160
v_lshlrev_b32 v160, 16, v160
v_lshlrev_b32 v162, 16, v56
v_and_b32 v163, 0xffff0000, v56
v_add_f32 v160, v160, v162
v_add_f32 v161, v161, v163
cvp 48,160,161
v_lshlrev_b32 v160, 16, v49
v_and_b32 v161, 0xffff0000, v49
v_lshlrev_b32 v162, 16, v53
v_and_b32 v163, 0xffff0000, v53
v_mul_f32 v160, v160, v162
v_mul_f32 v161, v161, v163
cvp 160,160,161
v_and_b32 v161, 0xffff0000, v160
v_lshlrev_b32 v160, 16, v160
v_lshlrev_b32 v162, 16, v57
v_and_b32 v163, 0xffff0000, v57
v_add_f32 v160, v160, v162
v_add_f32 v161, v161, v163
cvp 49,160,161
v_lshlrev_b32 v160, 16, v50
v_and_b32 v161, 0xffff0000, v50
v_lshlrev_b32 v162, 16, v54
v_and_b32 v163, 0xffff0000, v54
v_mul_f32 v160, v160, v162
v_mul_f32 v161, v161, v163
cvp 160,160,161
v_and_b32 v161, 0xffff0000, v160
v_lshlrev_b32 v160, 16, v160
v_lshlrev_b32 v162, 16, v58
v_and_b32 v163, 0xffff0000, v58
v_add_f32 v160, v160, v162
v_add_f32 v161, v161, v163
cvp 50,160,161
v_lshlrev_b32 v160, 16, v51
v_and_b32 v161, 0xffff0000, v51
v_lshlrev_b32 v162, 16, v55
v_and_b32 v163, 0xffff0000, v55
v_mul_f32 v160, v160, v162
v_mul_f32 v161, v161, v163
cvp 160,160,161
v_and_b32 v161, 0xffff0000, v160
v_lshlrev_b32 v160, 16, v160
v_lshlrev_b32 v162, 16, v59
v_and_b32 v163, 0xffff0000, v59
v_add_f32 v160, v160, v162
v_add_f32 v161, v161, v163
cvp 51,160,161
sad 39,38,8192
buffer_store_dwordx4 v[48:51], v7, s[28:31], s39 offen
wv 21
v_lshlrev_b32 v160, 16, v60
v_and_b32 v161, 0xffff0000, v60
v_lshlrev_b32 v162, 16, v64
v_and_b32 v163, 0xffff0000, v64
v_mul_f32 v160, v160, v162
v_mul_f32 v161, v161, v163
cvp 160,160,161
v_and_b32 v161, 0xffff0000, v160
v_lshlrev_b32 v160, 16, v160
v_lshlrev_b32 v162, 16, v68
v_and_b32 v163, 0xffff0000, v68
v_add_f32 v160, v160, v162
v_add_f32 v161, v161, v163
cvp 60,160,161
v_lshlrev_b32 v160, 16, v61
v_and_b32 v161, 0xffff0000, v61
v_lshlrev_b32 v162, 16, v65
v_and_b32 v163, 0xffff0000, v65
v_mul_f32 v160, v160, v162
v_mul_f32 v161, v161, v163
cvp 160,160,161
v_and_b32 v161, 0xffff0000, v160
v_lshlrev_b32 v160, 16, v160
v_lshlrev_b32 v162, 16, v69
v_and_b32 v163, 0xffff0000, v69
v_add_f32 v160, v160, v162
v_add_f32 v161, v161, v163
cvp 61,160,161
v_lshlrev_b32 v160, 16, v62
v_and_b32 v161, 0xffff0000, v62
v_lshlrev_b32 v162, 16, v66
v_and_b32 v163, 0xffff0000, v66
v_mul_f32 v160, v160, v162
v_mul_f32 v161, v161, v163
cvp 160,160,161
v_and_b32 v161, 0xffff0000, v160
v_lshlrev_b32 v160, 16, v160
v_lshlrev_b32 v162, 16, v70
v_and_b32 v163, 0xffff0000, v70
v_add_f32 v160, v160, v162
v_add_f32 v161, v161, v163
cvp 62,160,161
v_lshlrev_b32 v160, 16, v63
v_and_b32 v161, 0xffff0000, v63
v_lshlrev_b32 v162, 16, v67
v_and_b32 v163, 0xffff0000, v67
v_mul_f32 v160, v160, v162
v_mul_f32 v161, v161, v163
cvp 160,160,161
v_and_b32 v161, 0xffff0000, v160
v_lshlrev_b32 v160, 16, v160
v_lshlrev_b32 v162, 16, v71
v_and_b32 v163, 0xffff0000, v71
v_add_f32 v160, v160, v162
v_add_f32 v161, v161, v163
cvp 63,160,161
sad 39,38,12288
buffer_store_dwordx4 v[60:63], v7, s[28:31], s39 offen
wv 19
v_lshlrev_b32 v160, 16, v72
v_and_b32 v161, 0xffff0000, v72
v_lshlrev_b32 v162, 16, v76
v_and_b32 v163, 0xffff0000, v76
v_mul_f32 v160, v160, v162
v_mul_f32 v161, v161, v163
cvp 160,160,161
v_and_b32 v161, 0xffff0000, v160
v_lshlrev_b32 v160, 16, v160
v_lshlrev_b32 v162, 16, v80
v_and_b32 v163, 0xffff0000, v80
v_add_f32 v160, v160, v162
v_add_f32 v161, v161, v163
cvp 72,160,161
v_lshlrev_b32 v160, 16, v73
v_and_b32 v161, 0xffff0000, v73
v_lshlrev_b32 v162, 16, v77
v_and_b32 v163, 0xffff0000, v77
v_mul_f32 v160, v160, v162
v_mul_f32 v161, v161, v163
cvp 160,160,161
v_and_b32 v161, 0xffff0000, v160
v_lshlrev_b32 v160, 16, v160
v_lshlrev_b32 v162, 16, v81
v_and_b32 v163, 0xffff0000, v81
v_add_f32 v160, v160, v162
v_add_f32 v161, v161, v163
cvp 73,160,161
v_lshlrev_b32 v160, 16, v74
v_and_b32 v161, 0xffff0000, v74
v_lshlrev_b32 v162, 16, v78
v_and_b32 v163, 0xffff0000, v78
v_mul_f32 v160, v160, v162
v_mul_f32 v161, v161, v163
cvp 160,160,161
v_and_b32 v161, 0xffff0000, v160
v_lshlrev_b32 v160, 16, v160
v_lshlrev_b32 v162, 16, v82
v_and_b32 v163, 0xffff0000, v82
v_add_f32 v160, v160, v162
v_add_f32 v161, v161, v163
cvp 74,160,161
v_lshlrev_b32 v160, 16, v75
v_and_b32 v161, 0xffff0000, v75
v_lshlrev_b32 v162, 16, v79
v_and_b32 v163, 0xffff0000, v79
v_mul_f32 v160, v160, v162
v_mul_f32 v161, v161, v163
cvp 160,160,161
v_and_b32 v161, 0xffff0000, v160
v_lshlrev_b32 v160, 16, v160
v_lshlrev_b32 v162, 16, v83
v_and_b32 v163, 0xffff0000, v83
v_add_f32 v160, v160, v162
v_add_f32 v161, v161, v163
cvp 75,160,161
sad 39,38,16384
buffer_store_dwordx4 v[72:75], v7, s[28:31], s39 offen
wv 17
v_lshlrev_b32 v160, 16, v84
v_and_b32 v161, 0xffff0000, v84
v_lshlrev_b32 v162, 16, v88
v_and_b32 v163, 0xffff0000, v88
v_mul_f32 v160, v160, v162
v_mul_f32 v161, v161, v163
cvp 160,160,161
v_and_b32 v161, 0xffff0000, v160
v_lshlrev_b32 v160, 16, v160
v_lshlrev_b32 v162, 16, v92
v_and_b32 v163, 0xffff0000, v92
v_add_f32 v160, v160, v162
v_add_f32 v161, v161, v163
cvp 84,160,161
v_lshlrev_b32 v160, 16, v85
v_and_b32 v161, 0xffff0000, v85
v_lshlrev_b32 v162, 16, v89
v_and_b32 v163, 0xffff0000, v89
v_mul_f32 v160, v160, v162
v_mul_f32 v161, v161, v163
cvp 160,160,161
v_and_b32 v161, 0xffff0000, v160
v_lshlrev_b32 v160, 16, v160
v_lshlrev_b32 v162, 16, v93
v_and_b32 v163, 0xffff0000, v93
v_add_f32 v160, v160, v162
v_add_f32 v161, v161, v163
cvp 85,160,161
v_lshlrev_b32 v160, 16, v86
v_and_b32 v161, 0xffff0000, v86
v_lshlrev_b32 v162, 16, v90
v_and_b32 v163, 0xffff0000, v90
v_mul_f32 v160, v160, v162
v_mul_f32 v161, v161, v163
cvp 160,160,161
v_and_b32 v161, 0xffff0000, v160
v_lshlrev_b32 v160, 16, v160
v_lshlrev_b32 v162, 16, v94
v_and_b32 v163, 0xffff0000, v94
v_add_f32 v160, v160, v162
v_add_f32 v161, v161, v163
cvp 86,160,161
v_lshlrev_b32 v160, 16, v87
v_and_b32 v161, 0xffff0000, v87
v_lshlrev_b32 v162, 16, v91
v_and_b32 v163, 0xffff0000, v91
v_mul_f32 v160, v160, v162
v_mul_f32 v161, v161, v163
cvp 160,160,161
v_and_b32 v161, 0xffff0000, v160
v_lshlrev_b32 v160, 16, v160
v_lshlrev_b32 v162, 16, v95
v_and_b32 v163, 0xffff0000, v95
v_add_f32 v160, v160, v162
v_add_f32 v161, v161, v163
cvp 87,160,161
sad 39,38,20480
buffer_store_dwordx4 v[84:87], v7, s[28:31], s39 offen
wv 15
v_lshlrev_b32 v160, 16, v96
v_and_b32 v161, 0xffff0000, v96
v_lshlrev_b32 v162, 16, v100
v_and_b32 v163, 0xffff0000, v100
v_mul_f32 v160, v160, v162
v_mul_f32 v161, v161, v163
cvp 160,160,161
v_and_b32 v161, 0xffff0000, v160
v_lshlrev_b32 v160, 16, v160
v_lshlrev_b32 v162, 16, v104
v_and_b32 v163, 0xffff0000, v104
v_add_f32 v160, v160, v162
v_add_f32 v161, v161, v163
cvp 96,160,161
v_lshlrev_b32 v160, 16, v97
v_and_b32 v161, 0xffff0000, v97
v_lshlrev_b32 v162, 16, v101
v_and_b32 v163, 0xffff0000, v101
v_mul_f32 v160, v160, v162
v_mul_f32 v161, v161, v163
cvp 160,160,161
v_and_b32 v161, 0xffff0000, v160
v_lshlrev_b32 v160, 16, v160
v_lshlrev_b32 v162, 16, v105
v_and_b32 v163, 0xffff0000, v105
v_add_f32 v160, v160, v162
v_add_f32 v161, v161, v163
cvp 97,160,161
v_lshlrev_b32 v160, 16, v98
v_and_b32 v161, 0xffff0000, v98
v_lshlrev_b32 v162, 16, v102
v_and_b32 v163, 0xffff0000, v102
v_mul_f32 v160, v160, v162
v_mul_f32 v161, v161, v163
cvp 160,160,161
v_and_b32 v161, 0xffff0000, v160
v_lshlrev_b32 v160, 16, v160
v_lshlrev_b32 v162, 16, v106
v_and_b32 v163, 0xffff0000, v106
v_add_f32 v160, v160, v162
v_add_f32 v161, v161, v163
cvp 98,160,161
v_lshlrev_b32 v160, 16, v99
v_and_b32 v161, 0xffff0000, v99
v_lshlrev_b32 v162, 16, v103
v_and_b32 v163, 0xffff0000, v103
v_mul_f32 v160, v160, v162
v_mul_f32 v161, v161, v163
cvp 160,160,161
v_and_b32 v161, 0xffff0000, v160
v_lshlrev_b32 v160, 16, v160
v_lshlrev_b32 v162, 16, v107
v_and_b32 v163, 0xffff0000, v107
v_add_f32 v160, v160, v162
v_add_f32 v161, v161, v163
cvp 99,160,161
sad 39,38,24576
buffer_store_dwordx4 v[96:99], v7, s[28:31], s39 offen
wv 13
v_lshlrev_b32 v160, 16, v108
v_and_b32 v161, 0xffff0000, v108
v_lshlrev_b32 v162, 16, v112
v_and_b32 v163, 0xffff0000, v112
v_mul_f32 v160, v160, v162
v_mul_f32 v161, v161, v163
cvp 160,160,161
v_and_b32 v161, 0xffff0000, v160
v_lshlrev_b32 v160, 16, v160
v_lshlrev_b32 v162, 16, v116
v_and_b32 v163, 0xffff0000, v116
v_add_f32 v160, v160, v162
v_add_f32 v161, v161, v163
cvp 108,160,161
v_lshlrev_b32 v160, 16, v109
v_and_b32 v161, 0xffff0000, v109
v_lshlrev_b32 v162, 16, v113
v_and_b32 v163, 0xffff0000, v113
v_mul_f32 v160, v160, v162
v_mul_f32 v161, v161, v163
cvp 160,160,161
v_and_b32 v161, 0xffff0000, v160
v_lshlrev_b32 v160, 16, v160
v_lshlrev_b32 v162, 16, v117
v_and_b32 v163, 0xffff0000, v117
v_add_f32 v160, v160, v162
v_add_f32 v161, v161, v163
cvp 109,160,161
v_lshlrev_b32 v160, 16, v110
v_and_b32 v161, 0xffff0000, v110
v_lshlrev_b32 v162, 16, v114
v_and_b32 v163, 0xffff0000, v114
v_mul_f32 v160, v160, v162
v_mul_f32 v161, v161, v163
cvp 160,160,161
v_and_b32 v161, 0xffff0000, v160
v_lshlrev_b32 v160, 16, v160
v_lshlrev_b32 v162, 16, v118
v_and_b32 v163, 0xffff0000, v118
v_add_f32 v160, v160, v162
v_add_f32 v161, v161, v163
cvp 110,160,161
v_lshlrev_b32 v160, 16, v111
v_and_b32 v161, 0xffff0000, v111
v_lshlrev_b32 v162, 16, v115
v_and_b32 v163, 0xffff0000, v115
v_mul_f32 v160, v160, v162
v_mul_f32 v161, v161, v163
cvp 160,160,161
v_and_b32 v161, 0xffff0000, v160
v_lshlrev_b32 v160, 16, v160
v_lshlrev_b32 v162, 16, v119
v_and_b32 v163, 0xffff0000, v119
v_add_f32 v160, v160, v162
v_add_f32 v161, v161, v163
cvp 111,160,161
sad 39,38,28672
buffer_store_dwordx4 v[108:111], v7, s[28:31], s39 offen
wv 11
v_lshlrev_b32 v160, 16, v120
v_and_b32 v161, 0xffff0000, v120
v_lshlrev_b32 v162, 16, v124
v_and_b32 v163, 0xffff0000, v124
v_mul_f32 v160, v160, v162
v_mul_f32 v161, v161, v163
cvp 160,160,161
v_and_b32 v161, 0xffff0000, v160
v_lshlrev_b32 v160, 16, v160
v_lshlrev_b32 v162, 16, v128
v_and_b32 v163, 0xffff0000, v128
v_add_f32 v160, v160, v162
v_add_f32 v161, v161, v163
cvp 120,160,161
v_lshlrev_b32 v160, 16, v121
v_and_b32 v161, 0xffff0000, v121
v_lshlrev_b32 v162, 16, v125
v_and_b32 v163, 0xffff0000, v125
v_mul_f32 v160, v160, v162
v_mul_f32 v161, v161, v163
cvp 160,160,161
v_and_b32 v161, 0xffff0000, v160
v_lshlrev_b32 v160, 16, v160
v_lshlrev_b32 v162, 16, v129
v_and_b32 v163, 0xffff0000, v129
v_add_f32 v160, v160, v162
v_add_f32 v161, v161, v163
cvp 121,160,161
v_lshlrev_b32 v160, 16, v122
v_and_b32 v161, 0xffff0000, v122
v_lshlrev_b32 v162, 16, v126
v_and_b32 v163, 0xffff0000, v126
v_mul_f32 v160, v160, v162
v_mul_f32 v161, v161, v163
cvp 160,160,161
v_and_b32 v161, 0xffff0000, v160
v_lshlrev_b32 v160, 16, v160
v_lshlrev_b32 v162, 16, v130
v_and_b32 v163, 0xffff0000, v130
v_add_f32 v160, v160, v162
v_add_f32 v161, v161, v163
cvp 122,160,161
v_lshlrev_b32 v160, 16, v123
v_and_b32 v161, 0xffff0000, v123
v_lshlrev_b32 v162, 16, v127
v_and_b32 v163, 0xffff0000, v127
v_mul_f32 v160, v160, v162
v_mul_f32 v161, v161, v163
cvp 160,160,161
v_and_b32 v161, 0xffff0000, v160
v_lshlrev_b32 v160, 16, v160
v_lshlrev_b32 v162, 16, v131
v_and_b32 v163, 0xffff0000, v131
v_add_f32 v160, v160, v162
v_add_f32 v161, v161, v163
cvp 123,160,161
sad 39,38,32768
buffer_store_dwordx4 v[120:123], v7, s[28:31], s39 offen
wv 9
v_lshlrev_b32 v160, 16, v132
v_and_b32 v161, 0xffff0000, v132
v_lshlrev_b32 v162, 16, v136
v_and_b32 v163, 0xffff0000, v136
v_mul_f32 v160, v160, v162
v_mul_f32 v161, v161, v163
cvp 160,160,161
v_and_b32 v161, 0xffff0000, v160
v_lshlrev_b32 v160, 16, v160
v_lshlrev_b32 v162, 16, v140
v_and_b32 v163, 0xffff0000, v140
v_add_f32 v160, v160, v162
v_add_f32 v161, v161, v163
cvp 132,160,161
v_lshlrev_b32 v160, 16, v133
v_and_b32 v161, 0xffff0000, v133
v_lshlrev_b32 v162, 16, v137
v_and_b32 v163, 0xffff0000, v137
v_mul_f32 v160, v160, v162
v_mul_f32 v161, v161, v163
cvp 160,160,161
v_and_b32 v161, 0xffff0000, v160
v_lshlrev_b32 v160, 16, v160
v_lshlrev_b32 v162, 16, v141
v_and_b32 v163, 0xffff0000, v141
v_add_f32 v160, v160, v162
v_add_f32 v161, v161, v163
cvp 133,160,161
v_lshlrev_b32 v160, 16, v134
v_and_b32 v161, 0xffff0000, v134
v_lshlrev_b32 v162, 16, v138
v_and_b32 v163, 0xffff0000, v138
v_mul_f32 v160, v160, v162
v_mul_f32 v161, v161, v163
cvp 160,160,161
v_and_b32 v161, 0xffff0000, v160
v_lshlrev_b32 v160, 16, v160
v_lshlrev_b32 v162, 16, v142
v_and_b32 v163, 0xffff0000, v142
v_add_f32 v160, v160, v162
v_add_f32 v161, v161, v163
cvp 134,160,161
v_lshlrev_b32 v160, 16, v135
v_and_b32 v161, 0xffff0000, v135
v_lshlrev_b32 v162, 16, v139
v_and_b32 v163, 0xffff0000, v139
v_mul_f32 v160, v160, v162
v_mul_f32 v161, v161, v163
cvp 160,160,161
v_and_b32 v161, 0xffff0000, v160
v_lshlrev_b32 v160, 16, v160
v_lshlrev_b32 v162, 16, v143
v_and_b32 v163, 0xffff0000, v143
v_add_f32 v160, v160, v162
v_add_f32 v161, v161, v163
cvp 135,160,161
sad 39,38,36864
buffer_store_dwordx4 v[132:135], v7, s[28:31], s39 offen
s_cmp_lg_u32 s4, 0
s_cbranch_scc1 L_ti_201
s_lshl_b32 s83, s76, 2
v_mov_b32 v18, 1
v_mov_b32 v2, 0
s_mov_b64 exec, 1
buffer_atomic_add v18, v2, s[84:87], s83 offen sc0 sc1
s_mov_b64 exec, -1
L_ti_201:
s_branch L_x_next
L_x_c:
s_mul_hi_u32 s53, s78, 858993460
s_mul_i32 s54, s53, 5
s_sub_u32 s54, s78, s54
s_cmp_lt_u32 s53, 48
s_cselect_b32 s72, 1, 0
s_cbranch_scc1 L_x_ng
s_lshr_b32 s80, s53, 3
s_lshl_b32 s80, s80, 7
s_add_u32 s80, s80, s54
sad 80,80,760
s_lshl_b32 s81, s80, 7
v_min_u32 v3, 0, v1
v_mul_u32_u24 v3, 128, v3
s_mov_b32 s82, 0
L_fw_202:
buffer_load_dwordx2 v[4:5], v3, s[88:91], s81 offen sc1
wv 0
v_xor_b32 v4, s100, v4
v_xor_b32 v5, s101, v5
v_or_b32 v4, v4, v5
v_cmp_ne_u32 vcc, 0, v4
sad 82,82,1
s_cbranch_vccz L_fwd_203
s_sleep 4
s_cmp_lt_u32 s82, 400000
s_cbranch_scc1 L_fw_202
L_fwd_203:
L_x_ng:
s_mul_i32 s58, s53, 40960
s_lshl_b32 s38, s54, 8
s_add_u32 s58, s58, s38
s_lshl_b32 s38, s4, 6
s_add_u32 s58, s58, s38
s_mul_i32 s56, s53, 1310720
s_lshl_b32 s38, s54, 18
s_add_u32 s56, s56, s38
s_lshl_b32 s38, s4, 12
s_add_u32 s56, s56, s38
s_mul_i32 s57, s53, 327680
s_lshl_b32 s38, s54, 16
s_add_u32 s57, s57, s38
s_lshl_b32 s38, s4, 10
s_add_u32 s57, s57, s38
s_cmp_ge_u32 s53, 62
s_cbranch_scc1 L_xfin_206
sad 41,53,2
s_lshl_b32 s41, s41, 17
sad 41,41,102400
s_mov_b32 s43, 0
v_mov_b32 v3, 0
L_xf_204:
buffer_load_dword v2, v3, s[8:11], s41 offen sc1
wv 0
v_cmp_eq_u32 vcc, -1, v2
sad 43,43,1
s_cbranch_vccz L_xfd_205
s_sleep 8
s_cmp_lt_u32 s43, s42
s_cbranch_scc1 L_xf_204
s_mov_b32 s42, 0
s_branch L_xfd_205
L_xfin_206:
s_lshl_b32 s38, s54, 4
s_lshl_b32 s39, s38, 7
v_min_u32 v3, 15, v1
v_mul_u32_u24 v3, 128, v3
s_mov_b32 s43, 0
L_fw_207:
buffer_load_dwordx2 v[4:5], v3, s[88:91], s39 offen sc1
wv 0
v_xor_b32 v4, s100, v4
v_xor_b32 v5, s101, v5
v_or_b32 v4, v4, v5
v_cmp_ne_u32 vcc, 0, v4
sad 43,43,1
s_cbranch_vccz L_fwd_208
s_sleep 4
s_cmp_lt_u32 s43, 400000
s_cbranch_scc1 L_fw_207
L_fwd_208:
s_mov_b32 s39, 229376
v_min_u32 v3, 31, v1
v_mul_u32_u24 v3, 128, v3
s_mov_b32 s43, 0
L_fw_209:
buffer_load_dwordx2 v[4:5], v3, s[88:91], s39 offen sc1
wv 0
v_xor_b32 v4, s100, v4
v_xor_b32 v5, s101, v5
v_or_b32 v4, v4, v5
v_cmp_ne_u32 vcc, 0, v4
sad 43,43,1
s_cbranch_vccz L_fwd_210
s_sleep 2
s_cmp_lt_u32 s43, 400000
s_cbranch_scc1 L_fw_209
L_fwd_210:
L_xfd_205:
s_mul_i32 s40, s53, 81920
s_mul_i32 s38, s4, 20480
s_add_u32 s40, s40, s38
sad 41,40,0
buffer_load_dwordx4 v[24:27], v7, s[20:23], s41 offen offset:0 sc1
buffer_load_dwordx4 v[28:31], v7, s[20:23], s41 offen offset:1024 sc1
buffer_load_dwordx4 v[32:35], v7, s[20:23], s41 offen offset:2048 sc1
buffer_load_dwordx4 v[36:39], v7, s[20:23], s41 offen offset:3072 sc1
sad 41,40,4096
buffer_load_dwordx4 v[40:43], v7, s[20:23], s41 offen offset:0 sc1
buffer_load_dwordx4 v[44:47], v7, s[20:23], s41 offen offset:1024 sc1
buffer_load_dwordx4 v[48:51], v7, s[20:23], s41 offen offset:2048 sc1
buffer_load_dwordx4 v[52:55], v7, s[20:23], s41 offen offset:3072 sc1
sad 41,40,8192
buffer_load_dwordx4 v[56:59], v7, s[20:23], s41 offen offset:0 sc1
buffer_load_dwordx4 v[60:63], v7, s[20:23], s41 offen offset:1024 sc1
buffer_load_dwordx4 v[64:67], v7, s[20:23], s41 offen offset:2048 sc1
buffer_load_dwordx4 v[68:71], v7, s[20:23], s41 offen offset:3072 sc1
sad 41,40,12288
buffer_load_dwordx4 v[72:75], v7, s[20:23], s41 offen offset:0 sc1
buffer_load_dwordx4 v[76:79], v7, s[20:23], s41 offen offset:1024 sc1
buffer_load_dwordx4 v[80:83], v7, s[20:23], s41 offen offset:2048 sc1
buffer_load_dwordx4 v[84:87], v7, s[20:23], s41 offen offset:3072 sc1
sad 41,40,16384
buffer_load_dwordx4 v[88:91], v7, s[20:23], s41 offen offset:0 sc1
buffer_load_dwordx4 v[92:95], v7, s[20:23], s41 offen offset:1024 sc1
buffer_load_dwordx4 v[96:99], v7, s[20:23], s41 offen offset:2048 sc1
buffer_load_dwordx4 v[100:103], v7, s[20:23], s41 offen offset:3072 sc1
sad 38,57,0
sad 39,56,0
buffer_load_dwordx4 a[0:3], v7, s[12:15], s38 offen sc1
buffer_load_dwordx4 a[4:7], v7, s[16:19], s39 offen offset:0 sc1
buffer_load_dwordx4 a[8:11], v7, s[16:19], s39 offen offset:1024 sc1
buffer_load_dwordx4 a[12:15], v7, s[16:19], s39 offen offset:2048 sc1
buffer_load_dwordx4 a[16:19], v7, s[16:19], s39 offen offset:3072 sc1
sad 38,57,4096
sad 39,56,16384
buffer_load_dwordx4 a[20:23], v7, s[12:15], s38 offen sc1
buffer_load_dwordx4 a[24:27], v7, s[16:19], s39 offen offset:0 sc1
buffer_load_dwordx4 a[28:31], v7, s[16:19], s39 offen offset:1024 sc1
buffer_load_dwordx4 a[32:35], v7, s[16:19], s39 offen offset:2048 sc1
buffer_load_dwordx4 a[36:39], v7, s[16:19], s39 offen offset:3072 sc1
sad 38,57,8192
sad 39,56,32768
buffer_load_dwordx4 a[40:43], v7, s[12:15], s38 offen sc1
buffer_load_dwordx4 a[44:47], v7, s[16:19], s39 offen offset:0 sc1
buffer_load_dwordx4 a[48:51], v7, s[16:19], s39 offen offset:1024 sc1
buffer_load_dwordx4 a[52:55], v7, s[16:19], s39 offen offset:2048 sc1
buffer_load_dwordx4 a[56:59], v7, s[16:19], s39 offen offset:3072 sc1
sad 38,57,12288
sad 39,56,49152
buffer_load_dwordx4 a[60:63], v7, s[12:15], s38 offen sc1
buffer_load_dwordx4 a[64:67], v7, s[16:19], s39 offen offset:0 sc1
buffer_load_dwordx4 a[68:71], v7, s[16:19], s39 offen offset:1024 sc1
buffer_load_dwordx4 a[72:75], v7, s[16:19], s39 offen offset:2048 sc1
buffer_load_dwordx4 a[76:79], v7, s[16:19], s39 offen offset:3072 sc1
buffer_load_dwordx2 v[208:209], v8, s[24:27], s58 offen offset:0
buffer_load_dwordx2 v[210:211], v8, s[32:35], s58 offen offset:0 sc1
buffer_load_dwordx2 v[212:213], v8, s[24:27], s58 offen offset:16
buffer_load_dwordx2 v[214:215], v8, s[32:35], s58 offen offset:16 sc1
buffer_load_dwordx2 v[216:217], v8, s[24:27], s58 offen offset:32
buffer_load_dwordx2 v[218:219], v8, s[32:35], s58 offen offset:32 sc1
buffer_load_dwordx2 v[220:221], v8, s[24:27], s58 offen offset:48
buffer_load_dwordx2 v[222:223], v8, s[32:35], s58 offen offset:48 sc1
wv 23
v_mfma_f32_16x16x32_bf16 v[184:187], a[0:3], v[24:27], 0
v_mfma_f32_16x16x32_bf16 v[188:191], a[0:3], v[28:31], 0
v_mfma_f32_16x16x32_bf16 v[192:195], a[0:3], v[32:35], 0
v_mfma_f32_16x16x32_bf16 v[196:199], a[0:3], v[36:39], 0
v_mfma_f32_16x16x32_bf16 v[184:187], a[4:7], v[40:43], v[184:187]
v_mfma_f32_16x16x32_bf16 v[188:191], a[4:7], v[44:47], v[188:191]
v_mfma_f32_16x16x32_bf16 v[192:195], a[4:7], v[48:51], v[192:195]
v_mfma_f32_16x16x32_bf16 v[196:199], a[4:7], v[52:55], v[196:199]
v_mfma_f32_16x16x32_bf16 v[184:187], a[8:11], v[56:59], v[184:187]
v_mfma_f32_16x16x32_bf16 v[188:191], a[8:11], v[60:63], v[188:191]
v_mfma_f32_16x16x32_bf16 v[192:195], a[8:11], v[64:67], v[192:195]
v_mfma_f32_16x16x32_bf16 v[196:199], a[8:11], v[68:71], v[196:199]
v_mfma_f32_16x16x32_bf16 v[184:187], a[12:15], v[72:75], v[184:187]
v_mfma_f32_16x16x32_bf16 v[188:191], a[12:15], v[76:79], v[188:191]
v_mfma_f32_16x16x32_bf16 v[192:195], a[12:15], v[80:83], v[192:195]
v_mfma_f32_16x16x32_bf16 v[196:199], a[12:15], v[84:87], v[196:199]
v_mfma_f32_16x16x32_bf16 v[184:187], a[16:19], v[88:91], v[184:187]
v_mfma_f32_16x16x32_bf16 v[188:191], a[16:19], v[92:95], v[188:191]
v_mfma_f32_16x16x32_bf16 v[192:195], a[16:19], v[96:99], v[192:195]
v_mfma_f32_16x16x32_bf16 v[196:199], a[16:19], v[100:103], v[196:199]
sad 38,57,16384
sad 39,56,65536
buffer_load_dwordx4 a[80:83], v7, s[12:15], s38 offen sc1
buffer_load_dwordx4 a[84:87], v7, s[16:19], s39 offen offset:0 sc1
buffer_load_dwordx4 a[88:91], v7, s[16:19], s39 offen offset:1024 sc1
buffer_load_dwordx4 a[92:95], v7, s[16:19], s39 offen offset:2048 sc1
buffer_load_dwordx4 a[96:99], v7, s[16:19], s39 offen offset:3072 sc1
s_nop 7
v_cndmask_b32 v200, v192, v184, s[66:67]
v_cndmask_b32 v201, v193, v185, s[66:67]
v_cndmask_b32 v202, v194, v186, s[66:67]
v_cndmask_b32 v203, v195, v187, s[66:67]
v_cndmask_b32 v204, v196, v188, s[66:67]
v_cndmask_b32 v205, v197, v189, s[66:67]
v_cndmask_b32 v206, v198, v190, s[66:67]
v_cndmask_b32 v207, v199, v191, s[66:67]
s_nop 0
v_permlane32_swap_b32 v200, v204
v_permlane32_swap_b32 v201, v205
v_permlane32_swap_b32 v202, v206
v_permlane32_swap_b32 v203, v207
s_nop 0
v_add_f32 v200, v200, v204
v_add_f32 v201, v201, v205
v_add_f32 v202, v202, v206
v_add_f32 v203, v203, v207
ds_write_b128 v10, v[200:203] offset:0
wv 23
v_mfma_f32_16x16x32_bf16 v[184:187], a[20:23], v[24:27], 0
v_mfma_f32_16x16x32_bf16 v[188:191], a[20:23], v[28:31], 0
v_mfma_f32_16x16x32_bf16 v[192:195], a[20:23], v[32:35], 0
v_mfma_f32_16x16x32_bf16 v[196:199], a[20:23], v[36:39], 0
v_mfma_f32_16x16x32_bf16 v[184:187], a[24:27], v[40:43], v[184:187]
v_mfma_f32_16x16x32_bf16 v[188:191], a[24:27], v[44:47], v[188:191]
v_mfma_f32_16x16x32_bf16 v[192:195], a[24:27], v[48:51], v[192:195]
v_mfma_f32_16x16x32_bf16 v[196:199], a[24:27], v[52:55], v[196:199]
v_mfma_f32_16x16x32_bf16 v[184:187], a[28:31], v[56:59], v[184:187]
v_mfma_f32_16x16x32_bf16 v[188:191], a[28:31], v[60:63], v[188:191]
v_mfma_f32_16x16x32_bf16 v[192:195], a[28:31], v[64:67], v[192:195]
v_mfma_f32_16x16x32_bf16 v[196:199], a[28:31], v[68:71], v[196:199]
v_mfma_f32_16x16x32_bf16 v[184:187], a[32:35], v[72:75], v[184:187]
v_mfma_f32_16x16x32_bf16 v[188:191], a[32:35], v[76:79], v[188:191]
v_mfma_f32_16x16x32_bf16 v[192:195], a[32:35], v[80:83], v[192:195]
v_mfma_f32_16x16x32_bf16 v[196:199], a[32:35], v[84:87], v[196:199]
v_mfma_f32_16x16x32_bf16 v[184:187], a[36:39], v[88:91], v[184:187]
v_mfma_f32_16x16x32_bf16 v[188:191], a[36:39], v[92:95], v[188:191]
v_mfma_f32_16x16x32_bf16 v[192:195], a[36:39], v[96:99], v[192:195]
v_mfma_f32_16x16x32_bf16 v[196:199], a[36:39], v[100:103], v[196:199]
sad 38,57,20480
sad 39,56,81920
buffer_load_dwordx4 a[100:103], v7, s[12:15], s38 offen sc1
buffer_load_dwordx4 a[104:107], v7, s[16:19], s39 offen offset:0 sc1
buffer_load_dwordx4 a[108:111], v7, s[16:19], s39 offen offset:1024 sc1
buffer_load_dwordx4 a[112:115], v7, s[16:19], s39 offen offset:2048 sc1
buffer_load_dwordx4 a[116:119], v7, s[16:19], s39 offen offset:3072 sc1
s_nop 7
v_cndmask_b32 v200, v192, v184, s[66:67]
v_cndmask_b32 v201, v193, v185, s[66:67]
v_cndmask_b32 v202, v194, v186, s[66:67]
v_cndmask_b32 v203, v195, v187, s[66:67]
v_cndmask_b32 v204, v196, v188, s[66:67]
v_cndmask_b32 v205, v197, v189, s[66:67]
v_cndmask_b32 v206, v198, v190, s[66:67]
v_cndmask_b32 v207, v199, v191, s[66:67]
s_nop 0
v_permlane32_swap_b32 v200, v204
v_permlane32_swap_b32 v201, v205
v_permlane32_swap_b32 v202, v206
v_permlane32_swap_b32 v203, v207
s_nop 0
v_add_f32 v200, v200, v204
v_add_f32 v201, v201, v205
v_add_f32 v202, v202, v206
v_add_f32 v203, v203, v207
ds_write_b128 v10, v[200:203] offset:1024
wv 23
v_mfma_f32_16x16x32_bf16 v[184:187], a[40:43], v[24:27], 0
v_mfma_f32_16x16x32_bf16 v[188:191], a[40:43], v[28:31], 0
v_mfma_f32_16x16x32_bf16 v[192:195], a[40:43], v[32:35], 0
v_mfma_f32_16x16x32_bf16 v[196:199], a[40:43], v[36:39], 0
v_mfma_f32_16x16x32_bf16 v[184:187], a[44:47], v[40:43], v[184:187]
v_mfma_f32_16x16x32_bf16 v[188:191], a[44:47], v[44:47], v[188:191]
v_mfma_f32_16x16x32_bf16 v[192:195], a[44:47], v[48:51], v[192:195]
v_mfma_f32_16x16x32_bf16 v[196:199], a[44:47], v[52:55], v[196:199]
v_mfma_f32_16x16x32_bf16 v[184:187], a[48:51], v[56:59], v[184:187]
v_mfma_f32_16x16x32_bf16 v[188:191], a[48:51], v[60:63], v[188:191]
v_mfma_f32_16x16x32_bf16 v[192:195], a[48:51], v[64:67], v[192:195]
v_mfma_f32_16x16x32_bf16 v[196:199], a[48:51], v[68:71], v[196:199]
v_mfma_f32_16x16x32_bf16 v[184:187], a[52:55], v[72:75], v[184:187]
v_mfma_f32_16x16x32_bf16 v[188:191], a[52:55], v[76:79], v[188:191]
v_mfma_f32_16x16x32_bf16 v[192:195], a[52:55], v[80:83], v[192:195]
v_mfma_f32_16x16x32_bf16 v[196:199], a[52:55], v[84:87], v[196:199]
v_mfma_f32_16x16x32_bf16 v[184:187], a[56:59], v[88:91], v[184:187]
v_mfma_f32_16x16x32_bf16 v[188:191], a[56:59], v[92:95], v[188:191]
v_mfma_f32_16x16x32_bf16 v[192:195], a[56:59], v[96:99], v[192:195]
v_mfma_f32_16x16x32_bf16 v[196:199], a[56:59], v[100:103], v[196:199]
sad 38,57,24576
sad 39,56,98304
buffer_load_dwordx4 a[120:123], v7, s[12:15], s38 offen sc1
buffer_load_dwordx4 a[124:127], v7, s[16:19], s39 offen offset:0 sc1
buffer_load_dwordx4 a[128:131], v7, s[16:19], s39 offen offset:1024 sc1
buffer_load_dwordx4 a[132:135], v7, s[16:19], s39 offen offset:2048 sc1
buffer_load_dwordx4 a[136:139], v7, s[16:19], s39 offen offset:3072 sc1
s_nop 7
v_cndmask_b32 v200, v192, v184, s[66:67]
v_cndmask_b32 v201, v193, v185, s[66:67]
v_cndmask_b32 v202, v194, v186, s[66:67]
v_cndmask_b32 v203, v195, v187, s[66:67]
v_cndmask_b32 v204, v196, v188, s[66:67]
v_cndmask_b32 v205, v197, v189, s[66:67]
v_cndmask_b32 v206, v198, v190, s[66:67]
v_cndmask_b32 v207, v199, v191, s[66:67]
s_nop 0
v_permlane32_swap_b32 v200, v204
v_permlane32_swap_b32 v201, v205
v_permlane32_swap_b32 v202, v206
v_permlane32_swap_b32 v203, v207
s_nop 0
v_add_f32 v200, v200, v204
v_add_f32 v201, v201, v205
v_add_f32 v202, v202, v206
v_add_f32 v203, v203, v207
ds_write_b128 v10, v[200:203] offset:2048
wv 23
v_mfma_f32_16x16x32_bf16 v[184:187], a[60:63], v[24:27], 0
v_mfma_f32_16x16x32_bf16 v[188:191], a[60:63], v[28:31], 0
v_mfma_f32_16x16x32_bf16 v[192:195], a[60:63], v[32:35], 0
v_mfma_f32_16x16x32_bf16 v[196:199], a[60:63], v[36:39], 0
v_mfma_f32_16x16x32_bf16 v[184:187], a[64:67], v[40:43], v[184:187]
v_mfma_f32_16x16x32_bf16 v[188:191], a[64:67], v[44:47], v[188:191]
v_mfma_f32_16x16x32_bf16 v[192:195], a[64:67], v[48:51], v[192:195]
v_mfma_f32_16x16x32_bf16 v[196:199], a[64:67], v[52:55], v[196:199]
v_mfma_f32_16x16x32_bf16 v[184:187], a[68:71], v[56:59], v[184:187]
v_mfma_f32_16x16x32_bf16 v[188:191], a[68:71], v[60:63], v[188:191]
v_mfma_f32_16x16x32_bf16 v[192:195], a[68:71], v[64:67], v[192:195]
v_mfma_f32_16x16x32_bf16 v[196:199], a[68:71], v[68:71], v[196:199]
v_mfma_f32_16x16x32_bf16 v[184:187], a[72:75], v[72:75], v[184:187]
v_mfma_f32_16x16x32_bf16 v[188:191], a[72:75], v[76:79], v[188:191]
v_mfma_f32_16x16x32_bf16 v[192:195], a[72:75], v[80:83], v[192:195]
v_mfma_f32_16x16x32_bf16 v[196:199], a[72:75], v[84:87], v[196:199]
v_mfma_f32_16x16x32_bf16 v[184:187], a[76:79], v[88:91], v[184:187]
v_mfma_f32_16x16x32_bf16 v[188:191], a[76:79], v[92:95], v[188:191]
v_mfma_f32_16x16x32_bf16 v[192:195], a[76:79], v[96:99], v[192:195]
v_mfma_f32_16x16x32_bf16 v[196:199], a[76:79], v[100:103], v[196:199]
sad 38,57,28672
sad 39,56,114688
buffer_load_dwordx4 a[140:143], v7, s[12:15], s38 offen sc1
buffer_load_dwordx4 a[144:147], v7, s[16:19], s39 offen offset:0 sc1
buffer_load_dwordx4 a[148:151], v7, s[16:19], s39 offen offset:1024 sc1
buffer_load_dwordx4 a[152:155], v7, s[16:19], s39 offen offset:2048 sc1
buffer_load_dwordx4 a[156:159], v7, s[16:19], s39 offen offset:3072 sc1
s_nop 7
v_cndmask_b32 v200, v192, v184, s[66:67]
v_cndmask_b32 v201, v193, v185, s[66:67]
v_cndmask_b32 v202, v194, v186, s[66:67]
v_cndmask_b32 v203, v195, v187, s[66:67]
v_cndmask_b32 v204, v196, v188, s[66:67]
v_cndmask_b32 v205, v197, v189, s[66:67]
v_cndmask_b32 v206, v198, v190, s[66:67]
v_cndmask_b32 v207, v199, v191, s[66:67]
s_nop 0
v_permlane32_swap_b32 v200, v204
v_permlane32_swap_b32 v201, v205
v_permlane32_swap_b32 v202, v206
v_permlane32_swap_b32 v203, v207
s_nop 0
v_add_f32 v200, v200, v204
v_add_f32 v201, v201, v205
v_add_f32 v202, v202, v206
v_add_f32 v203, v203, v207
ds_write_b128 v10, v[200:203] offset:3072
wv 15
v_mfma_f32_16x16x32_bf16 v[184:187], a[80:83], v[24:27], 0
v_mfma_f32_16x16x32_bf16 v[188:191], a[80:83], v[28:31], 0
v_mfma_f32_16x16x32_bf16 v[192:195], a[80:83], v[32:35], 0
v_mfma_f32_16x16x32_bf16 v[196:199], a[80:83], v[36:39], 0
v_mfma_f32_16x16x32_bf16 v[184:187], a[84:87], v[40:43], v[184:187]
v_mfma_f32_16x16x32_bf16 v[188:191], a[84:87], v[44:47], v[188:191]
v_mfma_f32_16x16x32_bf16 v[192:195], a[84:87], v[48:51], v[192:195]
v_mfma_f32_16x16x32_bf16 v[196:199], a[84:87], v[52:55], v[196:199]
v_mfma_f32_16x16x32_bf16 v[184:187], a[88:91], v[56:59], v[184:187]
v_mfma_f32_16x16x32_bf16 v[188:191], a[88:91], v[60:63], v[188:191]
v_mfma_f32_16x16x32_bf16 v[192:195], a[88:91], v[64:67], v[192:195]
v_mfma_f32_16x16x32_bf16 v[196:199], a[88:91], v[68:71], v[196:199]
v_mfma_f32_16x16x32_bf16 v[184:187], a[92:95], v[72:75], v[184:187]
v_mfma_f32_16x16x32_bf16 v[188:191], a[92:95], v[76:79], v[188:191]
v_mfma_f32_16x16x32_bf16 v[192:195], a[92:95], v[80:83], v[192:195]
v_mfma_f32_16x16x32_bf16 v[196:199], a[92:95], v[84:87], v[196:199]
v_mfma_f32_16x16x32_bf16 v[184:187], a[96:99], v[88:91], v[184:187]
v_mfma_f32_16x16x32_bf16 v[188:191], a[96:99], v[92:95], v[188:191]
v_mfma_f32_16x16x32_bf16 v[192:195], a[96:99], v[96:99], v[192:195]
v_mfma_f32_16x16x32_bf16 v[196:199], a[96:99], v[100:103], v[196:199]
sad 38,57,32768
sad 39,56,131072
buffer_load_dwordx4 a[160:163], v7, s[12:15], s38 offen sc1
buffer_load_dwordx4 a[164:167], v7, s[16:19], s39 offen offset:0 sc1
buffer_load_dwordx4 a[168:171], v7, s[16:19], s39 offen offset:1024 sc1
buffer_load_dwordx4 a[172:175], v7, s[16:19], s39 offen offset:2048 sc1
buffer_load_dwordx4 a[176:179], v7, s[16:19], s39 offen offset:3072 sc1
s_nop 7
v_cndmask_b32 v200, v192, v184, s[66:67]
v_cndmask_b32 v201, v193, v185, s[66:67]
v_cndmask_b32 v202, v194, v186, s[66:67]
v_cndmask_b32 v203, v195, v187, s[66:67]
v_cndmask_b32 v204, v196, v188, s[66:67]
v_cndmask_b32 v205, v197, v189, s[66:67]
v_cndmask_b32 v206, v198, v190, s[66:67]
v_cndmask_b32 v207, v199, v191, s[66:67]
s_nop 0
v_permlane32_swap_b32 v200, v204
v_permlane32_swap_b32 v201, v205
v_permlane32_swap_b32 v202, v206
v_permlane32_swap_b32 v203, v207
s_nop 0
v_add_f32 v200, v200, v204
v_add_f32 v201, v201, v205
v_add_f32 v202, v202, v206
v_add_f32 v203, v203, v207
ds_write_b128 v10, v[200:203] offset:4096
wv 15
v_mfma_f32_16x16x32_bf16 v[184:187], a[100:103], v[24:27], 0
v_mfma_f32_16x16x32_bf16 v[188:191], a[100:103], v[28:31], 0
v_mfma_f32_16x16x32_bf16 v[192:195], a[100:103], v[32:35], 0
v_mfma_f32_16x16x32_bf16 v[196:199], a[100:103], v[36:39], 0
v_mfma_f32_16x16x32_bf16 v[184:187], a[104:107], v[40:43], v[184:187]
v_mfma_f32_16x16x32_bf16 v[188:191], a[104:107], v[44:47], v[188:191]
v_mfma_f32_16x16x32_bf16 v[192:195], a[104:107], v[48:51], v[192:195]
v_mfma_f32_16x16x32_bf16 v[196:199], a[104:107], v[52:55], v[196:199]
v_mfma_f32_16x16x32_bf16 v[184:187], a[108:111], v[56:59], v[184:187]
v_mfma_f32_16x16x32_bf16 v[188:191], a[108:111], v[60:63], v[188:191]
v_mfma_f32_16x16x32_bf16 v[192:195], a[108:111], v[64:67], v[192:195]
v_mfma_f32_16x16x32_bf16 v[196:199], a[108:111], v[68:71], v[196:199]
v_mfma_f32_16x16x32_bf16 v[184:187], a[112:115], v[72:75], v[184:187]
v_mfma_f32_16x16x32_bf16 v[188:191], a[112:115], v[76:79], v[188:191]
v_mfma_f32_16x16x32_bf16 v[192:195], a[112:115], v[80:83], v[192:195]
v_mfma_f32_16x16x32_bf16 v[196:199], a[112:115], v[84:87], v[196:199]
v_mfma_f32_16x16x32_bf16 v[184:187], a[116:119], v[88:91], v[184:187]
v_mfma_f32_16x16x32_bf16 v[188:191], a[116:119], v[92:95], v[188:191]
v_mfma_f32_16x16x32_bf16 v[192:195], a[116:119], v[96:99], v[192:195]
v_mfma_f32_16x16x32_bf16 v[196:199], a[116:119], v[100:103], v[196:199]
sad 38,57,36864
sad 39,56,147456
buffer_load_dwordx4 a[180:183], v7, s[12:15], s38 offen sc1
buffer_load_dwordx4 a[184:187], v7, s[16:19], s39 offen offset:0 sc1
buffer_load_dwordx4 a[188:191], v7, s[16:19], s39 offen offset:1024 sc1
buffer_load_dwordx4 a[192:195], v7, s[16:19], s39 offen offset:2048 sc1
buffer_load_dwordx4 a[196:199], v7, s[16:19], s39 offen offset:3072 sc1
s_nop 7
v_cndmask_b32 v200, v192, v184, s[66:67]
v_cndmask_b32 v201, v193, v185, s[66:67]
v_cndmask_b32 v202, v194, v186, s[66:67]
v_cndmask_b32 v203, v195, v187, s[66:67]
v_cndmask_b32 v204, v196, v188, s[66:67]
v_cndmask_b32 v205, v197, v189, s[66:67]
v_cndmask_b32 v206, v198, v190, s[66:67]
v_cndmask_b32 v207, v199, v191, s[66:67]
s_nop 0
v_permlane32_swap_b32 v200, v204
v_permlane32_swap_b32 v201, v205
v_permlane32_swap_b32 v202, v206
v_permlane32_swap_b32 v203, v207
s_nop 0
v_add_f32 v200, v200, v204
v_add_f32 v201, v201, v205
v_add_f32 v202, v202, v206
v_add_f32 v203, v203, v207
ds_write_b128 v10, v[200:203] offset:5120
wv 15
v_mfma_f32_16x16x32_bf16 v[184:187], a[120:123], v[24:27], 0
v_mfma_f32_16x16x32_bf16 v[188:191], a[120:123], v[28:31], 0
v_mfma_f32_16x16x32_bf16 v[192:195], a[120:123], v[32:35], 0
v_mfma_f32_16x16x32_bf16 v[196:199], a[120:123], v[36:39], 0
v_mfma_f32_16x16x32_bf16 v[184:187], a[124:127], v[40:43], v[184:187]
v_mfma_f32_16x16x32_bf16 v[188:191], a[124:127], v[44:47], v[188:191]
v_mfma_f32_16x16x32_bf16 v[192:195], a[124:127], v[48:51], v[192:195]
v_mfma_f32_16x16x32_bf16 v[196:199], a[124:127], v[52:55], v[196:199]
v_mfma_f32_16x16x32_bf16 v[184:187], a[128:131], v[56:59], v[184:187]
v_mfma_f32_16x16x32_bf16 v[188:191], a[128:131], v[60:63], v[188:191]
v_mfma_f32_16x16x32_bf16 v[192:195], a[128:131], v[64:67], v[192:195]
v_mfma_f32_16x16x32_bf16 v[196:199], a[128:131], v[68:71], v[196:199]
v_mfma_f32_16x16x32_bf16 v[184:187], a[132:135], v[72:75], v[184:187]
v_mfma_f32_16x16x32_bf16 v[188:191], a[132:135], v[76:79], v[188:191]
v_mfma_f32_16x16x32_bf16 v[192:195], a[132:135], v[80:83], v[192:195]
v_mfma_f32_16x16x32_bf16 v[196:199], a[132:135], v[84:87], v[196:199]
v_mfma_f32_16x16x32_bf16 v[184:187], a[136:139], v[88:91], v[184:187]
v_mfma_f32_16x16x32_bf16 v[188:191], a[136:139], v[92:95], v[188:191]
v_mfma_f32_16x16x32_bf16 v[192:195], a[136:139], v[96:99], v[192:195]
v_mfma_f32_16x16x32_bf16 v[196:199], a[136:139], v[100:103], v[196:199]
sad 38,57,40960
sad 39,56,163840
buffer_load_dwordx4 a[200:203], v7, s[12:15], s38 offen sc1
buffer_load_dwordx4 a[204:207], v7, s[16:19], s39 offen offset:0 sc1
buffer_load_dwordx4 a[208:211], v7, s[16:19], s39 offen offset:1024 sc1
buffer_load_dwordx4 a[212:215], v7, s[16:19], s39 offen offset:2048 sc1
buffer_load_dwordx4 a[216:219], v7, s[16:19], s39 offen offset:3072 sc1
s_nop 7
v_cndmask_b32 v200, v192, v184, s[66:67]
v_cndmask_b32 v201, v193, v185, s[66:67]
v_cndmask_b32 v202, v194, v186, s[66:67]
v_cndmask_b32 v203, v195, v187, s[66:67]
v_cndmask_b32 v204, v196, v188, s[66:67]
v_cndmask_b32 v205, v197, v189, s[66:67]
v_cndmask_b32 v206, v198, v190, s[66:67]
v_cndmask_b32 v207, v199, v191, s[66:67]
s_nop 0
v_permlane32_swap_b32 v200, v204
v_permlane32_swap_b32 v201, v205
v_permlane32_swap_b32 v202, v206
v_permlane32_swap_b32 v203, v207
s_nop 0
v_add_f32 v200, v200, v204
v_add_f32 v201, v201, v205
v_add_f32 v202, v202, v206
v_add_f32 v203, v203, v207
ds_write_b128 v10, v[200:203] offset:6144
wv 15
v_mfma_f32_16x16x32_bf16 v[184:187], a[140:143], v[24:27], 0
v_mfma_f32_16x16x32_bf16 v[188:191], a[140:143], v[28:31], 0
v_mfma_f32_16x16x32_bf16 v[192:195], a[140:143], v[32:35], 0
v_mfma_f32_16x16x32_bf16 v[196:199], a[140:143], v[36:39], 0
v_mfma_f32_16x16x32_bf16 v[184:187], a[144:147], v[40:43], v[184:187]
v_mfma_f32_16x16x32_bf16 v[188:191], a[144:147], v[44:47], v[188:191]
v_mfma_f32_16x16x32_bf16 v[192:195], a[144:147], v[48:51], v[192:195]
v_mfma_f32_16x16x32_bf16 v[196:199], a[144:147], v[52:55], v[196:199]
v_mfma_f32_16x16x32_bf16 v[184:187], a[148:151], v[56:59], v[184:187]
v_mfma_f32_16x16x32_bf16 v[188:191], a[148:151], v[60:63], v[188:191]
v_mfma_f32_16x16x32_bf16 v[192:195], a[148:151], v[64:67], v[192:195]
v_mfma_f32_16x16x32_bf16 v[196:199], a[148:151], v[68:71], v[196:199]
v_mfma_f32_16x16x32_bf16 v[184:187], a[152:155], v[72:75], v[184:187]
v_mfma_f32_16x16x32_bf16 v[188:191], a[152:155], v[76:79], v[188:191]
v_mfma_f32_16x16x32_bf16 v[192:195], a[152:155], v[80:83], v[192:195]
v_mfma_f32_16x16x32_bf16 v[196:199], a[152:155], v[84:87], v[196:199]
v_mfma_f32_16x16x32_bf16 v[184:187], a[156:159], v[88:91], v[184:187]
v_mfma_f32_16x16x32_bf16 v[188:191], a[156:159], v[92:95], v[188:191]
v_mfma_f32_16x16x32_bf16 v[192:195], a[156:159], v[96:99], v[192:195]
v_mfma_f32_16x16x32_bf16 v[196:199], a[156:159], v[100:103], v[196:199]
sad 38,57,45056
sad 39,56,180224
buffer_load_dwordx4 a[220:223], v7, s[12:15], s38 offen sc1
buffer_load_dwordx4 a[224:227], v7, s[16:19], s39 offen offset:0 sc1
buffer_load_dwordx4 a[228:231], v7, s[16:19], s39 offen offset:1024 sc1
buffer_load_dwordx4 a[232:235], v7, s[16:19], s39 offen offset:2048 sc1
buffer_load_dwordx4 a[236:239], v7, s[16:19], s39 offen offset:3072 sc1
s_nop 7
v_cndmask_b32 v200, v192, v184, s[66:67]
v_cndmask_b32 v201, v193, v185, s[66:67]
v_cndmask_b32 v202, v194, v186, s[66:67]
v_cndmask_b32 v203, v195, v187, s[66:67]
v_cndmask_b32 v204, v196, v188, s[66:67]
v_cndmask_b32 v205, v197, v189, s[66:67]
v_cndmask_b32 v206, v198, v190, s[66:67]
v_cndmask_b32 v207, v199, v191, s[66:67]
s_nop 0
v_permlane32_swap_b32 v200, v204
v_permlane32_swap_b32 v201, v205
v_permlane32_swap_b32 v202, v206
v_permlane32_swap_b32 v203, v207
s_nop 0
v_add_f32 v200, v200, v204
v_add_f32 v201, v201, v205
v_add_f32 v202, v202, v206
v_add_f32 v203, v203, v207
ds_write_b128 v10, v[200:203] offset:7168
wv 15
v_mfma_f32_16x16x32_bf16 v[184:187], a[160:163], v[24:27], 0
v_mfma_f32_16x16x32_bf16 v[188:191], a[160:163], v[28:31], 0
v_mfma_f32_16x16x32_bf16 v[192:195], a[160:163], v[32:35], 0
v_mfma_f32_16x16x32_bf16 v[196:199], a[160:163], v[36:39], 0
v_mfma_f32_16x16x32_bf16 v[184:187], a[164:167], v[40:43], v[184:187]
v_mfma_f32_16x16x32_bf16 v[188:191], a[164:167], v[44:47], v[188:191]
v_mfma_f32_16x16x32_bf16 v[192:195], a[164:167], v[48:51], v[192:195]
v_mfma_f32_16x16x32_bf16 v[196:199], a[164:167], v[52:55], v[196:199]
v_mfma_f32_16x16x32_bf16 v[184:187], a[168:171], v[56:59], v[184:187]
v_mfma_f32_16x16x32_bf16 v[188:191], a[168:171], v[60:63], v[188:191]
v_mfma_f32_16x16x32_bf16 v[192:195], a[168:171], v[64:67], v[192:195]
v_mfma_f32_16x16x32_bf16 v[196:199], a[168:171], v[68:71], v[196:199]
v_mfma_f32_16x16x32_bf16 v[184:187], a[172:175], v[72:75], v[184:187]
v_mfma_f32_16x16x32_bf16 v[188:191], a[172:175], v[76:79], v[188:191]
v_mfma_f32_16x16x32_bf16 v[192:195], a[172:175], v[80:83], v[192:195]
v_mfma_f32_16x16x32_bf16 v[196:199], a[172:175], v[84:87], v[196:199]
v_mfma_f32_16x16x32_bf16 v[184:187], a[176:179], v[88:91], v[184:187]
v_mfma_f32_16x16x32_bf16 v[188:191], a[176:179], v[92:95], v[188:191]
v_mfma_f32_16x16x32_bf16 v[192:195], a[176:179], v[96:99], v[192:195]
v_mfma_f32_16x16x32_bf16 v[196:199], a[176:179], v[100:103], v[196:199]
sad 38,57,49152
sad 39,56,196608
buffer_load_dwordx4 a[0:3], v7, s[12:15], s38 offen sc1
buffer_load_dwordx4 a[4:7], v7, s[16:19], s39 offen offset:0 sc1
buffer_load_dwordx4 a[8:11], v7, s[16:19], s39 offen offset:1024 sc1
buffer_load_dwordx4 a[12:15], v7, s[16:19], s39 offen offset:2048 sc1
buffer_load_dwordx4 a[16:19], v7, s[16:19], s39 offen offset:3072 sc1
s_nop 7
v_cndmask_b32 v200, v192, v184, s[66:67]
v_cndmask_b32 v201, v193, v185, s[66:67]
v_cndmask_b32 v202, v194, v186, s[66:67]
v_cndmask_b32 v203, v195, v187, s[66:67]
v_cndmask_b32 v204, v196, v188, s[66:67]
v_cndmask_b32 v205, v197, v189, s[66:67]
v_cndmask_b32 v206, v198, v190, s[66:67]
v_cndmask_b32 v207, v199, v191, s[66:67]
s_nop 0
v_permlane32_swap_b32 v200, v204
v_permlane32_swap_b32 v201, v205
v_permlane32_swap_b32 v202, v206
v_permlane32_swap_b32 v203, v207
s_nop 0
v_add_f32 v200, v200, v204
v_add_f32 v201, v201, v205
v_add_f32 v202, v202, v206
v_add_f32 v203, v203, v207
ds_write_b128 v10, v[200:203] offset:8192
wv 15
v_mfma_f32_16x16x32_bf16 v[184:187], a[180:183], v[24:27], 0
v_mfma_f32_16x16x32_bf16 v[188:191], a[180:183], v[28:31], 0
v_mfma_f32_16x16x32_bf16 v[192:195], a[180:183], v[32:35], 0
v_mfma_f32_16x16x32_bf16 v[196:199], a[180:183], v[36:39], 0
v_mfma_f32_16x16x32_bf16 v[184:187], a[184:187], v[40:43], v[184:187]
v_mfma_f32_16x16x32_bf16 v[188:191], a[184:187], v[44:47], v[188:191]
v_mfma_f32_16x16x32_bf16 v[192:195], a[184:187], v[48:51], v[192:195]
v_mfma_f32_16x16x32_bf16 v[196:199], a[184:187], v[52:55], v[196:199]
v_mfma_f32_16x16x32_bf16 v[184:187], a[188:191], v[56:59], v[184:187]
v_mfma_f32_16x16x32_bf16 v[188:191], a[188:191], v[60:63], v[188:191]
v_mfma_f32_16x16x32_bf16 v[192:195], a[188:191], v[64:67], v[192:195]
v_mfma_f32_16x16x32_bf16 v[196:199], a[188:191], v[68:71], v[196:199]
v_mfma_f32_16x16x32_bf16 v[184:187], a[192:195], v[72:75], v[184:187]
v_mfma_f32_16x16x32_bf16 v[188:191], a[192:195], v[76:79], v[188:191]
v_mfma_f32_16x16x32_bf16 v[192:195], a[192:195], v[80:83], v[192:195]
v_mfma_f32_16x16x32_bf16 v[196:199], a[192:195], v[84:87], v[196:199]
v_mfma_f32_16x16x32_bf16 v[184:187], a[196:199], v[88:91], v[184:187]
v_mfma_f32_16x16x32_bf16 v[188:191], a[196:199], v[92:95], v[188:191]
v_mfma_f32_16x16x32_bf16 v[192:195], a[196:199], v[96:99], v[192:195]
v_mfma_f32_16x16x32_bf16 v[196:199], a[196:199], v[100:103], v[196:199]
sad 38,57,53248
sad 39,56,212992
buffer_load_dwordx4 a[20:23], v7, s[12:15], s38 offen sc1
buffer_load_dwordx4 a[24:27], v7, s[16:19], s39 offen offset:0 sc1
buffer_load_dwordx4 a[28:31], v7, s[16:19], s39 offen offset:1024 sc1
buffer_load_dwordx4 a[32:35], v7, s[16:19], s39 offen offset:2048 sc1
buffer_load_dwordx4 a[36:39], v7, s[16:19], s39 offen offset:3072 sc1
s_nop 7
v_cndmask_b32 v200, v192, v184, s[66:67]
v_cndmask_b32 v201, v193, v185, s[66:67]
v_cndmask_b32 v202, v194, v186, s[66:67]
v_cndmask_b32 v203, v195, v187, s[66:67]
v_cndmask_b32 v204, v196, v188, s[66:67]
v_cndmask_b32 v205, v197, v189, s[66:67]
v_cndmask_b32 v206, v198, v190, s[66:67]
v_cndmask_b32 v207, v199, v191, s[66:67]
s_nop 0
v_permlane32_swap_b32 v200, v204
v_permlane32_swap_b32 v201, v205
v_permlane32_swap_b32 v202, v206
v_permlane32_swap_b32 v203, v207
s_nop 0
v_add_f32 v200, v200, v204
v_add_f32 v201, v201, v205
v_add_f32 v202, v202, v206
v_add_f32 v203, v203, v207
ds_write_b128 v10, v[200:203] offset:9216
wv 15
v_mfma_f32_16x16x32_bf16 v[184:187], a[200:203], v[24:27], 0
v_mfma_f32_16x16x32_bf16 v[188:191], a[200:203], v[28:31], 0
v_mfma_f32_16x16x32_bf16 v[192:195], a[200:203], v[32:35], 0
v_mfma_f32_16x16x32_bf16 v[196:199], a[200:203], v[36:39], 0
v_mfma_f32_16x16x32_bf16 v[184:187], a[204:207], v[40:43], v[184:187]
v_mfma_f32_16x16x32_bf16 v[188:191], a[204:207], v[44:47], v[188:191]
v_mfma_f32_16x16x32_bf16 v[192:195], a[204:207], v[48:51], v[192:195]
v_mfma_f32_16x16x32_bf16 v[196:199], a[204:207], v[52:55], v[196:199]
v_mfma_f32_16x16x32_bf16 v[184:187], a[208:211], v[56:59], v[184:187]
v_mfma_f32_16x16x32_bf16 v[188:191], a[208:211], v[60:63], v[188:191]
v_mfma_f32_16x16x32_bf16 v[192:195], a[208:211], v[64:67], v[192:195]
v_mfma_f32_16x16x32_bf16 v[196:199], a[208:211], v[68:71], v[196:199]
v_mfma_f32_16x16x32_bf16 v[184:187], a[212:215], v[72:75], v[184:187]
v_mfma_f32_16x16x32_bf16 v[188:191], a[212:215], v[76:79], v[188:191]
v_mfma_f32_16x16x32_bf16 v[192:195], a[212:215], v[80:83], v[192:195]
v_mfma_f32_16x16x32_bf16 v[196:199], a[212:215], v[84:87], v[196:199]
v_mfma_f32_16x16x32_bf16 v[184:187], a[216:219], v[88:91], v[184:187]
v_mfma_f32_16x16x32_bf16 v[188:191], a[216:219], v[92:95], v[188:191]
v_mfma_f32_16x16x32_bf16 v[192:195], a[216:219], v[96:99], v[192:195]
v_mfma_f32_16x16x32_bf16 v[196:199], a[216:219], v[100:103], v[196:199]
sad 38,57,57344
sad 39,56,229376
buffer_load_dwordx4 a[40:43], v7, s[12:15], s38 offen sc1
buffer_load_dwordx4 a[44:47], v7, s[16:19], s39 offen offset:0 sc1
buffer_load_dwordx4 a[48:51], v7, s[16:19], s39 offen offset:1024 sc1
buffer_load_dwordx4 a[52:55], v7, s[16:19], s39 offen offset:2048 sc1
buffer_load_dwordx4 a[56:59], v7, s[16:19], s39 offen offset:3072 sc1
s_nop 7
v_cndmask_b32 v200, v192, v184, s[66:67]
v_cndmask_b32 v201, v193, v185, s[66:67]
v_cndmask_b32 v202, v194, v186, s[66:67]
v_cndmask_b32 v203, v195, v187, s[66:67]
v_cndmask_b32 v204, v196, v188, s[66:67]
v_cndmask_b32 v205, v197, v189, s[66:67]
v_cndmask_b32 v206, v198, v190, s[66:67]
v_cndmask_b32 v207, v199, v191, s[66:67]
s_nop 0
v_permlane32_swap_b32 v200, v204
v_permlane32_swap_b32 v201, v205
v_permlane32_swap_b32 v202, v206
v_permlane32_swap_b32 v203, v207
s_nop 0
v_add_f32 v200, v200, v204
v_add_f32 v201, v201, v205
v_add_f32 v202, v202, v206
v_add_f32 v203, v203, v207
ds_write_b128 v10, v[200:203] offset:10240
wv 15
v_mfma_f32_16x16x32_bf16 v[184:187], a[220:223], v[24:27], 0
v_mfma_f32_16x16x32_bf16 v[188:191], a[220:223], v[28:31], 0
v_mfma_f32_16x16x32_bf16 v[192:195], a[220:223], v[32:35], 0
v_mfma_f32_16x16x32_bf16 v[196:199], a[220:223], v[36:39], 0
v_mfma_f32_16x16x32_bf16 v[184:187], a[224:227], v[40:43], v[184:187]
v_mfma_f32_16x16x32_bf16 v[188:191], a[224:227], v[44:47], v[188:191]
v_mfma_f32_16x16x32_bf16 v[192:195], a[224:227], v[48:51], v[192:195]
v_mfma_f32_16x16x32_bf16 v[196:199], a[224:227], v[52:55], v[196:199]
v_mfma_f32_16x16x32_bf16 v[184:187], a[228:231], v[56:59], v[184:187]
v_mfma_f32_16x16x32_bf16 v[188:191], a[228:231], v[60:63], v[188:191]
v_mfma_f32_16x16x32_bf16 v[192:195], a[228:231], v[64:67], v[192:195]
v_mfma_f32_16x16x32_bf16 v[196:199], a[228:231], v[68:71], v[196:199]
v_mfma_f32_16x16x32_bf16 v[184:187], a[232:235], v[72:75], v[184:187]
v_mfma_f32_16x16x32_bf16 v[188:191], a[232:235], v[76:79], v[188:191]
v_mfma_f32_16x16x32_bf16 v[192:195], a[232:235], v[80:83], v[192:195]
v_mfma_f32_16x16x32_bf16 v[196:199], a[232:235], v[84:87], v[196:199]
v_mfma_f32_16x16x32_bf16 v[184:187], a[236:239], v[88:91], v[184:187]
v_mfma_f32_16x16x32_bf16 v[188:191], a[236:239], v[92:95], v[188:191]
v_mfma_f32_16x16x32_bf16 v[192:195], a[236:239], v[96:99], v[192:195]
v_mfma_f32_16x16x32_bf16 v[196:199], a[236:239], v[100:103], v[196:199]
sad 38,57,61440
sad 39,56,245760
buffer_load_dwordx4 a[60:63], v7, s[12:15], s38 offen sc1
buffer_load_dwordx4 a[64:67], v7, s[16:19], s39 offen offset:0 sc1
buffer_load_dwordx4 a[68:71], v7, s[16:19], s39 offen offset:1024 sc1
buffer_load_dwordx4 a[72:75], v7, s[16:19], s39 offen offset:2048 sc1
buffer_load_dwordx4 a[76:79], v7, s[16:19], s39 offen offset:3072 sc1
s_nop 7
v_cndmask_b32 v200, v192, v184, s[66:67]
v_cndmask_b32 v201, v193, v185, s[66:67]
v_cndmask_b32 v202, v194, v186, s[66:67]
v_cndmask_b32 v203, v195, v187, s[66:67]
v_cndmask_b32 v204, v196, v188, s[66:67]
v_cndmask_b32 v205, v197, v189, s[66:67]
v_cndmask_b32 v206, v198, v190, s[66:67]
v_cndmask_b32 v207, v199, v191, s[66:67]
s_nop 0
v_permlane32_swap_b32 v200, v204
v_permlane32_swap_b32 v201, v205
v_permlane32_swap_b32 v202, v206
v_permlane32_swap_b32 v203, v207
s_nop 0
v_add_f32 v200, v200, v204
v_add_f32 v201, v201, v205
v_add_f32 v202, v202, v206
v_add_f32 v203, v203, v207
ds_write_b128 v10, v[200:203] offset:11264
wv 15
v_mfma_f32_16x16x32_bf16 v[184:187], a[0:3], v[24:27], 0
v_mfma_f32_16x16x32_bf16 v[188:191], a[0:3], v[28:31], 0
v_mfma_f32_16x16x32_bf16 v[192:195], a[0:3], v[32:35], 0
v_mfma_f32_16x16x32_bf16 v[196:199], a[0:3], v[36:39], 0
v_mfma_f32_16x16x32_bf16 v[184:187], a[4:7], v[40:43], v[184:187]
v_mfma_f32_16x16x32_bf16 v[188:191], a[4:7], v[44:47], v[188:191]
v_mfma_f32_16x16x32_bf16 v[192:195], a[4:7], v[48:51], v[192:195]
v_mfma_f32_16x16x32_bf16 v[196:199], a[4:7], v[52:55], v[196:199]
v_mfma_f32_16x16x32_bf16 v[184:187], a[8:11], v[56:59], v[184:187]
v_mfma_f32_16x16x32_bf16 v[188:191], a[8:11], v[60:63], v[188:191]
v_mfma_f32_16x16x32_bf16 v[192:195], a[8:11], v[64:67], v[192:195]
v_mfma_f32_16x16x32_bf16 v[196:199], a[8:11], v[68:71], v[196:199]
v_mfma_f32_16x16x32_bf16 v[184:187], a[12:15], v[72:75], v[184:187]
v_mfma_f32_16x16x32_bf16 v[188:191], a[12:15], v[76:79], v[188:191]
v_mfma_f32_16x16x32_bf16 v[192:195], a[12:15], v[80:83], v[192:195]
v_mfma_f32_16x16x32_bf16 v[196:199], a[12:15], v[84:87], v[196:199]
v_mfma_f32_16x16x32_bf16 v[184:187], a[16:19], v[88:91], v[184:187]
v_mfma_f32_16x16x32_bf16 v[188:191], a[16:19], v[92:95], v[188:191]
v_mfma_f32_16x16x32_bf16 v[192:195], a[16:19], v[96:99], v[192:195]
v_mfma_f32_16x16x32_bf16 v[196:199], a[16:19], v[100:103], v[196:199]
s_nop 7
v_cndmask_b32 v200, v192, v184, s[66:67]
v_cndmask_b32 v201, v193, v185, s[66:67]
v_cndmask_b32 v202, v194, v186, s[66:67]
v_cndmask_b32 v203, v195, v187, s[66:67]
v_cndmask_b32 v204, v196, v188, s[66:67]
v_cndmask_b32 v205, v197, v189, s[66:67]
v_cndmask_b32 v206, v198, v190, s[66:67]
v_cndmask_b32 v207, v199, v191, s[66:67]
s_nop 0
v_permlane32_swap_b32 v200, v204
v_permlane32_swap_b32 v201, v205
v_permlane32_swap_b32 v202, v206
v_permlane32_swap_b32 v203, v207
s_nop 0
v_add_f32 v200, v200, v204
v_add_f32 v201, v201, v205
v_add_f32 v202, v202, v206
v_add_f32 v203, v203, v207
ds_write_b128 v10, v[200:203] offset:12288
wv 10
v_mfma_f32_16x16x32_bf16 v[184:187], a[20:23], v[24:27], 0
v_mfma_f32_16x16x32_bf16 v[188:191], a[20:23], v[28:31], 0
v_mfma_f32_16x16x32_bf16 v[192:195], a[20:23], v[32:35], 0
v_mfma_f32_16x16x32_bf16 v[196:199], a[20:23], v[36:39], 0
v_mfma_f32_16x16x32_bf16 v[184:187], a[24:27], v[40:43], v[184:187]
v_mfma_f32_16x16x32_bf16 v[188:191], a[24:27], v[44:47], v[188:191]
v_mfma_f32_16x16x32_bf16 v[192:195], a[24:27], v[48:51], v[192:195]
v_mfma_f32_16x16x32_bf16 v[196:199], a[24:27], v[52:55], v[196:199]
v_mfma_f32_16x16x32_bf16 v[184:187], a[28:31], v[56:59], v[184:187]
v_mfma_f32_16x16x32_bf16 v[188:191], a[28:31], v[60:63], v[188:191]
v_mfma_f32_16x16x32_bf16 v[192:195], a[28:31], v[64:67], v[192:195]
v_mfma_f32_16x16x32_bf16 v[196:199], a[28:31], v[68:71], v[196:199]
v_mfma_f32_16x16x32_bf16 v[184:187], a[32:35], v[72:75], v[184:187]
v_mfma_f32_16x16x32_bf16 v[188:191], a[32:35], v[76:79], v[188:191]
v_mfma_f32_16x16x32_bf16 v[192:195], a[32:35], v[80:83], v[192:195]
v_mfma_f32_16x16x32_bf16 v[196:199], a[32:35], v[84:87], v[196:199]
v_mfma_f32_16x16x32_bf16 v[184:187], a[36:39], v[88:91], v[184:187]
v_mfma_f32_16x16x32_bf16 v[188:191], a[36:39], v[92:95], v[188:191]
v_mfma_f32_16x16x32_bf16 v[192:195], a[36:39], v[96:99], v[192:195]
v_mfma_f32_16x16x32_bf16 v[196:199], a[36:39], v[100:103], v[196:199]
s_nop 7
v_cndmask_b32 v200, v192, v184, s[66:67]
v_cndmask_b32 v201, v193, v185, s[66:67]
v_cndmask_b32 v202, v194, v186, s[66:67]
v_cndmask_b32 v203, v195, v187, s[66:67]
v_cndmask_b32 v204, v196, v188, s[66:67]
v_cndmask_b32 v205, v197, v189, s[66:67]
v_cndmask_b32 v206, v198, v190, s[66:67]
v_cndmask_b32 v207, v199, v191, s[66:67]
s_nop 0
v_permlane32_swap_b32 v200, v204
v_permlane32_swap_b32 v201, v205
v_permlane32_swap_b32 v202, v206
v_permlane32_swap_b32 v203, v207
s_nop 0
v_add_f32 v200, v200, v204
v_add_f32 v201, v201, v205
v_add_f32 v202, v202, v206
v_add_f32 v203, v203, v207
ds_write_b128 v10, v[200:203] offset:13312
wv 5
v_mfma_f32_16x16x32_bf16 v[184:187], a[40:43], v[24:27], 0
v_mfma_f32_16x16x32_bf16 v[188:191], a[40:43], v[28:31], 0
v_mfma_f32_16x16x32_bf16 v[192:195], a[40:43], v[32:35], 0
v_mfma_f32_16x16x32_bf16 v[196:199], a[40:43], v[36:39], 0
v_mfma_f32_16x16x32_bf16 v[184:187], a[44:47], v[40:43], v[184:187]
v_mfma_f32_16x16x32_bf16 v[188:191], a[44:47], v[44:47], v[188:191]
v_mfma_f32_16x16x32_bf16 v[192:195], a[44:47], v[48:51], v[192:195]
v_mfma_f32_16x16x32_bf16 v[196:199], a[44:47], v[52:55], v[196:199]
v_mfma_f32_16x16x32_bf16 v[184:187], a[48:51], v[56:59], v[184:187]
v_mfma_f32_16x16x32_bf16 v[188:191], a[48:51], v[60:63], v[188:191]
v_mfma_f32_16x16x32_bf16 v[192:195], a[48:51], v[64:67], v[192:195]
v_mfma_f32_16x16x32_bf16 v[196:199], a[48:51], v[68:71], v[196:199]
v_mfma_f32_16x16x32_bf16 v[184:187], a[52:55], v[72:75], v[184:187]
v_mfma_f32_16x16x32_bf16 v[188:191], a[52:55], v[76:79], v[188:191]
v_mfma_f32_16x16x32_bf16 v[192:195], a[52:55], v[80:83], v[192:195]
v_mfma_f32_16x16x32_bf16 v[196:199], a[52:55], v[84:87], v[196:199]
v_mfma_f32_16x16x32_bf16 v[184:187], a[56:59], v[88:91], v[184:187]
v_mfma_f32_16x16x32_bf16 v[188:191], a[56:59], v[92:95], v[188:191]
v_mfma_f32_16x16x32_bf16 v[192:195], a[56:59], v[96:99], v[192:195]
v_mfma_f32_16x16x32_bf16 v[196:199], a[56:59], v[100:103], v[196:199]
s_nop 7
v_cndmask_b32 v200, v192, v184, s[66:67]
v_cndmask_b32 v201, v193, v185, s[66:67]
v_cndmask_b32 v202, v194, v186, s[66:67]
v_cndmask_b32 v203, v195, v187, s[66:67]
v_cndmask_b32 v204, v196, v188, s[66:67]
v_cndmask_b32 v205, v197, v189, s[66:67]
v_cndmask_b32 v206, v198, v190, s[66:67]
v_cndmask_b32 v207, v199, v191, s[66:67]
s_nop 0
v_permlane32_swap_b32 v200, v204
v_permlane32_swap_b32 v201, v205
v_permlane32_swap_b32 v202, v206
v_permlane32_swap_b32 v203, v207
s_nop 0
v_add_f32 v200, v200, v204
v_add_f32 v201, v201, v205
v_add_f32 v202, v202, v206
v_add_f32 v203, v203, v207
ds_write_b128 v10, v[200:203] offset:14336
wv 0
v_mfma_f32_16x16x32_bf16 v[184:187], a[60:63], v[24:27], 0
v_mfma_f32_16x16x32_bf16 v[188:191], a[60:63], v[28:31], 0
v_mfma_f32_16x16x32_bf16 v[192:195], a[60:63], v[32:35], 0
v_mfma_f32_16x16x32_bf16 v[196:199], a[60:63], v[36:39], 0
v_mfma_f32_16x16x32_bf16 v[184:187], a[64:67], v[40:43], v[184:187]
v_mfma_f32_16x16x32_bf16 v[188:191], a[64:67], v[44:47], v[188:191]
v_mfma_f32_16x16x32_bf16 v[192:195], a[64:67], v[48:51], v[192:195]
v_mfma_f32_16x16x32_bf16 v[196:199], a[64:67], v[52:55], v[196:199]
v_mfma_f32_16x16x32_bf16 v[184:187], a[68:71], v[56:59], v[184:187]
v_mfma_f32_16x16x32_bf16 v[188:191], a[68:71], v[60:63], v[188:191]
v_mfma_f32_16x16x32_bf16 v[192:195], a[68:71], v[64:67], v[192:195]
v_mfma_f32_16x16x32_bf16 v[196:199], a[68:71], v[68:71], v[196:199]
v_mfma_f32_16x16x32_bf16 v[184:187], a[72:75], v[72:75], v[184:187]
v_mfma_f32_16x16x32_bf16 v[188:191], a[72:75], v[76:79], v[188:191]
v_mfma_f32_16x16x32_bf16 v[192:195], a[72:75], v[80:83], v[192:195]
v_mfma_f32_16x16x32_bf16 v[196:199], a[72:75], v[84:87], v[196:199]
v_mfma_f32_16x16x32_bf16 v[184:187], a[76:79], v[88:91], v[184:187]
v_mfma_f32_16x16x32_bf16 v[188:191], a[76:79], v[92:95], v[188:191]
v_mfma_f32_16x16x32_bf16 v[192:195], a[76:79], v[96:99], v[192:195]
v_mfma_f32_16x16x32_bf16 v[196:199], a[76:79], v[100:103], v[196:199]
s_nop 7
v_cndmask_b32 v200, v192, v184, s[66:67]
v_cndmask_b32 v201, v193, v185, s[66:67]
v_cndmask_b32 v202, v194, v186, s[66:67]
v_cndmask_b32 v203, v195, v187, s[66:67]
v_cndmask_b32 v204, v196, v188, s[66:67]
v_cndmask_b32 v205, v197, v189, s[66:67]
v_cndmask_b32 v206, v198, v190, s[66:67]
v_cndmask_b32 v207, v199, v191, s[66:67]
s_nop 0
v_permlane32_swap_b32 v200, v204
v_permlane32_swap_b32 v201, v205
v_permlane32_swap_b32 v202, v206
v_permlane32_swap_b32 v203, v207
s_nop 0
v_add_f32 v200, v200, v204
v_add_f32 v201, v201, v205
v_add_f32 v202, v202, v206
v_add_f32 v203, v203, v207
ds_write_b128 v10, v[200:203] offset:15360
s_waitcnt vmcnt(0) lgkmcnt(0)
s_barrier
s_lshl_b32 s38, s4, 12
v_add_u32 v11, s38, v7
ds_read_b128 v[24:27], v11 offset:0
ds_read_b128 v[28:31], v11 offset:16384
ds_read_b128 v[32:35], v11 offset:32768
ds_read_b128 v[36:39], v11 offset:49152
ds_read_b128 v[40:43], v11 offset:1024
ds_read_b128 v[44:47], v11 offset:17408
ds_read_b128 v[48:51], v11 offset:33792
ds_read_b128 v[52:55], v11 offset:50176
ds_read_b128 v[56:59], v11 offset:2048
ds_read_b128 v[60:63], v11 offset:18432
ds_read_b128 v[64:67], v11 offset:34816
ds_read_b128 v[68:71], v11 offset:51200
ds_read_b128 v[72:75], v11 offset:3072
ds_read_b128 v[76:79], v11 offset:19456
ds_read_b128 v[80:83], v11 offset:35840
ds_read_b128 v[84:87], v11 offset:52224
wl 12
v_pk_add_f32 v[24:25], v[24:25], v[28:29]
v_pk_add_f32 v[26:27], v[26:27], v[30:31]
v_pk_add_f32 v[32:33], v[32:33], v[36:37]
v_pk_add_f32 v[34:35], v[34:35], v[38:39]
v_pk_add_f32 v[24:25], v[24:25], v[32:33]
v_pk_add_f32 v[26:27], v[26:27], v[34:35]
cvp 28,24,25
cvp 29,26,27
s_cmp_eq_u32 s72, 0
s_cbranch_scc1 L_xc_211
buffer_store_dwordx2 v[28:29], v8, s[68:71], s58 offen offset:0 sc1
s_branch L_xn_212
L_xc_211:
v_lshlrev_b32 v32, 16, v28
v_and_b32 v33, 0xffff0000, v28
v_lshlrev_b32 v34, 16, v210
v_and_b32 v35, 0xffff0000, v210
v_mul_f32 v32, v32, v34
v_mul_f32 v33, v33, v35
cvp 32,32,33
v_and_b32 v33, 0xffff0000, v32
v_lshlrev_b32 v32, 16, v32
v_lshlrev_b32 v34, 16, v208
v_and_b32 v35, 0xffff0000, v208
v_add_f32 v32, v32, v34
v_add_f32 v33, v33, v35
cvp 30,32,33
v_lshlrev_b32 v32, 16, v29
v_and_b32 v33, 0xffff0000, v29
v_lshlrev_b32 v34, 16, v211
v_and_b32 v35, 0xffff0000, v211
v_mul_f32 v32, v32, v34
v_mul_f32 v33, v33, v35
cvp 32,32,33
v_and_b32 v33, 0xffff0000, v32
v_lshlrev_b32 v32, 16, v32
v_lshlrev_b32 v34, 16, v209
v_and_b32 v35, 0xffff0000, v209
v_add_f32 v32, v32, v34
v_add_f32 v33, v33, v35
cvp 31,32,33
buffer_store_dwordx2 v[30:31], v8, s[28:31], s58 offen offset:0
L_xn_212:
wl 8
v_pk_add_f32 v[40:41], v[40:41], v[44:45]
v_pk_add_f32 v[42:43], v[42:43], v[46:47]
v_pk_add_f32 v[48:49], v[48:49], v[52:53]
v_pk_add_f32 v[50:51], v[50:51], v[54:55]
v_pk_add_f32 v[40:41], v[40:41], v[48:49]
v_pk_add_f32 v[42:43], v[42:43], v[50:51]
cvp 44,40,41
cvp 45,42,43
s_cmp_eq_u32 s72, 0
s_cbranch_scc1 L_xc_213
buffer_store_dwordx2 v[44:45], v8, s[68:71], s58 offen offset:16 sc1
s_branch L_xn_214
L_xc_213:
v_lshlrev_b32 v48, 16, v44
v_and_b32 v49, 0xffff0000, v44
v_lshlrev_b32 v50, 16, v214
v_and_b32 v51, 0xffff0000, v214
v_mul_f32 v48, v48, v50
v_mul_f32 v49, v49, v51
cvp 48,48,49
v_and_b32 v49, 0xffff0000, v48
v_lshlrev_b32 v48, 16, v48
v_lshlrev_b32 v50, 16, v212
v_and_b32 v51, 0xffff0000, v212
v_add_f32 v48, v48, v50
v_add_f32 v49, v49, v51
cvp 46,48,49
v_lshlrev_b32 v48, 16, v45
v_and_b32 v49, 0xffff0000, v45
v_lshlrev_b32 v50, 16, v215
v_and_b32 v51, 0xffff0000, v215
v_mul_f32 v48, v48, v50
v_mul_f32 v49, v49, v51
cvp 48,48,49
v_and_b32 v49, 0xffff0000, v48
v_lshlrev_b32 v48, 16, v48
v_lshlrev_b32 v50, 16, v213
v_and_b32 v51, 0xffff0000, v213
v_add_f32 v48, v48, v50
v_add_f32 v49, v49, v51
cvp 47,48,49
buffer_store_dwordx2 v[46:47], v8, s[28:31], s58 offen offset:16
L_xn_214:
wl 4
v_pk_add_f32 v[56:57], v[56:57], v[60:61]
v_pk_add_f32 v[58:59], v[58:59], v[62:63]
v_pk_add_f32 v[64:65], v[64:65], v[68:69]
v_pk_add_f32 v[66:67], v[66:67], v[70:71]
v_pk_add_f32 v[56:57], v[56:57], v[64:65]
v_pk_add_f32 v[58:59], v[58:59], v[66:67]
cvp 60,56,57
cvp 61,58,59
s_cmp_eq_u32 s72, 0
s_cbranch_scc1 L_xc_215
buffer_store_dwordx2 v[60:61], v8, s[68:71], s58 offen offset:32 sc1
s_branch L_xn_216
L_xc_215:
v_lshlrev_b32 v64, 16, v60
v_and_b32 v65, 0xffff0000, v60
v_lshlrev_b32 v66, 16, v218
v_and_b32 v67, 0xffff0000, v218
v_mul_f32 v64, v64, v66
v_mul_f32 v65, v65, v67
cvp 64,64,65
v_and_b32 v65, 0xffff0000, v64
v_lshlrev_b32 v64, 16, v64
v_lshlrev_b32 v66, 16, v216
v_and_b32 v67, 0xffff0000, v216
v_add_f32 v64, v64, v66
v_add_f32 v65, v65, v67
cvp 62,64,65
v_lshlrev_b32 v64, 16, v61
v_and_b32 v65, 0xffff0000, v61
v_lshlrev_b32 v66, 16, v219
v_and_b32 v67, 0xffff0000, v219
v_mul_f32 v64, v64, v66
v_mul_f32 v65, v65, v67
cvp 64,64,65
v_and_b32 v65, 0xffff0000, v64
v_lshlrev_b32 v64, 16, v64
v_lshlrev_b32 v66, 16, v217
v_and_b32 v67, 0xffff0000, v217
v_add_f32 v64, v64, v66
v_add_f32 v65, v65, v67
cvp 63,64,65
buffer_store_dwordx2 v[62:63], v8, s[28:31], s58 offen offset:32
L_xn_216:
wl 0
v_pk_add_f32 v[72:73], v[72:73], v[76:77]
v_pk_add_f32 v[74:75], v[74:75], v[78:79]
v_pk_add_f32 v[80:81], v[80:81], v[84:85]
v_pk_add_f32 v[82:83], v[82:83], v[86:87]
v_pk_add_f32 v[72:73], v[72:73], v[80:81]
v_pk_add_f32 v[74:75], v[74:75], v[82:83]
cvp 76,72,73
cvp 77,74,75
s_cmp_eq_u32 s72, 0
s_cbranch_scc1 L_xc_217
buffer_store_dwordx2 v[76:77], v8, s[68:71], s58 offen offset:48 sc1
s_branch L_xn_218
L_xc_217:
v_lshlrev_b32 v80, 16, v76
v_and_b32 v81, 0xffff0000, v76
v_lshlrev_b32 v82, 16, v222
v_and_b32 v83, 0xffff0000, v222
v_mul_f32 v80, v80, v82
v_mul_f32 v81, v81, v83
cvp 80,80,81
v_and_b32 v81, 0xffff0000, v80
v_lshlrev_b32 v80, 16, v80
v_lshlrev_b32 v82, 16, v220
v_and_b32 v83, 0xffff0000, v220
v_add_f32 v80, v80, v82
v_add_f32 v81, v81, v83
cvp 78,80,81
v_lshlrev_b32 v80, 16, v77
v_and_b32 v81, 0xffff0000, v77
v_lshlrev_b32 v82, 16, v223
v_and_b32 v83, 0xffff0000, v223
v_mul_f32 v80, v80, v82
v_mul_f32 v81, v81, v83
cvp 80,80,81
v_and_b32 v81, 0xffff0000, v80
v_lshlrev_b32 v80, 16, v80
v_lshlrev_b32 v82, 16, v221
v_and_b32 v83, 0xffff0000, v221
v_add_f32 v80, v80, v82
v_add_f32 v81, v81, v83
cvp 79,80,81
buffer_store_dwordx2 v[78:79], v8, s[28:31], s58 offen offset:48
L_xn_218:
wv 0
s_barrier
sad 79,78,1920
wv 0
s_cmp_lg_u32 s4, 1
s_cbranch_scc1 L_nf_219
s_lshl_b32 s83, s79, 7
v_and_b32 v2, 1, v1
v_cmp_eq_u32 vcc, 1, v2
v_mov_b32 v2, s100
v_mov_b32 v3, s101
v_cndmask_b32 v3, v2, v3, vcc
v_and_b32 v2, 31, v1
v_lshlrev_b32 v2, 2, v2
buffer_store_dword v3, v2, s[88:91], s83 offen sc1
L_nf_219:
s_cmp_lg_u32 s4, 0
s_cbranch_scc1 L_ti_220
s_lshl_b32 s83, s76, 2
v_mov_b32 v18, 1
v_mov_b32 v2, 0
s_mov_b64 exec, 1
buffer_atomic_add v18, v2, s[84:87], s83 offen sc0 sc1
s_mov_b64 exec, -1
L_ti_220:
s_branch L_x_next
L_x_fine:
s_sub_u32 s80, s78, 343
s_mul_hi_u32 s53, s80, 214748365
s_mul_i32 s54, s53, 20
s_sub_u32 s54, s80, s54
sad 53,53,59
s_lshr_b32 s80, s54, 2
sad 80,80,1656
s_lshl_b32 s81, s80, 7
v_min_u32 v3, 0, v1
v_mul_u32_u24 v3, 128, v3
s_mov_b32 s82, 0
L_fw_221:
buffer_load_dwordx2 v[4:5], v3, s[88:91], s81 offen sc1
wv 0
v_xor_b32 v4, s100, v4
v_xor_b32 v5, s101, v5
v_or_b32 v4, v4, v5
v_cmp_ne_u32 vcc, 0, v4
sad 82,82,1
s_cbranch_vccz L_fwd_222
s_sleep 4
s_cmp_lt_u32 s82, 400000
s_cbranch_scc1 L_fw_221
L_fwd_222:
s_mul_i32 s58, s53, 40960
s_lshl_b32 s38, s54, 6
s_add_u32 s58, s58, s38
s_lshl_b32 s38, s4, 4
s_add_u32 s58, s58, s38
s_mul_i32 s56, s53, 1310720
s_lshl_b32 s38, s54, 16
s_add_u32 s56, s56, s38
s_lshl_b32 s38, s4, 12
s_add_u32 s56, s56, s38
s_mul_i32 s57, s53, 327680
s_lshl_b32 s38, s54, 14
s_add_u32 s57, s57, s38
s_lshl_b32 s38, s4, 10
s_add_u32 s57, s57, s38
s_mov_b32 s39, 204800
v_min_u32 v3, 31, v1
v_mul_u32_u24 v3, 128, v3
s_mov_b32 s43, 0
L_fw_223:
buffer_load_dwordx2 v[4:5], v3, s[88:91], s39 offen sc1
wv 0
v_xor_b32 v4, s100, v4
v_xor_b32 v5, s101, v5
v_or_b32 v4, v4, v5
v_cmp_ne_u32 vcc, 0, v4
sad 43,43,1
s_cbranch_vccz L_fwd_224
s_sleep 4
s_cmp_lt_u32 s43, 400000
s_cbranch_scc1 L_fw_223
L_fwd_224:
sad 38,57,0
sad 39,56,0
buffer_load_dwordx4 a[4:7], v7, s[16:19], s39 offen offset:0 sc1
buffer_load_dwordx4 a[8:11], v7, s[16:19], s39 offen offset:1024 sc1
buffer_load_dwordx4 a[12:15], v7, s[16:19], s39 offen offset:2048 sc1
buffer_load_dwordx4 a[16:19], v7, s[16:19], s39 offen offset:3072 sc1
sad 38,57,4096
sad 39,56,16384
buffer_load_dwordx4 a[24:27], v7, s[16:19], s39 offen offset:0 sc1
buffer_load_dwordx4 a[28:31], v7, s[16:19], s39 offen offset:1024 sc1
buffer_load_dwordx4 a[32:35], v7, s[16:19], s39 offen offset:2048 sc1
buffer_load_dwordx4 a[36:39], v7, s[16:19], s39 offen offset:3072 sc1
sad 38,57,8192
sad 39,56,32768
buffer_load_dwordx4 a[44:47], v7, s[16:19], s39 offen offset:0 sc1
buffer_load_dwordx4 a[48:51], v7, s[16:19], s39 offen offset:1024 sc1
buffer_load_dwordx4 a[52:55], v7, s[16:19], s39 offen offset:2048 sc1
buffer_load_dwordx4 a[56:59], v7, s[16:19], s39 offen offset:3072 sc1
sad 38,57,12288
sad 39,56,49152
buffer_load_dwordx4 a[64:67], v7, s[16:19], s39 offen offset:0 sc1
buffer_load_dwordx4 a[68:71], v7, s[16:19], s39 offen offset:1024 sc1
buffer_load_dwordx4 a[72:75], v7, s[16:19], s39 offen offset:2048 sc1
buffer_load_dwordx4 a[76:79], v7, s[16:19], s39 offen offset:3072 sc1
s_cmp_ge_u32 s53, 62
s_cbranch_scc1 L_xfin_227
sad 41,53,2
s_lshl_b32 s41, s41, 17
sad 41,41,102400
s_mov_b32 s43, 0
v_mov_b32 v3, 0
L_xf_225:
buffer_load_dword v2, v3, s[8:11], s41 offen sc1
wv 0
v_cmp_eq_u32 vcc, -1, v2
sad 43,43,1
s_cbranch_vccz L_xfd_226
s_sleep 8
s_cmp_lt_u32 s43, s42
s_cbranch_scc1 L_xf_225
s_mov_b32 s42, 0
s_branch L_xfd_226
L_xfin_227:
s_lshl_b32 s38, s54, 2
s_lshl_b32 s39, s38, 7
v_min_u32 v3, 3, v1
v_mul_u32_u24 v3, 128, v3
s_mov_b32 s43, 0
L_fw_228:
buffer_load_dwordx2 v[4:5], v3, s[88:91], s39 offen sc1
wv 0
v_xor_b32 v4, s100, v4
v_xor_b32 v5, s101, v5
v_or_b32 v4, v4, v5
v_cmp_ne_u32 vcc, 0, v4
sad 43,43,1
s_cbranch_vccz L_fwd_229
s_sleep 4
s_cmp_lt_u32 s43, 400000
s_cbranch_scc1 L_fw_228
L_fwd_229:
s_mov_b32 s39, 229376
v_min_u32 v3, 31, v1
v_mul_u32_u24 v3, 128, v3
s_mov_b32 s43, 0
L_fw_230:
buffer_load_dwordx2 v[4:5], v3, s[88:91], s39 offen sc1
wv 0
v_xor_b32 v4, s100, v4
v_xor_b32 v5, s101, v5
v_or_b32 v4, v4, v5
v_cmp_ne_u32 vcc, 0, v4
sad 43,43,1
s_cbranch_vccz L_fwd_231
s_sleep 2
s_cmp_lt_u32 s43, 400000
s_cbranch_scc1 L_fw_230
L_fwd_231:
L_xfd_226:
s_mul_i32 s40, s53, 81920
s_mul_i32 s38, s4, 20480
s_add_u32 s40, s40, s38
sad 41,40,0
buffer_load_dwordx4 v[24:27], v7, s[20:23], s41 offen offset:0 sc1
buffer_load_dwordx4 v[28:31], v7, s[20:23], s41 offen offset:1024 sc1
buffer_load_dwordx4 v[32:35], v7, s[20:23], s41 offen offset:2048 sc1
buffer_load_dwordx4 v[36:39], v7, s[20:23], s41 offen offset:3072 sc1
sad 41,40,4096
buffer_load_dwordx4 v[40:43], v7, s[20:23], s41 offen offset:0 sc1
buffer_load_dwordx4 v[44:47], v7, s[20:23], s41 offen offset:1024 sc1
buffer_load_dwordx4 v[48:51], v7, s[20:23], s41 offen offset:2048 sc1
buffer_load_dwordx4 v[52:55], v7, s[20:23], s41 offen offset:3072 sc1
sad 41,40,8192
buffer_load_dwordx4 v[56:59], v7, s[20:23], s41 offen offset:0 sc1
buffer_load_dwordx4 v[60:63], v7, s[20:23], s41 offen offset:1024 sc1
buffer_load_dwordx4 v[64:67], v7, s[20:23], s41 offen offset:2048 sc1
buffer_load_dwordx4 v[68:71], v7, s[20:23], s41 offen offset:3072 sc1
sad 41,40,12288
buffer_load_dwordx4 v[72:75], v7, s[20:23], s41 offen offset:0 sc1
buffer_load_dwordx4 v[76:79], v7, s[20:23], s41 offen offset:1024 sc1
buffer_load_dwordx4 v[80:83], v7, s[20:23], s41 offen offset:2048 sc1
buffer_load_dwordx4 v[84:87], v7, s[20:23], s41 offen offset:3072 sc1
sad 41,40,16384
buffer_load_dwordx4 v[88:91], v7, s[20:23], s41 offen offset:0 sc1
buffer_load_dwordx4 v[92:95], v7, s[20:23], s41 offen offset:1024 sc1
buffer_load_dwordx4 v[96:99], v7, s[20:23], s41 offen offset:2048 sc1
buffer_load_dwordx4 v[100:103], v7, s[20:23], s41 offen offset:3072 sc1
sad 38,57,0
sad 39,56,0
buffer_load_dwordx4 a[0:3], v7, s[12:15], s38 offen sc1
sad 38,57,4096
sad 39,56,16384
buffer_load_dwordx4 a[20:23], v7, s[12:15], s38 offen sc1
sad 38,57,8192
sad 39,56,32768
buffer_load_dwordx4 a[40:43], v7, s[12:15], s38 offen sc1
sad 38,57,12288
sad 39,56,49152
buffer_load_dwordx4 a[60:63], v7, s[12:15], s38 offen sc1
buffer_load_dwordx2 v[208:209], v8, s[24:27], s58 offen offset:0
buffer_load_dwordx2 v[210:211], v8, s[32:35], s58 offen offset:0 sc1
wv 5
v_mfma_f32_16x16x32_bf16 v[184:187], a[0:3], v[24:27], 0
v_mfma_f32_16x16x32_bf16 v[188:191], a[0:3], v[28:31], 0
v_mfma_f32_16x16x32_bf16 v[192:195], a[0:3], v[32:35], 0
v_mfma_f32_16x16x32_bf16 v[196:199], a[0:3], v[36:39], 0
v_mfma_f32_16x16x32_bf16 v[184:187], a[4:7], v[40:43], v[184:187]
v_mfma_f32_16x16x32_bf16 v[188:191], a[4:7], v[44:47], v[188:191]
v_mfma_f32_16x16x32_bf16 v[192:195], a[4:7], v[48:51], v[192:195]
v_mfma_f32_16x16x32_bf16 v[196:199], a[4:7], v[52:55], v[196:199]
v_mfma_f32_16x16x32_bf16 v[184:187], a[8:11], v[56:59], v[184:187]
v_mfma_f32_16x16x32_bf16 v[188:191], a[8:11], v[60:63], v[188:191]
v_mfma_f32_16x16x32_bf16 v[192:195], a[8:11], v[64:67], v[192:195]
v_mfma_f32_16x16x32_bf16 v[196:199], a[8:11], v[68:71], v[196:199]
v_mfma_f32_16x16x32_bf16 v[184:187], a[12:15], v[72:75], v[184:187]
v_mfma_f32_16x16x32_bf16 v[188:191], a[12:15], v[76:79], v[188:191]
v_mfma_f32_16x16x32_bf16 v[192:195], a[12:15], v[80:83], v[192:195]
v_mfma_f32_16x16x32_bf16 v[196:199], a[12:15], v[84:87], v[196:199]
v_mfma_f32_16x16x32_bf16 v[184:187], a[16:19], v[88:91], v[184:187]
v_mfma_f32_16x16x32_bf16 v[188:191], a[16:19], v[92:95], v[188:191]
v_mfma_f32_16x16x32_bf16 v[192:195], a[16:19], v[96:99], v[192:195]
v_mfma_f32_16x16x32_bf16 v[196:199], a[16:19], v[100:103], v[196:199]
s_nop 7
v_cndmask_b32 v200, v192, v184, s[66:67]
v_cndmask_b32 v201, v193, v185, s[66:67]
v_cndmask_b32 v202, v194, v186, s[66:67]
v_cndmask_b32 v203, v195, v187, s[66:67]
v_cndmask_b32 v204, v196, v188, s[66:67]
v_cndmask_b32 v205, v197, v189, s[66:67]
v_cndmask_b32 v206, v198, v190, s[66:67]
v_cndmask_b32 v207, v199, v191, s[66:67]
s_nop 0
v_permlane32_swap_b32 v200, v204
v_permlane32_swap_b32 v201, v205
v_permlane32_swap_b32 v202, v206
v_permlane32_swap_b32 v203, v207
s_nop 0
v_add_f32 v200, v200, v204
v_add_f32 v201, v201, v205
v_add_f32 v202, v202, v206
v_add_f32 v203, v203, v207
ds_write_b128 v10, v[200:203] offset:0
wv 4
v_mfma_f32_16x16x32_bf16 v[184:187], a[20:23], v[24:27], 0
v_mfma_f32_16x16x32_bf16 v[188:191], a[20:23], v[28:31], 0
v_mfma_f32_16x16x32_bf16 v[192:195], a[20:23], v[32:35], 0
v_mfma_f32_16x16x32_bf16 v[196:199], a[20:23], v[36:39], 0
v_mfma_f32_16x16x32_bf16 v[184:187], a[24:27], v[40:43], v[184:187]
v_mfma_f32_16x16x32_bf16 v[188:191], a[24:27], v[44:47], v[188:191]
v_mfma_f32_16x16x32_bf16 v[192:195], a[24:27], v[48:51], v[192:195]
v_mfma_f32_16x16x32_bf16 v[196:199], a[24:27], v[52:55], v[196:199]
v_mfma_f32_16x16x32_bf16 v[184:187], a[28:31], v[56:59], v[184:187]
v_mfma_f32_16x16x32_bf16 v[188:191], a[28:31], v[60:63], v[188:191]
v_mfma_f32_16x16x32_bf16 v[192:195], a[28:31], v[64:67], v[192:195]
v_mfma_f32_16x16x32_bf16 v[196:199], a[28:31], v[68:71], v[196:199]
v_mfma_f32_16x16x32_bf16 v[184:187], a[32:35], v[72:75], v[184:187]
v_mfma_f32_16x16x32_bf16 v[188:191], a[32:35], v[76:79], v[188:191]
v_mfma_f32_16x16x32_bf16 v[192:195], a[32:35], v[80:83], v[192:195]
v_mfma_f32_16x16x32_bf16 v[196:199], a[32:35], v[84:87], v[196:199]
v_mfma_f32_16x16x32_bf16 v[184:187], a[36:39], v[88:91], v[184:187]
v_mfma_f32_16x16x32_bf16 v[188:191], a[36:39], v[92:95], v[188:191]
v_mfma_f32_16x16x32_bf16 v[192:195], a[36:39], v[96:99], v[192:195]
v_mfma_f32_16x16x32_bf16 v[196:199], a[36:39], v[100:103], v[196:199]
s_nop 7
v_cndmask_b32 v200, v192, v184, s[66:67]
v_cndmask_b32 v201, v193, v185, s[66:67]
v_cndmask_b32 v202, v194, v186, s[66:67]
v_cndmask_b32 v203, v195, v187, s[66:67]
v_cndmask_b32 v204, v196, v188, s[66:67]
v_cndmask_b32 v205, v197, v189, s[66:67]
v_cndmask_b32 v206, v198, v190, s[66:67]
v_cndmask_b32 v207, v199, v191, s[66:67]
s_nop 0
v_permlane32_swap_b32 v200, v204
v_permlane32_swap_b32 v201, v205
v_permlane32_swap_b32 v202, v206
v_permlane32_swap_b32 v203, v207
s_nop 0
v_add_f32 v200, v200, v204
v_add_f32 v201, v201, v205
v_add_f32 v202, v202, v206
v_add_f32 v203, v203, v207
ds_write_b128 v10, v[200:203] offset:1024
wv 3
v_mfma_f32_16x16x32_bf16 v[184:187], a[40:43], v[24:27], 0
v_mfma_f32_16x16x32_bf16 v[188:191], a[40:43], v[28:31], 0
v_mfma_f32_16x16x32_bf16 v[192:195], a[40:43], v[32:35], 0
v_mfma_f32_16x16x32_bf16 v[196:199], a[40:43], v[36:39], 0
v_mfma_f32_16x16x32_bf16 v[184:187], a[44:47], v[40:43], v[184:187]
v_mfma_f32_16x16x32_bf16 v[188:191], a[44:47], v[44:47], v[188:191]
v_mfma_f32_16x16x32_bf16 v[192:195], a[44:47], v[48:51], v[192:195]
v_mfma_f32_16x16x32_bf16 v[196:199], a[44:47], v[52:55], v[196:199]
v_mfma_f32_16x16x32_bf16 v[184:187], a[48:51], v[56:59], v[184:187]
v_mfma_f32_16x16x32_bf16 v[188:191], a[48:51], v[60:63], v[188:191]
v_mfma_f32_16x16x32_bf16 v[192:195], a[48:51], v[64:67], v[192:195]
v_mfma_f32_16x16x32_bf16 v[196:199], a[48:51], v[68:71], v[196:199]
v_mfma_f32_16x16x32_bf16 v[184:187], a[52:55], v[72:75], v[184:187]
v_mfma_f32_16x16x32_bf16 v[188:191], a[52:55], v[76:79], v[188:191]
v_mfma_f32_16x16x32_bf16 v[192:195], a[52:55], v[80:83], v[192:195]
v_mfma_f32_16x16x32_bf16 v[196:199], a[52:55], v[84:87], v[196:199]
v_mfma_f32_16x16x32_bf16 v[184:187], a[56:59], v[88:91], v[184:187]
v_mfma_f32_16x16x32_bf16 v[188:191], a[56:59], v[92:95], v[188:191]
v_mfma_f32_16x16x32_bf16 v[192:195], a[56:59], v[96:99], v[192:195]
v_mfma_f32_16x16x32_bf16 v[196:199], a[56:59], v[100:103], v[196:199]
s_nop 7
v_cndmask_b32 v200, v192, v184, s[66:67]
v_cndmask_b32 v201, v193, v185, s[66:67]
v_cndmask_b32 v202, v194, v186, s[66:67]
v_cndmask_b32 v203, v195, v187, s[66:67]
v_cndmask_b32 v204, v196, v188, s[66:67]
v_cndmask_b32 v205, v197, v189, s[66:67]
v_cndmask_b32 v206, v198, v190, s[66:67]
v_cndmask_b32 v207, v199, v191, s[66:67]
s_nop 0
v_permlane32_swap_b32 v200, v204
v_permlane32_swap_b32 v201, v205
v_permlane32_swap_b32 v202, v206
v_permlane32_swap_b32 v203, v207
s_nop 0
v_add_f32 v200, v200, v204
v_add_f32 v201, v201, v205
v_add_f32 v202, v202, v206
v_add_f32 v203, v203, v207
ds_write_b128 v10, v[200:203] offset:2048
wv 2
v_mfma_f32_16x16x32_bf16 v[184:187], a[60:63], v[24:27], 0
v_mfma_f32_16x16x32_bf16 v[188:191], a[60:63], v[28:31], 0
v_mfma_f32_16x16x32_bf16 v[192:195], a[60:63], v[32:35], 0
v_mfma_f32_16x16x32_bf16 v[196:199], a[60:63], v[36:39], 0
v_mfma_f32_16x16x32_bf16 v[184:187], a[64:67], v[40:43], v[184:187]
v_mfma_f32_16x16x32_bf16 v[188:191], a[64:67], v[44:47], v[188:191]
v_mfma_f32_16x16x32_bf16 v[192:195], a[64:67], v[48:51], v[192:195]
v_mfma_f32_16x16x32_bf16 v[196:199], a[64:67], v[52:55], v[196:199]
v_mfma_f32_16x16x32_bf16 v[184:187], a[68:71], v[56:59], v[184:187]
v_mfma_f32_16x16x32_bf16 v[188:191], a[68:71], v[60:63], v[188:191]
v_mfma_f32_16x16x32_bf16 v[192:195], a[68:71], v[64:67], v[192:195]
v_mfma_f32_16x16x32_bf16 v[196:199], a[68:71], v[68:71], v[196:199]
v_mfma_f32_16x16x32_bf16 v[184:187], a[72:75], v[72:75], v[184:187]
v_mfma_f32_16x16x32_bf16 v[188:191], a[72:75], v[76:79], v[188:191]
v_mfma_f32_16x16x32_bf16 v[192:195], a[72:75], v[80:83], v[192:195]
v_mfma_f32_16x16x32_bf16 v[196:199], a[72:75], v[84:87], v[196:199]
v_mfma_f32_16x16x32_bf16 v[184:187], a[76:79], v[88:91], v[184:187]
v_mfma_f32_16x16x32_bf16 v[188:191], a[76:79], v[92:95], v[188:191]
v_mfma_f32_16x16x32_bf16 v[192:195], a[76:79], v[96:99], v[192:195]
v_mfma_f32_16x16x32_bf16 v[196:199], a[76:79], v[100:103], v[196:199]
s_nop 7
v_cndmask_b32 v200, v192, v184, s[66:67]
v_cndmask_b32 v201, v193, v185, s[66:67]
v_cndmask_b32 v202, v194, v186, s[66:67]
v_cndmask_b32 v203, v195, v187, s[66:67]
v_cndmask_b32 v204, v196, v188, s[66:67]
v_cndmask_b32 v205, v197, v189, s[66:67]
v_cndmask_b32 v206, v198, v190, s[66:67]
v_cndmask_b32 v207, v199, v191, s[66:67]
s_nop 0
v_permlane32_swap_b32 v200, v204
v_permlane32_swap_b32 v201, v205
v_permlane32_swap_b32 v202, v206
v_permlane32_swap_b32 v203, v207
s_nop 0
v_add_f32 v200, v200, v204
v_add_f32 v201, v201, v205
v_add_f32 v202, v202, v206
v_add_f32 v203, v203, v207
ds_write_b128 v10, v[200:203] offset:3072
s_waitcnt vmcnt(0) lgkmcnt(0)
s_barrier
s_lshl_b32 s38, s4, 10
v_add_u32 v11, s38, v7
ds_read_b128 v[24:27], v11 offset:0
ds_read_b128 v[28:31], v11 offset:16384
ds_read_b128 v[32:35], v11 offset:32768
ds_read_b128 v[36:39], v11 offset:49152
wl 0
v_pk_add_f32 v[24:25], v[24:25], v[28:29]
v_pk_add_f32 v[26:27], v[26:27], v[30:31]
v_pk_add_f32 v[32:33], v[32:33], v[36:37]
v_pk_add_f32 v[34:35], v[34:35], v[38:39]
v_pk_add_f32 v[24:25], v[24:25], v[32:33]
v_pk_add_f32 v[26:27], v[26:27], v[34:35]
cvp 28,24,25
cvp 29,26,27
v_lshlrev_b32 v32, 16, v28
v_and_b32 v33, 0xffff0000, v28
v_lshlrev_b32 v34, 16, v210
v_and_b32 v35, 0xffff0000, v210
v_mul_f32 v32, v32, v34
v_mul_f32 v33, v33, v35
cvp 32,32,33
v_and_b32 v33, 0xffff0000, v32
v_lshlrev_b32 v32, 16, v32
v_lshlrev_b32 v34, 16, v208
v_and_b32 v35, 0xffff0000, v208
v_add_f32 v32, v32, v34
v_add_f32 v33, v33, v35
cvp 30,32,33
v_lshlrev_b32 v32, 16, v29
v_and_b32 v33, 0xffff0000, v29
v_lshlrev_b32 v34, 16, v211
v_and_b32 v35, 0xffff0000, v211
v_mul_f32 v32, v32, v34
v_mul_f32 v33, v33, v35
cvp 32,32,33
v_and_b32 v33, 0xffff0000, v32
v_lshlrev_b32 v32, 16, v32
v_lshlrev_b32 v34, 16, v209
v_and_b32 v35, 0xffff0000, v209
v_add_f32 v32, v32, v34
v_add_f32 v33, v33, v35
cvp 31,32,33
buffer_store_dwordx2 v[30:31], v8, s[28:31], s58 offen offset:0
s_barrier
s_cmp_lg_u32 s4, 0
s_cbranch_scc1 L_ti_232
s_lshl_b32 s83, s76, 2
v_mov_b32 v18, 1
v_mov_b32 v2, 0
s_mov_b64 exec, 1
buffer_atomic_add v18, v2, s[84:87], s83 offen sc0 sc1
s_mov_b64 exec, -1
L_ti_232:
s_branch L_x_next
.p2align 3
.type L_qtab,@object
L_qtab:
.long 16842756, 46137344
.long 16842756, 113246240
.long 16842756, 46661640
.long 16842756, 113770536
.long 16842756, 47185936
.long 16842756, 114294832
.long 16842756, 47710232
.long 16842756, 114819128
.long 16842753, 41943072
.long 16842753, 42467368
.long 16842753, 42991664
.long 16842753, 43515960
.long 16843008, 54525984
.long 16843008, 55050280
.long 16843008, 55574576
.long 16843008, 56098872
.long 16843009, 50331744
.long 16843009, 50856040
.long 16843009, 51380336
.long 16843009, 51904632
.long 16843009, 52428864
.long 16843009, 52953160
.long 16843009, 53477456
.long 16843009, 54001752
.long 16843264, 62914624
.long 16843264, 63438920
.long 16843264, 63963216
.long 16843264, 64487512
.long 16843520, 71303264
.long 16843520, 71827560
.long 16843520, 72351856
.long 16843520, 72876152
.long 16843265, 58720416
.long 16843265, 59244712
.long 16843265, 59769008
.long 16843265, 60293304
.long 16843265, 60817536
.long 16843265, 61341832
.long 16843265, 61866128
.long 16843265, 62390424
.long 16843521, 67109088
.long 16843521, 67633384
.long 16843521, 68157680
.long 16843521, 68681976
.long 16843521, 69206208
.long 16843521, 69730504
.long 16843521, 70254800
.long 16843521, 70779096
.long 16843776, 79691904
.long 16844032, 88080544
.long 16843776, 80216200
.long 16844032, 88604840
.long 16843776, 80740496
.long 16844032, 89129136
.long 16843776, 81264792
.long 16844032, 89653432
.long 16843777, 75497760
.long 16844033, 83886432
.long 16843777, 76022056
.long 16844033, 84410728
.long 16843777, 76546352
.long 16844033, 84935024
.long 16843777, 77070648
.long 16844033, 85459320
.long 16843777, 77594880
.long 16844033, 85983552
.long 16843777, 78119176
.long 16844033, 86507848
.long 16843777, 78643472
.long 16844033, 87032144
.long 16843777, 79167768
.long 16844033, 87556440
.long 16844288, 96469184
.long 16844544, 104857824
.long 16844288, 96993480
.long 16844544, 105382120
.long 16844288, 97517776
.long 16844544, 105906416
.long 16844288, 98042072
.long 16844544, 106430712
.long 50529794, 98566288
.long 50530050, 106954920
.long 50529794, 98631825
.long 50530050, 107020457
.long 50529794, 98697362
.long 50530050, 107085994
.long 16844289, 92275104
.long 16844289, 92799400
.long 16844289, 93323696
.long 16844289, 93847992
.long 16844289, 94372224
.long 16844289, 94896520
.long 16844289, 95420816
.long 16844289, 95945112
.long 50528258, 48234496
.long 50528514, 56623128
.long 50528770, 65011760
.long 50528258, 48300033
.long 50528514, 56688665
.long 50528770, 65077297
.long 50528258, 48365570
.long 50528514, 56754202
.long 50528770, 65142834
.long 16844291, 100139038
.long 16844547, 108527651
.long 50529026, 73400392
.long 50529282, 81789024
.long 50529538, 90177656
.long 50529026, 73465929
.long 50529282, 81854561
.long 50529538, 90243193
.long 50529026, 73531466
.long 50529282, 81920098
.long 50529538, 90308730
.long 16844545, 100663776
.long 16844545, 101188072
.long 16844545, 101712368
.long 16844545, 102236664
.long 16844545, 102760896
.long 16844545, 103285192
.long 16844545, 103809488
.long 16844545, 104333784
.long 16842755, 49807360
.long 16843011, 58195973
.long 16843267, 66584586
.long 16843523, 74973199
.long 16843779, 83361812
.long 16844035, 91750425
.long 16842753, 44040192
.long 16842753, 44564488
.long 16842753, 45088784
.long 16842753, 45613080
L_vmap:
.long 50462976
.long 2206368128
.long 117835012
.long 2273740164
.long 185207048
.long 2341112200
.long 252579084
.long 2408484236
.long 319951120
.long 2475856272
.long 387323156
.long 2543228308
.long 454695192
.long 2610600344
.long 522067228
.long 2677972380
.long 589439264
.long 2745344416
.long 656811300
.long 2812716452
.long 724183336
.long 2880088488
.long 791555372
.long 2947460524
.long 858927408
.long 3014832560
.long 926299444
.long 3082204596
.long 993671480
.long 3149576632
.long 1061043516
.long 3216948668
.long 1128415552
.long 3284320704
.long 1195787588
.long 3351692740
.long 1263159624
.long 3419064776
.long 1330531660
.long 3486436812
.long 1397903696
.long 3553808848
.long 1465275732
.long 3621180884
.long 1532647768
.long 3688552920
.long 1600019804
.long 3755924956
.long 1667391840
.long 3823296992
.long 1734763876
.long 3890669028
.long 1802135912
.long 3958041064
.long 1869507948
.long 4025413100
.long 1936879984
.long 4092785136
.long 2004252020
.long 4160157172
.long 2071624056
.long 4227529208
.long 2138996092
.long 4294901244
.size L_qtab, .-L_qtab
.section .rodata,"a"
.p2align 6
.amdhsa_kernel recurrent_scan__memory_aug_recurrent_mem_tr__glu_gated_bilinear__prompt_kernel
  .amdhsa_next_free_vgpr 512
  .amdhsa_next_free_sgpr 102
  .amdhsa_accum_offset 256
  .amdhsa_group_segment_fixed_size 0
  .amdhsa_kernarg_size 112
  .amdhsa_user_sgpr_count 2
  .amdhsa_user_sgpr_kernarg_segment_ptr 1
  .amdhsa_system_sgpr_workgroup_id_x 1
  .amdhsa_float_denorm_mode_32 3
.end_amdhsa_kernel
```
